```python
import torch

def _softmax(x, axis=-1):
    return torch.softmax(x, dim=axis)

def _gelu(x):
    return torch.nn.functional.gelu(x, approximate='tanh')

def _silu(x):
    return torch.nn.functional.silu(x)

def _sigmoid(x):
    return torch.sigmoid(x)

def _layernorm(x, axis=-1, eps=1e-05):
    m = x.mean(dim=axis, keepdim=True)
    v = x.var(dim=axis, keepdim=True, unbiased=False)
    return (x - m) / torch.sqrt(v + eps)

def _scatter_add(tgt, idx, src, axis=0):
    return tgt.clone().index_add_(axis, idx, src)

def _segment_sum(src, seg, n):
    out = torch.zeros((n,) + src.shape[1:], dtype=src.dtype)
    return out.index_add_(0, seg, src)

def _pad(x, pw):
    flat = tuple((v for pair in reversed(pw) for v in pair))
    return torch.nn.functional.pad(x, flat)
kernel_name = 'concat_heads__mha_block__memory_aug_recurrent_mem_tr__prompt'

def setup_inputs():

    _w = lambda a: (lambda t: t.to(torch.bfloat16) if t.is_floating_point() else t)(torch.as_tensor(a))

    def _A_setup():
        B, S, D, H = (1, 2048, 512, 32)
        return {'x': _w((lambda *s: torch.randn(*s, dtype=torch.bfloat16) * 0.2)(B, S, D)), 'wqkv': _w((lambda *s: torch.randn(*s, dtype=torch.bfloat16) * 0.2)(D, 3 * D)), 'wo': _w((lambda *s: torch.randn(*s, dtype=torch.bfloat16) * 0.05)(D, D))}
    _A_in = _A_setup()

    def _B_setup():
        B, S, Dm = (1, 2048, 512)
        H, Dh = (32, 128)
        M, seg = (8, 32)
        seg = min(seg, S)
        S = S // seg * seg
        return {'x': _w((lambda *s: torch.randn(*s, dtype=torch.bfloat16) * 0.05)(B, S, Dm)), 'mem0': _w((lambda *s: torch.randn(*s, dtype=torch.bfloat16) * 0.8)(B, M, Dm)), 'Wq': _w((lambda *s: torch.randn(*s, dtype=torch.bfloat16) * 1.6)(Dm, H, Dh) * Dm ** (-0.5)), 'Wk': _w((lambda *s: torch.randn(*s, dtype=torch.bfloat16) * 1.6)(Dm, H, Dh) * Dm ** (-0.5)), 'Wv': _w((lambda *s: torch.randn(*s, dtype=torch.bfloat16) * 0.8)(Dm, H, Dh) * Dm ** (-0.5)), 'Wo': _w((lambda *s: torch.randn(*s, dtype=torch.bfloat16) * 0.8)(H, Dh, Dm) * (H * Dh) ** (-0.5)), 'seg_len': seg}
    _B_in = _B_setup()
    return {'A_x': _A_in['x'], 'A_wqkv': _A_in['wqkv'], 'A_wo': _A_in['wo'], 'B_x': _B_in['x'], 'B_mem0': _B_in['mem0'], 'B_Wq': _B_in['Wq'], 'B_Wk': _B_in['Wk'], 'B_Wv': _B_in['Wv'], 'B_Wo': _B_in['Wo'], 'B_seg_len': _B_in['seg_len']}

def reference(A_x, A_wqkv, A_wo, B_x, B_mem0, B_Wq, B_Wk, B_Wv, B_Wo, B_seg_len):

    def _A_ref(x, wqkv, wo):
        B, S, D = x.shape
        H = 32
        Dh = D // H
        qkv = (lambda x, *d: x.permute(*d))((x @ wqkv).reshape(B, S, 3, H, Dh), 2, 0, 3, 1, 4)
        q, k, v = (qkv[0], qkv[1], qkv[2])
        scores = torch.einsum('bhqd,bhkd->bhqk', q, k) * Dh ** (-0.5)
        p = _softmax(scores, axis=-1)
        o = torch.einsum('bhqk,bhkd->bhqd', p, v)
        return (lambda x, *d: x.permute(*d))(o, 0, 2, 1, 3).reshape(B, S, D) @ wo

    def _B_ref(x, mem0, Wq, Wk, Wv, Wo, seg_len):
        B, S, Dm = x.shape
        H, Dh = (Wq.shape[1], Wq.shape[2])
        M = mem0.shape[1]
        scale = Dh ** (-0.5)
        n_seg = S // seg_len
        L = M + seg_len
        idx = torch.arange(L)
        mask = (idx[:, None] < M) | (idx[:, None] >= idx[None, :])
        mem = mem0
        outs = []
        for s in range(n_seg):
            xs = x[:, s * seg_len:(s + 1) * seg_len, :].clone()
            h = torch.concatenate([mem, xs], axis=1)
            q = torch.einsum('btd,dhe->bhte', h, Wq)
            k = torch.einsum('btd,dhe->bhte', h, Wk)
            v = torch.einsum('btd,dhe->bhte', h, Wv)
            scores = torch.einsum('bhqe,bhke->bhqk', q, k) * scale
            scores = torch.where(mask[None, None], scores, -1000000000.0)
            p = _softmax(scores, axis=-1)
            o = torch.einsum('bhqk,bhke->bhqe', p, v)
            o = torch.einsum('bhte,hed->btd', o, Wo)
            mem = o[:, :M, :].clone()
            outs.append(o[:, M:, :])
        return torch.concatenate(outs, axis=1)
    a = _A_ref(A_x, A_wqkv, A_wo)
    b = _B_ref(B_x, B_mem0, B_Wq, B_Wk, B_Wv, B_Wo, B_seg_len)
    return torch.concatenate([a, b], axis=-1)
```

```asm
; @launch grid=(256,1,1) block=(256,1,1) lds=163840
.amdgcn_target "amdgcn-amd-amdhsa--gfx950"
.text
.globl concat_heads__mha_block__memory_aug_recurrent_mem_tr__prompt_kernel
.p2align 8
.type concat_heads__mha_block__memory_aug_recurrent_mem_tr__prompt_kernel,@function
concat_heads__mha_block__memory_aug_recurrent_mem_tr__prompt_kernel:
    s_cmp_ge_u32 s2, 256
    s_cbranch_scc1 L_exit
    s_load_dwordx16 s[64:79], s[0:1], 0
    s_load_dwordx8 s[80:87], s[0:1], 64
    s_load_dwordx2 s[88:89], s[0:1], 96
    s_getreg_b32 s3, hwreg(HW_REG_XCC_ID, 0, 3)
    s_getreg_b32 s18, hwreg(HW_REG_HW_ID, 13, 2)
    s_getreg_b32 s19, hwreg(HW_REG_HW_ID, 8, 3)
    v_lshrrev_b32 v1, 6, v0
    s_lshl_b32 s93, s3, 2
    v_readfirstlane_b32 s17, v1
    s_add_u32 s93, s93, s18
    s_lshl_b32 s93, s93, 3
    s_add_u32 s93, s93, s19
    s_mov_b32 s92, 0
    v_mov_b32 v2, 0
    v_and_b32 v5, 31, v0
    v_lshlrev_b32 v5, 2, v5
    s_lshl_b32 s16, s2, 7
    s_add_u32 s16, s16, 60817408
    s_cmp_eq_u32 s17, 0
    s_cselect_b32 s16, s16, 0x7ff00000
    s_waitcnt lgkmcnt(0)
    s_mov_b32 s4, s88
    s_and_b32 s5, s89, 0xffff
    s_mov_b32 s6, 0x10000000
    s_mov_b32 s7, 0x20000
    buffer_store_dword v2, v5, s[4:7], s16 offen sc1
L_role:
    s_mov_b32 s16, s93
    s_cmp_lt_u32 s16, 32
    s_cbranch_scc1 L_chain
    s_lshr_b32 s18, s16, 5
    s_lshl_b32 s18, s18, 2
    s_lshr_b32 s18, 0x32106540, s18
    s_and_b32 s18, s18, 7
    s_and_b32 s16, s16, 31
    s_branch L_worker
L_exit:
    s_endpgm
L_lost:
    s_waitcnt vmcnt(0) lgkmcnt(0)
    s_barrier
    v_mbcnt_lo_u32_b32 v0, -1, 0
    v_mbcnt_hi_u32_b32 v0, -1, v0
    v_mov_b32 v2, 0
    s_cmp_lg_u32 s17, 0
    s_cbranch_scc1 L_lost_j
    v_mov_b32 v3, 1
    s_lshl_b32 s16, s3, 2
    v_mov_b32 v4, s16
    s_cmp_lg_u32 s92, 0
    s_cbranch_scc1 L_lost_p
    s_mov_b64 exec, 1
    global_atomic_add v4, v3, s[86:87] offset:32 sc1
    s_mov_b64 exec, -1
L_lost_p:
    v_and_b32 v5, 7, v0
    v_add_u32 v5, s3, v5
    v_and_b32 v5, 7, v5
    v_lshlrev_b32 v6, 2, v5
    global_load_dword v7, v6, s[86:87] offset:0 sc1
    global_load_dword v8, v6, s[86:87] offset:32 sc1
    global_load_dword v9, v6, s[86:87] offset:64 sc1
    s_mov_b32 s93, 256
    s_sub_u32 s48, s48, 1
    s_cbranch_scc1 L_lost_w
    s_waitcnt vmcnt(0)
    v_bcnt_u32_b32 v8, v7, v8
    v_or_b32 v7, v7, v9
    v_cmp_ne_u32 vcc, -1, v7
    s_mov_b32 s16, 0
    v_readlane_b32 s18, v8, 7
    s_nop 0
    s_add_u32 s16, s16, s18
    v_readlane_b32 s18, v8, 6
    s_nop 0
    s_add_u32 s16, s16, s18
    v_readlane_b32 s18, v8, 5
    s_nop 0
    s_add_u32 s16, s16, s18
    v_readlane_b32 s18, v8, 4
    s_nop 0
    s_add_u32 s16, s16, s18
    v_readlane_b32 s18, v8, 3
    s_nop 0
    s_add_u32 s16, s16, s18
    v_readlane_b32 s18, v8, 2
    s_nop 0
    s_add_u32 s16, s16, s18
    v_readlane_b32 s18, v8, 1
    s_nop 0
    s_add_u32 s16, s16, s18
    v_readlane_b32 s18, v8, 0
    s_nop 0
    s_add_u32 s16, s16, s18
    s_and_b32 s19, vcc_lo, 0xff
    s_cbranch_scc0 L_lost_w
    s_cmp_ge_u32 s16, 256
    s_cbranch_scc1 L_lost_t
    s_cmp_lt_u32 s18, 32
    s_cbranch_scc1 L_lost_p
    s_bitcmp0_b32 s19, 0
    s_cbranch_scc1 L_lost_p
L_lost_t:
    s_ff1_i32_b32 s19, s19
    s_nop 3
    v_readlane_b32 s16, v7, s19
    v_readlane_b32 s18, v5, s19
    s_not_b32 s16, s16
    s_ff1_i32_b32 s16, s16
    s_lshl_b32 s93, s18, 5
    s_add_u32 s93, s93, s16
    s_lshl_b32 s19, s18, 2
    s_add_u32 s19, s19, 64
    s_lshl_b32 s94, 1, s16
    s_atomic_or s94, s[86:87], s19 glc
    s_waitcnt lgkmcnt(0)
    s_bitcmp1_b32 s94, s16
    s_cbranch_scc1 L_lost_p
    s_cmp_eq_u32 s3, s18
    s_cbranch_scc1 L_lost_w
    global_store_dword v2, v3, s[86:87] offset:96 sc1
    s_waitcnt vmcnt(0)
L_lost_w:
    v_mov_b32 v4, s93
    ds_write_b32 v2, v4
    s_waitcnt lgkmcnt(0)
L_lost_j:
    s_barrier
    ds_read_b32 v4, v2
    s_lshl_b32 s16, s17, 6
    v_add_u32 v0, s16, v0
    s_mov_b32 s92, 1
    s_waitcnt lgkmcnt(0)
    v_readfirstlane_b32 s93, v4
    s_barrier
    s_cmp_lt_u32 s93, 256
    s_cbranch_scc1 L_role
    s_endpgm
L_chain:
    s_cmp_eq_u32 s17, 1
    s_cbranch_scc1 C1_entry
    s_cmp_eq_u32 s17, 2
    s_cbranch_scc1 C2_entry
    s_cmp_eq_u32 s17, 3
    s_cbranch_scc1 C3_entry
C0_entry:
    v_and_b32 v68, 63, v0
    v_lshlrev_b32 v117, 4, v68
    v_xor_b32 v125, 128, v117
    v_add_u32 v118, 16384, v117
    v_lshrrev_b32 v69, 4, v68
    v_and_b32 v70, 15, v68
    v_bfe_u32 v71, v68, 1, 1
    v_mul_u32_u24 v116, 0xaaaa, v71
    v_add_u32 v116, 0x4444, v116
    v_lshlrev_b32 v119, 2, v70
    v_xor_b32 v119, 0, v119
    v_lshl_add_u32 v119, v69, 7, v119
    v_add_u32 v119, 8192, v119
    v_lshrrev_b32 v64, 2, v70
    v_and_b32 v65, 1, v70
    v_lshl_add_u32 v66, v64, 1, v65
    v_lshlrev_b32 v67, 1, v71
    v_xor_b32 v67, v67, v69
    v_lshlrev_b32 v121, 4, v67
    v_lshl_add_u32 v121, v66, 6, v121
    v_lshl_add_u32 v121, v71, 10, v121
    v_add_u32 v121, 8704, v121
    v_lshrrev_b32 v72, 3, v70
    v_and_b32 v73, 7, v70
    v_lshlrev_b32 v67, 1, v72
    v_xor_b32 v67, v67, v69
    v_lshlrev_b32 v120, 4, v67
    v_lshl_add_u32 v120, v73, 6, v120
    v_lshl_add_u32 v120, v72, 10, v120
    v_add_u32 v120, 8192, v120
    v_lshrrev_b32 v67, 1, v73
    v_lshlrev_b32 v126, 6, v67
    v_lshl_add_u32 v126, v65, 4, v126
    v_lshl_add_u32 v126, v72, 3, v126
    v_lshl_add_u32 v126, v69, 8, v126
    v_lshrrev_b32 v67, 3, v68
    v_lshlrev_b32 v122, 13, v67
    v_lshl_add_u32 v122, v73, 3, v122
    v_lshlrev_b32 v123, 8, v69
    v_lshl_add_u32 v123, v70, 2, v123
    v_lshlrev_b32 v124, 8, v69
    v_lshl_add_u32 v124, v66, 4, v124
    v_lshl_add_u32 v124, v71, 10, v124
    v_lshlrev_b32 v106, 10, v66
    v_lshl_add_u32 v106, v71, 5, v106
    v_and_b32 v67, 1, v69
    v_lshl_add_u32 v106, v67, 3, v106
    v_lshrrev_b32 v67, 1, v69
    v_lshl_add_u32 v106, v67, 2, v106
    v_mov_b32 v104, 0
    v_mov_b32 v105, 0
    v_mov_b32 v127, 0
    v_mov_b32 v108, 0
    v_mov_b32 v109, 0
    v_mov_b32 v110, 0
    v_mov_b32 v111, 0
    v_mov_b32 v112, -1
    v_mov_b32 v113, -1
    v_mov_b32 v114, -1
    v_mov_b32 v115, -1
    s_mov_b32 s50, 0x00ff00ff
    s_mov_b32 s51, s50
    s_mov_b32 s49, 0x3e0293ee
    s_mov_b32 s60, 0x30800000
    s_mov_b32 s61, 0x1e000000
    s_mov_b32 s48, 400000
    s_mov_b32 s54, 0
    s_mov_b32 s55, 0
    s_lshl_b32 s36, s16, 8
    s_lshl_b32 s37, s16, 17
    s_lshr_b32 s52, s16, 3
    s_lshl_b32 s52, s52, 11
    s_and_b32 s19, s16, 1
    s_lshl_b32 s19, s19, 10
    s_add_u32 s52, s52, s19
    s_and_b32 s19, s16, 6
    s_lshl_b32 s19, s19, 5
    s_add_u32 s52, s52, s19
    s_lshl_b32 s19, s16, 13
    s_add_u32 s19, s19, 58720256
    buffer_store_dwordx4 v[112:115], v117, s[4:7], s19 offen offset:0 sc1
    buffer_store_dwordx4 v[112:115], v117, s[4:7], s19 offen offset:1024 sc1
    buffer_store_dwordx4 v[112:115], v117, s[4:7], s19 offen offset:2048 sc1
    buffer_store_dwordx4 v[112:115], v117, s[4:7], s19 offen offset:3072 sc1
    s_add_u32 s19, s52, 59768832
    buffer_store_dword v112, v123, s[4:7], s19 offen sc1
    s_mov_b32 s20, s74
    s_and_b32 s21, s75, 0xffff
    s_mov_b32 s22, 0x400000
    s_mov_b32 s23, 0x20000
    s_mov_b32 s24, s76
    s_and_b32 s25, s77, 0xffff
    s_mov_b32 s26, 0x400000
    s_mov_b32 s27, 0x20000
    s_mov_b32 s28, s78
    s_and_b32 s29, s79, 0xffff
    s_mov_b32 s30, 0x400000
    s_mov_b32 s31, 0x20000
    s_mov_b32 s32, s80
    s_and_b32 s33, s81, 0xffff
    s_mov_b32 s34, 0x400000
    s_mov_b32 s35, 0x20000
    v_lshrrev_b32 v80, 4, v117
    v_lshrrev_b32 v81, 4, v80
    v_and_b32 v82, 1, v81
    v_lshlrev_b32 v64, 6, v82
    v_lshrrev_b32 v82, 1, v81
    v_lshl_add_u32 v64, v82, 4, v64
    v_lshlrev_b32 v64, 13, v64
    v_add_u32 v82, 0, v81
    v_lshlrev_b32 v82, 1, v82
    v_and_b32 v83, 15, v80
    v_xor_b32 v82, v82, v83
    v_lshl_add_u32 v64, v82, 4, v64
    v_lshrrev_b32 v82, 5, v80
    v_lshlrev_b32 v65, 4, v82
    v_bfe_u32 v82, v80, 4, 1
    v_lshl_add_u32 v65, v82, 5, v65
    v_bfe_u32 v82, v80, 3, 1
    v_add_u32 v65, v82, v65
    v_lshlrev_b32 v65, 10, v65
    v_and_b32 v82, 7, v80
    v_lshl_add_u32 v65, v82, 4, v65
    v_lshrrev_b32 v81, 2, v80
    v_lshlrev_b32 v66, 7, v81
    v_bfe_u32 v82, v80, 1, 1
    v_lshl_add_u32 v66, v82, 6, v66
    v_and_b32 v82, 1, v80
    v_lshl_add_u32 v66, v82, 3, v66
    v_add_u32 v66, 16384, v66
    v_and_b32 v82, 7, v81
    v_xor_b32 v82, 0, v82
    v_lshlrev_b32 v68, 8, v81
    v_lshl_add_u32 v68, v82, 5, v68
    v_and_b32 v82, 3, v80
    v_lshl_add_u32 v68, v82, 3, v68
    v_xor_b32 v69, 32, v68
    v_add_u32 v72, 45056, v68
    v_add_u32 v73, 45056, v69
    v_add_u32 v74, 81920, v68
    v_add_u32 v75, 81920, v69
    v_add_u32 v76, 118784, v68
    v_add_u32 v77, 118784, v69
    v_add_u32 v78, 155648, v68
    v_add_u32 v79, 155648, v69
    s_mov_b32 m0, 16384
    s_add_u32 s19, s37, 0
    buffer_load_dwordx4 v65, s[32:35], s19 offen lds
    s_mov_b32 m0, 17408
    s_add_u32 s19, s37, 4096
    buffer_load_dwordx4 v65, s[32:35], s19 offen lds
    s_mov_b32 m0, 18432
    s_add_u32 s19, s37, 2048
    buffer_load_dwordx4 v65, s[32:35], s19 offen lds
    s_mov_b32 m0, 19456
    s_add_u32 s19, s37, 6144
    buffer_load_dwordx4 v65, s[32:35], s19 offen lds
    s_mov_b32 m0, 20480
    s_add_u32 s19, s37, 8192
    buffer_load_dwordx4 v65, s[32:35], s19 offen lds
    s_mov_b32 m0, 21504
    s_add_u32 s19, s37, 12288
    buffer_load_dwordx4 v65, s[32:35], s19 offen lds
    s_mov_b32 m0, 22528
    s_add_u32 s19, s37, 10240
    buffer_load_dwordx4 v65, s[32:35], s19 offen lds
    s_mov_b32 m0, 23552
    s_add_u32 s19, s37, 14336
    buffer_load_dwordx4 v65, s[32:35], s19 offen lds
    s_mov_b32 m0, 24576
    s_add_u32 s19, s37, 65536
    buffer_load_dwordx4 v65, s[32:35], s19 offen lds
    s_mov_b32 m0, 25600
    s_add_u32 s19, s37, 69632
    buffer_load_dwordx4 v65, s[32:35], s19 offen lds
    s_mov_b32 m0, 26624
    s_add_u32 s19, s37, 67584
    buffer_load_dwordx4 v65, s[32:35], s19 offen lds
    s_mov_b32 m0, 27648
    s_add_u32 s19, s37, 71680
    buffer_load_dwordx4 v65, s[32:35], s19 offen lds
    s_mov_b32 m0, 28672
    s_add_u32 s19, s37, 73728
    buffer_load_dwordx4 v65, s[32:35], s19 offen lds
    s_mov_b32 m0, 29696
    s_add_u32 s19, s37, 77824
    buffer_load_dwordx4 v65, s[32:35], s19 offen lds
    s_mov_b32 m0, 30720
    s_add_u32 s19, s37, 75776
    buffer_load_dwordx4 v65, s[32:35], s19 offen lds
    s_mov_b32 m0, 31744
    s_add_u32 s19, s37, 79872
    buffer_load_dwordx4 v65, s[32:35], s19 offen lds
    s_mov_b32 m0, 32768
    s_add_u32 s19, s37, 128
    buffer_load_dwordx4 v65, s[32:35], s19 offen lds
    s_mov_b32 m0, 33792
    s_add_u32 s19, s37, 4224
    buffer_load_dwordx4 v65, s[32:35], s19 offen lds
    s_mov_b32 m0, 34816
    s_add_u32 s19, s37, 2176
    buffer_load_dwordx4 v65, s[32:35], s19 offen lds
    s_mov_b32 m0, 35840
    s_add_u32 s19, s37, 6272
    buffer_load_dwordx4 v65, s[32:35], s19 offen lds
    s_mov_b32 m0, 36864
    s_add_u32 s19, s37, 8320
    buffer_load_dwordx4 v65, s[32:35], s19 offen lds
    s_mov_b32 m0, 37888
    s_add_u32 s19, s37, 12416
    buffer_load_dwordx4 v65, s[32:35], s19 offen lds
    s_mov_b32 m0, 38912
    s_add_u32 s19, s37, 10368
    buffer_load_dwordx4 v65, s[32:35], s19 offen lds
    s_mov_b32 m0, 39936
    s_add_u32 s19, s37, 14464
    buffer_load_dwordx4 v65, s[32:35], s19 offen lds
    s_waitcnt vmcnt(16)
    ds_read_b64_tr_b16 v[160:161], v66 offset:0
    ds_read_b64_tr_b16 v[162:163], v66 offset:2048
    ds_read_b64_tr_b16 v[164:165], v66 offset:4096
    ds_read_b64_tr_b16 v[166:167], v66 offset:6144
    ds_read_b64_tr_b16 v[168:169], v66 offset:16
    ds_read_b64_tr_b16 v[170:171], v66 offset:2064
    ds_read_b64_tr_b16 v[172:173], v66 offset:4112
    ds_read_b64_tr_b16 v[174:175], v66 offset:6160
    ds_read_b64_tr_b16 v[176:177], v66 offset:32
    ds_read_b64_tr_b16 v[178:179], v66 offset:2080
    ds_read_b64_tr_b16 v[180:181], v66 offset:4128
    ds_read_b64_tr_b16 v[182:183], v66 offset:6176
    ds_read_b64_tr_b16 v[184:185], v66 offset:48
    ds_read_b64_tr_b16 v[186:187], v66 offset:2096
    ds_read_b64_tr_b16 v[188:189], v66 offset:4144
    ds_read_b64_tr_b16 v[190:191], v66 offset:6192
    s_waitcnt lgkmcnt(0)
    s_mov_b32 m0, 16384
    s_add_u32 s19, s37, 65664
    buffer_load_dwordx4 v65, s[32:35], s19 offen lds
    s_mov_b32 m0, 17408
    s_add_u32 s19, s37, 69760
    buffer_load_dwordx4 v65, s[32:35], s19 offen lds
    s_mov_b32 m0, 18432
    s_add_u32 s19, s37, 67712
    buffer_load_dwordx4 v65, s[32:35], s19 offen lds
    s_mov_b32 m0, 19456
    s_add_u32 s19, s37, 71808
    buffer_load_dwordx4 v65, s[32:35], s19 offen lds
    s_mov_b32 m0, 20480
    s_add_u32 s19, s37, 73856
    buffer_load_dwordx4 v65, s[32:35], s19 offen lds
    s_mov_b32 m0, 21504
    s_add_u32 s19, s37, 77952
    buffer_load_dwordx4 v65, s[32:35], s19 offen lds
    s_mov_b32 m0, 22528
    s_add_u32 s19, s37, 75904
    buffer_load_dwordx4 v65, s[32:35], s19 offen lds
    s_mov_b32 m0, 23552
    s_add_u32 s19, s37, 80000
    buffer_load_dwordx4 v65, s[32:35], s19 offen lds
    s_mov_b32 m0, 0
    s_add_u32 s19, s36, 0
    buffer_load_dwordx4 v64, s[20:23], s19 offen lds
    s_mov_b32 m0, 4096
    s_add_u32 s19, s36, 65536
    buffer_load_dwordx4 v64, s[20:23], s19 offen lds
    s_mov_b32 m0, 8192
    s_add_u32 s19, s36, 16384
    buffer_load_dwordx4 v64, s[20:23], s19 offen lds
    s_mov_b32 m0, 12288
    s_add_u32 s19, s36, 81920
    buffer_load_dwordx4 v64, s[20:23], s19 offen lds
    s_mov_b32 m0, 45056
    s_add_u32 s19, s36, 262144
    buffer_load_dwordx4 v64, s[20:23], s19 offen lds
    s_mov_b32 m0, 81920
    s_add_u32 s19, s36, 327680
    buffer_load_dwordx4 v64, s[20:23], s19 offen lds
    s_mov_b32 m0, 118784
    s_add_u32 s19, s36, 278528
    buffer_load_dwordx4 v64, s[20:23], s19 offen lds
    s_mov_b32 m0, 155648
    s_add_u32 s19, s36, 344064
    buffer_load_dwordx4 v64, s[20:23], s19 offen lds
    s_waitcnt vmcnt(24)
    ds_read_b64_tr_b16 v[192:193], v66 offset:8192
    ds_read_b64_tr_b16 v[194:195], v66 offset:10240
    ds_read_b64_tr_b16 v[196:197], v66 offset:12288
    ds_read_b64_tr_b16 v[198:199], v66 offset:14336
    ds_read_b64_tr_b16 v[200:201], v66 offset:8208
    ds_read_b64_tr_b16 v[202:203], v66 offset:10256
    ds_read_b64_tr_b16 v[204:205], v66 offset:12304
    ds_read_b64_tr_b16 v[206:207], v66 offset:14352
    ds_read_b64_tr_b16 v[208:209], v66 offset:8224
    ds_read_b64_tr_b16 v[210:211], v66 offset:10272
    ds_read_b64_tr_b16 v[212:213], v66 offset:12320
    ds_read_b64_tr_b16 v[214:215], v66 offset:14368
    ds_read_b64_tr_b16 v[216:217], v66 offset:8240
    ds_read_b64_tr_b16 v[218:219], v66 offset:10288
    ds_read_b64_tr_b16 v[220:221], v66 offset:12336
    ds_read_b64_tr_b16 v[222:223], v66 offset:14384
    s_waitcnt vmcnt(16)
    ds_read_b64_tr_b16 v[224:225], v66 offset:16384
    ds_read_b64_tr_b16 v[226:227], v66 offset:18432
    ds_read_b64_tr_b16 v[228:229], v66 offset:20480
    ds_read_b64_tr_b16 v[230:231], v66 offset:22528
    ds_read_b64_tr_b16 v[232:233], v66 offset:16400
    ds_read_b64_tr_b16 v[234:235], v66 offset:18448
    ds_read_b64_tr_b16 v[236:237], v66 offset:20496
    ds_read_b64_tr_b16 v[238:239], v66 offset:22544
    ds_read_b64_tr_b16 v[240:241], v66 offset:16416
    ds_read_b64_tr_b16 v[242:243], v66 offset:18464
    ds_read_b64_tr_b16 v[244:245], v66 offset:20512
    ds_read_b64_tr_b16 v[246:247], v66 offset:22560
    ds_read_b64_tr_b16 v[248:249], v66 offset:16432
    ds_read_b64_tr_b16 v[250:251], v66 offset:18480
    ds_read_b64_tr_b16 v[252:253], v66 offset:20528
    ds_read_b64_tr_b16 v[254:255], v66 offset:22576
    s_waitcnt vmcnt(8)
    ds_read_b64_tr_b16 v[32:33], v66 offset:0
    ds_read_b64_tr_b16 v[34:35], v66 offset:2048
    ds_read_b64_tr_b16 v[36:37], v66 offset:4096
    ds_read_b64_tr_b16 v[38:39], v66 offset:6144
    ds_read_b64_tr_b16 v[40:41], v66 offset:16
    ds_read_b64_tr_b16 v[42:43], v66 offset:2064
    ds_read_b64_tr_b16 v[44:45], v66 offset:4112
    ds_read_b64_tr_b16 v[46:47], v66 offset:6160
    ds_read_b64_tr_b16 v[48:49], v66 offset:32
    ds_read_b64_tr_b16 v[50:51], v66 offset:2080
    ds_read_b64_tr_b16 v[52:53], v66 offset:4128
    ds_read_b64_tr_b16 v[54:55], v66 offset:6176
    ds_read_b64_tr_b16 v[56:57], v66 offset:48
    ds_read_b64_tr_b16 v[58:59], v66 offset:2096
    ds_read_b64_tr_b16 v[60:61], v66 offset:4144
    ds_read_b64_tr_b16 v[62:63], v66 offset:6192
    s_waitcnt lgkmcnt(0)
    s_waitcnt vmcnt(4)
    s_barrier
    s_mov_b32 m0, 49152
    s_add_u32 s19, s36, 1048576
    buffer_load_dwordx4 v64, s[20:23], s19 offen lds
    s_mov_b32 m0, 86016
    s_add_u32 s19, s36, 1114112
    buffer_load_dwordx4 v64, s[20:23], s19 offen lds
    s_mov_b32 m0, 122880
    s_add_u32 s19, s36, 1064960
    buffer_load_dwordx4 v64, s[20:23], s19 offen lds
    s_mov_b32 m0, 159744
    s_add_u32 s19, s36, 1130496
    buffer_load_dwordx4 v64, s[20:23], s19 offen lds
    s_lshr_b32 s95, s93, 5
    s_lshl_b32 s95, s95, 2
    s_lshl_b32 s94, 1, s93
    s_atomic_or s94, s[86:87], s95 glc
    ds_read_b64_tr_b16 v[0:1], v68 offset:0
    ds_read_b64_tr_b16 v[2:3], v68 offset:4096
    ds_read_b64_tr_b16 v[4:5], v68 offset:8192
    ds_read_b64_tr_b16 v[6:7], v68 offset:12288
    ds_read_b64_tr_b16 v[8:9], v69 offset:0
    ds_read_b64_tr_b16 v[10:11], v69 offset:4096
    ds_read_b64_tr_b16 v[12:13], v69 offset:8192
    ds_read_b64_tr_b16 v[14:15], v69 offset:12288
    s_waitcnt lgkmcnt(0)
    ds_write_b128 v118, v[0:3] offset:0
    ds_write_b128 v118, v[4:7] offset:1024
    ds_write_b128 v118, v[8:11] offset:2048
    ds_write_b128 v118, v[12:15] offset:3072
    s_waitcnt lgkmcnt(0)
    s_waitcnt vmcnt(4)
    s_waitcnt lgkmcnt(0)
    v_mov_b32 v84, s94
    ds_write_b32 v127, v84 offset:40960
    s_waitcnt lgkmcnt(0)
    s_barrier
    s_mov_b32 m0, 0
    s_add_u32 s19, s36, 1310720
    buffer_load_dwordx4 v64, s[20:23], s19 offen lds
    s_mov_b32 m0, 4096
    s_add_u32 s19, s36, 1376256
    buffer_load_dwordx4 v64, s[20:23], s19 offen lds
    s_mov_b32 m0, 8192
    s_add_u32 s19, s36, 1327104
    buffer_load_dwordx4 v64, s[20:23], s19 offen lds
    s_mov_b32 m0, 12288
    s_add_u32 s19, s36, 1392640
    buffer_load_dwordx4 v64, s[20:23], s19 offen lds
    ds_read_b32 v84, v127 offset:40960
    s_waitcnt lgkmcnt(0)
    v_readfirstlane_b32 s19, v84
    s_nop 0
    s_bitcmp1_b32 s19, s93
    s_cbranch_scc1 L_lost
    ds_read_b64_tr_b16 a[0:1], v72 offset:0
    ds_read_b64_tr_b16 a[2:3], v74 offset:0
    ds_read_b64_tr_b16 a[4:5], v76 offset:0
    ds_read_b64_tr_b16 a[6:7], v78 offset:0
    ds_read_b64_tr_b16 a[8:9], v73 offset:0
    ds_read_b64_tr_b16 a[10:11], v75 offset:0
    ds_read_b64_tr_b16 a[12:13], v77 offset:0
    ds_read_b64_tr_b16 a[14:15], v79 offset:0
    s_waitcnt lgkmcnt(0)
    s_waitcnt vmcnt(4)
    s_barrier
    s_mov_b32 m0, 45056
    s_add_u32 s19, s36, 2097152
    buffer_load_dwordx4 v64, s[20:23], s19 offen lds
    s_mov_b32 m0, 81920
    s_add_u32 s19, s36, 2162688
    buffer_load_dwordx4 v64, s[20:23], s19 offen lds
    s_mov_b32 m0, 118784
    s_add_u32 s19, s36, 2113536
    buffer_load_dwordx4 v64, s[20:23], s19 offen lds
    s_mov_b32 m0, 155648
    s_add_u32 s19, s36, 2179072
    buffer_load_dwordx4 v64, s[20:23], s19 offen lds
    ds_read_b64_tr_b16 a[16:17], v72 offset:4096
    ds_read_b64_tr_b16 a[18:19], v74 offset:4096
    ds_read_b64_tr_b16 a[20:21], v76 offset:4096
    ds_read_b64_tr_b16 a[22:23], v78 offset:4096
    ds_read_b64_tr_b16 a[24:25], v73 offset:4096
    ds_read_b64_tr_b16 a[26:27], v75 offset:4096
    ds_read_b64_tr_b16 a[28:29], v77 offset:4096
    ds_read_b64_tr_b16 a[30:31], v79 offset:4096
    s_waitcnt lgkmcnt(0)
    s_waitcnt vmcnt(4)
    s_barrier
    s_mov_b32 m0, 49152
    s_add_u32 s19, s36, 2359296
    buffer_load_dwordx4 v64, s[20:23], s19 offen lds
    s_mov_b32 m0, 86016
    s_add_u32 s19, s36, 2424832
    buffer_load_dwordx4 v64, s[20:23], s19 offen lds
    s_mov_b32 m0, 122880
    s_add_u32 s19, s36, 2375680
    buffer_load_dwordx4 v64, s[20:23], s19 offen lds
    s_mov_b32 m0, 159744
    s_add_u32 s19, s36, 2441216
    buffer_load_dwordx4 v64, s[20:23], s19 offen lds
    ds_read_b64_tr_b16 a[32:33], v68 offset:0
    ds_read_b64_tr_b16 a[34:35], v68 offset:4096
    ds_read_b64_tr_b16 a[36:37], v68 offset:8192
    ds_read_b64_tr_b16 a[38:39], v68 offset:12288
    ds_read_b64_tr_b16 a[40:41], v69 offset:0
    ds_read_b64_tr_b16 a[42:43], v69 offset:4096
    ds_read_b64_tr_b16 a[44:45], v69 offset:8192
    ds_read_b64_tr_b16 a[46:47], v69 offset:12288
    s_waitcnt lgkmcnt(0)
    s_waitcnt vmcnt(4)
    s_barrier
    s_mov_b32 m0, 0
    s_add_u32 s19, s36, 3145728
    buffer_load_dwordx4 v64, s[20:23], s19 offen lds
    s_mov_b32 m0, 4096
    s_add_u32 s19, s36, 3211264
    buffer_load_dwordx4 v64, s[20:23], s19 offen lds
    s_mov_b32 m0, 8192
    s_add_u32 s19, s36, 3162112
    buffer_load_dwordx4 v64, s[20:23], s19 offen lds
    s_mov_b32 m0, 12288
    s_add_u32 s19, s36, 3227648
    buffer_load_dwordx4 v64, s[20:23], s19 offen lds
    ds_read_b64_tr_b16 v[0:1], v72 offset:0
    ds_read_b64_tr_b16 v[2:3], v74 offset:0
    ds_read_b64_tr_b16 v[4:5], v76 offset:0
    ds_read_b64_tr_b16 v[6:7], v78 offset:0
    ds_read_b64_tr_b16 v[8:9], v73 offset:0
    ds_read_b64_tr_b16 v[10:11], v75 offset:0
    ds_read_b64_tr_b16 v[12:13], v77 offset:0
    ds_read_b64_tr_b16 v[14:15], v79 offset:0
    s_waitcnt lgkmcnt(0)
    ds_write_b128 v118, v[0:3] offset:12288
    ds_write_b128 v118, v[4:7] offset:13312
    ds_write_b128 v118, v[8:11] offset:14336
    ds_write_b128 v118, v[12:15] offset:15360
    s_waitcnt lgkmcnt(0)
    s_waitcnt vmcnt(4)
    s_barrier
    s_mov_b32 m0, 45056
    s_add_u32 s19, s36, 3407872
    buffer_load_dwordx4 v64, s[20:23], s19 offen lds
    s_mov_b32 m0, 81920
    s_add_u32 s19, s36, 3473408
    buffer_load_dwordx4 v64, s[20:23], s19 offen lds
    s_mov_b32 m0, 118784
    s_add_u32 s19, s36, 3424256
    buffer_load_dwordx4 v64, s[20:23], s19 offen lds
    s_mov_b32 m0, 155648
    s_add_u32 s19, s36, 3489792
    buffer_load_dwordx4 v64, s[20:23], s19 offen lds
    ds_read_b64_tr_b16 a[48:49], v72 offset:4096
    ds_read_b64_tr_b16 a[50:51], v74 offset:4096
    ds_read_b64_tr_b16 a[52:53], v76 offset:4096
    ds_read_b64_tr_b16 a[54:55], v78 offset:4096
    ds_read_b64_tr_b16 a[56:57], v73 offset:4096
    ds_read_b64_tr_b16 a[58:59], v75 offset:4096
    ds_read_b64_tr_b16 a[60:61], v77 offset:4096
    ds_read_b64_tr_b16 a[62:63], v79 offset:4096
    s_waitcnt lgkmcnt(0)
    s_waitcnt vmcnt(4)
    s_barrier
    s_mov_b32 m0, 49152
    s_add_u32 s19, s36, 0
    buffer_load_dwordx4 v64, s[24:27], s19 offen lds
    s_mov_b32 m0, 86016
    s_add_u32 s19, s36, 65536
    buffer_load_dwordx4 v64, s[24:27], s19 offen lds
    s_mov_b32 m0, 122880
    s_add_u32 s19, s36, 16384
    buffer_load_dwordx4 v64, s[24:27], s19 offen lds
    s_mov_b32 m0, 159744
    s_add_u32 s19, s36, 81920
    buffer_load_dwordx4 v64, s[24:27], s19 offen lds
    ds_read_b64_tr_b16 a[64:65], v68 offset:0
    ds_read_b64_tr_b16 a[66:67], v68 offset:4096
    ds_read_b64_tr_b16 a[68:69], v68 offset:8192
    ds_read_b64_tr_b16 a[70:71], v68 offset:12288
    ds_read_b64_tr_b16 a[72:73], v69 offset:0
    ds_read_b64_tr_b16 a[74:75], v69 offset:4096
    ds_read_b64_tr_b16 a[76:77], v69 offset:8192
    ds_read_b64_tr_b16 a[78:79], v69 offset:12288
    s_waitcnt lgkmcnt(0)
    s_waitcnt vmcnt(4)
    s_barrier
    s_mov_b32 m0, 0
    s_add_u32 s19, s36, 262144
    buffer_load_dwordx4 v64, s[24:27], s19 offen lds
    s_mov_b32 m0, 4096
    s_add_u32 s19, s36, 327680
    buffer_load_dwordx4 v64, s[24:27], s19 offen lds
    s_mov_b32 m0, 8192
    s_add_u32 s19, s36, 278528
    buffer_load_dwordx4 v64, s[24:27], s19 offen lds
    s_mov_b32 m0, 12288
    s_add_u32 s19, s36, 344064
    buffer_load_dwordx4 v64, s[24:27], s19 offen lds
    ds_read_b64_tr_b16 v[0:1], v72 offset:0
    ds_read_b64_tr_b16 v[2:3], v74 offset:0
    ds_read_b64_tr_b16 v[4:5], v76 offset:0
    ds_read_b64_tr_b16 v[6:7], v78 offset:0
    ds_read_b64_tr_b16 v[8:9], v73 offset:0
    ds_read_b64_tr_b16 v[10:11], v75 offset:0
    ds_read_b64_tr_b16 v[12:13], v77 offset:0
    ds_read_b64_tr_b16 v[14:15], v79 offset:0
    s_waitcnt lgkmcnt(0)
    ds_write_b128 v118, v[0:3] offset:16384
    ds_write_b128 v118, v[4:7] offset:17408
    ds_write_b128 v118, v[8:11] offset:18432
    ds_write_b128 v118, v[12:15] offset:19456
    s_waitcnt lgkmcnt(0)
    s_waitcnt vmcnt(4)
    s_barrier
    s_mov_b32 m0, 45056
    s_add_u32 s19, s36, 1048576
    buffer_load_dwordx4 v64, s[24:27], s19 offen lds
    s_mov_b32 m0, 81920
    s_add_u32 s19, s36, 1114112
    buffer_load_dwordx4 v64, s[24:27], s19 offen lds
    s_mov_b32 m0, 118784
    s_add_u32 s19, s36, 1064960
    buffer_load_dwordx4 v64, s[24:27], s19 offen lds
    s_mov_b32 m0, 155648
    s_add_u32 s19, s36, 1130496
    buffer_load_dwordx4 v64, s[24:27], s19 offen lds
    ds_read_b64_tr_b16 v[0:1], v72 offset:4096
    ds_read_b64_tr_b16 v[2:3], v74 offset:4096
    ds_read_b64_tr_b16 v[4:5], v76 offset:4096
    ds_read_b64_tr_b16 v[6:7], v78 offset:4096
    ds_read_b64_tr_b16 v[8:9], v73 offset:4096
    ds_read_b64_tr_b16 v[10:11], v75 offset:4096
    ds_read_b64_tr_b16 v[12:13], v77 offset:4096
    ds_read_b64_tr_b16 v[14:15], v79 offset:4096
    s_waitcnt lgkmcnt(0)
    ds_write_b128 v118, v[0:3] offset:4096
    ds_write_b128 v118, v[4:7] offset:5120
    ds_write_b128 v118, v[8:11] offset:6144
    ds_write_b128 v118, v[12:15] offset:7168
    s_waitcnt lgkmcnt(0)
    s_waitcnt vmcnt(4)
    s_barrier
    s_mov_b32 m0, 49152
    s_add_u32 s19, s36, 1310720
    buffer_load_dwordx4 v64, s[24:27], s19 offen lds
    s_mov_b32 m0, 86016
    s_add_u32 s19, s36, 1376256
    buffer_load_dwordx4 v64, s[24:27], s19 offen lds
    s_mov_b32 m0, 122880
    s_add_u32 s19, s36, 1327104
    buffer_load_dwordx4 v64, s[24:27], s19 offen lds
    s_mov_b32 m0, 159744
    s_add_u32 s19, s36, 1392640
    buffer_load_dwordx4 v64, s[24:27], s19 offen lds
    ds_read_b64_tr_b16 a[80:81], v68 offset:0
    ds_read_b64_tr_b16 a[82:83], v68 offset:4096
    ds_read_b64_tr_b16 a[84:85], v68 offset:8192
    ds_read_b64_tr_b16 a[86:87], v68 offset:12288
    ds_read_b64_tr_b16 a[88:89], v69 offset:0
    ds_read_b64_tr_b16 a[90:91], v69 offset:4096
    ds_read_b64_tr_b16 a[92:93], v69 offset:8192
    ds_read_b64_tr_b16 a[94:95], v69 offset:12288
    s_waitcnt lgkmcnt(0)
    s_waitcnt vmcnt(4)
    s_barrier
    s_mov_b32 m0, 0
    s_add_u32 s19, s36, 2097152
    buffer_load_dwordx4 v64, s[24:27], s19 offen lds
    s_mov_b32 m0, 4096
    s_add_u32 s19, s36, 2162688
    buffer_load_dwordx4 v64, s[24:27], s19 offen lds
    s_mov_b32 m0, 8192
    s_add_u32 s19, s36, 2113536
    buffer_load_dwordx4 v64, s[24:27], s19 offen lds
    s_mov_b32 m0, 12288
    s_add_u32 s19, s36, 2179072
    buffer_load_dwordx4 v64, s[24:27], s19 offen lds
    ds_read_b64_tr_b16 a[96:97], v72 offset:0
    ds_read_b64_tr_b16 a[98:99], v74 offset:0
    ds_read_b64_tr_b16 a[100:101], v76 offset:0
    ds_read_b64_tr_b16 a[102:103], v78 offset:0
    ds_read_b64_tr_b16 a[104:105], v73 offset:0
    ds_read_b64_tr_b16 a[106:107], v75 offset:0
    ds_read_b64_tr_b16 a[108:109], v77 offset:0
    ds_read_b64_tr_b16 a[110:111], v79 offset:0
    s_waitcnt lgkmcnt(0)
    s_waitcnt vmcnt(4)
    s_barrier
    s_mov_b32 m0, 45056
    s_add_u32 s19, s36, 2359296
    buffer_load_dwordx4 v64, s[24:27], s19 offen lds
    s_mov_b32 m0, 81920
    s_add_u32 s19, s36, 2424832
    buffer_load_dwordx4 v64, s[24:27], s19 offen lds
    s_mov_b32 m0, 118784
    s_add_u32 s19, s36, 2375680
    buffer_load_dwordx4 v64, s[24:27], s19 offen lds
    s_mov_b32 m0, 155648
    s_add_u32 s19, s36, 2441216
    buffer_load_dwordx4 v64, s[24:27], s19 offen lds
    ds_read_b64_tr_b16 a[112:113], v72 offset:4096
    ds_read_b64_tr_b16 a[114:115], v74 offset:4096
    ds_read_b64_tr_b16 a[116:117], v76 offset:4096
    ds_read_b64_tr_b16 a[118:119], v78 offset:4096
    ds_read_b64_tr_b16 a[120:121], v73 offset:4096
    ds_read_b64_tr_b16 a[122:123], v75 offset:4096
    ds_read_b64_tr_b16 a[124:125], v77 offset:4096
    ds_read_b64_tr_b16 a[126:127], v79 offset:4096
    s_waitcnt lgkmcnt(0)
    s_waitcnt vmcnt(4)
    s_barrier
    s_mov_b32 m0, 49152
    s_add_u32 s19, s36, 3145728
    buffer_load_dwordx4 v64, s[24:27], s19 offen lds
    s_mov_b32 m0, 86016
    s_add_u32 s19, s36, 3211264
    buffer_load_dwordx4 v64, s[24:27], s19 offen lds
    s_mov_b32 m0, 122880
    s_add_u32 s19, s36, 3162112
    buffer_load_dwordx4 v64, s[24:27], s19 offen lds
    s_mov_b32 m0, 159744
    s_add_u32 s19, s36, 3227648
    buffer_load_dwordx4 v64, s[24:27], s19 offen lds
    ds_read_b64_tr_b16 v[0:1], v68 offset:0
    ds_read_b64_tr_b16 v[2:3], v68 offset:4096
    ds_read_b64_tr_b16 v[4:5], v68 offset:8192
    ds_read_b64_tr_b16 v[6:7], v68 offset:12288
    ds_read_b64_tr_b16 v[8:9], v69 offset:0
    ds_read_b64_tr_b16 v[10:11], v69 offset:4096
    ds_read_b64_tr_b16 v[12:13], v69 offset:8192
    ds_read_b64_tr_b16 v[14:15], v69 offset:12288
    s_waitcnt lgkmcnt(0)
    ds_write_b128 v118, v[0:3] offset:20480
    ds_write_b128 v118, v[4:7] offset:21504
    ds_write_b128 v118, v[8:11] offset:22528
    ds_write_b128 v118, v[12:15] offset:23552
    s_waitcnt lgkmcnt(0)
    s_waitcnt vmcnt(4)
    s_barrier
    s_mov_b32 m0, 0
    s_add_u32 s19, s36, 3407872
    buffer_load_dwordx4 v64, s[24:27], s19 offen lds
    s_mov_b32 m0, 4096
    s_add_u32 s19, s36, 3473408
    buffer_load_dwordx4 v64, s[24:27], s19 offen lds
    s_mov_b32 m0, 8192
    s_add_u32 s19, s36, 3424256
    buffer_load_dwordx4 v64, s[24:27], s19 offen lds
    s_mov_b32 m0, 12288
    s_add_u32 s19, s36, 3489792
    buffer_load_dwordx4 v64, s[24:27], s19 offen lds
    ds_read_b64_tr_b16 a[128:129], v72 offset:0
    ds_read_b64_tr_b16 a[130:131], v74 offset:0
    ds_read_b64_tr_b16 a[132:133], v76 offset:0
    ds_read_b64_tr_b16 a[134:135], v78 offset:0
    ds_read_b64_tr_b16 a[136:137], v73 offset:0
    ds_read_b64_tr_b16 a[138:139], v75 offset:0
    ds_read_b64_tr_b16 a[140:141], v77 offset:0
    ds_read_b64_tr_b16 a[142:143], v79 offset:0
    s_waitcnt lgkmcnt(0)
    s_waitcnt vmcnt(4)
    s_barrier
    s_mov_b32 m0, 45056
    s_add_u32 s19, s36, 0
    buffer_load_dwordx4 v64, s[28:31], s19 offen lds
    s_mov_b32 m0, 81920
    s_add_u32 s19, s36, 65536
    buffer_load_dwordx4 v64, s[28:31], s19 offen lds
    s_mov_b32 m0, 118784
    s_add_u32 s19, s36, 16384
    buffer_load_dwordx4 v64, s[28:31], s19 offen lds
    s_mov_b32 m0, 155648
    s_add_u32 s19, s36, 81920
    buffer_load_dwordx4 v64, s[28:31], s19 offen lds
    ds_read_b64_tr_b16 a[144:145], v72 offset:4096
    ds_read_b64_tr_b16 a[146:147], v74 offset:4096
    ds_read_b64_tr_b16 a[148:149], v76 offset:4096
    ds_read_b64_tr_b16 a[150:151], v78 offset:4096
    ds_read_b64_tr_b16 a[152:153], v73 offset:4096
    ds_read_b64_tr_b16 a[154:155], v75 offset:4096
    ds_read_b64_tr_b16 a[156:157], v77 offset:4096
    ds_read_b64_tr_b16 a[158:159], v79 offset:4096
    s_waitcnt lgkmcnt(0)
    s_waitcnt vmcnt(4)
    s_barrier
    s_mov_b32 m0, 49152
    s_add_u32 s19, s36, 262144
    buffer_load_dwordx4 v64, s[28:31], s19 offen lds
    s_mov_b32 m0, 86016
    s_add_u32 s19, s36, 327680
    buffer_load_dwordx4 v64, s[28:31], s19 offen lds
    s_mov_b32 m0, 122880
    s_add_u32 s19, s36, 278528
    buffer_load_dwordx4 v64, s[28:31], s19 offen lds
    s_mov_b32 m0, 159744
    s_add_u32 s19, s36, 344064
    buffer_load_dwordx4 v64, s[28:31], s19 offen lds
    ds_read_b64_tr_b16 v[0:1], v68 offset:0
    ds_read_b64_tr_b16 v[2:3], v68 offset:4096
    ds_read_b64_tr_b16 v[4:5], v68 offset:8192
    ds_read_b64_tr_b16 v[6:7], v68 offset:12288
    ds_read_b64_tr_b16 v[8:9], v69 offset:0
    ds_read_b64_tr_b16 v[10:11], v69 offset:4096
    ds_read_b64_tr_b16 v[12:13], v69 offset:8192
    ds_read_b64_tr_b16 v[14:15], v69 offset:12288
    s_waitcnt lgkmcnt(0)
    ds_write_b128 v118, v[0:3] offset:24576
    ds_write_b128 v118, v[4:7] offset:25600
    ds_write_b128 v118, v[8:11] offset:26624
    ds_write_b128 v118, v[12:15] offset:27648
    s_waitcnt lgkmcnt(0)
    s_waitcnt vmcnt(4)
    s_barrier
    s_mov_b32 m0, 0
    s_add_u32 s19, s36, 1048576
    buffer_load_dwordx4 v64, s[28:31], s19 offen lds
    s_mov_b32 m0, 4096
    s_add_u32 s19, s36, 1114112
    buffer_load_dwordx4 v64, s[28:31], s19 offen lds
    s_mov_b32 m0, 8192
    s_add_u32 s19, s36, 1064960
    buffer_load_dwordx4 v64, s[28:31], s19 offen lds
    s_mov_b32 m0, 12288
    s_add_u32 s19, s36, 1130496
    buffer_load_dwordx4 v64, s[28:31], s19 offen lds
    ds_read_b64_tr_b16 v[0:1], v72 offset:0
    ds_read_b64_tr_b16 v[2:3], v74 offset:0
    ds_read_b64_tr_b16 v[4:5], v76 offset:0
    ds_read_b64_tr_b16 v[6:7], v78 offset:0
    ds_read_b64_tr_b16 v[8:9], v73 offset:0
    ds_read_b64_tr_b16 v[10:11], v75 offset:0
    ds_read_b64_tr_b16 v[12:13], v77 offset:0
    ds_read_b64_tr_b16 v[14:15], v79 offset:0
    s_waitcnt lgkmcnt(0)
    ds_write_b128 v118, v[0:3] offset:8192
    ds_write_b128 v118, v[4:7] offset:9216
    ds_write_b128 v118, v[8:11] offset:10240
    ds_write_b128 v118, v[12:15] offset:11264
    s_waitcnt lgkmcnt(0)
    s_waitcnt vmcnt(4)
    s_barrier
    s_mov_b32 m0, 45056
    s_add_u32 s19, s36, 1310720
    buffer_load_dwordx4 v64, s[28:31], s19 offen lds
    s_mov_b32 m0, 81920
    s_add_u32 s19, s36, 1376256
    buffer_load_dwordx4 v64, s[28:31], s19 offen lds
    s_mov_b32 m0, 118784
    s_add_u32 s19, s36, 1327104
    buffer_load_dwordx4 v64, s[28:31], s19 offen lds
    s_mov_b32 m0, 155648
    s_add_u32 s19, s36, 1392640
    buffer_load_dwordx4 v64, s[28:31], s19 offen lds
    ds_read_b64_tr_b16 a[160:161], v72 offset:4096
    ds_read_b64_tr_b16 a[162:163], v74 offset:4096
    ds_read_b64_tr_b16 a[164:165], v76 offset:4096
    ds_read_b64_tr_b16 a[166:167], v78 offset:4096
    ds_read_b64_tr_b16 a[168:169], v73 offset:4096
    ds_read_b64_tr_b16 a[170:171], v75 offset:4096
    ds_read_b64_tr_b16 a[172:173], v77 offset:4096
    ds_read_b64_tr_b16 a[174:175], v79 offset:4096
    s_waitcnt lgkmcnt(0)
    s_waitcnt vmcnt(4)
    s_barrier
    s_mov_b32 m0, 49152
    s_add_u32 s19, s36, 2097152
    buffer_load_dwordx4 v64, s[28:31], s19 offen lds
    s_mov_b32 m0, 86016
    s_add_u32 s19, s36, 2162688
    buffer_load_dwordx4 v64, s[28:31], s19 offen lds
    s_mov_b32 m0, 122880
    s_add_u32 s19, s36, 2113536
    buffer_load_dwordx4 v64, s[28:31], s19 offen lds
    s_mov_b32 m0, 159744
    s_add_u32 s19, s36, 2179072
    buffer_load_dwordx4 v64, s[28:31], s19 offen lds
    ds_read_b64_tr_b16 a[176:177], v68 offset:0
    ds_read_b64_tr_b16 a[178:179], v68 offset:4096
    ds_read_b64_tr_b16 a[180:181], v68 offset:8192
    ds_read_b64_tr_b16 a[182:183], v68 offset:12288
    ds_read_b64_tr_b16 a[184:185], v69 offset:0
    ds_read_b64_tr_b16 a[186:187], v69 offset:4096
    ds_read_b64_tr_b16 a[188:189], v69 offset:8192
    ds_read_b64_tr_b16 a[190:191], v69 offset:12288
    s_waitcnt lgkmcnt(0)
    s_waitcnt vmcnt(4)
    s_barrier
    s_mov_b32 m0, 0
    s_add_u32 s19, s36, 2359296
    buffer_load_dwordx4 v64, s[28:31], s19 offen lds
    s_mov_b32 m0, 4096
    s_add_u32 s19, s36, 2424832
    buffer_load_dwordx4 v64, s[28:31], s19 offen lds
    s_mov_b32 m0, 8192
    s_add_u32 s19, s36, 2375680
    buffer_load_dwordx4 v64, s[28:31], s19 offen lds
    s_mov_b32 m0, 12288
    s_add_u32 s19, s36, 2441216
    buffer_load_dwordx4 v64, s[28:31], s19 offen lds
    ds_read_b64_tr_b16 a[192:193], v72 offset:0
    ds_read_b64_tr_b16 a[194:195], v74 offset:0
    ds_read_b64_tr_b16 a[196:197], v76 offset:0
    ds_read_b64_tr_b16 a[198:199], v78 offset:0
    ds_read_b64_tr_b16 a[200:201], v73 offset:0
    ds_read_b64_tr_b16 a[202:203], v75 offset:0
    ds_read_b64_tr_b16 a[204:205], v77 offset:0
    ds_read_b64_tr_b16 a[206:207], v79 offset:0
    s_waitcnt lgkmcnt(0)
    s_waitcnt vmcnt(4)
    s_barrier
    s_mov_b32 m0, 45056
    s_add_u32 s19, s36, 3145728
    buffer_load_dwordx4 v64, s[28:31], s19 offen lds
    s_mov_b32 m0, 81920
    s_add_u32 s19, s36, 3211264
    buffer_load_dwordx4 v64, s[28:31], s19 offen lds
    s_mov_b32 m0, 118784
    s_add_u32 s19, s36, 3162112
    buffer_load_dwordx4 v64, s[28:31], s19 offen lds
    s_mov_b32 m0, 155648
    s_add_u32 s19, s36, 3227648
    buffer_load_dwordx4 v64, s[28:31], s19 offen lds
    ds_read_b64_tr_b16 a[208:209], v72 offset:4096
    ds_read_b64_tr_b16 a[210:211], v74 offset:4096
    ds_read_b64_tr_b16 a[212:213], v76 offset:4096
    ds_read_b64_tr_b16 a[214:215], v78 offset:4096
    ds_read_b64_tr_b16 a[216:217], v73 offset:4096
    ds_read_b64_tr_b16 a[218:219], v75 offset:4096
    ds_read_b64_tr_b16 a[220:221], v77 offset:4096
    ds_read_b64_tr_b16 a[222:223], v79 offset:4096
    s_waitcnt lgkmcnt(0)
    s_waitcnt vmcnt(4)
    s_barrier
    s_mov_b32 m0, 49152
    s_add_u32 s19, s36, 3407872
    buffer_load_dwordx4 v64, s[28:31], s19 offen lds
    s_mov_b32 m0, 86016
    s_add_u32 s19, s36, 3473408
    buffer_load_dwordx4 v64, s[28:31], s19 offen lds
    s_mov_b32 m0, 122880
    s_add_u32 s19, s36, 3424256
    buffer_load_dwordx4 v64, s[28:31], s19 offen lds
    s_mov_b32 m0, 159744
    s_add_u32 s19, s36, 3489792
    buffer_load_dwordx4 v64, s[28:31], s19 offen lds
    ds_read_b64_tr_b16 a[224:225], v68 offset:0
    ds_read_b64_tr_b16 a[226:227], v68 offset:4096
    ds_read_b64_tr_b16 a[228:229], v68 offset:8192
    ds_read_b64_tr_b16 a[230:231], v68 offset:12288
    ds_read_b64_tr_b16 a[232:233], v69 offset:0
    ds_read_b64_tr_b16 a[234:235], v69 offset:4096
    ds_read_b64_tr_b16 a[236:237], v69 offset:8192
    ds_read_b64_tr_b16 a[238:239], v69 offset:12288
    s_waitcnt lgkmcnt(0)
    s_waitcnt vmcnt(4)
    s_barrier
    ds_read_b64_tr_b16 a[240:241], v72 offset:0
    ds_read_b64_tr_b16 a[242:243], v74 offset:0
    ds_read_b64_tr_b16 a[244:245], v76 offset:0
    ds_read_b64_tr_b16 a[246:247], v78 offset:0
    ds_read_b64_tr_b16 a[248:249], v73 offset:0
    ds_read_b64_tr_b16 a[250:251], v75 offset:0
    ds_read_b64_tr_b16 a[252:253], v77 offset:0
    ds_read_b64_tr_b16 a[254:255], v79 offset:0
    s_waitcnt lgkmcnt(0)
    s_waitcnt vmcnt(0)
    s_barrier
    ds_read_b64_tr_b16 v[144:145], v72 offset:4096
    ds_read_b64_tr_b16 v[146:147], v74 offset:4096
    ds_read_b64_tr_b16 v[148:149], v76 offset:4096
    ds_read_b64_tr_b16 v[150:151], v78 offset:4096
    ds_read_b64_tr_b16 v[152:153], v73 offset:4096
    ds_read_b64_tr_b16 v[154:155], v75 offset:4096
    ds_read_b64_tr_b16 v[156:157], v77 offset:4096
    ds_read_b64_tr_b16 v[158:159], v79 offset:4096
    s_waitcnt lgkmcnt(0)
    s_barrier
    ds_write_b128 v118, v[32:35] offset:28672
    ds_write_b128 v118, v[36:39] offset:29696
    ds_write_b128 v118, v[40:43] offset:30720
    ds_write_b128 v118, v[44:47] offset:31744
    ds_write_b128 v118, v[48:51] offset:32768
    ds_write_b128 v118, v[52:55] offset:33792
    ds_write_b128 v118, v[56:59] offset:34816
    ds_write_b128 v118, v[60:63] offset:35840
    s_mov_b32 s35, s52
    s_lshl_b32 s34, s16, 6
    s_mov_b32 s52, 0
    v_and_b32 v113, 0xf0, v117
    v_bfe_u32 v64, v117, 9, 1
    v_lshl_add_u32 v113, v64, 8, v113
    v_bfe_u32 v64, v117, 8, 1
    v_lshl_add_u32 v113, v64, 2, v113
    v_bfe_u32 v64, v117, 4, 4
    v_and_b32 v65, 11, v64
    v_bfe_u32 v66, v64, 2, 1
    v_lshlrev_b32 v66, 4, v66
    v_mov_b32 v67, 0x3f80
    v_lshlrev_b32 v67, v66, v67
    v_and_b32 v66, 0xf0, v117
    v_cmp_eq_u32 vcc, 0, v65
    s_nop 1
    v_cndmask_b32 v72, v127, v67, vcc
    v_cmp_eq_u32 vcc, 1, v65
    s_nop 1
    v_cndmask_b32 v73, v127, v67, vcc
    v_cmp_eq_u32 vcc, 2, v65
    s_nop 1
    v_cndmask_b32 v74, v127, v67, vcc
    v_cmp_eq_u32 vcc, 3, v65
    s_nop 1
    v_cndmask_b32 v75, v127, v67, vcc
    ds_write_b128 v66, v[72:75] offset:15360
    ds_write_b128 v117, v[108:111] offset:14336
    v_mov_b32 v76, 0x3f803f80
    v_mov_b32 v77, 0x3f803f80
    v_mov_b32 v78, 0x3f803f80
    v_mov_b32 v79, 0x3f803f80
    ds_write_b128 v127, v[76:79] offset:15616
    s_lshl_b32 s19, s16, 14
    s_add_u32 s38, s19, 0
    s_add_u32 s97, s19, 8192
    s_mov_b32 s39, 59834368
    s_mov_b32 s45, 59834368
    s_mov_b32 s18, 0
    s_mov_b32 s8, s72
    s_and_b32 s9, s73, 0xffff
    s_mov_b32 s10, 0x2000
    s_mov_b32 s11, 0x20000
    buffer_load_dword v8, v106, s[8:11], 0 offen offset:0
    buffer_load_dword v9, v106, s[8:11], 0 offen offset:128
    buffer_load_dword v10, v106, s[8:11], 0 offen offset:16
    buffer_load_dword v11, v106, s[8:11], 0 offen offset:144
    buffer_load_dword v12, v106, s[8:11], 0 offen offset:64
    buffer_load_dword v13, v106, s[8:11], 0 offen offset:192
    buffer_load_dword v14, v106, s[8:11], 0 offen offset:80
    buffer_load_dword v15, v106, s[8:11], 0 offen offset:208
    s_add_u32 s96, s36, 60817408
    v_bfe_u32 v85, v117, 4, 3
    v_lshlrev_b32 v85, 2, v85
C0_init:
    global_load_dword v84, v85, s[86:87] offset:0 sc1
    s_sub_u32 s48, s48, 1
    s_cbranch_scc1 C0_bail
    s_waitcnt vmcnt(0)
    v_cmp_ne_u32 vcc, -1, v84
    s_cbranch_vccnz C0_init
    global_load_dword v86, v127, s[86:87] offset:96 sc1
    v_and_b32 v85, 4, v85
C0_f01:
    buffer_load_dword v84, v85, s[4:7], s96 offen sc1
    s_sub_u32 s48, s48, 1
    s_cbranch_scc1 C0_bail
    s_waitcnt vmcnt(0)
    v_cmp_ne_u32 vcc, 1, v84
    s_cbranch_vccnz C0_f01
    s_add_u32 s96, s96, 8
    buffer_load_dwordx4 v[136:139], v124, s[4:7], s38 offen sc1
    buffer_load_dwordx4 v[128:131], v117, s[4:7], s97 offen sc1
    buffer_load_dwordx4 v[140:143], v124, s[4:7], s38 offen offset:2048 sc1
    buffer_load_dwordx4 v[132:135], v117, s[4:7], s97 offen offset:1024 sc1
    s_add_u32 s38, s38, 524288
    s_add_u32 s97, s97, 524288
    s_mov_b32 s8, 0x05040100
    s_mov_b32 s9, 0x07060302
    s_waitcnt vmcnt(0) lgkmcnt(0)
    v_cmp_ne_u32 s[58:59], 0, v86
    s_barrier
    v_perm_b32 v0, v9, v8, s8
    v_min_u32 v0, -2, v0
    v_perm_b32 v1, v11, v10, s8
    v_min_u32 v1, -2, v1
    v_perm_b32 v2, v9, v8, s9
    v_min_u32 v2, -2, v2
    v_perm_b32 v3, v11, v10, s9
    v_min_u32 v3, -2, v3
    v_perm_b32 v4, v13, v12, s8
    v_min_u32 v4, -2, v4
    v_perm_b32 v5, v15, v14, s8
    v_min_u32 v5, -2, v5
    v_perm_b32 v6, v13, v12, s9
    v_min_u32 v6, -2, v6
    v_perm_b32 v7, v15, v14, s9
    v_min_u32 v7, -2, v7
    ds_read_b128 v[64:67], v118 offset:0
    ds_read_b128 v[68:71], v118 offset:1024
    ds_read_b128 v[72:75], v118 offset:2048
    ds_read_b128 v[76:79], v118 offset:3072
    ds_read_b128 v[16:19], v118 offset:4096
    ds_read_b128 v[20:23], v118 offset:5120
    ds_read_b128 v[24:27], v118 offset:6144
    ds_read_b128 v[28:31], v118 offset:7168
    ds_read_b128 v[32:35], v118 offset:8192
    ds_read_b128 v[36:39], v118 offset:9216
    ds_read_b128 v[40:43], v118 offset:10240
    ds_read_b128 v[44:47], v118 offset:11264
    v_mov_b32 v48, v128
    v_mov_b32 v49, v129
    v_mov_b32 v50, v130
    v_mov_b32 v51, v131
    v_mov_b32 v52, v132
    v_mov_b32 v53, v133
    v_mov_b32 v54, v134
    v_mov_b32 v55, v135
    v_mov_b32 v56, v136
    v_mov_b32 v57, v137
    v_mov_b32 v58, v138
    v_mov_b32 v59, v139
    v_mov_b32 v60, v140
    v_mov_b32 v61, v141
    v_mov_b32 v62, v142
    v_mov_b32 v63, v143
    v_mov_b32 v80, 0
    v_mov_b32 v81, 0
    v_mov_b32 v82, 0
    v_mov_b32 v83, 0
    v_mov_b32 v84, 0
    v_mov_b32 v85, 0
    v_mov_b32 v86, 0
    v_mov_b32 v87, 0
    v_mov_b32 v88, 0
    v_mov_b32 v89, 0
    v_mov_b32 v90, 0
    v_mov_b32 v91, 0
    v_mov_b32 v92, 0
    v_mov_b32 v93, 0
    v_mov_b32 v94, 0
    v_mov_b32 v95, 0
    v_mov_b32 v96, 0
    v_mov_b32 v97, 0
    v_mov_b32 v98, 0
    v_mov_b32 v99, 0
    v_mov_b32 v100, 0
    v_mov_b32 v101, 0
    v_mov_b32 v102, 0
    v_mov_b32 v103, 0
    s_cmp_lg_u64 s[58:59], 0
    s_cbranch_scc1 D0_step
C0_step:
    s_waitcnt vmcnt(3)
    s_waitcnt lgkmcnt(0)
    v_max3_u32 v106, v0, v1, v2
    v_max_u32 v106, v106, v3
    v_smfmac_f32_16x16x64_bf16 v[80:83], v[0:3], v[64:71], v116
    ds_write_b128 v117, v[0:3] offset:0
    v_smfmac_f32_16x16x64_bf16 v[84:87], v[0:3], v[72:79], v116
    s_waitcnt vmcnt(2)
    v_max3_u32 v106, v106, v4, v5
    v_max3_u32 v106, v106, v6, v7
    v_cmp_eq_u32 vcc, -1, v106
    v_smfmac_f32_16x16x64_bf16 v[88:91], v[0:3], v[16:23], v116
    ds_write_b128 v117, v[4:7] offset:1024
    v_smfmac_f32_16x16x64_bf16 v[92:95], v[0:3], v[24:31], v116
    s_cbranch_vccnz C0_re2
    ds_read_b128 v[64:67], v118 offset:12288
    v_smfmac_f32_16x16x64_bf16 v[96:99], v[0:3], v[32:39], v116
    ds_read_b128 v[68:71], v118 offset:13312
    buffer_load_dwordx4 v[136:139], v124, s[4:7], s38 offen sc1
    v_smfmac_f32_16x16x64_bf16 v[100:103], v[0:3], v[40:47], v116
    ds_read_b128 v[72:75], v118 offset:14336
    v_smfmac_f32_16x16x64_bf16 v[80:83], v[4:7], a[0:7], v116
    ds_read_b128 v[76:79], v118 offset:15360
    buffer_load_dwordx4 v[128:131], v117, s[4:7], s97 offen sc1
    v_smfmac_f32_16x16x64_bf16 v[84:87], v[4:7], a[8:15], v116
    s_waitcnt lgkmcnt(4)
    s_barrier
    ds_read_b128 v[8:11], v117 offset:2048
    v_smfmac_f32_16x16x64_bf16 v[88:91], v[4:7], a[80:87], v116
    s_and_b32 s19, s18, 1
    ds_read_b128 v[12:15], v117 offset:3072
    buffer_load_dwordx4 v[140:143], v124, s[4:7], s38 offen offset:2048 sc1
    v_smfmac_f32_16x16x64_bf16 v[92:95], v[4:7], a[88:95], v116
    s_lshl_b32 s19, s19, 18
    s_add_u32 s40, s19, s34
    ds_read_b128 v[16:19], v117 offset:4096
    v_smfmac_f32_16x16x64_bf16 v[96:99], v[4:7], a[160:167], v116
    s_add_u32 s40, s40, 58720256
    ds_read_b128 v[20:23], v117 offset:5120
    buffer_load_dwordx4 v[132:135], v117, s[4:7], s97 offen offset:1024 sc1
    v_smfmac_f32_16x16x64_bf16 v[100:103], v[4:7], a[168:175], v116
    s_waitcnt lgkmcnt(3)
    s_add_u32 s41, s40, 4096
    ds_read_b128 v[24:27], v117 offset:6144
    v_smfmac_f32_16x16x64_bf16 v[80:83], v[8:11], a[16:23], v116
    s_lshl_b32 s42, s16, 13
    s_add_u32 s42, s42, s19
    ds_read_b128 v[28:31], v117 offset:7168
    v_smfmac_f32_16x16x64_bf16 v[84:87], v[8:11], a[24:31], v116
    s_waitcnt lgkmcnt(4)
    s_add_u32 s42, s42, 58720256
    ds_read_b128 v[32:35], v118 offset:16384
    v_smfmac_f32_16x16x64_bf16 v[80:83], v[12:15], a[32:39], v116
    s_bfe_u32 s46, s18, 0x10001
    ds_read_b128 v[36:39], v118 offset:17408
    buffer_store_dwordx4 v[108:111], v117, s[4:7], s39 offen sc1
    v_smfmac_f32_16x16x64_bf16 v[84:87], v[12:15], a[40:47], v116
    s_waitcnt lgkmcnt(2)
    s_add_u32 s43, s42, 4096
    ds_read_b128 v[40:43], v118 offset:18432
    v_smfmac_f32_16x16x64_bf16 v[80:83], v[16:19], v[64:71], v116
    s_waitcnt lgkmcnt(9)
    s_add_u32 s19, s18, 1
    ds_read_b128 v[44:47], v118 offset:19456
    v_smfmac_f32_16x16x64_bf16 v[84:87], v[16:19], v[72:79], v116
    s_and_b32 s19, s19, 3
    s_lshl_b32 s19, s19, 13
    ds_read_b128 v[64:67], v118 offset:20480
    v_smfmac_f32_16x16x64_bf16 v[80:83], v[20:23], a[48:55], v116
    s_add_u32 s45, s19, 59768832
    s_add_u32 s44, s45, s35
    ds_read_b128 v[68:71], v118 offset:21504
    v_smfmac_f32_16x16x64_bf16 v[84:87], v[20:23], a[56:63], v116
    ds_read_b128 v[72:75], v118 offset:22528
    v_smfmac_f32_16x16x64_bf16 v[80:83], v[24:27], a[64:71], v116
    ds_read_b128 v[76:79], v118 offset:23552
    v_smfmac_f32_16x16x64_bf16 v[84:87], v[24:27], a[72:79], v116
    s_waitcnt lgkmcnt(4)
    v_smfmac_f32_16x16x64_bf16 v[80:83], v[28:31], v[32:39], v116
    s_nop 1
    v_smfmac_f32_16x16x64_bf16 v[84:87], v[28:31], v[40:47], v116
    s_nop 0
    ds_read_b128 v[32:35], v118 offset:24576
    v_smfmac_f32_16x16x64_bf16 v[88:91], v[8:11], a[96:103], v116
    s_nop 0
    ds_read_b128 v[36:39], v118 offset:25600
    v_add_f32 v80, v80, v82
    v_smfmac_f32_16x16x64_bf16 v[92:95], v[8:11], a[104:111], v116
    ds_read_b128 v[40:43], v118 offset:26624
    v_add_f32 v81, v81, v83
    v_add_f32 v84, v84, v86
    v_smfmac_f32_16x16x64_bf16 v[88:91], v[12:15], a[112:119], v116
    ds_read_b128 v[44:47], v118 offset:27648
    v_add_f32 v85, v85, v87
    v_cvt_pk_bf16_f32 v80, v80, v84
    v_smfmac_f32_16x16x64_bf16 v[92:95], v[12:15], a[120:127], v116
    s_waitcnt lgkmcnt(4)
    v_cvt_pk_bf16_f32 v81, v81, v85
    v_smfmac_f32_16x16x64_bf16 v[88:91], v[16:19], v[64:71], v116
    ds_write2_b32 v119, v80, v81 offset0:0 offset1:16
    v_smfmac_f32_16x16x64_bf16 v[92:95], v[16:19], v[72:79], v116
    v_smfmac_f32_16x16x64_bf16 v[88:91], v[20:23], a[128:135], v116
    v_smfmac_f32_16x16x64_bf16 v[92:95], v[20:23], a[136:143], v116
    v_smfmac_f32_16x16x64_bf16 v[88:91], v[24:27], a[144:151], v116
    s_waitcnt vmcnt(5) lgkmcnt(0)
    s_barrier
    ds_read_b128 v[0:3], v120 offset:0
    v_smfmac_f32_16x16x64_bf16 v[92:95], v[24:27], a[152:159], v116
    s_waitcnt lgkmcnt(2)
    ds_read_b128 v[4:7], v120 offset:2048
    v_smfmac_f32_16x16x64_bf16 v[88:91], v[28:31], v[32:39], v116
    s_nop 0
    ds_read_b128 v[72:75], v127 offset:15616
    v_smfmac_f32_16x16x64_bf16 v[92:95], v[28:31], v[40:47], v116
    s_nop 2
    v_smfmac_f32_16x16x64_bf16 v[96:99], v[8:11], a[176:183], v116
    s_waitcnt lgkmcnt(2)
    v_add_f32 v88, v88, v90
    v_mfma_f32_16x16x32_bf16 v[80:83], v[56:59], v[0:3], 0
    s_waitcnt lgkmcnt(1)
    v_add_f32 v89, v89, v91
    v_add_f32 v92, v92, v94
    v_mfma_f32_16x16x32_bf16 v[80:83], v[60:63], v[4:7], v[80:83]
    s_nop 0
    v_add_f32 v93, v93, v95
    v_cvt_pk_bf16_f32 v108, v88, v92
    v_smfmac_f32_16x16x64_bf16 v[100:103], v[8:11], a[184:191], v116
    s_nop 1
    v_cvt_pk_bf16_f32 v109, v89, v93
    ds_write2_b32 v119, v108, v109 offset0:128 offset1:144
    v_smfmac_f32_16x16x64_bf16 v[96:99], v[12:15], a[192:199], v116
    v_add_f32_dpp v80, v82, v80 row_ror:8 row_mask:0xf bank_mask:0xf
    v_add_f32_dpp v81, v83, v81 row_ror:8 row_mask:0xf bank_mask:0xf
    v_smfmac_f32_16x16x64_bf16 v[100:103], v[12:15], a[200:207], v116
    v_exp_f32 v82, v80
    v_smfmac_f32_16x16x64_bf16 v[96:99], v[16:19], a[208:215], v116
    v_exp_f32 v83, v81
    v_smfmac_f32_16x16x64_bf16 v[100:103], v[16:19], a[216:223], v116
    s_waitcnt lgkmcnt(0)
    s_barrier
    ds_read_b128 v[8:11], v121 offset:0
    v_cvt_pk_bf16_f32 v82, v82, v83
    s_mov_b64 exec, s[50:51]
    ds_write_b32 v113, v82 offset:14336
    s_mov_b64 exec, -1
    v_smfmac_f32_16x16x64_bf16 v[96:99], v[20:23], a[224:231], v116
    ds_read_b128 v[12:15], v121 offset:2048
    v_smfmac_f32_16x16x64_bf16 v[100:103], v[20:23], a[232:239], v116
    v_smfmac_f32_16x16x64_bf16 v[96:99], v[24:27], a[240:247], v116
    v_smfmac_f32_16x16x64_bf16 v[100:103], v[24:27], a[248:255], v116
    s_waitcnt lgkmcnt(2)
    s_waitcnt lgkmcnt(1)
    s_barrier
    ds_read_b128 v[88:91], v117 offset:14336
    v_mfma_f32_16x16x32_bf16 v[84:87], v[8:11], v[0:3], 0
    s_waitcnt lgkmcnt(1)
    ds_read_b128 v[92:95], v125 offset:14336
    v_mfma_f32_16x16x32_bf16 v[84:87], v[12:15], v[4:7], v[84:87]
    s_nop 1
    v_smfmac_f32_16x16x64_bf16 v[96:99], v[28:31], v[144:151], v116
    s_nop 1
    v_smfmac_f32_16x16x64_bf16 v[100:103], v[28:31], v[152:159], v116
    s_cmp_eq_u32 s18, 63
    s_waitcnt lgkmcnt(1)
    v_add_f32_dpp v84, v86, v84 row_ror:8 row_mask:0xf bank_mask:0xf
    v_add_f32_dpp v85, v87, v85 row_ror:8 row_mask:0xf bank_mask:0xf
    v_mfma_f32_16x16x32_bf16 v[68:71], v[72:75], v[88:91], 0
    s_cbranch_scc1 C0_fin
    v_mul_f32 v84, s49, v84
    v_mul_f32 v85, s49, v85
    v_mfma_f32_16x16x32_bf16 v[64:67], v[48:51], v[88:91], 0
    s_waitcnt lgkmcnt(0)
    v_exp_f32 v86, v84
    v_add_f32 v96, v96, v98
    v_mfma_f32_16x16x32_bf16 v[64:67], v[52:55], v[92:95], v[64:67]
    v_exp_f32 v87, v85
    v_add_f32 v97, v97, v99
    v_add_f32 v100, v100, v102
    s_mov_b64 exec, s[50:51]
    v_cvt_pk_bf16_f32 v104, v86, v87
    s_mov_b64 exec, -1
    v_add_f32 v101, v101, v103
    v_mfma_f32_16x16x16_bf16 v[68:71], v[72:73], v[104:105], v[68:71]
    v_mov_b32_dpp v105, v104 row_ror:8 row_mask:0xf bank_mask:0xf
    v_cvt_pk_bf16_f32 v110, v96, v97
    v_cvt_pk_bf16_f32 v111, v100, v101
    s_nop 1
    v_mfma_f32_16x16x16_bf16 v[64:67], v[110:111], v[104:105], v[64:67]
    s_nop 1
    v_rcp_f32 v106, v68
    v_subrev_u32 v107, s60, v68
    v_cmp_lt_u32 vcc, s61, v107
    v_mov_b32_dpp v106, v106 row_ror:8 row_mask:0xf bank_mask:0xc
    s_nop 1
    v_mul_f32 v64, v106, v64
    v_mul_f32 v65, v106, v65
    v_mul_f32 v66, v106, v66
    v_mul_f32 v67, v106, v67
    v_cvt_pk_bf16_f32 v96, v64, v65
    v_cvt_pk_bf16_f32 v97, v66, v67
    ds_write_b64 v126, v[96:97] offset:12288
    v_mfma_f32_16x16x1_4b_f32 v[32:47], v127, v127, 0
    s_and_b64 vcc, vcc, s[50:51]
    s_cbranch_scc1 C0_slow
C0_back:
    v_mov_b32 v107, 0
    v_mov_b32 v107, 0
    v_mov_b32 v107, 0
    s_waitcnt lgkmcnt(0)
    s_barrier
    ds_read_b128 v[80:83], v117 offset:12288
    ds_read_b128 v[84:87], v117 offset:13312
    v_mfma_f32_16x16x1_4b_f32 v[48:63], v127, v127, 0
    v_mov_b32 v107, 0
    s_waitcnt lgkmcnt(1)
    v_smfmac_f32_16x16x64_bf16 v[32:35], v[80:83], v[160:167], v116
    s_waitcnt lgkmcnt(0)
    ds_read_b128 v[0:3], v118 offset:28672
    v_smfmac_f32_16x16x64_bf16 v[32:35], v[84:87], v[192:199], v116
    s_lshl_b32 s39, s18, 5
    ds_read_b128 v[4:7], v118 offset:29696
    v_smfmac_f32_16x16x64_bf16 v[36:39], v[80:83], v[168:175], v116
    s_add_u32 s39, s39, s16
    ds_read_b128 v[8:11], v118 offset:30720
    v_smfmac_f32_16x16x64_bf16 v[36:39], v[84:87], v[200:207], v116
    s_lshl_b32 s39, s39, 12
    ds_read_b128 v[12:15], v118 offset:31744
    v_add_f32 v32, v32, v34
    v_smfmac_f32_16x16x64_bf16 v[40:43], v[80:83], v[176:183], v116
    s_add_u32 s39, s39, 50331648
    ds_read_b128 v[16:19], v118 offset:32768
    v_add_f32 v33, v33, v35
    v_cvt_pk_bf16_f32 v88, v32, v33
    v_smfmac_f32_16x16x64_bf16 v[40:43], v[84:87], v[208:215], v116
    s_cmp_lt_u32 s18, 62
    ds_read_b128 v[20:23], v118 offset:33792
    v_add_f32 v36, v36, v38
    v_smfmac_f32_16x16x64_bf16 v[44:47], v[80:83], v[184:191], v116
    s_cselect_b32 s19, 524288, 0
    ds_read_b128 v[24:27], v118 offset:34816
    v_add_f32 v37, v37, v39
    v_cvt_pk_bf16_f32 v89, v36, v37
    v_and_or_b32 v89, v89, -2, s46
    v_smfmac_f32_16x16x64_bf16 v[44:47], v[84:87], v[216:223], v116
    s_add_u32 s38, s38, s19
    ds_read_b128 v[28:31], v118 offset:35840
    buffer_store_dwordx2 v[88:89], v122, s[4:7], s40 offen offset:0
    v_add_f32 v40, v40, v42
    v_smfmac_f32_16x16x64_bf16 v[48:51], v[80:83], v[224:231], v116
    s_waitcnt lgkmcnt(6)
    ds_read_b128 v[64:67], v118 offset:0
    v_add_f32 v41, v41, v43
    v_cvt_pk_bf16_f32 v90, v40, v41
    v_smfmac_f32_16x16x64_bf16 v[48:51], v[84:87], v[0:7], v116
    s_add_u32 s97, s97, s19
    ds_read_b128 v[68:71], v118 offset:1024
    v_add_f32 v44, v44, v46
    v_smfmac_f32_16x16x64_bf16 v[52:55], v[80:83], v[232:239], v116
    s_waitcnt lgkmcnt(6)
    ds_read_b128 v[72:75], v118 offset:2048
    v_add_f32 v45, v45, v47
    v_cvt_pk_bf16_f32 v91, v44, v45
    v_and_or_b32 v91, v91, -2, s46
    v_smfmac_f32_16x16x64_bf16 v[52:55], v[84:87], v[8:15], v116
    s_nop 0
    buffer_store_dwordx2 v[90:91], v122, s[4:7], s40 offen offset:2048
    v_add_f32 v48, v48, v50
    v_smfmac_f32_16x16x64_bf16 v[56:59], v[80:83], v[240:247], v116
    s_waitcnt lgkmcnt(3)
    ds_read_b128 v[76:79], v118 offset:3072
    v_add_f32 v49, v49, v51
    v_cvt_pk_bf16_f32 v92, v48, v49
    v_smfmac_f32_16x16x64_bf16 v[56:59], v[84:87], v[16:23], v116
    s_nop 0
    v_add_f32 v52, v52, v54
    v_smfmac_f32_16x16x64_bf16 v[60:63], v[80:83], v[248:255], v116
    s_nop 0
    v_add_f32 v53, v53, v55
    v_cvt_pk_bf16_f32 v93, v52, v53
    v_and_or_b32 v93, v93, -2, s46
    v_smfmac_f32_16x16x64_bf16 v[60:63], v[84:87], v[24:31], v116
    buffer_store_dwordx2 v[92:93], v122, s[4:7], s41 offen offset:0
    v_add_f32 v56, v56, v58
    v_add_f32 v57, v57, v59
    v_cvt_pk_bf16_f32 v94, v56, v57
    s_nop 3
    v_add_f32 v60, v60, v62
    v_add_f32 v61, v61, v63
    v_cvt_pk_bf16_f32 v95, v60, v61
    v_and_or_b32 v95, v95, -2, s46
    buffer_store_dwordx2 v[94:95], v122, s[4:7], s41 offen offset:2048
    v_and_b32 v106, 0xf0, v117
    v_and_b32 v107, 0xf0, v125
    ds_read_b128 v[96:99], v106 offset:15360
    v_mov_b32 v88, 0
    ds_read_b128 v[100:103], v107 offset:15360
    v_mov_b32 v89, 0
    ds_read_b128 v[32:35], v118 offset:8192
    v_mov_b32 v90, 0
    ds_read_b128 v[36:39], v118 offset:9216
    v_mov_b32 v91, 0
    ds_read_b128 v[40:43], v118 offset:10240
    v_mov_b32 v92, 0
    ds_read_b128 v[44:47], v118 offset:11264
    v_mov_b32 v93, 0
    v_mov_b32 v94, 0
    v_mov_b32 v95, 0
    v_mov_b32 v107, 0
    s_nop 2
    v_mov_b32 v107, 0
    s_nop 2
    v_mov_b32 v107, 0
    s_nop 2
    buffer_load_dwordx4 v[0:3], v117, s[4:7], s42 offen offset:0 sc1
    buffer_load_dwordx4 v[4:7], v117, s[4:7], s42 offen offset:1024 sc1
    buffer_load_dwordx4 v[8:11], v117, s[4:7], s42 offen offset:2048 sc1
    buffer_load_dwordx4 v[12:15], v117, s[4:7], s42 offen offset:3072 sc1
    buffer_load_dwordx4 v[16:19], v117, s[4:7], s43 offen offset:0 sc1
    buffer_load_dwordx4 v[20:23], v117, s[4:7], s43 offen offset:1024 sc1
    buffer_load_dwordx4 v[24:27], v117, s[4:7], s43 offen offset:2048 sc1
    buffer_load_dwordx4 v[28:31], v117, s[4:7], s43 offen offset:3072 sc1
    buffer_load_dwordx4 v[16:19], v117, s[4:7], s43 offen offset:0 sc1
    buffer_load_dwordx4 v[20:23], v117, s[4:7], s43 offen offset:1024 sc1
    buffer_load_dwordx4 v[24:27], v117, s[4:7], s43 offen offset:2048 sc1
    buffer_load_dwordx4 v[28:31], v117, s[4:7], s43 offen offset:3072 sc1
    buffer_load_dwordx4 v[0:3], v117, s[4:7], s42 offen offset:0 sc1
    buffer_load_dwordx4 v[4:7], v117, s[4:7], s42 offen offset:1024 sc1
    buffer_load_dwordx4 v[8:11], v117, s[4:7], s42 offen offset:2048 sc1
    buffer_load_dwordx4 v[12:15], v117, s[4:7], s42 offen offset:3072 sc1
    s_waitcnt lgkmcnt(0)
    s_waitcnt vmcnt(15)
    v_bitop3_b32 v107, s46, v1, v3 bitop3:0x7e
    v_mfma_f32_16x16x32_bf16 v[80:83], v[0:3], v[96:99], 0
    s_waitcnt vmcnt(14)
    v_bitop3_b32 v114, s46, v5, v7 bitop3:0x7e
    v_or_b32 v107, v107, v114
    v_mfma_f32_16x16x32_bf16 v[80:83], v[4:7], v[96:99], v[80:83]
    s_waitcnt vmcnt(13)
    v_bitop3_b32 v114, s46, v9, v11 bitop3:0x7e
    v_or_b32 v107, v107, v114
    v_mfma_f32_16x16x32_bf16 v[80:83], v[8:11], v[100:103], v[80:83]
    s_waitcnt vmcnt(12)
    v_bitop3_b32 v114, s46, v13, v15 bitop3:0x7e
    v_bitop3_b32 v107, v107, v114, 1 bitop3:0xa8
    v_mfma_f32_16x16x32_bf16 v[80:83], v[12:15], v[100:103], v[80:83]
    v_cmp_ne_u32 vcc, 0, v107
    s_waitcnt vmcnt(11)
    v_bitop3_b32 v106, s46, v17, v19 bitop3:0x7e
    v_mfma_f32_16x16x32_bf16 v[84:87], v[16:19], v[96:99], 0
    s_waitcnt vmcnt(10)
    v_bitop3_b32 v114, s46, v21, v23 bitop3:0x7e
    v_or_b32 v106, v106, v114
    v_mfma_f32_16x16x32_bf16 v[84:87], v[20:23], v[96:99], v[84:87]
    s_cbranch_vccnz C0_ra
    s_waitcnt vmcnt(9)
    v_bitop3_b32 v114, s46, v25, v27 bitop3:0x7e
    v_or_b32 v106, v106, v114
    v_mfma_f32_16x16x32_bf16 v[84:87], v[24:27], v[100:103], v[84:87]
    s_waitcnt vmcnt(8)
    v_bitop3_b32 v114, s46, v29, v31 bitop3:0x7e
    v_bitop3_b32 v106, v106, v114, 1 bitop3:0xa8
    v_mfma_f32_16x16x32_bf16 v[84:87], v[28:31], v[100:103], v[84:87]
    v_cmp_ne_u32 vcc, 0, v106
    v_permlane32_swap_b32 v80, v81
    v_permlane32_swap_b32 v82, v83
    v_add_f32 v80, v80, v81
    v_add_f32 v82, v82, v83
    s_cbranch_vccnz C0_rb
C0_q1:
    s_nop 0
    v_permlane16_swap_b32 v80, v82
    v_permlane32_swap_b32 v84, v85
    v_permlane32_swap_b32 v86, v87
    v_add_f32 v84, v84, v85
    v_add_f32 v86, v86, v87
    v_add_f32 v80, v80, v82
    s_nop 0
    v_permlane16_swap_b32 v84, v86
    v_add_f32 v84, v84, v86
    v_cvt_pk_bf16_f32 v106, v80, v84
    buffer_store_dword v106, v123, s[4:7], s44 offen
    v_mov_b32 v96, 0
    v_mov_b32 v97, 0
    v_mov_b32 v98, 0
    v_mov_b32 v99, 0
    v_mov_b32 v100, 0
    v_mov_b32 v101, 0
    v_mov_b32 v102, 0
    v_mov_b32 v103, 0
    v_mov_b32 v80, 0
    v_mov_b32 v81, 0
    v_mov_b32 v82, 0
    v_mov_b32 v83, 0
    v_mov_b32 v84, 0
    v_mov_b32 v85, 0
    v_mov_b32 v86, 0
    v_mov_b32 v87, 0
    v_mov_b32 v48, v128
    v_mov_b32 v49, v129
    v_mov_b32 v50, v130
    v_mov_b32 v51, v131
    v_mov_b32 v52, v132
    v_mov_b32 v53, v133
    v_mov_b32 v54, v134
    v_mov_b32 v55, v135
    v_mov_b32 v56, v136
    v_mov_b32 v57, v137
    v_mov_b32 v58, v138
    v_mov_b32 v59, v139
    v_mov_b32 v60, v140
    v_mov_b32 v61, v141
    v_mov_b32 v62, v142
    v_mov_b32 v63, v143
    v_mov_b32 v107, 0
    s_nop 2
    v_mov_b32 v107, 0
    s_nop 2
    s_barrier
    buffer_load_dwordx4 v[0:3], v117, s[4:7], s45 offen offset:0 sc1
    v_mov_b32 v107, 0
    s_add_u32 s18, s18, 1
    buffer_load_dwordx4 v[4:7], v117, s[4:7], s45 offen offset:1024 sc1
    v_mov_b32 v107, 0
    s_waitcnt vmcnt(3)
    v_mov_b32 v107, 0
    ds_read_b128 v[16:19], v118 offset:4096
    v_mov_b32 v107, 0
    ds_read_b128 v[20:23], v118 offset:5120
    v_mov_b32 v107, 0
    ds_read_b128 v[24:27], v118 offset:6144
    v_mov_b32 v107, 0
    ds_read_b128 v[28:31], v118 offset:7168
    v_mov_b32 v107, 0
    s_nop 2
    v_mov_b32 v107, 0
    s_nop 2
    v_mov_b32 v107, 0
    s_nop 2
    v_mov_b32 v107, 0
    s_nop 2
    v_mov_b32 v107, 0
    s_nop 2
    buffer_load_dwordx4 v[0:3], v117, s[4:7], s45 offen offset:0 sc1
    buffer_load_dwordx4 v[4:7], v117, s[4:7], s45 offen offset:1024 sc1
    v_mov_b32 v107, 0
    s_nop 2
    v_mov_b32 v107, 0
    s_nop 2
    v_mov_b32 v107, 0
    s_nop 2
    v_mov_b32 v107, 0
    s_nop 2
    s_branch C0_step
C0_re2:
    buffer_load_dwordx4 v[0:3], v117, s[4:7], s45 offen offset:0 sc1
    buffer_load_dwordx4 v[4:7], v117, s[4:7], s45 offen offset:1024 sc1
    s_add_u32 s55, s55, 1
    s_sub_u32 s48, s48, 1
    s_nop 0
    v_mfma_f32_16x16x1_4b_f32 v[80:95], v127, v127, 0
    s_cbranch_scc0 C0_step
C0_bail:
    s_endpgm
C0_rb:
    s_waitcnt vmcnt(7)
    v_bitop3_b32 v106, s46, v17, v19 bitop3:0x7e
    v_mfma_f32_16x16x32_bf16 v[84:87], v[16:19], v[96:99], 0
    s_waitcnt vmcnt(6)
    v_bitop3_b32 v114, s46, v21, v23 bitop3:0x7e
    v_or_b32 v106, v106, v114
    v_mfma_f32_16x16x32_bf16 v[84:87], v[20:23], v[96:99], v[84:87]
    s_waitcnt vmcnt(5)
    v_bitop3_b32 v114, s46, v25, v27 bitop3:0x7e
    v_or_b32 v106, v106, v114
    v_mfma_f32_16x16x32_bf16 v[84:87], v[24:27], v[100:103], v[84:87]
    s_waitcnt vmcnt(4)
    v_bitop3_b32 v114, s46, v29, v31 bitop3:0x7e
    v_bitop3_b32 v106, v106, v114, 1 bitop3:0xa8
    v_mfma_f32_16x16x32_bf16 v[84:87], v[28:31], v[100:103], v[84:87]
    v_cmp_ne_u32 vcc, 0, v106
    s_add_u32 s54, s54, 1
    s_nop 3
    s_cbranch_vccz C0_q1
C0_ra:
    buffer_load_dwordx4 v[0:3], v117, s[4:7], s42 offen offset:0 sc1
    buffer_load_dwordx4 v[4:7], v117, s[4:7], s42 offen offset:1024 sc1
    buffer_load_dwordx4 v[8:11], v117, s[4:7], s42 offen offset:2048 sc1
    buffer_load_dwordx4 v[12:15], v117, s[4:7], s42 offen offset:3072 sc1
    buffer_load_dwordx4 v[16:19], v117, s[4:7], s43 offen offset:0 sc1
    buffer_load_dwordx4 v[20:23], v117, s[4:7], s43 offen offset:1024 sc1
    buffer_load_dwordx4 v[24:27], v117, s[4:7], s43 offen offset:2048 sc1
    buffer_load_dwordx4 v[28:31], v117, s[4:7], s43 offen offset:3072 sc1
    s_add_u32 s54, s54, 0x10000
    s_sub_u32 s48, s48, 1
    s_cbranch_scc1 C0_bail
    s_waitcnt vmcnt(8)
    v_bitop3_b32 v106, s46, v1, v3 bitop3:0x7e
    v_mfma_f32_16x16x32_bf16 v[80:83], v[0:3], v[96:99], 0
    v_bitop3_b32 v114, s46, v5, v7 bitop3:0x7e
    v_or_b32 v106, v106, v114
    v_mfma_f32_16x16x32_bf16 v[80:83], v[4:7], v[96:99], v[80:83]
    v_bitop3_b32 v114, s46, v9, v11 bitop3:0x7e
    v_or_b32 v106, v106, v114
    v_mfma_f32_16x16x32_bf16 v[80:83], v[8:11], v[100:103], v[80:83]
    v_bitop3_b32 v114, s46, v13, v15 bitop3:0x7e
    v_or_b32 v106, v106, v114
    v_mfma_f32_16x16x32_bf16 v[80:83], v[12:15], v[100:103], v[80:83]
    v_bitop3_b32 v114, s46, v17, v19 bitop3:0x7e
    v_or_b32 v106, v106, v114
    v_mfma_f32_16x16x32_bf16 v[84:87], v[16:19], v[96:99], 0
    v_bitop3_b32 v114, s46, v21, v23 bitop3:0x7e
    v_or_b32 v106, v106, v114
    v_mfma_f32_16x16x32_bf16 v[84:87], v[20:23], v[96:99], v[84:87]
    v_bitop3_b32 v114, s46, v25, v27 bitop3:0x7e
    v_or_b32 v106, v106, v114
    v_mfma_f32_16x16x32_bf16 v[84:87], v[24:27], v[100:103], v[84:87]
    v_bitop3_b32 v114, s46, v29, v31 bitop3:0x7e
    v_bitop3_b32 v106, v106, v114, 1 bitop3:0xa8
    v_mfma_f32_16x16x32_bf16 v[84:87], v[28:31], v[100:103], v[84:87]
    v_cmp_ne_u32 vcc, 0, v106
    v_permlane32_swap_b32 v80, v81
    v_permlane32_swap_b32 v82, v83
    v_add_f32 v80, v80, v81
    v_add_f32 v82, v82, v83
    s_cbranch_vccnz C0_ra
    s_branch C0_q1
C0_slow:
    v_max3_f32 v106, v80, v81, v84
    v_max_f32 v106, v106, v85
    v_mov_b32 v107, v106
    s_nop 1
    v_permlane32_swap_b32 v107, v106
    v_max_f32 v106, v106, v107
    v_mov_b32 v107, v106
    s_nop 1
    v_permlane16_swap_b32 v107, v106
    v_max_f32 v106, v106, v107
    ds_write_b32 v117, v106 offset:0
    s_waitcnt lgkmcnt(0)
    s_barrier
    ds_read_b128 v[96:99], v117 offset:0
    s_waitcnt lgkmcnt(0)
    v_max3_f32 v106, v96, v97, v98
    v_max_f32 v106, v106, v99
    v_sub_f32 v82, v80, v106
    v_exp_f32 v82, v82
    v_sub_f32 v83, v81, v106
    v_exp_f32 v83, v83
    v_sub_f32 v86, v84, v106
    v_exp_f32 v86, v86
    v_sub_f32 v87, v85, v106
    v_exp_f32 v87, v87
    v_cvt_pk_bf16_f32 v82, v82, v83
    s_mov_b64 exec, s[50:51]
    ds_write_b32 v113, v82 offset:14336
    s_mov_b64 exec, -1
    s_waitcnt lgkmcnt(0)
    s_barrier
    ds_read_b128 v[88:91], v117 offset:14336
    ds_read_b128 v[92:95], v125 offset:14336
    s_waitcnt lgkmcnt(0)
    v_mfma_f32_16x16x32_bf16 v[68:71], v[72:75], v[88:91], 0
    v_mfma_f32_16x16x32_bf16 v[64:67], v[48:51], v[88:91], 0
    v_mfma_f32_16x16x32_bf16 v[64:67], v[52:55], v[92:95], v[64:67]
    s_mov_b64 exec, s[50:51]
    v_cvt_pk_bf16_f32 v104, v86, v87
    s_mov_b64 exec, -1
    s_nop 0
    v_mfma_f32_16x16x16_bf16 v[68:71], v[72:73], v[104:105], v[68:71]
    v_mov_b32_dpp v105, v104 row_ror:8 row_mask:0xf bank_mask:0xf
    s_nop 1
    v_mfma_f32_16x16x16_bf16 v[64:67], v[110:111], v[104:105], v[64:67]
    s_nop 1
    s_nop 1
    v_rcp_f32 v106, v68
    v_subrev_u32 v107, s60, v68
    v_cmp_lt_u32 vcc, s61, v107
    v_mov_b32_dpp v106, v106 row_ror:8 row_mask:0xf bank_mask:0xc
    v_mul_f32 v64, v106, v64
    v_mul_f32 v65, v106, v65
    v_mul_f32 v66, v106, v66
    v_mul_f32 v67, v106, v67
    v_cvt_pk_bf16_f32 v96, v64, v65
    v_cvt_pk_bf16_f32 v97, v66, v67
    ds_write_b64 v126, v[96:97] offset:12288
    s_branch C0_back
C0_fin:
    v_add_f32 v96, v96, v98
    v_add_f32 v97, v97, v99
    v_add_f32 v100, v100, v102
    v_add_f32 v101, v101, v103
    v_cvt_pk_bf16_f32 v110, v96, v97
    v_cvt_pk_bf16_f32 v111, v100, v101
    s_add_u32 s39, s39, 131072
    buffer_store_dwordx4 v[108:111], v117, s[4:7], s39 offen sc1
    s_endpgm
D0_step:
    s_waitcnt vmcnt(3)
    s_waitcnt lgkmcnt(0)
    v_max3_u32 v106, v0, v1, v2
    v_max_u32 v106, v106, v3
    v_smfmac_f32_16x16x64_bf16 v[80:83], v[0:3], v[64:71], v116
    ds_write_b128 v117, v[0:3] offset:0
    v_smfmac_f32_16x16x64_bf16 v[84:87], v[0:3], v[72:79], v116
    s_waitcnt vmcnt(2)
    v_max3_u32 v106, v106, v4, v5
    v_max3_u32 v106, v106, v6, v7
    v_cmp_eq_u32 vcc, -1, v106
    v_smfmac_f32_16x16x64_bf16 v[88:91], v[0:3], v[16:23], v116
    ds_write_b128 v117, v[4:7] offset:1024
    v_smfmac_f32_16x16x64_bf16 v[92:95], v[0:3], v[24:31], v116
    s_cbranch_vccnz D0_re2
    ds_read_b128 v[64:67], v118 offset:12288
    v_smfmac_f32_16x16x64_bf16 v[96:99], v[0:3], v[32:39], v116
    ds_read_b128 v[68:71], v118 offset:13312
    buffer_load_dwordx4 v[136:139], v124, s[4:7], s38 offen sc1
    v_smfmac_f32_16x16x64_bf16 v[100:103], v[0:3], v[40:47], v116
    ds_read_b128 v[72:75], v118 offset:14336
    v_smfmac_f32_16x16x64_bf16 v[80:83], v[4:7], a[0:7], v116
    ds_read_b128 v[76:79], v118 offset:15360
    buffer_load_dwordx4 v[128:131], v117, s[4:7], s97 offen sc1
    v_smfmac_f32_16x16x64_bf16 v[84:87], v[4:7], a[8:15], v116
    s_waitcnt lgkmcnt(4)
    s_barrier
    ds_read_b128 v[8:11], v117 offset:2048
    v_smfmac_f32_16x16x64_bf16 v[88:91], v[4:7], a[80:87], v116
    s_and_b32 s19, s18, 1
    ds_read_b128 v[12:15], v117 offset:3072
    buffer_load_dwordx4 v[140:143], v124, s[4:7], s38 offen offset:2048 sc1
    v_smfmac_f32_16x16x64_bf16 v[92:95], v[4:7], a[88:95], v116
    s_lshl_b32 s19, s19, 18
    s_add_u32 s40, s19, s34
    ds_read_b128 v[16:19], v117 offset:4096
    v_smfmac_f32_16x16x64_bf16 v[96:99], v[4:7], a[160:167], v116
    s_add_u32 s40, s40, 58720256
    ds_read_b128 v[20:23], v117 offset:5120
    buffer_load_dwordx4 v[132:135], v117, s[4:7], s97 offen offset:1024 sc1
    v_smfmac_f32_16x16x64_bf16 v[100:103], v[4:7], a[168:175], v116
    s_waitcnt lgkmcnt(3)
    s_add_u32 s41, s40, 4096
    ds_read_b128 v[24:27], v117 offset:6144
    v_smfmac_f32_16x16x64_bf16 v[80:83], v[8:11], a[16:23], v116
    s_lshl_b32 s42, s16, 13
    s_add_u32 s42, s42, s19
    ds_read_b128 v[28:31], v117 offset:7168
    v_smfmac_f32_16x16x64_bf16 v[84:87], v[8:11], a[24:31], v116
    s_waitcnt lgkmcnt(4)
    s_add_u32 s42, s42, 58720256
    ds_read_b128 v[32:35], v118 offset:16384
    v_smfmac_f32_16x16x64_bf16 v[80:83], v[12:15], a[32:39], v116
    s_bfe_u32 s46, s18, 0x10001
    ds_read_b128 v[36:39], v118 offset:17408
    buffer_store_dwordx4 v[108:111], v117, s[4:7], s39 offen sc1
    v_smfmac_f32_16x16x64_bf16 v[84:87], v[12:15], a[40:47], v116
    s_waitcnt lgkmcnt(2)
    s_add_u32 s43, s42, 4096
    ds_read_b128 v[40:43], v118 offset:18432
    v_smfmac_f32_16x16x64_bf16 v[80:83], v[16:19], v[64:71], v116
    s_waitcnt lgkmcnt(9)
    s_add_u32 s19, s18, 1
    ds_read_b128 v[44:47], v118 offset:19456
    v_smfmac_f32_16x16x64_bf16 v[84:87], v[16:19], v[72:79], v116
    s_and_b32 s19, s19, 3
    s_lshl_b32 s19, s19, 13
    ds_read_b128 v[64:67], v118 offset:20480
    v_smfmac_f32_16x16x64_bf16 v[80:83], v[20:23], a[48:55], v116
    s_add_u32 s45, s19, 59768832
    s_add_u32 s44, s45, s35
    ds_read_b128 v[68:71], v118 offset:21504
    v_smfmac_f32_16x16x64_bf16 v[84:87], v[20:23], a[56:63], v116
    ds_read_b128 v[72:75], v118 offset:22528
    v_smfmac_f32_16x16x64_bf16 v[80:83], v[24:27], a[64:71], v116
    ds_read_b128 v[76:79], v118 offset:23552
    v_smfmac_f32_16x16x64_bf16 v[84:87], v[24:27], a[72:79], v116
    s_waitcnt lgkmcnt(4)
    v_smfmac_f32_16x16x64_bf16 v[80:83], v[28:31], v[32:39], v116
    s_nop 1
    v_smfmac_f32_16x16x64_bf16 v[84:87], v[28:31], v[40:47], v116
    s_nop 0
    ds_read_b128 v[32:35], v118 offset:24576
    v_smfmac_f32_16x16x64_bf16 v[88:91], v[8:11], a[96:103], v116
    s_nop 0
    ds_read_b128 v[36:39], v118 offset:25600
    v_add_f32 v80, v80, v82
    v_smfmac_f32_16x16x64_bf16 v[92:95], v[8:11], a[104:111], v116
    ds_read_b128 v[40:43], v118 offset:26624
    v_add_f32 v81, v81, v83
    v_add_f32 v84, v84, v86
    v_smfmac_f32_16x16x64_bf16 v[88:91], v[12:15], a[112:119], v116
    ds_read_b128 v[44:47], v118 offset:27648
    v_add_f32 v85, v85, v87
    v_cvt_pk_bf16_f32 v80, v80, v84
    v_smfmac_f32_16x16x64_bf16 v[92:95], v[12:15], a[120:127], v116
    s_waitcnt lgkmcnt(4)
    v_cvt_pk_bf16_f32 v81, v81, v85
    v_smfmac_f32_16x16x64_bf16 v[88:91], v[16:19], v[64:71], v116
    ds_write2_b32 v119, v80, v81 offset0:0 offset1:16
    v_smfmac_f32_16x16x64_bf16 v[92:95], v[16:19], v[72:79], v116
    v_smfmac_f32_16x16x64_bf16 v[88:91], v[20:23], a[128:135], v116
    v_smfmac_f32_16x16x64_bf16 v[92:95], v[20:23], a[136:143], v116
    v_smfmac_f32_16x16x64_bf16 v[88:91], v[24:27], a[144:151], v116
    s_waitcnt vmcnt(5) lgkmcnt(0)
    s_barrier
    ds_read_b128 v[0:3], v120 offset:0
    v_smfmac_f32_16x16x64_bf16 v[92:95], v[24:27], a[152:159], v116
    s_waitcnt lgkmcnt(2)
    ds_read_b128 v[4:7], v120 offset:2048
    v_smfmac_f32_16x16x64_bf16 v[88:91], v[28:31], v[32:39], v116
    s_nop 0
    ds_read_b128 v[72:75], v127 offset:15616
    v_smfmac_f32_16x16x64_bf16 v[92:95], v[28:31], v[40:47], v116
    s_nop 2
    v_smfmac_f32_16x16x64_bf16 v[96:99], v[8:11], a[176:183], v116
    s_waitcnt lgkmcnt(2)
    v_add_f32 v88, v88, v90
    v_mfma_f32_16x16x32_bf16 v[80:83], v[56:59], v[0:3], 0
    s_waitcnt lgkmcnt(1)
    v_add_f32 v89, v89, v91
    v_add_f32 v92, v92, v94
    v_mfma_f32_16x16x32_bf16 v[80:83], v[60:63], v[4:7], v[80:83]
    s_nop 0
    v_add_f32 v93, v93, v95
    v_cvt_pk_bf16_f32 v108, v88, v92
    v_smfmac_f32_16x16x64_bf16 v[100:103], v[8:11], a[184:191], v116
    s_nop 1
    v_cvt_pk_bf16_f32 v109, v89, v93
    ds_write2_b32 v119, v108, v109 offset0:128 offset1:144
    v_smfmac_f32_16x16x64_bf16 v[96:99], v[12:15], a[192:199], v116
    v_add_f32_dpp v80, v82, v80 row_ror:8 row_mask:0xf bank_mask:0xf
    v_add_f32_dpp v81, v83, v81 row_ror:8 row_mask:0xf bank_mask:0xf
    v_smfmac_f32_16x16x64_bf16 v[100:103], v[12:15], a[200:207], v116
    v_exp_f32 v82, v80
    v_smfmac_f32_16x16x64_bf16 v[96:99], v[16:19], a[208:215], v116
    v_exp_f32 v83, v81
    v_smfmac_f32_16x16x64_bf16 v[100:103], v[16:19], a[216:223], v116
    s_waitcnt lgkmcnt(0)
    s_barrier
    ds_read_b128 v[8:11], v121 offset:0
    v_cvt_pk_bf16_f32 v82, v82, v83
    s_mov_b64 exec, s[50:51]
    ds_write_b32 v113, v82 offset:14336
    s_mov_b64 exec, -1
    v_smfmac_f32_16x16x64_bf16 v[96:99], v[20:23], a[224:231], v116
    ds_read_b128 v[12:15], v121 offset:2048
    v_smfmac_f32_16x16x64_bf16 v[100:103], v[20:23], a[232:239], v116
    v_smfmac_f32_16x16x64_bf16 v[96:99], v[24:27], a[240:247], v116
    v_smfmac_f32_16x16x64_bf16 v[100:103], v[24:27], a[248:255], v116
    s_waitcnt lgkmcnt(2)
    s_waitcnt lgkmcnt(1)
    s_barrier
    ds_read_b128 v[88:91], v117 offset:14336
    v_mfma_f32_16x16x32_bf16 v[84:87], v[8:11], v[0:3], 0
    s_waitcnt lgkmcnt(1)
    ds_read_b128 v[92:95], v125 offset:14336
    v_mfma_f32_16x16x32_bf16 v[84:87], v[12:15], v[4:7], v[84:87]
    s_nop 1
    v_smfmac_f32_16x16x64_bf16 v[96:99], v[28:31], v[144:151], v116
    s_nop 1
    v_smfmac_f32_16x16x64_bf16 v[100:103], v[28:31], v[152:159], v116
    s_cmp_eq_u32 s18, 63
    s_waitcnt lgkmcnt(1)
    v_add_f32_dpp v84, v86, v84 row_ror:8 row_mask:0xf bank_mask:0xf
    v_add_f32_dpp v85, v87, v85 row_ror:8 row_mask:0xf bank_mask:0xf
    v_mfma_f32_16x16x32_bf16 v[68:71], v[72:75], v[88:91], 0
    s_cbranch_scc1 D0_fin
    v_mul_f32 v84, s49, v84
    v_mul_f32 v85, s49, v85
    v_mfma_f32_16x16x32_bf16 v[64:67], v[48:51], v[88:91], 0
    s_waitcnt lgkmcnt(0)
    v_exp_f32 v86, v84
    v_add_f32 v96, v96, v98
    v_mfma_f32_16x16x32_bf16 v[64:67], v[52:55], v[92:95], v[64:67]
    v_exp_f32 v87, v85
    v_add_f32 v97, v97, v99
    v_add_f32 v100, v100, v102
    s_mov_b64 exec, s[50:51]
    v_cvt_pk_bf16_f32 v104, v86, v87
    s_mov_b64 exec, -1
    v_add_f32 v101, v101, v103
    v_mfma_f32_16x16x16_bf16 v[68:71], v[72:73], v[104:105], v[68:71]
    v_mov_b32_dpp v105, v104 row_ror:8 row_mask:0xf bank_mask:0xf
    v_cvt_pk_bf16_f32 v110, v96, v97
    v_cvt_pk_bf16_f32 v111, v100, v101
    s_nop 1
    v_mfma_f32_16x16x16_bf16 v[64:67], v[110:111], v[104:105], v[64:67]
    s_nop 1
    v_rcp_f32 v106, v68
    v_subrev_u32 v107, s60, v68
    v_cmp_lt_u32 vcc, s61, v107
    v_mov_b32_dpp v106, v106 row_ror:8 row_mask:0xf bank_mask:0xc
    s_nop 1
    v_mul_f32 v64, v106, v64
    v_mul_f32 v65, v106, v65
    v_mul_f32 v66, v106, v66
    v_mul_f32 v67, v106, v67
    v_cvt_pk_bf16_f32 v96, v64, v65
    v_cvt_pk_bf16_f32 v97, v66, v67
    ds_write_b64 v126, v[96:97] offset:12288
    v_mfma_f32_16x16x1_4b_f32 v[32:47], v127, v127, 0
    s_and_b64 vcc, vcc, s[50:51]
    s_cbranch_scc1 D0_slow
D0_back:
    v_mov_b32 v107, 0
    v_mov_b32 v107, 0
    v_mov_b32 v107, 0
    s_waitcnt lgkmcnt(0)
    s_barrier
    ds_read_b128 v[80:83], v117 offset:12288
    ds_read_b128 v[84:87], v117 offset:13312
    v_mfma_f32_16x16x1_4b_f32 v[48:63], v127, v127, 0
    v_mov_b32 v107, 0
    s_waitcnt lgkmcnt(1)
    v_smfmac_f32_16x16x64_bf16 v[32:35], v[80:83], v[160:167], v116
    s_waitcnt lgkmcnt(0)
    ds_read_b128 v[0:3], v118 offset:28672
    v_smfmac_f32_16x16x64_bf16 v[32:35], v[84:87], v[192:199], v116
    s_lshl_b32 s39, s18, 5
    ds_read_b128 v[4:7], v118 offset:29696
    v_smfmac_f32_16x16x64_bf16 v[36:39], v[80:83], v[168:175], v116
    s_add_u32 s39, s39, s16
    ds_read_b128 v[8:11], v118 offset:30720
    v_smfmac_f32_16x16x64_bf16 v[36:39], v[84:87], v[200:207], v116
    s_lshl_b32 s39, s39, 12
    ds_read_b128 v[12:15], v118 offset:31744
    v_add_f32 v32, v32, v34
    v_smfmac_f32_16x16x64_bf16 v[40:43], v[80:83], v[176:183], v116
    s_add_u32 s39, s39, 50331648
    ds_read_b128 v[16:19], v118 offset:32768
    v_add_f32 v33, v33, v35
    v_cvt_pk_bf16_f32 v88, v32, v33
    v_smfmac_f32_16x16x64_bf16 v[40:43], v[84:87], v[208:215], v116
    s_cmp_lt_u32 s18, 62
    ds_read_b128 v[20:23], v118 offset:33792
    v_add_f32 v36, v36, v38
    v_smfmac_f32_16x16x64_bf16 v[44:47], v[80:83], v[184:191], v116
    s_cselect_b32 s19, 524288, 0
    ds_read_b128 v[24:27], v118 offset:34816
    v_add_f32 v37, v37, v39
    v_cvt_pk_bf16_f32 v89, v36, v37
    v_and_or_b32 v89, v89, -2, s46
    v_smfmac_f32_16x16x64_bf16 v[44:47], v[84:87], v[216:223], v116
    s_add_u32 s38, s38, s19
    ds_read_b128 v[28:31], v118 offset:35840
    buffer_store_dwordx2 v[88:89], v122, s[4:7], s40 offen offset:0 sc1
    v_add_f32 v40, v40, v42
    v_smfmac_f32_16x16x64_bf16 v[48:51], v[80:83], v[224:231], v116
    s_waitcnt lgkmcnt(6)
    ds_read_b128 v[64:67], v118 offset:0
    v_add_f32 v41, v41, v43
    v_cvt_pk_bf16_f32 v90, v40, v41
    v_smfmac_f32_16x16x64_bf16 v[48:51], v[84:87], v[0:7], v116
    s_add_u32 s97, s97, s19
    ds_read_b128 v[68:71], v118 offset:1024
    v_add_f32 v44, v44, v46
    v_smfmac_f32_16x16x64_bf16 v[52:55], v[80:83], v[232:239], v116
    s_waitcnt lgkmcnt(6)
    ds_read_b128 v[72:75], v118 offset:2048
    v_add_f32 v45, v45, v47
    v_cvt_pk_bf16_f32 v91, v44, v45
    v_and_or_b32 v91, v91, -2, s46
    v_smfmac_f32_16x16x64_bf16 v[52:55], v[84:87], v[8:15], v116
    s_nop 0
    buffer_store_dwordx2 v[90:91], v122, s[4:7], s40 offen offset:2048 sc1
    v_add_f32 v48, v48, v50
    v_smfmac_f32_16x16x64_bf16 v[56:59], v[80:83], v[240:247], v116
    s_waitcnt lgkmcnt(3)
    ds_read_b128 v[76:79], v118 offset:3072
    v_add_f32 v49, v49, v51
    v_cvt_pk_bf16_f32 v92, v48, v49
    v_smfmac_f32_16x16x64_bf16 v[56:59], v[84:87], v[16:23], v116
    s_nop 0
    v_add_f32 v52, v52, v54
    v_smfmac_f32_16x16x64_bf16 v[60:63], v[80:83], v[248:255], v116
    s_nop 0
    v_add_f32 v53, v53, v55
    v_cvt_pk_bf16_f32 v93, v52, v53
    v_and_or_b32 v93, v93, -2, s46
    v_smfmac_f32_16x16x64_bf16 v[60:63], v[84:87], v[24:31], v116
    buffer_store_dwordx2 v[92:93], v122, s[4:7], s41 offen offset:0 sc1
    v_add_f32 v56, v56, v58
    v_add_f32 v57, v57, v59
    v_cvt_pk_bf16_f32 v94, v56, v57
    s_nop 3
    v_add_f32 v60, v60, v62
    v_add_f32 v61, v61, v63
    v_cvt_pk_bf16_f32 v95, v60, v61
    v_and_or_b32 v95, v95, -2, s46
    buffer_store_dwordx2 v[94:95], v122, s[4:7], s41 offen offset:2048 sc1
    v_and_b32 v106, 0xf0, v117
    v_and_b32 v107, 0xf0, v125
    ds_read_b128 v[96:99], v106 offset:15360
    v_mov_b32 v88, 0
    ds_read_b128 v[100:103], v107 offset:15360
    v_mov_b32 v89, 0
    ds_read_b128 v[32:35], v118 offset:8192
    v_mov_b32 v90, 0
    ds_read_b128 v[36:39], v118 offset:9216
    v_mov_b32 v91, 0
    ds_read_b128 v[40:43], v118 offset:10240
    v_mov_b32 v92, 0
    ds_read_b128 v[44:47], v118 offset:11264
    v_mov_b32 v93, 0
    v_mov_b32 v94, 0
    v_mov_b32 v95, 0
    v_mov_b32 v107, 0
    s_nop 2
    v_mov_b32 v107, 0
    s_nop 2
    v_mov_b32 v107, 0
    s_nop 2
    buffer_load_dwordx4 v[0:3], v117, s[4:7], s42 offen offset:0 sc1
    buffer_load_dwordx4 v[4:7], v117, s[4:7], s42 offen offset:1024 sc1
    buffer_load_dwordx4 v[8:11], v117, s[4:7], s42 offen offset:2048 sc1
    buffer_load_dwordx4 v[12:15], v117, s[4:7], s42 offen offset:3072 sc1
    buffer_load_dwordx4 v[16:19], v117, s[4:7], s43 offen offset:0 sc1
    buffer_load_dwordx4 v[20:23], v117, s[4:7], s43 offen offset:1024 sc1
    buffer_load_dwordx4 v[24:27], v117, s[4:7], s43 offen offset:2048 sc1
    buffer_load_dwordx4 v[28:31], v117, s[4:7], s43 offen offset:3072 sc1
    buffer_load_dwordx4 v[16:19], v117, s[4:7], s43 offen offset:0 sc1
    buffer_load_dwordx4 v[20:23], v117, s[4:7], s43 offen offset:1024 sc1
    buffer_load_dwordx4 v[24:27], v117, s[4:7], s43 offen offset:2048 sc1
    buffer_load_dwordx4 v[28:31], v117, s[4:7], s43 offen offset:3072 sc1
    buffer_load_dwordx4 v[0:3], v117, s[4:7], s42 offen offset:0 sc1
    buffer_load_dwordx4 v[4:7], v117, s[4:7], s42 offen offset:1024 sc1
    buffer_load_dwordx4 v[8:11], v117, s[4:7], s42 offen offset:2048 sc1
    buffer_load_dwordx4 v[12:15], v117, s[4:7], s42 offen offset:3072 sc1
    s_waitcnt lgkmcnt(0)
    s_waitcnt vmcnt(15)
    v_bitop3_b32 v107, s46, v1, v3 bitop3:0x7e
    v_mfma_f32_16x16x32_bf16 v[80:83], v[0:3], v[96:99], 0
    s_waitcnt vmcnt(14)
    v_bitop3_b32 v114, s46, v5, v7 bitop3:0x7e
    v_or_b32 v107, v107, v114
    v_mfma_f32_16x16x32_bf16 v[80:83], v[4:7], v[96:99], v[80:83]
    s_waitcnt vmcnt(13)
    v_bitop3_b32 v114, s46, v9, v11 bitop3:0x7e
    v_or_b32 v107, v107, v114
    v_mfma_f32_16x16x32_bf16 v[80:83], v[8:11], v[100:103], v[80:83]
    s_waitcnt vmcnt(12)
    v_bitop3_b32 v114, s46, v13, v15 bitop3:0x7e
    v_bitop3_b32 v107, v107, v114, 1 bitop3:0xa8
    v_mfma_f32_16x16x32_bf16 v[80:83], v[12:15], v[100:103], v[80:83]
    v_cmp_ne_u32 vcc, 0, v107
    s_waitcnt vmcnt(11)
    v_bitop3_b32 v106, s46, v17, v19 bitop3:0x7e
    v_mfma_f32_16x16x32_bf16 v[84:87], v[16:19], v[96:99], 0
    s_waitcnt vmcnt(10)
    v_bitop3_b32 v114, s46, v21, v23 bitop3:0x7e
    v_or_b32 v106, v106, v114
    v_mfma_f32_16x16x32_bf16 v[84:87], v[20:23], v[96:99], v[84:87]
    s_cbranch_vccnz D0_ra
    s_waitcnt vmcnt(9)
    v_bitop3_b32 v114, s46, v25, v27 bitop3:0x7e
    v_or_b32 v106, v106, v114
    v_mfma_f32_16x16x32_bf16 v[84:87], v[24:27], v[100:103], v[84:87]
    s_waitcnt vmcnt(8)
    v_bitop3_b32 v114, s46, v29, v31 bitop3:0x7e
    v_bitop3_b32 v106, v106, v114, 1 bitop3:0xa8
    v_mfma_f32_16x16x32_bf16 v[84:87], v[28:31], v[100:103], v[84:87]
    v_cmp_ne_u32 vcc, 0, v106
    v_permlane32_swap_b32 v80, v81
    v_permlane32_swap_b32 v82, v83
    v_add_f32 v80, v80, v81
    v_add_f32 v82, v82, v83
    s_cbranch_vccnz D0_rb
D0_q1:
    s_nop 0
    v_permlane16_swap_b32 v80, v82
    v_permlane32_swap_b32 v84, v85
    v_permlane32_swap_b32 v86, v87
    v_add_f32 v84, v84, v85
    v_add_f32 v86, v86, v87
    v_add_f32 v80, v80, v82
    s_nop 0
    v_permlane16_swap_b32 v84, v86
    v_add_f32 v84, v84, v86
    v_cvt_pk_bf16_f32 v106, v80, v84
    buffer_store_dword v106, v123, s[4:7], s44 offen sc1
    v_mov_b32 v96, 0
    v_mov_b32 v97, 0
    v_mov_b32 v98, 0
    v_mov_b32 v99, 0
    v_mov_b32 v100, 0
    v_mov_b32 v101, 0
    v_mov_b32 v102, 0
    v_mov_b32 v103, 0
    v_mov_b32 v80, 0
    v_mov_b32 v81, 0
    v_mov_b32 v82, 0
    v_mov_b32 v83, 0
    v_mov_b32 v84, 0
    v_mov_b32 v85, 0
    v_mov_b32 v86, 0
    v_mov_b32 v87, 0
    v_mov_b32 v48, v128
    v_mov_b32 v49, v129
    v_mov_b32 v50, v130
    v_mov_b32 v51, v131
    v_mov_b32 v52, v132
    v_mov_b32 v53, v133
    v_mov_b32 v54, v134
    v_mov_b32 v55, v135
    v_mov_b32 v56, v136
    v_mov_b32 v57, v137
    v_mov_b32 v58, v138
    v_mov_b32 v59, v139
    v_mov_b32 v60, v140
    v_mov_b32 v61, v141
    v_mov_b32 v62, v142
    v_mov_b32 v63, v143
    v_mov_b32 v107, 0
    s_nop 2
    v_mov_b32 v107, 0
    s_nop 2
    s_barrier
    buffer_load_dwordx4 v[0:3], v117, s[4:7], s45 offen offset:0 sc1
    v_mov_b32 v107, 0
    s_add_u32 s18, s18, 1
    buffer_load_dwordx4 v[4:7], v117, s[4:7], s45 offen offset:1024 sc1
    v_mov_b32 v107, 0
    s_waitcnt vmcnt(3)
    v_mov_b32 v107, 0
    ds_read_b128 v[16:19], v118 offset:4096
    v_mov_b32 v107, 0
    ds_read_b128 v[20:23], v118 offset:5120
    v_mov_b32 v107, 0
    ds_read_b128 v[24:27], v118 offset:6144
    v_mov_b32 v107, 0
    ds_read_b128 v[28:31], v118 offset:7168
    v_mov_b32 v107, 0
    s_nop 2
    v_mov_b32 v107, 0
    s_nop 2
    v_mov_b32 v107, 0
    s_nop 2
    v_mov_b32 v107, 0
    s_nop 2
    v_mov_b32 v107, 0
    s_nop 2
    buffer_load_dwordx4 v[0:3], v117, s[4:7], s45 offen offset:0 sc1
    buffer_load_dwordx4 v[4:7], v117, s[4:7], s45 offen offset:1024 sc1
    v_mov_b32 v107, 0
    s_nop 2
    v_mov_b32 v107, 0
    s_nop 2
    v_mov_b32 v107, 0
    s_nop 2
    v_mov_b32 v107, 0
    s_nop 2
    s_branch D0_step
D0_re2:
    buffer_load_dwordx4 v[0:3], v117, s[4:7], s45 offen offset:0 sc1
    buffer_load_dwordx4 v[4:7], v117, s[4:7], s45 offen offset:1024 sc1
    s_add_u32 s55, s55, 1
    s_sub_u32 s48, s48, 1
    s_nop 0
    v_mfma_f32_16x16x1_4b_f32 v[80:95], v127, v127, 0
    s_cbranch_scc0 D0_step
D0_bail:
    s_endpgm
D0_rb:
    s_waitcnt vmcnt(7)
    v_bitop3_b32 v106, s46, v17, v19 bitop3:0x7e
    v_mfma_f32_16x16x32_bf16 v[84:87], v[16:19], v[96:99], 0
    s_waitcnt vmcnt(6)
    v_bitop3_b32 v114, s46, v21, v23 bitop3:0x7e
    v_or_b32 v106, v106, v114
    v_mfma_f32_16x16x32_bf16 v[84:87], v[20:23], v[96:99], v[84:87]
    s_waitcnt vmcnt(5)
    v_bitop3_b32 v114, s46, v25, v27 bitop3:0x7e
    v_or_b32 v106, v106, v114
    v_mfma_f32_16x16x32_bf16 v[84:87], v[24:27], v[100:103], v[84:87]
    s_waitcnt vmcnt(4)
    v_bitop3_b32 v114, s46, v29, v31 bitop3:0x7e
    v_bitop3_b32 v106, v106, v114, 1 bitop3:0xa8
    v_mfma_f32_16x16x32_bf16 v[84:87], v[28:31], v[100:103], v[84:87]
    v_cmp_ne_u32 vcc, 0, v106
    s_add_u32 s54, s54, 1
    s_nop 3
    s_cbranch_vccz D0_q1
D0_ra:
    buffer_load_dwordx4 v[0:3], v117, s[4:7], s42 offen offset:0 sc1
    buffer_load_dwordx4 v[4:7], v117, s[4:7], s42 offen offset:1024 sc1
    buffer_load_dwordx4 v[8:11], v117, s[4:7], s42 offen offset:2048 sc1
    buffer_load_dwordx4 v[12:15], v117, s[4:7], s42 offen offset:3072 sc1
    buffer_load_dwordx4 v[16:19], v117, s[4:7], s43 offen offset:0 sc1
    buffer_load_dwordx4 v[20:23], v117, s[4:7], s43 offen offset:1024 sc1
    buffer_load_dwordx4 v[24:27], v117, s[4:7], s43 offen offset:2048 sc1
    buffer_load_dwordx4 v[28:31], v117, s[4:7], s43 offen offset:3072 sc1
    s_add_u32 s54, s54, 0x10000
    s_sub_u32 s48, s48, 1
    s_cbranch_scc1 D0_bail
    s_waitcnt vmcnt(8)
    v_bitop3_b32 v106, s46, v1, v3 bitop3:0x7e
    v_mfma_f32_16x16x32_bf16 v[80:83], v[0:3], v[96:99], 0
    v_bitop3_b32 v114, s46, v5, v7 bitop3:0x7e
    v_or_b32 v106, v106, v114
    v_mfma_f32_16x16x32_bf16 v[80:83], v[4:7], v[96:99], v[80:83]
    v_bitop3_b32 v114, s46, v9, v11 bitop3:0x7e
    v_or_b32 v106, v106, v114
    v_mfma_f32_16x16x32_bf16 v[80:83], v[8:11], v[100:103], v[80:83]
    v_bitop3_b32 v114, s46, v13, v15 bitop3:0x7e
    v_or_b32 v106, v106, v114
    v_mfma_f32_16x16x32_bf16 v[80:83], v[12:15], v[100:103], v[80:83]
    v_bitop3_b32 v114, s46, v17, v19 bitop3:0x7e
    v_or_b32 v106, v106, v114
    v_mfma_f32_16x16x32_bf16 v[84:87], v[16:19], v[96:99], 0
    v_bitop3_b32 v114, s46, v21, v23 bitop3:0x7e
    v_or_b32 v106, v106, v114
    v_mfma_f32_16x16x32_bf16 v[84:87], v[20:23], v[96:99], v[84:87]
    v_bitop3_b32 v114, s46, v25, v27 bitop3:0x7e
    v_or_b32 v106, v106, v114
    v_mfma_f32_16x16x32_bf16 v[84:87], v[24:27], v[100:103], v[84:87]
    v_bitop3_b32 v114, s46, v29, v31 bitop3:0x7e
    v_bitop3_b32 v106, v106, v114, 1 bitop3:0xa8
    v_mfma_f32_16x16x32_bf16 v[84:87], v[28:31], v[100:103], v[84:87]
    v_cmp_ne_u32 vcc, 0, v106
    v_permlane32_swap_b32 v80, v81
    v_permlane32_swap_b32 v82, v83
    v_add_f32 v80, v80, v81
    v_add_f32 v82, v82, v83
    s_cbranch_vccnz D0_ra
    s_branch D0_q1
D0_slow:
    v_max3_f32 v106, v80, v81, v84
    v_max_f32 v106, v106, v85
    v_mov_b32 v107, v106
    s_nop 1
    v_permlane32_swap_b32 v107, v106
    v_max_f32 v106, v106, v107
    v_mov_b32 v107, v106
    s_nop 1
    v_permlane16_swap_b32 v107, v106
    v_max_f32 v106, v106, v107
    ds_write_b32 v117, v106 offset:0
    s_waitcnt lgkmcnt(0)
    s_barrier
    ds_read_b128 v[96:99], v117 offset:0
    s_waitcnt lgkmcnt(0)
    v_max3_f32 v106, v96, v97, v98
    v_max_f32 v106, v106, v99
    v_sub_f32 v82, v80, v106
    v_exp_f32 v82, v82
    v_sub_f32 v83, v81, v106
    v_exp_f32 v83, v83
    v_sub_f32 v86, v84, v106
    v_exp_f32 v86, v86
    v_sub_f32 v87, v85, v106
    v_exp_f32 v87, v87
    v_cvt_pk_bf16_f32 v82, v82, v83
    s_mov_b64 exec, s[50:51]
    ds_write_b32 v113, v82 offset:14336
    s_mov_b64 exec, -1
    s_waitcnt lgkmcnt(0)
    s_barrier
    ds_read_b128 v[88:91], v117 offset:14336
    ds_read_b128 v[92:95], v125 offset:14336
    s_waitcnt lgkmcnt(0)
    v_mfma_f32_16x16x32_bf16 v[68:71], v[72:75], v[88:91], 0
    v_mfma_f32_16x16x32_bf16 v[64:67], v[48:51], v[88:91], 0
    v_mfma_f32_16x16x32_bf16 v[64:67], v[52:55], v[92:95], v[64:67]
    s_mov_b64 exec, s[50:51]
    v_cvt_pk_bf16_f32 v104, v86, v87
    s_mov_b64 exec, -1
    s_nop 0
    v_mfma_f32_16x16x16_bf16 v[68:71], v[72:73], v[104:105], v[68:71]
    v_mov_b32_dpp v105, v104 row_ror:8 row_mask:0xf bank_mask:0xf
    s_nop 1
    v_mfma_f32_16x16x16_bf16 v[64:67], v[110:111], v[104:105], v[64:67]
    s_nop 1
    s_nop 1
    v_rcp_f32 v106, v68
    v_subrev_u32 v107, s60, v68
    v_cmp_lt_u32 vcc, s61, v107
    v_mov_b32_dpp v106, v106 row_ror:8 row_mask:0xf bank_mask:0xc
    v_mul_f32 v64, v106, v64
    v_mul_f32 v65, v106, v65
    v_mul_f32 v66, v106, v66
    v_mul_f32 v67, v106, v67
    v_cvt_pk_bf16_f32 v96, v64, v65
    v_cvt_pk_bf16_f32 v97, v66, v67
    ds_write_b64 v126, v[96:97] offset:12288
    s_branch D0_back
D0_fin:
    v_add_f32 v96, v96, v98
    v_add_f32 v97, v97, v99
    v_add_f32 v100, v100, v102
    v_add_f32 v101, v101, v103
    v_cvt_pk_bf16_f32 v110, v96, v97
    v_cvt_pk_bf16_f32 v111, v100, v101
    s_add_u32 s39, s39, 131072
    buffer_store_dwordx4 v[108:111], v117, s[4:7], s39 offen sc1
    s_endpgm
C1_entry:
    v_and_b32 v68, 63, v0
    v_lshlrev_b32 v117, 4, v68
    v_xor_b32 v125, 128, v117
    v_add_u32 v118, 53248, v117
    v_lshrrev_b32 v69, 4, v68
    v_and_b32 v70, 15, v68
    v_bfe_u32 v71, v68, 1, 1
    v_mul_u32_u24 v116, 0xaaaa, v71
    v_add_u32 v116, 0x4444, v116
    v_lshlrev_b32 v119, 2, v70
    v_xor_b32 v119, 32, v119
    v_lshl_add_u32 v119, v69, 7, v119
    v_add_u32 v119, 9216, v119
    v_lshrrev_b32 v64, 2, v70
    v_and_b32 v65, 1, v70
    v_lshl_add_u32 v66, v64, 1, v65
    v_lshlrev_b32 v67, 1, v71
    v_xor_b32 v67, v67, v69
    v_lshlrev_b32 v121, 4, v67
    v_lshl_add_u32 v121, v66, 6, v121
    v_lshl_add_u32 v121, v71, 10, v121
    v_add_u32 v121, 8704, v121
    v_lshrrev_b32 v72, 3, v70
    v_and_b32 v73, 7, v70
    v_lshlrev_b32 v67, 1, v72
    v_xor_b32 v67, v67, v69
    v_lshlrev_b32 v120, 4, v67
    v_lshl_add_u32 v120, v73, 6, v120
    v_lshl_add_u32 v120, v72, 10, v120
    v_add_u32 v120, 8192, v120
    v_lshrrev_b32 v67, 1, v73
    v_lshlrev_b32 v126, 6, v67
    v_lshl_add_u32 v126, v65, 4, v126
    v_lshl_add_u32 v126, v72, 3, v126
    v_lshl_add_u32 v126, v69, 8, v126
    v_lshrrev_b32 v67, 3, v68
    v_lshlrev_b32 v122, 13, v67
    v_lshl_add_u32 v122, v73, 3, v122
    v_lshlrev_b32 v123, 8, v69
    v_lshl_add_u32 v123, v70, 2, v123
    v_lshlrev_b32 v124, 8, v69
    v_lshl_add_u32 v124, v66, 4, v124
    v_lshl_add_u32 v124, v71, 10, v124
    v_lshlrev_b32 v106, 10, v66
    v_lshl_add_u32 v106, v71, 5, v106
    v_and_b32 v67, 1, v69
    v_lshl_add_u32 v106, v67, 3, v106
    v_lshrrev_b32 v67, 1, v69
    v_lshl_add_u32 v106, v67, 2, v106
    v_mov_b32 v104, 0
    v_mov_b32 v105, 0
    v_mov_b32 v127, 0
    v_mov_b32 v108, 0
    v_mov_b32 v109, 0
    v_mov_b32 v110, 0
    v_mov_b32 v111, 0
    v_mov_b32 v112, -1
    v_mov_b32 v113, -1
    v_mov_b32 v114, -1
    v_mov_b32 v115, -1
    s_mov_b32 s50, 0x00ff00ff
    s_mov_b32 s51, s50
    s_mov_b32 s49, 0x3e0293ee
    s_mov_b32 s60, 0x30800000
    s_mov_b32 s61, 0x1e000000
    s_mov_b32 s48, 400000
    s_mov_b32 s54, 0
    s_mov_b32 s55, 0
    s_lshl_b32 s36, s16, 8
    s_lshl_b32 s37, s16, 17
    s_lshr_b32 s52, s16, 3
    s_lshl_b32 s52, s52, 11
    s_and_b32 s19, s16, 1
    s_lshl_b32 s19, s19, 10
    s_add_u32 s52, s52, s19
    s_and_b32 s19, s16, 6
    s_lshl_b32 s19, s19, 5
    s_add_u32 s52, s52, s19
    s_lshl_b32 s19, s16, 13
    s_add_u32 s19, s19, 58724352
    buffer_store_dwordx4 v[112:115], v117, s[4:7], s19 offen offset:0 sc1
    buffer_store_dwordx4 v[112:115], v117, s[4:7], s19 offen offset:1024 sc1
    buffer_store_dwordx4 v[112:115], v117, s[4:7], s19 offen offset:2048 sc1
    buffer_store_dwordx4 v[112:115], v117, s[4:7], s19 offen offset:3072 sc1
    s_add_u32 s19, s52, 59777024
    buffer_store_dword v112, v123, s[4:7], s19 offen sc1
    s_mov_b32 s20, s74
    s_and_b32 s21, s75, 0xffff
    s_mov_b32 s22, 0x400000
    s_mov_b32 s23, 0x20000
    s_mov_b32 s24, s76
    s_and_b32 s25, s77, 0xffff
    s_mov_b32 s26, 0x400000
    s_mov_b32 s27, 0x20000
    s_mov_b32 s28, s78
    s_and_b32 s29, s79, 0xffff
    s_mov_b32 s30, 0x400000
    s_mov_b32 s31, 0x20000
    s_mov_b32 s32, s80
    s_and_b32 s33, s81, 0xffff
    s_mov_b32 s34, 0x400000
    s_mov_b32 s35, 0x20000
    v_lshrrev_b32 v80, 4, v117
    v_lshrrev_b32 v81, 4, v80
    v_and_b32 v82, 1, v81
    v_lshlrev_b32 v64, 6, v82
    v_lshrrev_b32 v82, 1, v81
    v_lshl_add_u32 v64, v82, 4, v64
    v_lshlrev_b32 v64, 13, v64
    v_add_u32 v82, 4, v81
    v_lshlrev_b32 v82, 1, v82
    v_and_b32 v83, 15, v80
    v_xor_b32 v82, v82, v83
    v_lshl_add_u32 v64, v82, 4, v64
    v_lshrrev_b32 v82, 5, v80
    v_lshlrev_b32 v65, 4, v82
    v_bfe_u32 v82, v80, 4, 1
    v_lshl_add_u32 v65, v82, 5, v65
    v_bfe_u32 v82, v80, 3, 1
    v_add_u32 v65, v82, v65
    v_lshlrev_b32 v65, 10, v65
    v_and_b32 v82, 7, v80
    v_lshl_add_u32 v65, v82, 4, v65
    v_lshrrev_b32 v81, 2, v80
    v_lshlrev_b32 v66, 7, v81
    v_bfe_u32 v82, v80, 1, 1
    v_lshl_add_u32 v66, v82, 6, v66
    v_and_b32 v82, 1, v80
    v_lshl_add_u32 v66, v82, 3, v66
    v_add_u32 v66, 53248, v66
    v_and_b32 v82, 7, v81
    v_xor_b32 v82, 2, v82
    v_lshlrev_b32 v68, 8, v81
    v_lshl_add_u32 v68, v82, 5, v68
    v_and_b32 v82, 3, v80
    v_lshl_add_u32 v68, v82, 3, v68
    v_xor_b32 v69, 32, v68
    v_add_u32 v72, 45056, v68
    v_add_u32 v73, 45056, v69
    v_add_u32 v74, 81920, v68
    v_add_u32 v75, 81920, v69
    v_add_u32 v76, 118784, v68
    v_add_u32 v77, 118784, v69
    v_add_u32 v78, 155648, v68
    v_add_u32 v79, 155648, v69
    s_mov_b32 m0, 53248
    s_add_u32 s19, s37, 256
    buffer_load_dwordx4 v65, s[32:35], s19 offen lds
    s_mov_b32 m0, 54272
    s_add_u32 s19, s37, 4352
    buffer_load_dwordx4 v65, s[32:35], s19 offen lds
    s_mov_b32 m0, 55296
    s_add_u32 s19, s37, 2304
    buffer_load_dwordx4 v65, s[32:35], s19 offen lds
    s_mov_b32 m0, 56320
    s_add_u32 s19, s37, 6400
    buffer_load_dwordx4 v65, s[32:35], s19 offen lds
    s_mov_b32 m0, 57344
    s_add_u32 s19, s37, 8448
    buffer_load_dwordx4 v65, s[32:35], s19 offen lds
    s_mov_b32 m0, 58368
    s_add_u32 s19, s37, 12544
    buffer_load_dwordx4 v65, s[32:35], s19 offen lds
    s_mov_b32 m0, 59392
    s_add_u32 s19, s37, 10496
    buffer_load_dwordx4 v65, s[32:35], s19 offen lds
    s_mov_b32 m0, 60416
    s_add_u32 s19, s37, 14592
    buffer_load_dwordx4 v65, s[32:35], s19 offen lds
    s_mov_b32 m0, 61440
    s_add_u32 s19, s37, 65792
    buffer_load_dwordx4 v65, s[32:35], s19 offen lds
    s_mov_b32 m0, 62464
    s_add_u32 s19, s37, 69888
    buffer_load_dwordx4 v65, s[32:35], s19 offen lds
    s_mov_b32 m0, 63488
    s_add_u32 s19, s37, 67840
    buffer_load_dwordx4 v65, s[32:35], s19 offen lds
    s_mov_b32 m0, 64512
    s_add_u32 s19, s37, 71936
    buffer_load_dwordx4 v65, s[32:35], s19 offen lds
    s_mov_b32 m0, 65536
    s_add_u32 s19, s37, 73984
    buffer_load_dwordx4 v65, s[32:35], s19 offen lds
    s_mov_b32 m0, 66560
    s_add_u32 s19, s37, 78080
    buffer_load_dwordx4 v65, s[32:35], s19 offen lds
    s_mov_b32 m0, 67584
    s_add_u32 s19, s37, 76032
    buffer_load_dwordx4 v65, s[32:35], s19 offen lds
    s_mov_b32 m0, 68608
    s_add_u32 s19, s37, 80128
    buffer_load_dwordx4 v65, s[32:35], s19 offen lds
    s_mov_b32 m0, 69632
    s_add_u32 s19, s37, 384
    buffer_load_dwordx4 v65, s[32:35], s19 offen lds
    s_mov_b32 m0, 70656
    s_add_u32 s19, s37, 4480
    buffer_load_dwordx4 v65, s[32:35], s19 offen lds
    s_mov_b32 m0, 71680
    s_add_u32 s19, s37, 2432
    buffer_load_dwordx4 v65, s[32:35], s19 offen lds
    s_mov_b32 m0, 72704
    s_add_u32 s19, s37, 6528
    buffer_load_dwordx4 v65, s[32:35], s19 offen lds
    s_mov_b32 m0, 73728
    s_add_u32 s19, s37, 8576
    buffer_load_dwordx4 v65, s[32:35], s19 offen lds
    s_mov_b32 m0, 74752
    s_add_u32 s19, s37, 12672
    buffer_load_dwordx4 v65, s[32:35], s19 offen lds
    s_mov_b32 m0, 75776
    s_add_u32 s19, s37, 10624
    buffer_load_dwordx4 v65, s[32:35], s19 offen lds
    s_mov_b32 m0, 76800
    s_add_u32 s19, s37, 14720
    buffer_load_dwordx4 v65, s[32:35], s19 offen lds
    s_waitcnt vmcnt(16)
    ds_read_b64_tr_b16 v[160:161], v66 offset:0
    ds_read_b64_tr_b16 v[162:163], v66 offset:2048
    ds_read_b64_tr_b16 v[164:165], v66 offset:4096
    ds_read_b64_tr_b16 v[166:167], v66 offset:6144
    ds_read_b64_tr_b16 v[168:169], v66 offset:16
    ds_read_b64_tr_b16 v[170:171], v66 offset:2064
    ds_read_b64_tr_b16 v[172:173], v66 offset:4112
    ds_read_b64_tr_b16 v[174:175], v66 offset:6160
    ds_read_b64_tr_b16 v[176:177], v66 offset:32
    ds_read_b64_tr_b16 v[178:179], v66 offset:2080
    ds_read_b64_tr_b16 v[180:181], v66 offset:4128
    ds_read_b64_tr_b16 v[182:183], v66 offset:6176
    ds_read_b64_tr_b16 v[184:185], v66 offset:48
    ds_read_b64_tr_b16 v[186:187], v66 offset:2096
    ds_read_b64_tr_b16 v[188:189], v66 offset:4144
    ds_read_b64_tr_b16 v[190:191], v66 offset:6192
    s_waitcnt lgkmcnt(0)
    s_mov_b32 m0, 53248
    s_add_u32 s19, s37, 65920
    buffer_load_dwordx4 v65, s[32:35], s19 offen lds
    s_mov_b32 m0, 54272
    s_add_u32 s19, s37, 70016
    buffer_load_dwordx4 v65, s[32:35], s19 offen lds
    s_mov_b32 m0, 55296
    s_add_u32 s19, s37, 67968
    buffer_load_dwordx4 v65, s[32:35], s19 offen lds
    s_mov_b32 m0, 56320
    s_add_u32 s19, s37, 72064
    buffer_load_dwordx4 v65, s[32:35], s19 offen lds
    s_mov_b32 m0, 57344
    s_add_u32 s19, s37, 74112
    buffer_load_dwordx4 v65, s[32:35], s19 offen lds
    s_mov_b32 m0, 58368
    s_add_u32 s19, s37, 78208
    buffer_load_dwordx4 v65, s[32:35], s19 offen lds
    s_mov_b32 m0, 59392
    s_add_u32 s19, s37, 76160
    buffer_load_dwordx4 v65, s[32:35], s19 offen lds
    s_mov_b32 m0, 60416
    s_add_u32 s19, s37, 80256
    buffer_load_dwordx4 v65, s[32:35], s19 offen lds
    s_mov_b32 m0, 1024
    s_add_u32 s19, s36, 8192
    buffer_load_dwordx4 v64, s[20:23], s19 offen lds
    s_mov_b32 m0, 5120
    s_add_u32 s19, s36, 73728
    buffer_load_dwordx4 v64, s[20:23], s19 offen lds
    s_mov_b32 m0, 9216
    s_add_u32 s19, s36, 24576
    buffer_load_dwordx4 v64, s[20:23], s19 offen lds
    s_mov_b32 m0, 13312
    s_add_u32 s19, s36, 90112
    buffer_load_dwordx4 v64, s[20:23], s19 offen lds
    s_mov_b32 m0, 46080
    s_add_u32 s19, s36, 270336
    buffer_load_dwordx4 v64, s[20:23], s19 offen lds
    s_mov_b32 m0, 82944
    s_add_u32 s19, s36, 335872
    buffer_load_dwordx4 v64, s[20:23], s19 offen lds
    s_mov_b32 m0, 119808
    s_add_u32 s19, s36, 286720
    buffer_load_dwordx4 v64, s[20:23], s19 offen lds
    s_mov_b32 m0, 156672
    s_add_u32 s19, s36, 352256
    buffer_load_dwordx4 v64, s[20:23], s19 offen lds
    s_waitcnt vmcnt(24)
    ds_read_b64_tr_b16 v[192:193], v66 offset:8192
    ds_read_b64_tr_b16 v[194:195], v66 offset:10240
    ds_read_b64_tr_b16 v[196:197], v66 offset:12288
    ds_read_b64_tr_b16 v[198:199], v66 offset:14336
    ds_read_b64_tr_b16 v[200:201], v66 offset:8208
    ds_read_b64_tr_b16 v[202:203], v66 offset:10256
    ds_read_b64_tr_b16 v[204:205], v66 offset:12304
    ds_read_b64_tr_b16 v[206:207], v66 offset:14352
    ds_read_b64_tr_b16 v[208:209], v66 offset:8224
    ds_read_b64_tr_b16 v[210:211], v66 offset:10272
    ds_read_b64_tr_b16 v[212:213], v66 offset:12320
    ds_read_b64_tr_b16 v[214:215], v66 offset:14368
    ds_read_b64_tr_b16 v[216:217], v66 offset:8240
    ds_read_b64_tr_b16 v[218:219], v66 offset:10288
    ds_read_b64_tr_b16 v[220:221], v66 offset:12336
    ds_read_b64_tr_b16 v[222:223], v66 offset:14384
    s_waitcnt vmcnt(16)
    ds_read_b64_tr_b16 v[224:225], v66 offset:16384
    ds_read_b64_tr_b16 v[226:227], v66 offset:18432
    ds_read_b64_tr_b16 v[228:229], v66 offset:20480
    ds_read_b64_tr_b16 v[230:231], v66 offset:22528
    ds_read_b64_tr_b16 v[232:233], v66 offset:16400
    ds_read_b64_tr_b16 v[234:235], v66 offset:18448
    ds_read_b64_tr_b16 v[236:237], v66 offset:20496
    ds_read_b64_tr_b16 v[238:239], v66 offset:22544
    ds_read_b64_tr_b16 v[240:241], v66 offset:16416
    ds_read_b64_tr_b16 v[242:243], v66 offset:18464
    ds_read_b64_tr_b16 v[244:245], v66 offset:20512
    ds_read_b64_tr_b16 v[246:247], v66 offset:22560
    ds_read_b64_tr_b16 v[248:249], v66 offset:16432
    ds_read_b64_tr_b16 v[250:251], v66 offset:18480
    ds_read_b64_tr_b16 v[252:253], v66 offset:20528
    ds_read_b64_tr_b16 v[254:255], v66 offset:22576
    s_waitcnt vmcnt(8)
    ds_read_b64_tr_b16 v[32:33], v66 offset:0
    ds_read_b64_tr_b16 v[34:35], v66 offset:2048
    ds_read_b64_tr_b16 v[36:37], v66 offset:4096
    ds_read_b64_tr_b16 v[38:39], v66 offset:6144
    ds_read_b64_tr_b16 v[40:41], v66 offset:16
    ds_read_b64_tr_b16 v[42:43], v66 offset:2064
    ds_read_b64_tr_b16 v[44:45], v66 offset:4112
    ds_read_b64_tr_b16 v[46:47], v66 offset:6160
    ds_read_b64_tr_b16 v[48:49], v66 offset:32
    ds_read_b64_tr_b16 v[50:51], v66 offset:2080
    ds_read_b64_tr_b16 v[52:53], v66 offset:4128
    ds_read_b64_tr_b16 v[54:55], v66 offset:6176
    ds_read_b64_tr_b16 v[56:57], v66 offset:48
    ds_read_b64_tr_b16 v[58:59], v66 offset:2096
    ds_read_b64_tr_b16 v[60:61], v66 offset:4144
    ds_read_b64_tr_b16 v[62:63], v66 offset:6192
    s_waitcnt lgkmcnt(0)
    s_waitcnt vmcnt(4)
    s_barrier
    s_mov_b32 m0, 50176
    s_add_u32 s19, s36, 1056768
    buffer_load_dwordx4 v64, s[20:23], s19 offen lds
    s_mov_b32 m0, 87040
    s_add_u32 s19, s36, 1122304
    buffer_load_dwordx4 v64, s[20:23], s19 offen lds
    s_mov_b32 m0, 123904
    s_add_u32 s19, s36, 1073152
    buffer_load_dwordx4 v64, s[20:23], s19 offen lds
    s_mov_b32 m0, 160768
    s_add_u32 s19, s36, 1138688
    buffer_load_dwordx4 v64, s[20:23], s19 offen lds
    ds_read_b64_tr_b16 a[64:65], v68 offset:0
    ds_read_b64_tr_b16 a[66:67], v68 offset:4096
    ds_read_b64_tr_b16 a[68:69], v68 offset:8192
    ds_read_b64_tr_b16 a[70:71], v68 offset:12288
    ds_read_b64_tr_b16 a[72:73], v69 offset:0
    ds_read_b64_tr_b16 a[74:75], v69 offset:4096
    ds_read_b64_tr_b16 a[76:77], v69 offset:8192
    ds_read_b64_tr_b16 a[78:79], v69 offset:12288
    s_waitcnt lgkmcnt(0)
    s_waitcnt vmcnt(4)
    s_barrier
    s_mov_b32 m0, 1024
    s_add_u32 s19, s36, 1318912
    buffer_load_dwordx4 v64, s[20:23], s19 offen lds
    s_mov_b32 m0, 5120
    s_add_u32 s19, s36, 1384448
    buffer_load_dwordx4 v64, s[20:23], s19 offen lds
    s_mov_b32 m0, 9216
    s_add_u32 s19, s36, 1335296
    buffer_load_dwordx4 v64, s[20:23], s19 offen lds
    s_mov_b32 m0, 13312
    s_add_u32 s19, s36, 1400832
    buffer_load_dwordx4 v64, s[20:23], s19 offen lds
    ds_read_b32 v84, v127 offset:40960
    s_waitcnt lgkmcnt(0)
    v_readfirstlane_b32 s19, v84
    s_nop 0
    s_bitcmp1_b32 s19, s93
    s_cbranch_scc1 L_lost
    ds_read_b64_tr_b16 v[0:1], v72 offset:0
    ds_read_b64_tr_b16 v[2:3], v74 offset:0
    ds_read_b64_tr_b16 v[4:5], v76 offset:0
    ds_read_b64_tr_b16 v[6:7], v78 offset:0
    ds_read_b64_tr_b16 v[8:9], v73 offset:0
    ds_read_b64_tr_b16 v[10:11], v75 offset:0
    ds_read_b64_tr_b16 v[12:13], v77 offset:0
    ds_read_b64_tr_b16 v[14:15], v79 offset:0
    s_waitcnt lgkmcnt(0)
    ds_write_b128 v118, v[0:3] offset:16384
    ds_write_b128 v118, v[4:7] offset:17408
    ds_write_b128 v118, v[8:11] offset:18432
    ds_write_b128 v118, v[12:15] offset:19456
    s_waitcnt lgkmcnt(0)
    s_waitcnt vmcnt(4)
    s_barrier
    s_mov_b32 m0, 46080
    s_add_u32 s19, s36, 2105344
    buffer_load_dwordx4 v64, s[20:23], s19 offen lds
    s_mov_b32 m0, 82944
    s_add_u32 s19, s36, 2170880
    buffer_load_dwordx4 v64, s[20:23], s19 offen lds
    s_mov_b32 m0, 119808
    s_add_u32 s19, s36, 2121728
    buffer_load_dwordx4 v64, s[20:23], s19 offen lds
    s_mov_b32 m0, 156672
    s_add_u32 s19, s36, 2187264
    buffer_load_dwordx4 v64, s[20:23], s19 offen lds
    ds_read_b64_tr_b16 v[0:1], v72 offset:4096
    ds_read_b64_tr_b16 v[2:3], v74 offset:4096
    ds_read_b64_tr_b16 v[4:5], v76 offset:4096
    ds_read_b64_tr_b16 v[6:7], v78 offset:4096
    ds_read_b64_tr_b16 v[8:9], v73 offset:4096
    ds_read_b64_tr_b16 v[10:11], v75 offset:4096
    ds_read_b64_tr_b16 v[12:13], v77 offset:4096
    ds_read_b64_tr_b16 v[14:15], v79 offset:4096
    s_waitcnt lgkmcnt(0)
    ds_write_b128 v118, v[0:3] offset:0
    ds_write_b128 v118, v[4:7] offset:1024
    ds_write_b128 v118, v[8:11] offset:2048
    ds_write_b128 v118, v[12:15] offset:3072
    s_waitcnt lgkmcnt(0)
    s_waitcnt vmcnt(4)
    s_barrier
    s_mov_b32 m0, 50176
    s_add_u32 s19, s36, 2367488
    buffer_load_dwordx4 v64, s[20:23], s19 offen lds
    s_mov_b32 m0, 87040
    s_add_u32 s19, s36, 2433024
    buffer_load_dwordx4 v64, s[20:23], s19 offen lds
    s_mov_b32 m0, 123904
    s_add_u32 s19, s36, 2383872
    buffer_load_dwordx4 v64, s[20:23], s19 offen lds
    s_mov_b32 m0, 160768
    s_add_u32 s19, s36, 2449408
    buffer_load_dwordx4 v64, s[20:23], s19 offen lds
    ds_read_b64_tr_b16 a[0:1], v68 offset:0
    ds_read_b64_tr_b16 a[2:3], v68 offset:4096
    ds_read_b64_tr_b16 a[4:5], v68 offset:8192
    ds_read_b64_tr_b16 a[6:7], v68 offset:12288
    ds_read_b64_tr_b16 a[8:9], v69 offset:0
    ds_read_b64_tr_b16 a[10:11], v69 offset:4096
    ds_read_b64_tr_b16 a[12:13], v69 offset:8192
    ds_read_b64_tr_b16 a[14:15], v69 offset:12288
    s_waitcnt lgkmcnt(0)
    s_waitcnt vmcnt(4)
    s_barrier
    s_mov_b32 m0, 1024
    s_add_u32 s19, s36, 3153920
    buffer_load_dwordx4 v64, s[20:23], s19 offen lds
    s_mov_b32 m0, 5120
    s_add_u32 s19, s36, 3219456
    buffer_load_dwordx4 v64, s[20:23], s19 offen lds
    s_mov_b32 m0, 9216
    s_add_u32 s19, s36, 3170304
    buffer_load_dwordx4 v64, s[20:23], s19 offen lds
    s_mov_b32 m0, 13312
    s_add_u32 s19, s36, 3235840
    buffer_load_dwordx4 v64, s[20:23], s19 offen lds
    ds_read_b64_tr_b16 a[16:17], v72 offset:0
    ds_read_b64_tr_b16 a[18:19], v74 offset:0
    ds_read_b64_tr_b16 a[20:21], v76 offset:0
    ds_read_b64_tr_b16 a[22:23], v78 offset:0
    ds_read_b64_tr_b16 a[24:25], v73 offset:0
    ds_read_b64_tr_b16 a[26:27], v75 offset:0
    ds_read_b64_tr_b16 a[28:29], v77 offset:0
    ds_read_b64_tr_b16 a[30:31], v79 offset:0
    s_waitcnt lgkmcnt(0)
    s_waitcnt vmcnt(4)
    s_barrier
    s_mov_b32 m0, 46080
    s_add_u32 s19, s36, 3416064
    buffer_load_dwordx4 v64, s[20:23], s19 offen lds
    s_mov_b32 m0, 82944
    s_add_u32 s19, s36, 3481600
    buffer_load_dwordx4 v64, s[20:23], s19 offen lds
    s_mov_b32 m0, 119808
    s_add_u32 s19, s36, 3432448
    buffer_load_dwordx4 v64, s[20:23], s19 offen lds
    s_mov_b32 m0, 156672
    s_add_u32 s19, s36, 3497984
    buffer_load_dwordx4 v64, s[20:23], s19 offen lds
    ds_read_b64_tr_b16 a[32:33], v72 offset:4096
    ds_read_b64_tr_b16 a[34:35], v74 offset:4096
    ds_read_b64_tr_b16 a[36:37], v76 offset:4096
    ds_read_b64_tr_b16 a[38:39], v78 offset:4096
    ds_read_b64_tr_b16 a[40:41], v73 offset:4096
    ds_read_b64_tr_b16 a[42:43], v75 offset:4096
    ds_read_b64_tr_b16 a[44:45], v77 offset:4096
    ds_read_b64_tr_b16 a[46:47], v79 offset:4096
    s_waitcnt lgkmcnt(0)
    s_waitcnt vmcnt(4)
    s_barrier
    s_mov_b32 m0, 50176
    s_add_u32 s19, s36, 8192
    buffer_load_dwordx4 v64, s[24:27], s19 offen lds
    s_mov_b32 m0, 87040
    s_add_u32 s19, s36, 73728
    buffer_load_dwordx4 v64, s[24:27], s19 offen lds
    s_mov_b32 m0, 123904
    s_add_u32 s19, s36, 24576
    buffer_load_dwordx4 v64, s[24:27], s19 offen lds
    s_mov_b32 m0, 160768
    s_add_u32 s19, s36, 90112
    buffer_load_dwordx4 v64, s[24:27], s19 offen lds
    ds_read_b64_tr_b16 v[0:1], v68 offset:0
    ds_read_b64_tr_b16 v[2:3], v68 offset:4096
    ds_read_b64_tr_b16 v[4:5], v68 offset:8192
    ds_read_b64_tr_b16 v[6:7], v68 offset:12288
    ds_read_b64_tr_b16 v[8:9], v69 offset:0
    ds_read_b64_tr_b16 v[10:11], v69 offset:4096
    ds_read_b64_tr_b16 v[12:13], v69 offset:8192
    ds_read_b64_tr_b16 v[14:15], v69 offset:12288
    s_waitcnt lgkmcnt(0)
    ds_write_b128 v118, v[0:3] offset:12288
    ds_write_b128 v118, v[4:7] offset:13312
    ds_write_b128 v118, v[8:11] offset:14336
    ds_write_b128 v118, v[12:15] offset:15360
    s_waitcnt lgkmcnt(0)
    s_waitcnt vmcnt(4)
    s_barrier
    s_mov_b32 m0, 1024
    s_add_u32 s19, s36, 270336
    buffer_load_dwordx4 v64, s[24:27], s19 offen lds
    s_mov_b32 m0, 5120
    s_add_u32 s19, s36, 335872
    buffer_load_dwordx4 v64, s[24:27], s19 offen lds
    s_mov_b32 m0, 9216
    s_add_u32 s19, s36, 286720
    buffer_load_dwordx4 v64, s[24:27], s19 offen lds
    s_mov_b32 m0, 13312
    s_add_u32 s19, s36, 352256
    buffer_load_dwordx4 v64, s[24:27], s19 offen lds
    ds_read_b64_tr_b16 a[48:49], v72 offset:0
    ds_read_b64_tr_b16 a[50:51], v74 offset:0
    ds_read_b64_tr_b16 a[52:53], v76 offset:0
    ds_read_b64_tr_b16 a[54:55], v78 offset:0
    ds_read_b64_tr_b16 a[56:57], v73 offset:0
    ds_read_b64_tr_b16 a[58:59], v75 offset:0
    ds_read_b64_tr_b16 a[60:61], v77 offset:0
    ds_read_b64_tr_b16 a[62:63], v79 offset:0
    s_waitcnt lgkmcnt(0)
    s_waitcnt vmcnt(4)
    s_barrier
    s_mov_b32 m0, 46080
    s_add_u32 s19, s36, 1056768
    buffer_load_dwordx4 v64, s[24:27], s19 offen lds
    s_mov_b32 m0, 82944
    s_add_u32 s19, s36, 1122304
    buffer_load_dwordx4 v64, s[24:27], s19 offen lds
    s_mov_b32 m0, 119808
    s_add_u32 s19, s36, 1073152
    buffer_load_dwordx4 v64, s[24:27], s19 offen lds
    s_mov_b32 m0, 156672
    s_add_u32 s19, s36, 1138688
    buffer_load_dwordx4 v64, s[24:27], s19 offen lds
    ds_read_b64_tr_b16 a[144:145], v72 offset:4096
    ds_read_b64_tr_b16 a[146:147], v74 offset:4096
    ds_read_b64_tr_b16 a[148:149], v76 offset:4096
    ds_read_b64_tr_b16 a[150:151], v78 offset:4096
    ds_read_b64_tr_b16 a[152:153], v73 offset:4096
    ds_read_b64_tr_b16 a[154:155], v75 offset:4096
    ds_read_b64_tr_b16 a[156:157], v77 offset:4096
    ds_read_b64_tr_b16 a[158:159], v79 offset:4096
    s_waitcnt lgkmcnt(0)
    s_waitcnt vmcnt(4)
    s_barrier
    s_mov_b32 m0, 50176
    s_add_u32 s19, s36, 1318912
    buffer_load_dwordx4 v64, s[24:27], s19 offen lds
    s_mov_b32 m0, 87040
    s_add_u32 s19, s36, 1384448
    buffer_load_dwordx4 v64, s[24:27], s19 offen lds
    s_mov_b32 m0, 123904
    s_add_u32 s19, s36, 1335296
    buffer_load_dwordx4 v64, s[24:27], s19 offen lds
    s_mov_b32 m0, 160768
    s_add_u32 s19, s36, 1400832
    buffer_load_dwordx4 v64, s[24:27], s19 offen lds
    ds_read_b64_tr_b16 v[0:1], v68 offset:0
    ds_read_b64_tr_b16 v[2:3], v68 offset:4096
    ds_read_b64_tr_b16 v[4:5], v68 offset:8192
    ds_read_b64_tr_b16 v[6:7], v68 offset:12288
    ds_read_b64_tr_b16 v[8:9], v69 offset:0
    ds_read_b64_tr_b16 v[10:11], v69 offset:4096
    ds_read_b64_tr_b16 v[12:13], v69 offset:8192
    ds_read_b64_tr_b16 v[14:15], v69 offset:12288
    s_waitcnt lgkmcnt(0)
    ds_write_b128 v118, v[0:3] offset:24576
    ds_write_b128 v118, v[4:7] offset:25600
    ds_write_b128 v118, v[8:11] offset:26624
    ds_write_b128 v118, v[12:15] offset:27648
    s_waitcnt lgkmcnt(0)
    s_waitcnt vmcnt(4)
    s_barrier
    s_mov_b32 m0, 1024
    s_add_u32 s19, s36, 2105344
    buffer_load_dwordx4 v64, s[24:27], s19 offen lds
    s_mov_b32 m0, 5120
    s_add_u32 s19, s36, 2170880
    buffer_load_dwordx4 v64, s[24:27], s19 offen lds
    s_mov_b32 m0, 9216
    s_add_u32 s19, s36, 2121728
    buffer_load_dwordx4 v64, s[24:27], s19 offen lds
    s_mov_b32 m0, 13312
    s_add_u32 s19, s36, 2187264
    buffer_load_dwordx4 v64, s[24:27], s19 offen lds
    ds_read_b64_tr_b16 v[0:1], v72 offset:0
    ds_read_b64_tr_b16 v[2:3], v74 offset:0
    ds_read_b64_tr_b16 v[4:5], v76 offset:0
    ds_read_b64_tr_b16 v[6:7], v78 offset:0
    ds_read_b64_tr_b16 v[8:9], v73 offset:0
    ds_read_b64_tr_b16 v[10:11], v75 offset:0
    ds_read_b64_tr_b16 v[12:13], v77 offset:0
    ds_read_b64_tr_b16 v[14:15], v79 offset:0
    s_waitcnt lgkmcnt(0)
    ds_write_b128 v118, v[0:3] offset:4096
    ds_write_b128 v118, v[4:7] offset:5120
    ds_write_b128 v118, v[8:11] offset:6144
    ds_write_b128 v118, v[12:15] offset:7168
    s_waitcnt lgkmcnt(0)
    s_waitcnt vmcnt(4)
    s_barrier
    s_mov_b32 m0, 46080
    s_add_u32 s19, s36, 2367488
    buffer_load_dwordx4 v64, s[24:27], s19 offen lds
    s_mov_b32 m0, 82944
    s_add_u32 s19, s36, 2433024
    buffer_load_dwordx4 v64, s[24:27], s19 offen lds
    s_mov_b32 m0, 119808
    s_add_u32 s19, s36, 2383872
    buffer_load_dwordx4 v64, s[24:27], s19 offen lds
    s_mov_b32 m0, 156672
    s_add_u32 s19, s36, 2449408
    buffer_load_dwordx4 v64, s[24:27], s19 offen lds
    ds_read_b64_tr_b16 a[80:81], v72 offset:4096
    ds_read_b64_tr_b16 a[82:83], v74 offset:4096
    ds_read_b64_tr_b16 a[84:85], v76 offset:4096
    ds_read_b64_tr_b16 a[86:87], v78 offset:4096
    ds_read_b64_tr_b16 a[88:89], v73 offset:4096
    ds_read_b64_tr_b16 a[90:91], v75 offset:4096
    ds_read_b64_tr_b16 a[92:93], v77 offset:4096
    ds_read_b64_tr_b16 a[94:95], v79 offset:4096
    s_waitcnt lgkmcnt(0)
    s_waitcnt vmcnt(4)
    s_barrier
    s_mov_b32 m0, 50176
    s_add_u32 s19, s36, 3153920
    buffer_load_dwordx4 v64, s[24:27], s19 offen lds
    s_mov_b32 m0, 87040
    s_add_u32 s19, s36, 3219456
    buffer_load_dwordx4 v64, s[24:27], s19 offen lds
    s_mov_b32 m0, 123904
    s_add_u32 s19, s36, 3170304
    buffer_load_dwordx4 v64, s[24:27], s19 offen lds
    s_mov_b32 m0, 160768
    s_add_u32 s19, s36, 3235840
    buffer_load_dwordx4 v64, s[24:27], s19 offen lds
    ds_read_b64_tr_b16 a[96:97], v68 offset:0
    ds_read_b64_tr_b16 a[98:99], v68 offset:4096
    ds_read_b64_tr_b16 a[100:101], v68 offset:8192
    ds_read_b64_tr_b16 a[102:103], v68 offset:12288
    ds_read_b64_tr_b16 a[104:105], v69 offset:0
    ds_read_b64_tr_b16 a[106:107], v69 offset:4096
    ds_read_b64_tr_b16 a[108:109], v69 offset:8192
    ds_read_b64_tr_b16 a[110:111], v69 offset:12288
    s_waitcnt lgkmcnt(0)
    s_waitcnt vmcnt(4)
    s_barrier
    s_mov_b32 m0, 1024
    s_add_u32 s19, s36, 3416064
    buffer_load_dwordx4 v64, s[24:27], s19 offen lds
    s_mov_b32 m0, 5120
    s_add_u32 s19, s36, 3481600
    buffer_load_dwordx4 v64, s[24:27], s19 offen lds
    s_mov_b32 m0, 9216
    s_add_u32 s19, s36, 3432448
    buffer_load_dwordx4 v64, s[24:27], s19 offen lds
    s_mov_b32 m0, 13312
    s_add_u32 s19, s36, 3497984
    buffer_load_dwordx4 v64, s[24:27], s19 offen lds
    ds_read_b64_tr_b16 a[112:113], v72 offset:0
    ds_read_b64_tr_b16 a[114:115], v74 offset:0
    ds_read_b64_tr_b16 a[116:117], v76 offset:0
    ds_read_b64_tr_b16 a[118:119], v78 offset:0
    ds_read_b64_tr_b16 a[120:121], v73 offset:0
    ds_read_b64_tr_b16 a[122:123], v75 offset:0
    ds_read_b64_tr_b16 a[124:125], v77 offset:0
    ds_read_b64_tr_b16 a[126:127], v79 offset:0
    s_waitcnt lgkmcnt(0)
    s_waitcnt vmcnt(4)
    s_barrier
    s_mov_b32 m0, 46080
    s_add_u32 s19, s36, 8192
    buffer_load_dwordx4 v64, s[28:31], s19 offen lds
    s_mov_b32 m0, 82944
    s_add_u32 s19, s36, 73728
    buffer_load_dwordx4 v64, s[28:31], s19 offen lds
    s_mov_b32 m0, 119808
    s_add_u32 s19, s36, 24576
    buffer_load_dwordx4 v64, s[28:31], s19 offen lds
    s_mov_b32 m0, 156672
    s_add_u32 s19, s36, 90112
    buffer_load_dwordx4 v64, s[28:31], s19 offen lds
    ds_read_b64_tr_b16 v[0:1], v72 offset:4096
    ds_read_b64_tr_b16 v[2:3], v74 offset:4096
    ds_read_b64_tr_b16 v[4:5], v76 offset:4096
    ds_read_b64_tr_b16 v[6:7], v78 offset:4096
    ds_read_b64_tr_b16 v[8:9], v73 offset:4096
    ds_read_b64_tr_b16 v[10:11], v75 offset:4096
    ds_read_b64_tr_b16 v[12:13], v77 offset:4096
    ds_read_b64_tr_b16 v[14:15], v79 offset:4096
    s_waitcnt lgkmcnt(0)
    ds_write_b128 v118, v[0:3] offset:20480
    ds_write_b128 v118, v[4:7] offset:21504
    ds_write_b128 v118, v[8:11] offset:22528
    ds_write_b128 v118, v[12:15] offset:23552
    s_waitcnt lgkmcnt(0)
    s_waitcnt vmcnt(4)
    s_barrier
    s_mov_b32 m0, 50176
    s_add_u32 s19, s36, 270336
    buffer_load_dwordx4 v64, s[28:31], s19 offen lds
    s_mov_b32 m0, 87040
    s_add_u32 s19, s36, 335872
    buffer_load_dwordx4 v64, s[28:31], s19 offen lds
    s_mov_b32 m0, 123904
    s_add_u32 s19, s36, 286720
    buffer_load_dwordx4 v64, s[28:31], s19 offen lds
    s_mov_b32 m0, 160768
    s_add_u32 s19, s36, 352256
    buffer_load_dwordx4 v64, s[28:31], s19 offen lds
    ds_read_b64_tr_b16 a[128:129], v68 offset:0
    ds_read_b64_tr_b16 a[130:131], v68 offset:4096
    ds_read_b64_tr_b16 a[132:133], v68 offset:8192
    ds_read_b64_tr_b16 a[134:135], v68 offset:12288
    ds_read_b64_tr_b16 a[136:137], v69 offset:0
    ds_read_b64_tr_b16 a[138:139], v69 offset:4096
    ds_read_b64_tr_b16 a[140:141], v69 offset:8192
    ds_read_b64_tr_b16 a[142:143], v69 offset:12288
    s_waitcnt lgkmcnt(0)
    s_waitcnt vmcnt(4)
    s_barrier
    s_mov_b32 m0, 1024
    s_add_u32 s19, s36, 1056768
    buffer_load_dwordx4 v64, s[28:31], s19 offen lds
    s_mov_b32 m0, 5120
    s_add_u32 s19, s36, 1122304
    buffer_load_dwordx4 v64, s[28:31], s19 offen lds
    s_mov_b32 m0, 9216
    s_add_u32 s19, s36, 1073152
    buffer_load_dwordx4 v64, s[28:31], s19 offen lds
    s_mov_b32 m0, 13312
    s_add_u32 s19, s36, 1138688
    buffer_load_dwordx4 v64, s[28:31], s19 offen lds
    ds_read_b64_tr_b16 a[240:241], v72 offset:0
    ds_read_b64_tr_b16 a[242:243], v74 offset:0
    ds_read_b64_tr_b16 a[244:245], v76 offset:0
    ds_read_b64_tr_b16 a[246:247], v78 offset:0
    ds_read_b64_tr_b16 a[248:249], v73 offset:0
    ds_read_b64_tr_b16 a[250:251], v75 offset:0
    ds_read_b64_tr_b16 a[252:253], v77 offset:0
    ds_read_b64_tr_b16 a[254:255], v79 offset:0
    s_waitcnt lgkmcnt(0)
    s_waitcnt vmcnt(4)
    s_barrier
    s_mov_b32 m0, 46080
    s_add_u32 s19, s36, 1318912
    buffer_load_dwordx4 v64, s[28:31], s19 offen lds
    s_mov_b32 m0, 82944
    s_add_u32 s19, s36, 1384448
    buffer_load_dwordx4 v64, s[28:31], s19 offen lds
    s_mov_b32 m0, 119808
    s_add_u32 s19, s36, 1335296
    buffer_load_dwordx4 v64, s[28:31], s19 offen lds
    s_mov_b32 m0, 156672
    s_add_u32 s19, s36, 1400832
    buffer_load_dwordx4 v64, s[28:31], s19 offen lds
    ds_read_b64_tr_b16 v[144:145], v72 offset:4096
    ds_read_b64_tr_b16 v[146:147], v74 offset:4096
    ds_read_b64_tr_b16 v[148:149], v76 offset:4096
    ds_read_b64_tr_b16 v[150:151], v78 offset:4096
    ds_read_b64_tr_b16 v[152:153], v73 offset:4096
    ds_read_b64_tr_b16 v[154:155], v75 offset:4096
    ds_read_b64_tr_b16 v[156:157], v77 offset:4096
    ds_read_b64_tr_b16 v[158:159], v79 offset:4096
    s_waitcnt lgkmcnt(0)
    s_waitcnt vmcnt(4)
    s_barrier
    s_mov_b32 m0, 50176
    s_add_u32 s19, s36, 2105344
    buffer_load_dwordx4 v64, s[28:31], s19 offen lds
    s_mov_b32 m0, 87040
    s_add_u32 s19, s36, 2170880
    buffer_load_dwordx4 v64, s[28:31], s19 offen lds
    s_mov_b32 m0, 123904
    s_add_u32 s19, s36, 2121728
    buffer_load_dwordx4 v64, s[28:31], s19 offen lds
    s_mov_b32 m0, 160768
    s_add_u32 s19, s36, 2187264
    buffer_load_dwordx4 v64, s[28:31], s19 offen lds
    ds_read_b64_tr_b16 v[0:1], v68 offset:0
    ds_read_b64_tr_b16 v[2:3], v68 offset:4096
    ds_read_b64_tr_b16 v[4:5], v68 offset:8192
    ds_read_b64_tr_b16 v[6:7], v68 offset:12288
    ds_read_b64_tr_b16 v[8:9], v69 offset:0
    ds_read_b64_tr_b16 v[10:11], v69 offset:4096
    ds_read_b64_tr_b16 v[12:13], v69 offset:8192
    ds_read_b64_tr_b16 v[14:15], v69 offset:12288
    s_waitcnt lgkmcnt(0)
    ds_write_b128 v118, v[0:3] offset:8192
    ds_write_b128 v118, v[4:7] offset:9216
    ds_write_b128 v118, v[8:11] offset:10240
    ds_write_b128 v118, v[12:15] offset:11264
    s_waitcnt lgkmcnt(0)
    s_waitcnt vmcnt(4)
    s_barrier
    s_mov_b32 m0, 1024
    s_add_u32 s19, s36, 2367488
    buffer_load_dwordx4 v64, s[28:31], s19 offen lds
    s_mov_b32 m0, 5120
    s_add_u32 s19, s36, 2433024
    buffer_load_dwordx4 v64, s[28:31], s19 offen lds
    s_mov_b32 m0, 9216
    s_add_u32 s19, s36, 2383872
    buffer_load_dwordx4 v64, s[28:31], s19 offen lds
    s_mov_b32 m0, 13312
    s_add_u32 s19, s36, 2449408
    buffer_load_dwordx4 v64, s[28:31], s19 offen lds
    ds_read_b64_tr_b16 a[160:161], v72 offset:0
    ds_read_b64_tr_b16 a[162:163], v74 offset:0
    ds_read_b64_tr_b16 a[164:165], v76 offset:0
    ds_read_b64_tr_b16 a[166:167], v78 offset:0
    ds_read_b64_tr_b16 a[168:169], v73 offset:0
    ds_read_b64_tr_b16 a[170:171], v75 offset:0
    ds_read_b64_tr_b16 a[172:173], v77 offset:0
    ds_read_b64_tr_b16 a[174:175], v79 offset:0
    s_waitcnt lgkmcnt(0)
    s_waitcnt vmcnt(4)
    s_barrier
    s_mov_b32 m0, 46080
    s_add_u32 s19, s36, 3153920
    buffer_load_dwordx4 v64, s[28:31], s19 offen lds
    s_mov_b32 m0, 82944
    s_add_u32 s19, s36, 3219456
    buffer_load_dwordx4 v64, s[28:31], s19 offen lds
    s_mov_b32 m0, 119808
    s_add_u32 s19, s36, 3170304
    buffer_load_dwordx4 v64, s[28:31], s19 offen lds
    s_mov_b32 m0, 156672
    s_add_u32 s19, s36, 3235840
    buffer_load_dwordx4 v64, s[28:31], s19 offen lds
    ds_read_b64_tr_b16 a[176:177], v72 offset:4096
    ds_read_b64_tr_b16 a[178:179], v74 offset:4096
    ds_read_b64_tr_b16 a[180:181], v76 offset:4096
    ds_read_b64_tr_b16 a[182:183], v78 offset:4096
    ds_read_b64_tr_b16 a[184:185], v73 offset:4096
    ds_read_b64_tr_b16 a[186:187], v75 offset:4096
    ds_read_b64_tr_b16 a[188:189], v77 offset:4096
    ds_read_b64_tr_b16 a[190:191], v79 offset:4096
    s_waitcnt lgkmcnt(0)
    s_waitcnt vmcnt(4)
    s_barrier
    s_mov_b32 m0, 50176
    s_add_u32 s19, s36, 3416064
    buffer_load_dwordx4 v64, s[28:31], s19 offen lds
    s_mov_b32 m0, 87040
    s_add_u32 s19, s36, 3481600
    buffer_load_dwordx4 v64, s[28:31], s19 offen lds
    s_mov_b32 m0, 123904
    s_add_u32 s19, s36, 3432448
    buffer_load_dwordx4 v64, s[28:31], s19 offen lds
    s_mov_b32 m0, 160768
    s_add_u32 s19, s36, 3497984
    buffer_load_dwordx4 v64, s[28:31], s19 offen lds
    ds_read_b64_tr_b16 a[192:193], v68 offset:0
    ds_read_b64_tr_b16 a[194:195], v68 offset:4096
    ds_read_b64_tr_b16 a[196:197], v68 offset:8192
    ds_read_b64_tr_b16 a[198:199], v68 offset:12288
    ds_read_b64_tr_b16 a[200:201], v69 offset:0
    ds_read_b64_tr_b16 a[202:203], v69 offset:4096
    ds_read_b64_tr_b16 a[204:205], v69 offset:8192
    ds_read_b64_tr_b16 a[206:207], v69 offset:12288
    s_waitcnt lgkmcnt(0)
    s_waitcnt vmcnt(4)
    s_barrier
    ds_read_b64_tr_b16 a[208:209], v72 offset:0
    ds_read_b64_tr_b16 a[210:211], v74 offset:0
    ds_read_b64_tr_b16 a[212:213], v76 offset:0
    ds_read_b64_tr_b16 a[214:215], v78 offset:0
    ds_read_b64_tr_b16 a[216:217], v73 offset:0
    ds_read_b64_tr_b16 a[218:219], v75 offset:0
    ds_read_b64_tr_b16 a[220:221], v77 offset:0
    ds_read_b64_tr_b16 a[222:223], v79 offset:0
    s_waitcnt lgkmcnt(0)
    s_waitcnt vmcnt(0)
    s_barrier
    ds_read_b64_tr_b16 a[224:225], v72 offset:4096
    ds_read_b64_tr_b16 a[226:227], v74 offset:4096
    ds_read_b64_tr_b16 a[228:229], v76 offset:4096
    ds_read_b64_tr_b16 a[230:231], v78 offset:4096
    ds_read_b64_tr_b16 a[232:233], v73 offset:4096
    ds_read_b64_tr_b16 a[234:235], v75 offset:4096
    ds_read_b64_tr_b16 a[236:237], v77 offset:4096
    ds_read_b64_tr_b16 a[238:239], v79 offset:4096
    s_waitcnt lgkmcnt(0)
    s_barrier
    ds_write_b128 v118, v[32:35] offset:28672
    ds_write_b128 v118, v[36:39] offset:29696
    ds_write_b128 v118, v[40:43] offset:30720
    ds_write_b128 v118, v[44:47] offset:31744
    ds_write_b128 v118, v[48:51] offset:32768
    ds_write_b128 v118, v[52:55] offset:33792
    ds_write_b128 v118, v[56:59] offset:34816
    ds_write_b128 v118, v[60:63] offset:35840
    s_mov_b32 s35, s52
    s_lshl_b32 s34, s16, 6
    s_mov_b32 s52, 0
    v_and_b32 v113, 0xf0, v117
    v_bfe_u32 v64, v117, 9, 1
    v_lshl_add_u32 v113, v64, 8, v113
    v_bfe_u32 v64, v117, 8, 1
    v_lshl_add_u32 v113, v64, 2, v113
    s_lshl_b32 s19, s16, 14
    s_add_u32 s38, s19, 128
    s_add_u32 s97, s19, 10240
    s_mov_b32 s39, 59835392
    s_mov_b32 s45, 59834368
    s_mov_b32 s18, 0
    s_mov_b32 s8, s72
    s_and_b32 s9, s73, 0xffff
    s_mov_b32 s10, 0x2000
    s_mov_b32 s11, 0x20000
    buffer_load_dword v8, v106, s[8:11], 0 offen offset:256
    buffer_load_dword v9, v106, s[8:11], 0 offen offset:384
    buffer_load_dword v10, v106, s[8:11], 0 offen offset:272
    buffer_load_dword v11, v106, s[8:11], 0 offen offset:400
    buffer_load_dword v12, v106, s[8:11], 0 offen offset:320
    buffer_load_dword v13, v106, s[8:11], 0 offen offset:448
    buffer_load_dword v14, v106, s[8:11], 0 offen offset:336
    buffer_load_dword v15, v106, s[8:11], 0 offen offset:464
    s_add_u32 s96, s36, 60817408
    v_bfe_u32 v85, v117, 4, 3
    v_lshlrev_b32 v85, 2, v85
C1_init:
    global_load_dword v84, v85, s[86:87] offset:0 sc1
    s_sub_u32 s48, s48, 1
    s_cbranch_scc1 C1_bail
    s_waitcnt vmcnt(0)
    v_cmp_ne_u32 vcc, -1, v84
    s_cbranch_vccnz C1_init
    global_load_dword v86, v127, s[86:87] offset:96 sc1
    v_and_b32 v85, 4, v85
C1_f01:
    buffer_load_dword v84, v85, s[4:7], s96 offen sc1
    s_sub_u32 s48, s48, 1
    s_cbranch_scc1 C1_bail
    s_waitcnt vmcnt(0)
    v_cmp_ne_u32 vcc, 1, v84
    s_cbranch_vccnz C1_f01
    s_add_u32 s96, s96, 8
    buffer_load_dwordx4 v[136:139], v124, s[4:7], s38 offen sc1
    buffer_load_dwordx4 v[128:131], v117, s[4:7], s97 offen sc1
    buffer_load_dwordx4 v[140:143], v124, s[4:7], s38 offen offset:2048 sc1
    buffer_load_dwordx4 v[132:135], v117, s[4:7], s97 offen offset:1024 sc1
    s_add_u32 s38, s38, 524288
    s_add_u32 s97, s97, 524288
    s_mov_b32 s8, 0x05040100
    s_mov_b32 s9, 0x07060302
    s_waitcnt vmcnt(0) lgkmcnt(0)
    v_cmp_ne_u32 s[58:59], 0, v86
    s_barrier
    v_perm_b32 v0, v9, v8, s8
    v_min_u32 v0, -2, v0
    v_perm_b32 v1, v11, v10, s8
    v_min_u32 v1, -2, v1
    v_perm_b32 v2, v9, v8, s9
    v_min_u32 v2, -2, v2
    v_perm_b32 v3, v11, v10, s9
    v_min_u32 v3, -2, v3
    v_perm_b32 v4, v13, v12, s8
    v_min_u32 v4, -2, v4
    v_perm_b32 v5, v15, v14, s8
    v_min_u32 v5, -2, v5
    v_perm_b32 v6, v13, v12, s9
    v_min_u32 v6, -2, v6
    v_perm_b32 v7, v15, v14, s9
    v_min_u32 v7, -2, v7
    ds_read_b128 v[64:67], v118 offset:0
    ds_read_b128 v[68:71], v118 offset:1024
    ds_read_b128 v[72:75], v118 offset:2048
    ds_read_b128 v[76:79], v118 offset:3072
    ds_read_b128 v[16:19], v118 offset:4096
    ds_read_b128 v[20:23], v118 offset:5120
    ds_read_b128 v[24:27], v118 offset:6144
    ds_read_b128 v[28:31], v118 offset:7168
    ds_read_b128 v[32:35], v118 offset:8192
    ds_read_b128 v[36:39], v118 offset:9216
    ds_read_b128 v[40:43], v118 offset:10240
    ds_read_b128 v[44:47], v118 offset:11264
    v_mov_b32 v48, v128
    v_mov_b32 v49, v129
    v_mov_b32 v50, v130
    v_mov_b32 v51, v131
    v_mov_b32 v52, v132
    v_mov_b32 v53, v133
    v_mov_b32 v54, v134
    v_mov_b32 v55, v135
    v_mov_b32 v56, v136
    v_mov_b32 v57, v137
    v_mov_b32 v58, v138
    v_mov_b32 v59, v139
    v_mov_b32 v60, v140
    v_mov_b32 v61, v141
    v_mov_b32 v62, v142
    v_mov_b32 v63, v143
    v_mov_b32 v80, 0
    v_mov_b32 v81, 0
    v_mov_b32 v82, 0
    v_mov_b32 v83, 0
    v_mov_b32 v84, 0
    v_mov_b32 v85, 0
    v_mov_b32 v86, 0
    v_mov_b32 v87, 0
    v_mov_b32 v88, 0
    v_mov_b32 v89, 0
    v_mov_b32 v90, 0
    v_mov_b32 v91, 0
    v_mov_b32 v92, 0
    v_mov_b32 v93, 0
    v_mov_b32 v94, 0
    v_mov_b32 v95, 0
    v_mov_b32 v96, 0
    v_mov_b32 v97, 0
    v_mov_b32 v98, 0
    v_mov_b32 v99, 0
    v_mov_b32 v100, 0
    v_mov_b32 v101, 0
    v_mov_b32 v102, 0
    v_mov_b32 v103, 0
    s_cmp_lg_u64 s[58:59], 0
    s_cbranch_scc1 D1_step
C1_step:
    s_waitcnt vmcnt(3)
    s_waitcnt lgkmcnt(0)
    v_max3_u32 v106, v0, v1, v2
    v_max_u32 v106, v106, v3
    v_smfmac_f32_16x16x64_bf16 v[80:83], v[0:3], v[64:71], v116
    ds_write_b128 v117, v[0:3] offset:2048
    v_smfmac_f32_16x16x64_bf16 v[84:87], v[0:3], v[72:79], v116
    s_waitcnt vmcnt(2)
    v_max3_u32 v106, v106, v4, v5
    v_max3_u32 v106, v106, v6, v7
    v_cmp_eq_u32 vcc, -1, v106
    v_smfmac_f32_16x16x64_bf16 v[88:91], v[0:3], v[16:23], v116
    ds_write_b128 v117, v[4:7] offset:3072
    v_smfmac_f32_16x16x64_bf16 v[92:95], v[0:3], v[24:31], v116
    s_cbranch_vccnz C1_re2
    ds_read_b128 v[64:67], v118 offset:12288
    v_smfmac_f32_16x16x64_bf16 v[96:99], v[0:3], v[32:39], v116
    ds_read_b128 v[68:71], v118 offset:13312
    v_smfmac_f32_16x16x64_bf16 v[100:103], v[0:3], v[40:47], v116
    ds_read_b128 v[72:75], v118 offset:14336
    buffer_load_dword v123, v127, s[4:7], s96 offen sc1
    v_smfmac_f32_16x16x64_bf16 v[80:83], v[4:7], a[0:7], v116
    ds_read_b128 v[76:79], v118 offset:15360
    v_smfmac_f32_16x16x64_bf16 v[84:87], v[4:7], a[8:15], v116
    s_waitcnt lgkmcnt(4)
    s_barrier
    ds_read_b128 v[8:11], v117 offset:4096
    buffer_load_dwordx4 v[136:139], v124, s[4:7], s38 offen sc1
    v_smfmac_f32_16x16x64_bf16 v[88:91], v[4:7], a[80:87], v116
    s_and_b32 s19, s18, 1
    s_lshl_b32 s19, s19, 18
    ds_read_b128 v[12:15], v117 offset:5120
    v_smfmac_f32_16x16x64_bf16 v[92:95], v[4:7], a[88:95], v116
    s_add_u32 s40, s19, s34
    ds_read_b128 v[16:19], v117 offset:6144
    buffer_load_dwordx4 v[128:131], v117, s[4:7], s97 offen sc1
    v_smfmac_f32_16x16x64_bf16 v[96:99], v[4:7], a[160:167], v116
    s_add_u32 s40, s40, 58785792
    s_add_u32 s41, s40, 4096
    ds_read_b128 v[20:23], v117 offset:7168
    v_smfmac_f32_16x16x64_bf16 v[100:103], v[4:7], a[168:175], v116
    s_waitcnt lgkmcnt(3)
    ds_read_b128 v[24:27], v117 offset:0
    buffer_load_dwordx4 v[140:143], v124, s[4:7], s38 offen offset:2048 sc1
    v_smfmac_f32_16x16x64_bf16 v[80:83], v[8:11], a[16:23], v116
    s_lshl_b32 s42, s16, 13
    s_add_u32 s42, s42, s19
    ds_read_b128 v[28:31], v117 offset:1024
    v_smfmac_f32_16x16x64_bf16 v[84:87], v[8:11], a[24:31], v116
    s_waitcnt lgkmcnt(4)
    ds_read_b128 v[32:35], v118 offset:16384
    buffer_load_dwordx4 v[132:135], v117, s[4:7], s97 offen offset:1024 sc1
    v_smfmac_f32_16x16x64_bf16 v[80:83], v[12:15], a[32:39], v116
    s_add_u32 s42, s42, 58720256
    s_bfe_u32 s46, s18, 0x10001
    ds_read_b128 v[36:39], v118 offset:17408
    v_smfmac_f32_16x16x64_bf16 v[84:87], v[12:15], a[40:47], v116
    s_waitcnt lgkmcnt(2)
    ds_read_b128 v[40:43], v118 offset:18432
    buffer_store_dwordx4 v[108:111], v117, s[4:7], s39 offen sc1
    v_smfmac_f32_16x16x64_bf16 v[80:83], v[16:19], v[64:71], v116
    s_waitcnt lgkmcnt(9)
    s_add_u32 s19, s18, 1
    ds_read_b128 v[44:47], v118 offset:19456
    v_smfmac_f32_16x16x64_bf16 v[84:87], v[16:19], v[72:79], v116
    s_and_b32 s19, s19, 3
    s_lshl_b32 s19, s19, 13
    ds_read_b128 v[64:67], v118 offset:20480
    v_smfmac_f32_16x16x64_bf16 v[80:83], v[20:23], a[48:55], v116
    s_add_u32 s45, s19, 59770880
    ds_read_b128 v[68:71], v118 offset:21504
    v_smfmac_f32_16x16x64_bf16 v[84:87], v[20:23], a[56:63], v116
    ds_read_b128 v[72:75], v118 offset:22528
    v_smfmac_f32_16x16x64_bf16 v[80:83], v[24:27], a[64:71], v116
    ds_read_b128 v[76:79], v118 offset:23552
    v_smfmac_f32_16x16x64_bf16 v[84:87], v[24:27], a[72:79], v116
    s_waitcnt lgkmcnt(4)
    v_smfmac_f32_16x16x64_bf16 v[80:83], v[28:31], v[32:39], v116
    s_nop 1
    v_smfmac_f32_16x16x64_bf16 v[84:87], v[28:31], v[40:47], v116
    s_nop 0
    ds_read_b128 v[32:35], v118 offset:24576
    v_smfmac_f32_16x16x64_bf16 v[88:91], v[8:11], a[96:103], v116
    s_nop 0
    ds_read_b128 v[36:39], v118 offset:25600
    v_add_f32 v80, v80, v82
    v_smfmac_f32_16x16x64_bf16 v[92:95], v[8:11], a[104:111], v116
    ds_read_b128 v[40:43], v118 offset:26624
    v_add_f32 v81, v81, v83
    v_add_f32 v84, v84, v86
    v_smfmac_f32_16x16x64_bf16 v[88:91], v[12:15], a[112:119], v116
    ds_read_b128 v[44:47], v118 offset:27648
    v_add_f32 v85, v85, v87
    v_cvt_pk_bf16_f32 v80, v80, v84
    v_smfmac_f32_16x16x64_bf16 v[92:95], v[12:15], a[120:127], v116
    s_waitcnt lgkmcnt(4)
    v_cvt_pk_bf16_f32 v81, v81, v85
    v_smfmac_f32_16x16x64_bf16 v[88:91], v[16:19], v[64:71], v116
    ds_write2_b32 v119, v80, v81 offset0:0 offset1:16
    v_smfmac_f32_16x16x64_bf16 v[92:95], v[16:19], v[72:79], v116
    v_smfmac_f32_16x16x64_bf16 v[88:91], v[20:23], a[128:135], v116
    v_smfmac_f32_16x16x64_bf16 v[92:95], v[20:23], a[136:143], v116
    v_smfmac_f32_16x16x64_bf16 v[88:91], v[24:27], a[144:151], v116
    s_waitcnt vmcnt(6) lgkmcnt(0)
    s_barrier
    ds_read_b128 v[0:3], v120 offset:0
    v_smfmac_f32_16x16x64_bf16 v[92:95], v[24:27], a[152:159], v116
    s_waitcnt lgkmcnt(2)
    ds_read_b128 v[4:7], v120 offset:2048
    v_smfmac_f32_16x16x64_bf16 v[88:91], v[28:31], v[32:39], v116
    s_nop 0
    ds_read_b128 v[72:75], v127 offset:15616
    v_smfmac_f32_16x16x64_bf16 v[92:95], v[28:31], v[40:47], v116
    s_nop 2
    v_smfmac_f32_16x16x64_bf16 v[96:99], v[8:11], a[176:183], v116
    s_waitcnt lgkmcnt(2)
    v_add_f32 v88, v88, v90
    v_mfma_f32_16x16x32_bf16 v[80:83], v[56:59], v[0:3], 0
    s_waitcnt lgkmcnt(1)
    v_add_f32 v89, v89, v91
    v_add_f32 v92, v92, v94
    v_mfma_f32_16x16x32_bf16 v[80:83], v[60:63], v[4:7], v[80:83]
    s_nop 0
    v_add_f32 v93, v93, v95
    v_cvt_pk_bf16_f32 v108, v88, v92
    v_smfmac_f32_16x16x64_bf16 v[100:103], v[8:11], a[184:191], v116
    s_nop 1
    v_cvt_pk_bf16_f32 v109, v89, v93
    ds_write2_b32 v119, v108, v109 offset0:128 offset1:144
    v_smfmac_f32_16x16x64_bf16 v[96:99], v[12:15], a[192:199], v116
    v_add_f32_dpp v80, v82, v80 row_ror:8 row_mask:0xf bank_mask:0xf
    v_add_f32_dpp v81, v83, v81 row_ror:8 row_mask:0xf bank_mask:0xf
    v_smfmac_f32_16x16x64_bf16 v[100:103], v[12:15], a[200:207], v116
    v_exp_f32 v82, v80
    v_smfmac_f32_16x16x64_bf16 v[96:99], v[16:19], a[208:215], v116
    v_exp_f32 v83, v81
    v_smfmac_f32_16x16x64_bf16 v[100:103], v[16:19], a[216:223], v116
    s_waitcnt lgkmcnt(0)
    s_barrier
    ds_read_b128 v[8:11], v121 offset:0
    v_cvt_pk_bf16_f32 v82, v82, v83
    s_mov_b64 exec, s[50:51]
    ds_write_b32 v113, v82 offset:14848
    s_mov_b64 exec, -1
    v_smfmac_f32_16x16x64_bf16 v[96:99], v[20:23], a[224:231], v116
    ds_read_b128 v[12:15], v121 offset:2048
    v_smfmac_f32_16x16x64_bf16 v[100:103], v[20:23], a[232:239], v116
    v_smfmac_f32_16x16x64_bf16 v[96:99], v[24:27], a[240:247], v116
    v_smfmac_f32_16x16x64_bf16 v[100:103], v[24:27], a[248:255], v116
    s_waitcnt lgkmcnt(2)
    s_waitcnt lgkmcnt(1)
    s_barrier
    ds_read_b128 v[88:91], v117 offset:14336
    v_mfma_f32_16x16x32_bf16 v[84:87], v[8:11], v[0:3], 0
    s_waitcnt lgkmcnt(1)
    ds_read_b128 v[92:95], v125 offset:14336
    v_mfma_f32_16x16x32_bf16 v[84:87], v[12:15], v[4:7], v[84:87]
    s_nop 1
    v_smfmac_f32_16x16x64_bf16 v[96:99], v[28:31], v[144:151], v116
    s_nop 1
    v_smfmac_f32_16x16x64_bf16 v[100:103], v[28:31], v[152:159], v116
    s_cmp_eq_u32 s18, 63
    s_waitcnt lgkmcnt(1)
    v_add_f32_dpp v84, v86, v84 row_ror:8 row_mask:0xf bank_mask:0xf
    v_add_f32_dpp v85, v87, v85 row_ror:8 row_mask:0xf bank_mask:0xf
    v_mfma_f32_16x16x32_bf16 v[68:71], v[72:75], v[88:91], 0
    s_cbranch_scc1 C1_fin
    v_mul_f32 v84, s49, v84
    v_mul_f32 v85, s49, v85
    v_mfma_f32_16x16x32_bf16 v[64:67], v[48:51], v[88:91], 0
    s_waitcnt lgkmcnt(0)
    v_exp_f32 v86, v84
    v_add_f32 v96, v96, v98
    v_mfma_f32_16x16x32_bf16 v[64:67], v[52:55], v[92:95], v[64:67]
    v_exp_f32 v87, v85
    v_add_f32 v97, v97, v99
    v_add_f32 v100, v100, v102
    s_mov_b64 exec, s[50:51]
    v_cvt_pk_bf16_f32 v104, v86, v87
    s_mov_b64 exec, -1
    v_add_f32 v101, v101, v103
    v_mfma_f32_16x16x16_bf16 v[68:71], v[72:73], v[104:105], v[68:71]
    v_mov_b32_dpp v105, v104 row_ror:8 row_mask:0xf bank_mask:0xf
    v_cvt_pk_bf16_f32 v110, v96, v97
    v_cvt_pk_bf16_f32 v111, v100, v101
    s_nop 1
    v_mfma_f32_16x16x16_bf16 v[64:67], v[110:111], v[104:105], v[64:67]
    s_nop 1
    v_rcp_f32 v106, v68
    v_subrev_u32 v107, s60, v68
    v_cmp_lt_u32 vcc, s61, v107
    v_mov_b32_dpp v106, v106 row_ror:8 row_mask:0xf bank_mask:0xc
    s_nop 1
    v_mul_f32 v64, v106, v64
    v_mul_f32 v65, v106, v65
    v_mul_f32 v66, v106, v66
    v_mul_f32 v67, v106, v67
    v_cvt_pk_bf16_f32 v96, v64, v65
    v_cvt_pk_bf16_f32 v97, v66, v67
    ds_write_b64 v126, v[96:97] offset:12320
    v_mfma_f32_16x16x1_4b_f32 v[32:47], v127, v127, 0
    s_and_b64 vcc, vcc, s[50:51]
    s_cbranch_scc1 C1_slow
C1_back:
    v_mov_b32 v107, 0
    v_mov_b32 v107, 0
    v_mov_b32 v107, 0
    s_waitcnt lgkmcnt(0)
    s_barrier
    ds_read_b128 v[80:83], v117 offset:12288
    ds_read_b128 v[84:87], v117 offset:13312
    v_mfma_f32_16x16x1_4b_f32 v[48:63], v127, v127, 0
    v_mov_b32 v107, 0
    s_waitcnt lgkmcnt(1)
    v_smfmac_f32_16x16x64_bf16 v[32:35], v[80:83], v[160:167], v116
    s_waitcnt lgkmcnt(0)
    ds_read_b128 v[0:3], v118 offset:28672
    v_smfmac_f32_16x16x64_bf16 v[32:35], v[84:87], v[192:199], v116
    s_lshl_b32 s39, s18, 5
    ds_read_b128 v[4:7], v118 offset:29696
    v_smfmac_f32_16x16x64_bf16 v[36:39], v[80:83], v[168:175], v116
    s_add_u32 s39, s39, s16
    ds_read_b128 v[8:11], v118 offset:30720
    v_smfmac_f32_16x16x64_bf16 v[36:39], v[84:87], v[200:207], v116
    s_lshl_b32 s39, s39, 12
    ds_read_b128 v[12:15], v118 offset:31744
    v_add_f32 v32, v32, v34
    v_smfmac_f32_16x16x64_bf16 v[40:43], v[80:83], v[176:183], v116
    s_add_u32 s39, s39, 50332672
    ds_read_b128 v[16:19], v118 offset:32768
    v_add_f32 v33, v33, v35
    v_cvt_pk_bf16_f32 v88, v32, v33
    v_smfmac_f32_16x16x64_bf16 v[40:43], v[84:87], v[208:215], v116
    s_cmp_lt_u32 s18, 62
    ds_read_b128 v[20:23], v118 offset:33792
    v_add_f32 v36, v36, v38
    v_smfmac_f32_16x16x64_bf16 v[44:47], v[80:83], v[184:191], v116
    s_cselect_b32 s19, 524288, 0
    ds_read_b128 v[24:27], v118 offset:34816
    v_add_f32 v37, v37, v39
    v_cvt_pk_bf16_f32 v89, v36, v37
    v_and_or_b32 v89, v89, -2, s46
    v_smfmac_f32_16x16x64_bf16 v[44:47], v[84:87], v[216:223], v116
    s_add_u32 s38, s38, s19
    ds_read_b128 v[28:31], v118 offset:35840
    buffer_store_dwordx2 v[88:89], v122, s[4:7], s40 offen offset:0
    v_add_f32 v40, v40, v42
    v_smfmac_f32_16x16x64_bf16 v[48:51], v[80:83], v[224:231], v116
    s_waitcnt lgkmcnt(6)
    ds_read_b128 v[64:67], v118 offset:0
    v_add_f32 v41, v41, v43
    v_cvt_pk_bf16_f32 v90, v40, v41
    v_smfmac_f32_16x16x64_bf16 v[48:51], v[84:87], v[0:7], v116
    s_add_u32 s97, s97, s19
    ds_read_b128 v[68:71], v118 offset:1024
    v_add_f32 v44, v44, v46
    v_smfmac_f32_16x16x64_bf16 v[52:55], v[80:83], v[232:239], v116
    s_waitcnt lgkmcnt(6)
    ds_read_b128 v[72:75], v118 offset:2048
    v_add_f32 v45, v45, v47
    v_cvt_pk_bf16_f32 v91, v44, v45
    v_and_or_b32 v91, v91, -2, s46
    v_smfmac_f32_16x16x64_bf16 v[52:55], v[84:87], v[8:15], v116
    s_nop 0
    buffer_store_dwordx2 v[90:91], v122, s[4:7], s40 offen offset:2048
    v_add_f32 v48, v48, v50
    v_smfmac_f32_16x16x64_bf16 v[56:59], v[80:83], v[240:247], v116
    s_waitcnt lgkmcnt(3)
    ds_read_b128 v[76:79], v118 offset:3072
    v_add_f32 v49, v49, v51
    v_cvt_pk_bf16_f32 v92, v48, v49
    v_smfmac_f32_16x16x64_bf16 v[56:59], v[84:87], v[16:23], v116
    s_nop 0
    v_add_f32 v52, v52, v54
    v_smfmac_f32_16x16x64_bf16 v[60:63], v[80:83], v[248:255], v116
    s_nop 0
    v_add_f32 v53, v53, v55
    v_cvt_pk_bf16_f32 v93, v52, v53
    v_and_or_b32 v93, v93, -2, s46
    v_smfmac_f32_16x16x64_bf16 v[60:63], v[84:87], v[24:31], v116
    buffer_store_dwordx2 v[92:93], v122, s[4:7], s41 offen offset:0
    v_add_f32 v56, v56, v58
    v_add_f32 v57, v57, v59
    v_cvt_pk_bf16_f32 v94, v56, v57
    s_nop 3
    v_add_f32 v60, v60, v62
    v_add_f32 v61, v61, v63
    v_cvt_pk_bf16_f32 v95, v60, v61
    v_and_or_b32 v95, v95, -2, s46
    buffer_store_dwordx2 v[94:95], v122, s[4:7], s41 offen offset:2048
    v_mov_b32 v96, 0
    v_mov_b32 v97, 0
    v_mov_b32 v98, 0
    ds_read_b128 v[16:19], v118 offset:4096
    v_mov_b32 v99, 0
    v_mov_b32 v100, 0
    v_mov_b32 v101, 0
    ds_read_b128 v[20:23], v118 offset:5120
    v_mov_b32 v102, 0
    v_mov_b32 v103, 0
    v_mov_b32 v80, 0
    ds_read_b128 v[24:27], v118 offset:6144
    v_mov_b32 v81, 0
    v_mov_b32 v82, 0
    v_mov_b32 v83, 0
    ds_read_b128 v[28:31], v118 offset:7168
    v_mov_b32 v84, 0
    v_mov_b32 v85, 0
    v_mov_b32 v86, 0
    ds_read_b128 v[32:35], v118 offset:8192
    v_mov_b32 v87, 0
    v_mov_b32 v88, 0
    v_mov_b32 v89, 0
    ds_read_b128 v[36:39], v118 offset:9216
    v_mov_b32 v90, 0
    v_mov_b32 v91, 0
    v_mov_b32 v92, 0
    ds_read_b128 v[40:43], v118 offset:10240
    v_mov_b32 v93, 0
    v_mov_b32 v94, 0
    v_mov_b32 v95, 0
    ds_read_b128 v[44:47], v118 offset:11264
    s_waitcnt vmcnt(5)
    v_mov_b32 v48, v128
    v_mov_b32 v49, v129
    v_mov_b32 v50, v130
    v_mov_b32 v51, v131
    v_mov_b32 v52, v132
    v_mov_b32 v53, v133
    v_mov_b32 v54, v134
    v_mov_b32 v55, v135
    v_mov_b32 v56, v136
    v_mov_b32 v57, v137
    v_mov_b32 v58, v138
    v_mov_b32 v59, v139
    v_mov_b32 v60, v140
    v_mov_b32 v61, v141
    v_mov_b32 v62, v142
    v_mov_b32 v63, v143
    v_cmp_ne_u32 vcc, 1, v123
    s_cbranch_vccnz C1_flg
C1_flg_ok:
    s_cmp_lt_u32 s18, 61
    s_cselect_b32 s19, 4, 0
    s_add_u32 s96, s96, s19
    s_barrier
    buffer_load_dwordx4 v[0:3], v117, s[4:7], s45 offen offset:0 sc1
    v_mov_b32 v107, 0
    s_add_u32 s18, s18, 1
    buffer_load_dwordx4 v[4:7], v117, s[4:7], s45 offen offset:1024 sc1
    v_mov_b32 v107, 0
    s_nop 2
    v_mov_b32 v107, 0
    s_nop 2
    v_mov_b32 v107, 0
    s_nop 2
    v_mov_b32 v107, 0
    s_nop 2
    v_mov_b32 v107, 0
    s_nop 2
    v_mov_b32 v107, 0
    s_nop 2
    v_mov_b32 v107, 0
    s_nop 2
    buffer_load_dwordx4 v[0:3], v117, s[4:7], s45 offen offset:0 sc1
    buffer_load_dwordx4 v[4:7], v117, s[4:7], s45 offen offset:1024 sc1
    v_mov_b32 v107, 0
    s_nop 2
    v_mov_b32 v107, 0
    s_nop 2
    v_mov_b32 v107, 0
    s_nop 2
    v_mov_b32 v107, 0
    s_nop 2
    s_branch C1_step
C1_re2:
    buffer_load_dwordx4 v[0:3], v117, s[4:7], s45 offen offset:0 sc1
    buffer_load_dwordx4 v[4:7], v117, s[4:7], s45 offen offset:1024 sc1
    s_add_u32 s55, s55, 1
    s_sub_u32 s48, s48, 1
    s_nop 0
    v_mfma_f32_16x16x1_4b_f32 v[80:95], v127, v127, 0
    s_cbranch_scc0 C1_step
C1_bail:
    s_endpgm
C1_flg:
    buffer_load_dword v123, v127, s[4:7], s96 offen sc1
    s_sub_u32 s48, s48, 1
    s_cbranch_scc1 C1_bail
    s_waitcnt vmcnt(0)
    v_cmp_ne_u32 vcc, 1, v123
    s_cbranch_vccnz C1_flg
    s_branch C1_flg_ok
C1_slow:
    v_max3_f32 v106, v80, v81, v84
    v_max_f32 v106, v106, v85
    v_mov_b32 v107, v106
    s_nop 1
    v_permlane32_swap_b32 v107, v106
    v_max_f32 v106, v106, v107
    v_mov_b32 v107, v106
    s_nop 1
    v_permlane16_swap_b32 v107, v106
    v_max_f32 v106, v106, v107
    ds_write_b32 v117, v106 offset:4
    s_waitcnt lgkmcnt(0)
    s_barrier
    ds_read_b128 v[96:99], v117 offset:0
    s_waitcnt lgkmcnt(0)
    v_max3_f32 v106, v96, v97, v98
    v_max_f32 v106, v106, v99
    v_sub_f32 v82, v80, v106
    v_exp_f32 v82, v82
    v_sub_f32 v83, v81, v106
    v_exp_f32 v83, v83
    v_sub_f32 v86, v84, v106
    v_exp_f32 v86, v86
    v_sub_f32 v87, v85, v106
    v_exp_f32 v87, v87
    v_cvt_pk_bf16_f32 v82, v82, v83
    s_mov_b64 exec, s[50:51]
    ds_write_b32 v113, v82 offset:14848
    s_mov_b64 exec, -1
    s_waitcnt lgkmcnt(0)
    s_barrier
    ds_read_b128 v[88:91], v117 offset:14336
    ds_read_b128 v[92:95], v125 offset:14336
    s_waitcnt lgkmcnt(0)
    v_mfma_f32_16x16x32_bf16 v[68:71], v[72:75], v[88:91], 0
    v_mfma_f32_16x16x32_bf16 v[64:67], v[48:51], v[88:91], 0
    v_mfma_f32_16x16x32_bf16 v[64:67], v[52:55], v[92:95], v[64:67]
    s_mov_b64 exec, s[50:51]
    v_cvt_pk_bf16_f32 v104, v86, v87
    s_mov_b64 exec, -1
    s_nop 0
    v_mfma_f32_16x16x16_bf16 v[68:71], v[72:73], v[104:105], v[68:71]
    v_mov_b32_dpp v105, v104 row_ror:8 row_mask:0xf bank_mask:0xf
    s_nop 1
    v_mfma_f32_16x16x16_bf16 v[64:67], v[110:111], v[104:105], v[64:67]
    s_nop 1
    s_nop 1
    v_rcp_f32 v106, v68
    v_subrev_u32 v107, s60, v68
    v_cmp_lt_u32 vcc, s61, v107
    v_mov_b32_dpp v106, v106 row_ror:8 row_mask:0xf bank_mask:0xc
    v_mul_f32 v64, v106, v64
    v_mul_f32 v65, v106, v65
    v_mul_f32 v66, v106, v66
    v_mul_f32 v67, v106, v67
    v_cvt_pk_bf16_f32 v96, v64, v65
    v_cvt_pk_bf16_f32 v97, v66, v67
    ds_write_b64 v126, v[96:97] offset:12320
    s_branch C1_back
C1_fin:
    v_add_f32 v96, v96, v98
    v_add_f32 v97, v97, v99
    v_add_f32 v100, v100, v102
    v_add_f32 v101, v101, v103
    v_cvt_pk_bf16_f32 v110, v96, v97
    v_cvt_pk_bf16_f32 v111, v100, v101
    s_add_u32 s39, s39, 131072
    buffer_store_dwordx4 v[108:111], v117, s[4:7], s39 offen sc1
    s_endpgm
D1_step:
    s_waitcnt vmcnt(3)
    s_waitcnt lgkmcnt(0)
    v_max3_u32 v106, v0, v1, v2
    v_max_u32 v106, v106, v3
    v_smfmac_f32_16x16x64_bf16 v[80:83], v[0:3], v[64:71], v116
    ds_write_b128 v117, v[0:3] offset:2048
    v_smfmac_f32_16x16x64_bf16 v[84:87], v[0:3], v[72:79], v116
    s_waitcnt vmcnt(2)
    v_max3_u32 v106, v106, v4, v5
    v_max3_u32 v106, v106, v6, v7
    v_cmp_eq_u32 vcc, -1, v106
    v_smfmac_f32_16x16x64_bf16 v[88:91], v[0:3], v[16:23], v116
    ds_write_b128 v117, v[4:7] offset:3072
    v_smfmac_f32_16x16x64_bf16 v[92:95], v[0:3], v[24:31], v116
    s_cbranch_vccnz D1_re2
    ds_read_b128 v[64:67], v118 offset:12288
    v_smfmac_f32_16x16x64_bf16 v[96:99], v[0:3], v[32:39], v116
    ds_read_b128 v[68:71], v118 offset:13312
    v_smfmac_f32_16x16x64_bf16 v[100:103], v[0:3], v[40:47], v116
    ds_read_b128 v[72:75], v118 offset:14336
    buffer_load_dword v123, v127, s[4:7], s96 offen sc1
    v_smfmac_f32_16x16x64_bf16 v[80:83], v[4:7], a[0:7], v116
    ds_read_b128 v[76:79], v118 offset:15360
    v_smfmac_f32_16x16x64_bf16 v[84:87], v[4:7], a[8:15], v116
    s_waitcnt lgkmcnt(4)
    s_barrier
    ds_read_b128 v[8:11], v117 offset:4096
    buffer_load_dwordx4 v[136:139], v124, s[4:7], s38 offen sc1
    v_smfmac_f32_16x16x64_bf16 v[88:91], v[4:7], a[80:87], v116
    s_and_b32 s19, s18, 1
    s_lshl_b32 s19, s19, 18
    ds_read_b128 v[12:15], v117 offset:5120
    v_smfmac_f32_16x16x64_bf16 v[92:95], v[4:7], a[88:95], v116
    s_add_u32 s40, s19, s34
    ds_read_b128 v[16:19], v117 offset:6144
    buffer_load_dwordx4 v[128:131], v117, s[4:7], s97 offen sc1
    v_smfmac_f32_16x16x64_bf16 v[96:99], v[4:7], a[160:167], v116
    s_add_u32 s40, s40, 58785792
    s_add_u32 s41, s40, 4096
    ds_read_b128 v[20:23], v117 offset:7168
    v_smfmac_f32_16x16x64_bf16 v[100:103], v[4:7], a[168:175], v116
    s_waitcnt lgkmcnt(3)
    ds_read_b128 v[24:27], v117 offset:0
    buffer_load_dwordx4 v[140:143], v124, s[4:7], s38 offen offset:2048 sc1
    v_smfmac_f32_16x16x64_bf16 v[80:83], v[8:11], a[16:23], v116
    s_lshl_b32 s42, s16, 13
    s_add_u32 s42, s42, s19
    ds_read_b128 v[28:31], v117 offset:1024
    v_smfmac_f32_16x16x64_bf16 v[84:87], v[8:11], a[24:31], v116
    s_waitcnt lgkmcnt(4)
    ds_read_b128 v[32:35], v118 offset:16384
    buffer_load_dwordx4 v[132:135], v117, s[4:7], s97 offen offset:1024 sc1
    v_smfmac_f32_16x16x64_bf16 v[80:83], v[12:15], a[32:39], v116
    s_add_u32 s42, s42, 58720256
    s_bfe_u32 s46, s18, 0x10001
    ds_read_b128 v[36:39], v118 offset:17408
    v_smfmac_f32_16x16x64_bf16 v[84:87], v[12:15], a[40:47], v116
    s_waitcnt lgkmcnt(2)
    ds_read_b128 v[40:43], v118 offset:18432
    buffer_store_dwordx4 v[108:111], v117, s[4:7], s39 offen sc1
    v_smfmac_f32_16x16x64_bf16 v[80:83], v[16:19], v[64:71], v116
    s_waitcnt lgkmcnt(9)
    s_add_u32 s19, s18, 1
    ds_read_b128 v[44:47], v118 offset:19456
    v_smfmac_f32_16x16x64_bf16 v[84:87], v[16:19], v[72:79], v116
    s_and_b32 s19, s19, 3
    s_lshl_b32 s19, s19, 13
    ds_read_b128 v[64:67], v118 offset:20480
    v_smfmac_f32_16x16x64_bf16 v[80:83], v[20:23], a[48:55], v116
    s_add_u32 s45, s19, 59770880
    ds_read_b128 v[68:71], v118 offset:21504
    v_smfmac_f32_16x16x64_bf16 v[84:87], v[20:23], a[56:63], v116
    ds_read_b128 v[72:75], v118 offset:22528
    v_smfmac_f32_16x16x64_bf16 v[80:83], v[24:27], a[64:71], v116
    ds_read_b128 v[76:79], v118 offset:23552
    v_smfmac_f32_16x16x64_bf16 v[84:87], v[24:27], a[72:79], v116
    s_waitcnt lgkmcnt(4)
    v_smfmac_f32_16x16x64_bf16 v[80:83], v[28:31], v[32:39], v116
    s_nop 1
    v_smfmac_f32_16x16x64_bf16 v[84:87], v[28:31], v[40:47], v116
    s_nop 0
    ds_read_b128 v[32:35], v118 offset:24576
    v_smfmac_f32_16x16x64_bf16 v[88:91], v[8:11], a[96:103], v116
    s_nop 0
    ds_read_b128 v[36:39], v118 offset:25600
    v_add_f32 v80, v80, v82
    v_smfmac_f32_16x16x64_bf16 v[92:95], v[8:11], a[104:111], v116
    ds_read_b128 v[40:43], v118 offset:26624
    v_add_f32 v81, v81, v83
    v_add_f32 v84, v84, v86
    v_smfmac_f32_16x16x64_bf16 v[88:91], v[12:15], a[112:119], v116
    ds_read_b128 v[44:47], v118 offset:27648
    v_add_f32 v85, v85, v87
    v_cvt_pk_bf16_f32 v80, v80, v84
    v_smfmac_f32_16x16x64_bf16 v[92:95], v[12:15], a[120:127], v116
    s_waitcnt lgkmcnt(4)
    v_cvt_pk_bf16_f32 v81, v81, v85
    v_smfmac_f32_16x16x64_bf16 v[88:91], v[16:19], v[64:71], v116
    ds_write2_b32 v119, v80, v81 offset0:0 offset1:16
    v_smfmac_f32_16x16x64_bf16 v[92:95], v[16:19], v[72:79], v116
    v_smfmac_f32_16x16x64_bf16 v[88:91], v[20:23], a[128:135], v116
    v_smfmac_f32_16x16x64_bf16 v[92:95], v[20:23], a[136:143], v116
    v_smfmac_f32_16x16x64_bf16 v[88:91], v[24:27], a[144:151], v116
    s_waitcnt vmcnt(6) lgkmcnt(0)
    s_barrier
    ds_read_b128 v[0:3], v120 offset:0
    v_smfmac_f32_16x16x64_bf16 v[92:95], v[24:27], a[152:159], v116
    s_waitcnt lgkmcnt(2)
    ds_read_b128 v[4:7], v120 offset:2048
    v_smfmac_f32_16x16x64_bf16 v[88:91], v[28:31], v[32:39], v116
    s_nop 0
    ds_read_b128 v[72:75], v127 offset:15616
    v_smfmac_f32_16x16x64_bf16 v[92:95], v[28:31], v[40:47], v116
    s_nop 2
    v_smfmac_f32_16x16x64_bf16 v[96:99], v[8:11], a[176:183], v116
    s_waitcnt lgkmcnt(2)
    v_add_f32 v88, v88, v90
    v_mfma_f32_16x16x32_bf16 v[80:83], v[56:59], v[0:3], 0
    s_waitcnt lgkmcnt(1)
    v_add_f32 v89, v89, v91
    v_add_f32 v92, v92, v94
    v_mfma_f32_16x16x32_bf16 v[80:83], v[60:63], v[4:7], v[80:83]
    s_nop 0
    v_add_f32 v93, v93, v95
    v_cvt_pk_bf16_f32 v108, v88, v92
    v_smfmac_f32_16x16x64_bf16 v[100:103], v[8:11], a[184:191], v116
    s_nop 1
    v_cvt_pk_bf16_f32 v109, v89, v93
    ds_write2_b32 v119, v108, v109 offset0:128 offset1:144
    v_smfmac_f32_16x16x64_bf16 v[96:99], v[12:15], a[192:199], v116
    v_add_f32_dpp v80, v82, v80 row_ror:8 row_mask:0xf bank_mask:0xf
    v_add_f32_dpp v81, v83, v81 row_ror:8 row_mask:0xf bank_mask:0xf
    v_smfmac_f32_16x16x64_bf16 v[100:103], v[12:15], a[200:207], v116
    v_exp_f32 v82, v80
    v_smfmac_f32_16x16x64_bf16 v[96:99], v[16:19], a[208:215], v116
    v_exp_f32 v83, v81
    v_smfmac_f32_16x16x64_bf16 v[100:103], v[16:19], a[216:223], v116
    s_waitcnt lgkmcnt(0)
    s_barrier
    ds_read_b128 v[8:11], v121 offset:0
    v_cvt_pk_bf16_f32 v82, v82, v83
    s_mov_b64 exec, s[50:51]
    ds_write_b32 v113, v82 offset:14848
    s_mov_b64 exec, -1
    v_smfmac_f32_16x16x64_bf16 v[96:99], v[20:23], a[224:231], v116
    ds_read_b128 v[12:15], v121 offset:2048
    v_smfmac_f32_16x16x64_bf16 v[100:103], v[20:23], a[232:239], v116
    v_smfmac_f32_16x16x64_bf16 v[96:99], v[24:27], a[240:247], v116
    v_smfmac_f32_16x16x64_bf16 v[100:103], v[24:27], a[248:255], v116
    s_waitcnt lgkmcnt(2)
    s_waitcnt lgkmcnt(1)
    s_barrier
    ds_read_b128 v[88:91], v117 offset:14336
    v_mfma_f32_16x16x32_bf16 v[84:87], v[8:11], v[0:3], 0
    s_waitcnt lgkmcnt(1)
    ds_read_b128 v[92:95], v125 offset:14336
    v_mfma_f32_16x16x32_bf16 v[84:87], v[12:15], v[4:7], v[84:87]
    s_nop 1
    v_smfmac_f32_16x16x64_bf16 v[96:99], v[28:31], v[144:151], v116
    s_nop 1
    v_smfmac_f32_16x16x64_bf16 v[100:103], v[28:31], v[152:159], v116
    s_cmp_eq_u32 s18, 63
    s_waitcnt lgkmcnt(1)
    v_add_f32_dpp v84, v86, v84 row_ror:8 row_mask:0xf bank_mask:0xf
    v_add_f32_dpp v85, v87, v85 row_ror:8 row_mask:0xf bank_mask:0xf
    v_mfma_f32_16x16x32_bf16 v[68:71], v[72:75], v[88:91], 0
    s_cbranch_scc1 D1_fin
    v_mul_f32 v84, s49, v84
    v_mul_f32 v85, s49, v85
    v_mfma_f32_16x16x32_bf16 v[64:67], v[48:51], v[88:91], 0
    s_waitcnt lgkmcnt(0)
    v_exp_f32 v86, v84
    v_add_f32 v96, v96, v98
    v_mfma_f32_16x16x32_bf16 v[64:67], v[52:55], v[92:95], v[64:67]
    v_exp_f32 v87, v85
    v_add_f32 v97, v97, v99
    v_add_f32 v100, v100, v102
    s_mov_b64 exec, s[50:51]
    v_cvt_pk_bf16_f32 v104, v86, v87
    s_mov_b64 exec, -1
    v_add_f32 v101, v101, v103
    v_mfma_f32_16x16x16_bf16 v[68:71], v[72:73], v[104:105], v[68:71]
    v_mov_b32_dpp v105, v104 row_ror:8 row_mask:0xf bank_mask:0xf
    v_cvt_pk_bf16_f32 v110, v96, v97
    v_cvt_pk_bf16_f32 v111, v100, v101
    s_nop 1
    v_mfma_f32_16x16x16_bf16 v[64:67], v[110:111], v[104:105], v[64:67]
    s_nop 1
    v_rcp_f32 v106, v68
    v_subrev_u32 v107, s60, v68
    v_cmp_lt_u32 vcc, s61, v107
    v_mov_b32_dpp v106, v106 row_ror:8 row_mask:0xf bank_mask:0xc
    s_nop 1
    v_mul_f32 v64, v106, v64
    v_mul_f32 v65, v106, v65
    v_mul_f32 v66, v106, v66
    v_mul_f32 v67, v106, v67
    v_cvt_pk_bf16_f32 v96, v64, v65
    v_cvt_pk_bf16_f32 v97, v66, v67
    ds_write_b64 v126, v[96:97] offset:12320
    v_mfma_f32_16x16x1_4b_f32 v[32:47], v127, v127, 0
    s_and_b64 vcc, vcc, s[50:51]
    s_cbranch_scc1 D1_slow
D1_back:
    v_mov_b32 v107, 0
    v_mov_b32 v107, 0
    v_mov_b32 v107, 0
    s_waitcnt lgkmcnt(0)
    s_barrier
    ds_read_b128 v[80:83], v117 offset:12288
    ds_read_b128 v[84:87], v117 offset:13312
    v_mfma_f32_16x16x1_4b_f32 v[48:63], v127, v127, 0
    v_mov_b32 v107, 0
    s_waitcnt lgkmcnt(1)
    v_smfmac_f32_16x16x64_bf16 v[32:35], v[80:83], v[160:167], v116
    s_waitcnt lgkmcnt(0)
    ds_read_b128 v[0:3], v118 offset:28672
    v_smfmac_f32_16x16x64_bf16 v[32:35], v[84:87], v[192:199], v116
    s_lshl_b32 s39, s18, 5
    ds_read_b128 v[4:7], v118 offset:29696
    v_smfmac_f32_16x16x64_bf16 v[36:39], v[80:83], v[168:175], v116
    s_add_u32 s39, s39, s16
    ds_read_b128 v[8:11], v118 offset:30720
    v_smfmac_f32_16x16x64_bf16 v[36:39], v[84:87], v[200:207], v116
    s_lshl_b32 s39, s39, 12
    ds_read_b128 v[12:15], v118 offset:31744
    v_add_f32 v32, v32, v34
    v_smfmac_f32_16x16x64_bf16 v[40:43], v[80:83], v[176:183], v116
    s_add_u32 s39, s39, 50332672
    ds_read_b128 v[16:19], v118 offset:32768
    v_add_f32 v33, v33, v35
    v_cvt_pk_bf16_f32 v88, v32, v33
    v_smfmac_f32_16x16x64_bf16 v[40:43], v[84:87], v[208:215], v116
    s_cmp_lt_u32 s18, 62
    ds_read_b128 v[20:23], v118 offset:33792
    v_add_f32 v36, v36, v38
    v_smfmac_f32_16x16x64_bf16 v[44:47], v[80:83], v[184:191], v116
    s_cselect_b32 s19, 524288, 0
    ds_read_b128 v[24:27], v118 offset:34816
    v_add_f32 v37, v37, v39
    v_cvt_pk_bf16_f32 v89, v36, v37
    v_and_or_b32 v89, v89, -2, s46
    v_smfmac_f32_16x16x64_bf16 v[44:47], v[84:87], v[216:223], v116
    s_add_u32 s38, s38, s19
    ds_read_b128 v[28:31], v118 offset:35840
    buffer_store_dwordx2 v[88:89], v122, s[4:7], s40 offen offset:0 sc1
    v_add_f32 v40, v40, v42
    v_smfmac_f32_16x16x64_bf16 v[48:51], v[80:83], v[224:231], v116
    s_waitcnt lgkmcnt(6)
    ds_read_b128 v[64:67], v118 offset:0
    v_add_f32 v41, v41, v43
    v_cvt_pk_bf16_f32 v90, v40, v41
    v_smfmac_f32_16x16x64_bf16 v[48:51], v[84:87], v[0:7], v116
    s_add_u32 s97, s97, s19
    ds_read_b128 v[68:71], v118 offset:1024
    v_add_f32 v44, v44, v46
    v_smfmac_f32_16x16x64_bf16 v[52:55], v[80:83], v[232:239], v116
    s_waitcnt lgkmcnt(6)
    ds_read_b128 v[72:75], v118 offset:2048
    v_add_f32 v45, v45, v47
    v_cvt_pk_bf16_f32 v91, v44, v45
    v_and_or_b32 v91, v91, -2, s46
    v_smfmac_f32_16x16x64_bf16 v[52:55], v[84:87], v[8:15], v116
    s_nop 0
    buffer_store_dwordx2 v[90:91], v122, s[4:7], s40 offen offset:2048 sc1
    v_add_f32 v48, v48, v50
    v_smfmac_f32_16x16x64_bf16 v[56:59], v[80:83], v[240:247], v116
    s_waitcnt lgkmcnt(3)
    ds_read_b128 v[76:79], v118 offset:3072
    v_add_f32 v49, v49, v51
    v_cvt_pk_bf16_f32 v92, v48, v49
    v_smfmac_f32_16x16x64_bf16 v[56:59], v[84:87], v[16:23], v116
    s_nop 0
    v_add_f32 v52, v52, v54
    v_smfmac_f32_16x16x64_bf16 v[60:63], v[80:83], v[248:255], v116
    s_nop 0
    v_add_f32 v53, v53, v55
    v_cvt_pk_bf16_f32 v93, v52, v53
    v_and_or_b32 v93, v93, -2, s46
    v_smfmac_f32_16x16x64_bf16 v[60:63], v[84:87], v[24:31], v116
    buffer_store_dwordx2 v[92:93], v122, s[4:7], s41 offen offset:0 sc1
    v_add_f32 v56, v56, v58
    v_add_f32 v57, v57, v59
    v_cvt_pk_bf16_f32 v94, v56, v57
    s_nop 3
    v_add_f32 v60, v60, v62
    v_add_f32 v61, v61, v63
    v_cvt_pk_bf16_f32 v95, v60, v61
    v_and_or_b32 v95, v95, -2, s46
    buffer_store_dwordx2 v[94:95], v122, s[4:7], s41 offen offset:2048 sc1
    v_mov_b32 v96, 0
    v_mov_b32 v97, 0
    v_mov_b32 v98, 0
    ds_read_b128 v[16:19], v118 offset:4096
    v_mov_b32 v99, 0
    v_mov_b32 v100, 0
    v_mov_b32 v101, 0
    ds_read_b128 v[20:23], v118 offset:5120
    v_mov_b32 v102, 0
    v_mov_b32 v103, 0
    v_mov_b32 v80, 0
    ds_read_b128 v[24:27], v118 offset:6144
    v_mov_b32 v81, 0
    v_mov_b32 v82, 0
    v_mov_b32 v83, 0
    ds_read_b128 v[28:31], v118 offset:7168
    v_mov_b32 v84, 0
    v_mov_b32 v85, 0
    v_mov_b32 v86, 0
    ds_read_b128 v[32:35], v118 offset:8192
    v_mov_b32 v87, 0
    v_mov_b32 v88, 0
    v_mov_b32 v89, 0
    ds_read_b128 v[36:39], v118 offset:9216
    v_mov_b32 v90, 0
    v_mov_b32 v91, 0
    v_mov_b32 v92, 0
    ds_read_b128 v[40:43], v118 offset:10240
    v_mov_b32 v93, 0
    v_mov_b32 v94, 0
    v_mov_b32 v95, 0
    ds_read_b128 v[44:47], v118 offset:11264
    s_waitcnt vmcnt(5)
    v_mov_b32 v48, v128
    v_mov_b32 v49, v129
    v_mov_b32 v50, v130
    v_mov_b32 v51, v131
    v_mov_b32 v52, v132
    v_mov_b32 v53, v133
    v_mov_b32 v54, v134
    v_mov_b32 v55, v135
    v_mov_b32 v56, v136
    v_mov_b32 v57, v137
    v_mov_b32 v58, v138
    v_mov_b32 v59, v139
    v_mov_b32 v60, v140
    v_mov_b32 v61, v141
    v_mov_b32 v62, v142
    v_mov_b32 v63, v143
    v_cmp_ne_u32 vcc, 1, v123
    s_cbranch_vccnz D1_flg
D1_flg_ok:
    s_cmp_lt_u32 s18, 61
    s_cselect_b32 s19, 4, 0
    s_add_u32 s96, s96, s19
    s_barrier
    buffer_load_dwordx4 v[0:3], v117, s[4:7], s45 offen offset:0 sc1
    v_mov_b32 v107, 0
    s_add_u32 s18, s18, 1
    buffer_load_dwordx4 v[4:7], v117, s[4:7], s45 offen offset:1024 sc1
    v_mov_b32 v107, 0
    s_nop 2
    v_mov_b32 v107, 0
    s_nop 2
    v_mov_b32 v107, 0
    s_nop 2
    v_mov_b32 v107, 0
    s_nop 2
    v_mov_b32 v107, 0
    s_nop 2
    v_mov_b32 v107, 0
    s_nop 2
    v_mov_b32 v107, 0
    s_nop 2
    buffer_load_dwordx4 v[0:3], v117, s[4:7], s45 offen offset:0 sc1
    buffer_load_dwordx4 v[4:7], v117, s[4:7], s45 offen offset:1024 sc1
    v_mov_b32 v107, 0
    s_nop 2
    v_mov_b32 v107, 0
    s_nop 2
    v_mov_b32 v107, 0
    s_nop 2
    v_mov_b32 v107, 0
    s_nop 2
    s_branch D1_step
D1_re2:
    buffer_load_dwordx4 v[0:3], v117, s[4:7], s45 offen offset:0 sc1
    buffer_load_dwordx4 v[4:7], v117, s[4:7], s45 offen offset:1024 sc1
    s_add_u32 s55, s55, 1
    s_sub_u32 s48, s48, 1
    s_nop 0
    v_mfma_f32_16x16x1_4b_f32 v[80:95], v127, v127, 0
    s_cbranch_scc0 D1_step
D1_bail:
    s_endpgm
D1_flg:
    buffer_load_dword v123, v127, s[4:7], s96 offen sc1
    s_sub_u32 s48, s48, 1
    s_cbranch_scc1 D1_bail
    s_waitcnt vmcnt(0)
    v_cmp_ne_u32 vcc, 1, v123
    s_cbranch_vccnz D1_flg
    s_branch D1_flg_ok
D1_slow:
    v_max3_f32 v106, v80, v81, v84
    v_max_f32 v106, v106, v85
    v_mov_b32 v107, v106
    s_nop 1
    v_permlane32_swap_b32 v107, v106
    v_max_f32 v106, v106, v107
    v_mov_b32 v107, v106
    s_nop 1
    v_permlane16_swap_b32 v107, v106
    v_max_f32 v106, v106, v107
    ds_write_b32 v117, v106 offset:4
    s_waitcnt lgkmcnt(0)
    s_barrier
    ds_read_b128 v[96:99], v117 offset:0
    s_waitcnt lgkmcnt(0)
    v_max3_f32 v106, v96, v97, v98
    v_max_f32 v106, v106, v99
    v_sub_f32 v82, v80, v106
    v_exp_f32 v82, v82
    v_sub_f32 v83, v81, v106
    v_exp_f32 v83, v83
    v_sub_f32 v86, v84, v106
    v_exp_f32 v86, v86
    v_sub_f32 v87, v85, v106
    v_exp_f32 v87, v87
    v_cvt_pk_bf16_f32 v82, v82, v83
    s_mov_b64 exec, s[50:51]
    ds_write_b32 v113, v82 offset:14848
    s_mov_b64 exec, -1
    s_waitcnt lgkmcnt(0)
    s_barrier
    ds_read_b128 v[88:91], v117 offset:14336
    ds_read_b128 v[92:95], v125 offset:14336
    s_waitcnt lgkmcnt(0)
    v_mfma_f32_16x16x32_bf16 v[68:71], v[72:75], v[88:91], 0
    v_mfma_f32_16x16x32_bf16 v[64:67], v[48:51], v[88:91], 0
    v_mfma_f32_16x16x32_bf16 v[64:67], v[52:55], v[92:95], v[64:67]
    s_mov_b64 exec, s[50:51]
    v_cvt_pk_bf16_f32 v104, v86, v87
    s_mov_b64 exec, -1
    s_nop 0
    v_mfma_f32_16x16x16_bf16 v[68:71], v[72:73], v[104:105], v[68:71]
    v_mov_b32_dpp v105, v104 row_ror:8 row_mask:0xf bank_mask:0xf
    s_nop 1
    v_mfma_f32_16x16x16_bf16 v[64:67], v[110:111], v[104:105], v[64:67]
    s_nop 1
    s_nop 1
    v_rcp_f32 v106, v68
    v_subrev_u32 v107, s60, v68
    v_cmp_lt_u32 vcc, s61, v107
    v_mov_b32_dpp v106, v106 row_ror:8 row_mask:0xf bank_mask:0xc
    v_mul_f32 v64, v106, v64
    v_mul_f32 v65, v106, v65
    v_mul_f32 v66, v106, v66
    v_mul_f32 v67, v106, v67
    v_cvt_pk_bf16_f32 v96, v64, v65
    v_cvt_pk_bf16_f32 v97, v66, v67
    ds_write_b64 v126, v[96:97] offset:12320
    s_branch D1_back
D1_fin:
    v_add_f32 v96, v96, v98
    v_add_f32 v97, v97, v99
    v_add_f32 v100, v100, v102
    v_add_f32 v101, v101, v103
    v_cvt_pk_bf16_f32 v110, v96, v97
    v_cvt_pk_bf16_f32 v111, v100, v101
    s_add_u32 s39, s39, 131072
    buffer_store_dwordx4 v[108:111], v117, s[4:7], s39 offen sc1
    s_endpgm
C2_entry:
    v_and_b32 v68, 63, v0
    v_lshlrev_b32 v117, 4, v68
    v_xor_b32 v125, 128, v117
    v_add_u32 v118, 90112, v117
    v_lshrrev_b32 v69, 4, v68
    v_and_b32 v70, 15, v68
    v_bfe_u32 v71, v68, 1, 1
    v_mul_u32_u24 v116, 0xaaaa, v71
    v_add_u32 v116, 0x4444, v116
    v_lshlrev_b32 v119, 2, v70
    v_xor_b32 v119, 0, v119
    v_lshl_add_u32 v119, v69, 7, v119
    v_add_u32 v119, 10240, v119
    v_lshrrev_b32 v64, 2, v70
    v_and_b32 v65, 1, v70
    v_lshl_add_u32 v66, v64, 1, v65
    v_lshlrev_b32 v67, 1, v71
    v_xor_b32 v67, v67, v69
    v_lshlrev_b32 v121, 4, v67
    v_lshl_add_u32 v121, v66, 6, v121
    v_lshl_add_u32 v121, v71, 10, v121
    v_add_u32 v121, 8704, v121
    v_lshrrev_b32 v72, 3, v70
    v_and_b32 v73, 7, v70
    v_lshlrev_b32 v67, 1, v72
    v_xor_b32 v67, v67, v69
    v_lshlrev_b32 v120, 4, v67
    v_lshl_add_u32 v120, v73, 6, v120
    v_lshl_add_u32 v120, v72, 10, v120
    v_add_u32 v120, 8192, v120
    v_lshrrev_b32 v67, 1, v73
    v_lshlrev_b32 v126, 6, v67
    v_lshl_add_u32 v126, v65, 4, v126
    v_lshl_add_u32 v126, v72, 3, v126
    v_lshl_add_u32 v126, v69, 8, v126
    v_lshrrev_b32 v67, 3, v68
    v_lshlrev_b32 v122, 13, v67
    v_lshl_add_u32 v122, v73, 3, v122
    v_lshlrev_b32 v123, 8, v69
    v_lshl_add_u32 v123, v70, 2, v123
    v_lshlrev_b32 v124, 8, v69
    v_lshl_add_u32 v124, v66, 4, v124
    v_lshl_add_u32 v124, v71, 10, v124
    v_lshlrev_b32 v106, 10, v66
    v_lshl_add_u32 v106, v71, 5, v106
    v_and_b32 v67, 1, v69
    v_lshl_add_u32 v106, v67, 3, v106
    v_lshrrev_b32 v67, 1, v69
    v_lshl_add_u32 v106, v67, 2, v106
    v_mov_b32 v104, 0
    v_mov_b32 v105, 0
    v_mov_b32 v127, 0
    v_mov_b32 v108, 0
    v_mov_b32 v109, 0
    v_mov_b32 v110, 0
    v_mov_b32 v111, 0
    v_mov_b32 v112, -1
    v_mov_b32 v113, -1
    v_mov_b32 v114, -1
    v_mov_b32 v115, -1
    s_mov_b32 s50, 0x00ff00ff
    s_mov_b32 s51, s50
    s_mov_b32 s49, 0x3e0293ee
    s_mov_b32 s60, 0x30800000
    s_mov_b32 s61, 0x1e000000
    s_mov_b32 s48, 400000
    s_mov_b32 s54, 0
    s_mov_b32 s55, 0
    s_lshl_b32 s36, s16, 8
    s_lshl_b32 s37, s16, 17
    s_lshr_b32 s52, s16, 3
    s_lshl_b32 s52, s52, 11
    s_and_b32 s19, s16, 1
    s_lshl_b32 s19, s19, 10
    s_add_u32 s52, s52, s19
    s_and_b32 s19, s16, 6
    s_lshl_b32 s19, s19, 5
    s_add_u32 s52, s52, s19
    s_lshl_b32 s19, s16, 13
    s_add_u32 s19, s19, 58982400
    buffer_store_dwordx4 v[112:115], v117, s[4:7], s19 offen offset:0 sc1
    buffer_store_dwordx4 v[112:115], v117, s[4:7], s19 offen offset:1024 sc1
    buffer_store_dwordx4 v[112:115], v117, s[4:7], s19 offen offset:2048 sc1
    buffer_store_dwordx4 v[112:115], v117, s[4:7], s19 offen offset:3072 sc1
    s_add_u32 s19, s52, 59785216
    buffer_store_dword v112, v123, s[4:7], s19 offen sc1
    s_mov_b32 s20, s74
    s_and_b32 s21, s75, 0xffff
    s_mov_b32 s22, 0x400000
    s_mov_b32 s23, 0x20000
    s_mov_b32 s24, s76
    s_and_b32 s25, s77, 0xffff
    s_mov_b32 s26, 0x400000
    s_mov_b32 s27, 0x20000
    s_mov_b32 s28, s78
    s_and_b32 s29, s79, 0xffff
    s_mov_b32 s30, 0x400000
    s_mov_b32 s31, 0x20000
    s_mov_b32 s32, s80
    s_and_b32 s33, s81, 0xffff
    s_mov_b32 s34, 0x400000
    s_mov_b32 s35, 0x20000
    v_lshrrev_b32 v80, 4, v117
    v_lshrrev_b32 v81, 4, v80
    v_and_b32 v82, 1, v81
    v_lshlrev_b32 v64, 6, v82
    v_lshrrev_b32 v82, 1, v81
    v_lshl_add_u32 v64, v82, 4, v64
    v_lshlrev_b32 v64, 13, v64
    v_add_u32 v82, 0, v81
    v_lshlrev_b32 v82, 1, v82
    v_and_b32 v83, 15, v80
    v_xor_b32 v82, v82, v83
    v_lshl_add_u32 v64, v82, 4, v64
    v_lshrrev_b32 v82, 5, v80
    v_lshlrev_b32 v65, 4, v82
    v_bfe_u32 v82, v80, 4, 1
    v_lshl_add_u32 v65, v82, 5, v65
    v_bfe_u32 v82, v80, 3, 1
    v_add_u32 v65, v82, v65
    v_lshlrev_b32 v65, 10, v65
    v_and_b32 v82, 7, v80
    v_lshl_add_u32 v65, v82, 4, v65
    v_lshrrev_b32 v81, 2, v80
    v_lshlrev_b32 v66, 7, v81
    v_bfe_u32 v82, v80, 1, 1
    v_lshl_add_u32 v66, v82, 6, v66
    v_and_b32 v82, 1, v80
    v_lshl_add_u32 v66, v82, 3, v66
    v_add_u32 v66, 90112, v66
    v_and_b32 v82, 7, v81
    v_xor_b32 v82, 4, v82
    v_lshlrev_b32 v68, 8, v81
    v_lshl_add_u32 v68, v82, 5, v68
    v_and_b32 v82, 3, v80
    v_lshl_add_u32 v68, v82, 3, v68
    v_xor_b32 v69, 32, v68
    v_add_u32 v72, 45056, v68
    v_add_u32 v73, 45056, v69
    v_add_u32 v74, 81920, v68
    v_add_u32 v75, 81920, v69
    v_add_u32 v76, 118784, v68
    v_add_u32 v77, 118784, v69
    v_add_u32 v78, 155648, v68
    v_add_u32 v79, 155648, v69
    s_mov_b32 m0, 90112
    s_add_u32 s19, s37, 512
    buffer_load_dwordx4 v65, s[32:35], s19 offen lds
    s_mov_b32 m0, 91136
    s_add_u32 s19, s37, 4608
    buffer_load_dwordx4 v65, s[32:35], s19 offen lds
    s_mov_b32 m0, 92160
    s_add_u32 s19, s37, 2560
    buffer_load_dwordx4 v65, s[32:35], s19 offen lds
    s_mov_b32 m0, 93184
    s_add_u32 s19, s37, 6656
    buffer_load_dwordx4 v65, s[32:35], s19 offen lds
    s_mov_b32 m0, 94208
    s_add_u32 s19, s37, 8704
    buffer_load_dwordx4 v65, s[32:35], s19 offen lds
    s_mov_b32 m0, 95232
    s_add_u32 s19, s37, 12800
    buffer_load_dwordx4 v65, s[32:35], s19 offen lds
    s_mov_b32 m0, 96256
    s_add_u32 s19, s37, 10752
    buffer_load_dwordx4 v65, s[32:35], s19 offen lds
    s_mov_b32 m0, 97280
    s_add_u32 s19, s37, 14848
    buffer_load_dwordx4 v65, s[32:35], s19 offen lds
    s_mov_b32 m0, 98304
    s_add_u32 s19, s37, 66048
    buffer_load_dwordx4 v65, s[32:35], s19 offen lds
    s_mov_b32 m0, 99328
    s_add_u32 s19, s37, 70144
    buffer_load_dwordx4 v65, s[32:35], s19 offen lds
    s_mov_b32 m0, 100352
    s_add_u32 s19, s37, 68096
    buffer_load_dwordx4 v65, s[32:35], s19 offen lds
    s_mov_b32 m0, 101376
    s_add_u32 s19, s37, 72192
    buffer_load_dwordx4 v65, s[32:35], s19 offen lds
    s_mov_b32 m0, 102400
    s_add_u32 s19, s37, 74240
    buffer_load_dwordx4 v65, s[32:35], s19 offen lds
    s_mov_b32 m0, 103424
    s_add_u32 s19, s37, 78336
    buffer_load_dwordx4 v65, s[32:35], s19 offen lds
    s_mov_b32 m0, 104448
    s_add_u32 s19, s37, 76288
    buffer_load_dwordx4 v65, s[32:35], s19 offen lds
    s_mov_b32 m0, 105472
    s_add_u32 s19, s37, 80384
    buffer_load_dwordx4 v65, s[32:35], s19 offen lds
    s_mov_b32 m0, 106496
    s_add_u32 s19, s37, 640
    buffer_load_dwordx4 v65, s[32:35], s19 offen lds
    s_mov_b32 m0, 107520
    s_add_u32 s19, s37, 4736
    buffer_load_dwordx4 v65, s[32:35], s19 offen lds
    s_mov_b32 m0, 108544
    s_add_u32 s19, s37, 2688
    buffer_load_dwordx4 v65, s[32:35], s19 offen lds
    s_mov_b32 m0, 109568
    s_add_u32 s19, s37, 6784
    buffer_load_dwordx4 v65, s[32:35], s19 offen lds
    s_mov_b32 m0, 110592
    s_add_u32 s19, s37, 8832
    buffer_load_dwordx4 v65, s[32:35], s19 offen lds
    s_mov_b32 m0, 111616
    s_add_u32 s19, s37, 12928
    buffer_load_dwordx4 v65, s[32:35], s19 offen lds
    s_mov_b32 m0, 112640
    s_add_u32 s19, s37, 10880
    buffer_load_dwordx4 v65, s[32:35], s19 offen lds
    s_mov_b32 m0, 113664
    s_add_u32 s19, s37, 14976
    buffer_load_dwordx4 v65, s[32:35], s19 offen lds
    s_waitcnt vmcnt(16)
    ds_read_b64_tr_b16 v[160:161], v66 offset:0
    ds_read_b64_tr_b16 v[162:163], v66 offset:2048
    ds_read_b64_tr_b16 v[164:165], v66 offset:4096
    ds_read_b64_tr_b16 v[166:167], v66 offset:6144
    ds_read_b64_tr_b16 v[168:169], v66 offset:16
    ds_read_b64_tr_b16 v[170:171], v66 offset:2064
    ds_read_b64_tr_b16 v[172:173], v66 offset:4112
    ds_read_b64_tr_b16 v[174:175], v66 offset:6160
    ds_read_b64_tr_b16 v[176:177], v66 offset:32
    ds_read_b64_tr_b16 v[178:179], v66 offset:2080
    ds_read_b64_tr_b16 v[180:181], v66 offset:4128
    ds_read_b64_tr_b16 v[182:183], v66 offset:6176
    ds_read_b64_tr_b16 v[184:185], v66 offset:48
    ds_read_b64_tr_b16 v[186:187], v66 offset:2096
    ds_read_b64_tr_b16 v[188:189], v66 offset:4144
    ds_read_b64_tr_b16 v[190:191], v66 offset:6192
    s_waitcnt lgkmcnt(0)
    s_mov_b32 m0, 90112
    s_add_u32 s19, s37, 66176
    buffer_load_dwordx4 v65, s[32:35], s19 offen lds
    s_mov_b32 m0, 91136
    s_add_u32 s19, s37, 70272
    buffer_load_dwordx4 v65, s[32:35], s19 offen lds
    s_mov_b32 m0, 92160
    s_add_u32 s19, s37, 68224
    buffer_load_dwordx4 v65, s[32:35], s19 offen lds
    s_mov_b32 m0, 93184
    s_add_u32 s19, s37, 72320
    buffer_load_dwordx4 v65, s[32:35], s19 offen lds
    s_mov_b32 m0, 94208
    s_add_u32 s19, s37, 74368
    buffer_load_dwordx4 v65, s[32:35], s19 offen lds
    s_mov_b32 m0, 95232
    s_add_u32 s19, s37, 78464
    buffer_load_dwordx4 v65, s[32:35], s19 offen lds
    s_mov_b32 m0, 96256
    s_add_u32 s19, s37, 76416
    buffer_load_dwordx4 v65, s[32:35], s19 offen lds
    s_mov_b32 m0, 97280
    s_add_u32 s19, s37, 80512
    buffer_load_dwordx4 v65, s[32:35], s19 offen lds
    s_mov_b32 m0, 2048
    s_add_u32 s19, s36, 32768
    buffer_load_dwordx4 v64, s[20:23], s19 offen lds
    s_mov_b32 m0, 6144
    s_add_u32 s19, s36, 98304
    buffer_load_dwordx4 v64, s[20:23], s19 offen lds
    s_mov_b32 m0, 10240
    s_add_u32 s19, s36, 49152
    buffer_load_dwordx4 v64, s[20:23], s19 offen lds
    s_mov_b32 m0, 14336
    s_add_u32 s19, s36, 114688
    buffer_load_dwordx4 v64, s[20:23], s19 offen lds
    s_mov_b32 m0, 47104
    s_add_u32 s19, s36, 294912
    buffer_load_dwordx4 v64, s[20:23], s19 offen lds
    s_mov_b32 m0, 83968
    s_add_u32 s19, s36, 360448
    buffer_load_dwordx4 v64, s[20:23], s19 offen lds
    s_mov_b32 m0, 120832
    s_add_u32 s19, s36, 311296
    buffer_load_dwordx4 v64, s[20:23], s19 offen lds
    s_mov_b32 m0, 157696
    s_add_u32 s19, s36, 376832
    buffer_load_dwordx4 v64, s[20:23], s19 offen lds
    s_waitcnt vmcnt(24)
    ds_read_b64_tr_b16 v[192:193], v66 offset:8192
    ds_read_b64_tr_b16 v[194:195], v66 offset:10240
    ds_read_b64_tr_b16 v[196:197], v66 offset:12288
    ds_read_b64_tr_b16 v[198:199], v66 offset:14336
    ds_read_b64_tr_b16 v[200:201], v66 offset:8208
    ds_read_b64_tr_b16 v[202:203], v66 offset:10256
    ds_read_b64_tr_b16 v[204:205], v66 offset:12304
    ds_read_b64_tr_b16 v[206:207], v66 offset:14352
    ds_read_b64_tr_b16 v[208:209], v66 offset:8224
    ds_read_b64_tr_b16 v[210:211], v66 offset:10272
    ds_read_b64_tr_b16 v[212:213], v66 offset:12320
    ds_read_b64_tr_b16 v[214:215], v66 offset:14368
    ds_read_b64_tr_b16 v[216:217], v66 offset:8240
    ds_read_b64_tr_b16 v[218:219], v66 offset:10288
    ds_read_b64_tr_b16 v[220:221], v66 offset:12336
    ds_read_b64_tr_b16 v[222:223], v66 offset:14384
    s_waitcnt vmcnt(16)
    ds_read_b64_tr_b16 v[224:225], v66 offset:16384
    ds_read_b64_tr_b16 v[226:227], v66 offset:18432
    ds_read_b64_tr_b16 v[228:229], v66 offset:20480
    ds_read_b64_tr_b16 v[230:231], v66 offset:22528
    ds_read_b64_tr_b16 v[232:233], v66 offset:16400
    ds_read_b64_tr_b16 v[234:235], v66 offset:18448
    ds_read_b64_tr_b16 v[236:237], v66 offset:20496
    ds_read_b64_tr_b16 v[238:239], v66 offset:22544
    ds_read_b64_tr_b16 v[240:241], v66 offset:16416
    ds_read_b64_tr_b16 v[242:243], v66 offset:18464
    ds_read_b64_tr_b16 v[244:245], v66 offset:20512
    ds_read_b64_tr_b16 v[246:247], v66 offset:22560
    ds_read_b64_tr_b16 v[248:249], v66 offset:16432
    ds_read_b64_tr_b16 v[250:251], v66 offset:18480
    ds_read_b64_tr_b16 v[252:253], v66 offset:20528
    ds_read_b64_tr_b16 v[254:255], v66 offset:22576
    s_waitcnt vmcnt(8)
    ds_read_b64_tr_b16 v[32:33], v66 offset:0
    ds_read_b64_tr_b16 v[34:35], v66 offset:2048
    ds_read_b64_tr_b16 v[36:37], v66 offset:4096
    ds_read_b64_tr_b16 v[38:39], v66 offset:6144
    ds_read_b64_tr_b16 v[40:41], v66 offset:16
    ds_read_b64_tr_b16 v[42:43], v66 offset:2064
    ds_read_b64_tr_b16 v[44:45], v66 offset:4112
    ds_read_b64_tr_b16 v[46:47], v66 offset:6160
    ds_read_b64_tr_b16 v[48:49], v66 offset:32
    ds_read_b64_tr_b16 v[50:51], v66 offset:2080
    ds_read_b64_tr_b16 v[52:53], v66 offset:4128
    ds_read_b64_tr_b16 v[54:55], v66 offset:6176
    ds_read_b64_tr_b16 v[56:57], v66 offset:48
    ds_read_b64_tr_b16 v[58:59], v66 offset:2096
    ds_read_b64_tr_b16 v[60:61], v66 offset:4144
    ds_read_b64_tr_b16 v[62:63], v66 offset:6192
    s_waitcnt lgkmcnt(0)
    s_waitcnt vmcnt(4)
    s_barrier
    s_mov_b32 m0, 51200
    s_add_u32 s19, s36, 1081344
    buffer_load_dwordx4 v64, s[20:23], s19 offen lds
    s_mov_b32 m0, 88064
    s_add_u32 s19, s36, 1146880
    buffer_load_dwordx4 v64, s[20:23], s19 offen lds
    s_mov_b32 m0, 124928
    s_add_u32 s19, s36, 1097728
    buffer_load_dwordx4 v64, s[20:23], s19 offen lds
    s_mov_b32 m0, 161792
    s_add_u32 s19, s36, 1163264
    buffer_load_dwordx4 v64, s[20:23], s19 offen lds
    ds_read_b64_tr_b16 v[0:1], v68 offset:0
    ds_read_b64_tr_b16 v[2:3], v68 offset:4096
    ds_read_b64_tr_b16 v[4:5], v68 offset:8192
    ds_read_b64_tr_b16 v[6:7], v68 offset:12288
    ds_read_b64_tr_b16 v[8:9], v69 offset:0
    ds_read_b64_tr_b16 v[10:11], v69 offset:4096
    ds_read_b64_tr_b16 v[12:13], v69 offset:8192
    ds_read_b64_tr_b16 v[14:15], v69 offset:12288
    s_waitcnt lgkmcnt(0)
    ds_write_b128 v118, v[0:3] offset:12288
    ds_write_b128 v118, v[4:7] offset:13312
    ds_write_b128 v118, v[8:11] offset:14336
    ds_write_b128 v118, v[12:15] offset:15360
    s_waitcnt lgkmcnt(0)
    s_waitcnt vmcnt(4)
    s_barrier
    s_mov_b32 m0, 2048
    s_add_u32 s19, s36, 1343488
    buffer_load_dwordx4 v64, s[20:23], s19 offen lds
    s_mov_b32 m0, 6144
    s_add_u32 s19, s36, 1409024
    buffer_load_dwordx4 v64, s[20:23], s19 offen lds
    s_mov_b32 m0, 10240
    s_add_u32 s19, s36, 1359872
    buffer_load_dwordx4 v64, s[20:23], s19 offen lds
    s_mov_b32 m0, 14336
    s_add_u32 s19, s36, 1425408
    buffer_load_dwordx4 v64, s[20:23], s19 offen lds
    ds_read_b32 v84, v127 offset:40960
    s_waitcnt lgkmcnt(0)
    v_readfirstlane_b32 s19, v84
    s_nop 0
    s_bitcmp1_b32 s19, s93
    s_cbranch_scc1 L_lost
    ds_read_b64_tr_b16 a[48:49], v72 offset:0
    ds_read_b64_tr_b16 a[50:51], v74 offset:0
    ds_read_b64_tr_b16 a[52:53], v76 offset:0
    ds_read_b64_tr_b16 a[54:55], v78 offset:0
    ds_read_b64_tr_b16 a[56:57], v73 offset:0
    ds_read_b64_tr_b16 a[58:59], v75 offset:0
    ds_read_b64_tr_b16 a[60:61], v77 offset:0
    ds_read_b64_tr_b16 a[62:63], v79 offset:0
    s_waitcnt lgkmcnt(0)
    s_waitcnt vmcnt(4)
    s_barrier
    s_mov_b32 m0, 47104
    s_add_u32 s19, s36, 2129920
    buffer_load_dwordx4 v64, s[20:23], s19 offen lds
    s_mov_b32 m0, 83968
    s_add_u32 s19, s36, 2195456
    buffer_load_dwordx4 v64, s[20:23], s19 offen lds
    s_mov_b32 m0, 120832
    s_add_u32 s19, s36, 2146304
    buffer_load_dwordx4 v64, s[20:23], s19 offen lds
    s_mov_b32 m0, 157696
    s_add_u32 s19, s36, 2211840
    buffer_load_dwordx4 v64, s[20:23], s19 offen lds
    ds_read_b64_tr_b16 a[64:65], v72 offset:4096
    ds_read_b64_tr_b16 a[66:67], v74 offset:4096
    ds_read_b64_tr_b16 a[68:69], v76 offset:4096
    ds_read_b64_tr_b16 a[70:71], v78 offset:4096
    ds_read_b64_tr_b16 a[72:73], v73 offset:4096
    ds_read_b64_tr_b16 a[74:75], v75 offset:4096
    ds_read_b64_tr_b16 a[76:77], v77 offset:4096
    ds_read_b64_tr_b16 a[78:79], v79 offset:4096
    s_waitcnt lgkmcnt(0)
    s_waitcnt vmcnt(4)
    s_barrier
    s_mov_b32 m0, 51200
    s_add_u32 s19, s36, 2392064
    buffer_load_dwordx4 v64, s[20:23], s19 offen lds
    s_mov_b32 m0, 88064
    s_add_u32 s19, s36, 2457600
    buffer_load_dwordx4 v64, s[20:23], s19 offen lds
    s_mov_b32 m0, 124928
    s_add_u32 s19, s36, 2408448
    buffer_load_dwordx4 v64, s[20:23], s19 offen lds
    s_mov_b32 m0, 161792
    s_add_u32 s19, s36, 2473984
    buffer_load_dwordx4 v64, s[20:23], s19 offen lds
    ds_read_b64_tr_b16 v[0:1], v68 offset:0
    ds_read_b64_tr_b16 v[2:3], v68 offset:4096
    ds_read_b64_tr_b16 v[4:5], v68 offset:8192
    ds_read_b64_tr_b16 v[6:7], v68 offset:12288
    ds_read_b64_tr_b16 v[8:9], v69 offset:0
    ds_read_b64_tr_b16 v[10:11], v69 offset:4096
    ds_read_b64_tr_b16 v[12:13], v69 offset:8192
    ds_read_b64_tr_b16 v[14:15], v69 offset:12288
    s_waitcnt lgkmcnt(0)
    ds_write_b128 v118, v[0:3] offset:16384
    ds_write_b128 v118, v[4:7] offset:17408
    ds_write_b128 v118, v[8:11] offset:18432
    ds_write_b128 v118, v[12:15] offset:19456
    s_waitcnt lgkmcnt(0)
    s_waitcnt vmcnt(4)
    s_barrier
    s_mov_b32 m0, 2048
    s_add_u32 s19, s36, 3178496
    buffer_load_dwordx4 v64, s[20:23], s19 offen lds
    s_mov_b32 m0, 6144
    s_add_u32 s19, s36, 3244032
    buffer_load_dwordx4 v64, s[20:23], s19 offen lds
    s_mov_b32 m0, 10240
    s_add_u32 s19, s36, 3194880
    buffer_load_dwordx4 v64, s[20:23], s19 offen lds
    s_mov_b32 m0, 14336
    s_add_u32 s19, s36, 3260416
    buffer_load_dwordx4 v64, s[20:23], s19 offen lds
    ds_read_b64_tr_b16 v[0:1], v72 offset:0
    ds_read_b64_tr_b16 v[2:3], v74 offset:0
    ds_read_b64_tr_b16 v[4:5], v76 offset:0
    ds_read_b64_tr_b16 v[6:7], v78 offset:0
    ds_read_b64_tr_b16 v[8:9], v73 offset:0
    ds_read_b64_tr_b16 v[10:11], v75 offset:0
    ds_read_b64_tr_b16 v[12:13], v77 offset:0
    ds_read_b64_tr_b16 v[14:15], v79 offset:0
    s_waitcnt lgkmcnt(0)
    ds_write_b128 v118, v[0:3] offset:0
    ds_write_b128 v118, v[4:7] offset:1024
    ds_write_b128 v118, v[8:11] offset:2048
    ds_write_b128 v118, v[12:15] offset:3072
    s_waitcnt lgkmcnt(0)
    s_waitcnt vmcnt(4)
    s_barrier
    s_mov_b32 m0, 47104
    s_add_u32 s19, s36, 3440640
    buffer_load_dwordx4 v64, s[20:23], s19 offen lds
    s_mov_b32 m0, 83968
    s_add_u32 s19, s36, 3506176
    buffer_load_dwordx4 v64, s[20:23], s19 offen lds
    s_mov_b32 m0, 120832
    s_add_u32 s19, s36, 3457024
    buffer_load_dwordx4 v64, s[20:23], s19 offen lds
    s_mov_b32 m0, 157696
    s_add_u32 s19, s36, 3522560
    buffer_load_dwordx4 v64, s[20:23], s19 offen lds
    ds_read_b64_tr_b16 a[0:1], v72 offset:4096
    ds_read_b64_tr_b16 a[2:3], v74 offset:4096
    ds_read_b64_tr_b16 a[4:5], v76 offset:4096
    ds_read_b64_tr_b16 a[6:7], v78 offset:4096
    ds_read_b64_tr_b16 a[8:9], v73 offset:4096
    ds_read_b64_tr_b16 a[10:11], v75 offset:4096
    ds_read_b64_tr_b16 a[12:13], v77 offset:4096
    ds_read_b64_tr_b16 a[14:15], v79 offset:4096
    s_waitcnt lgkmcnt(0)
    s_waitcnt vmcnt(4)
    s_barrier
    s_mov_b32 m0, 51200
    s_add_u32 s19, s36, 32768
    buffer_load_dwordx4 v64, s[24:27], s19 offen lds
    s_mov_b32 m0, 88064
    s_add_u32 s19, s36, 98304
    buffer_load_dwordx4 v64, s[24:27], s19 offen lds
    s_mov_b32 m0, 124928
    s_add_u32 s19, s36, 49152
    buffer_load_dwordx4 v64, s[24:27], s19 offen lds
    s_mov_b32 m0, 161792
    s_add_u32 s19, s36, 114688
    buffer_load_dwordx4 v64, s[24:27], s19 offen lds
    ds_read_b64_tr_b16 a[16:17], v68 offset:0
    ds_read_b64_tr_b16 a[18:19], v68 offset:4096
    ds_read_b64_tr_b16 a[20:21], v68 offset:8192
    ds_read_b64_tr_b16 a[22:23], v68 offset:12288
    ds_read_b64_tr_b16 a[24:25], v69 offset:0
    ds_read_b64_tr_b16 a[26:27], v69 offset:4096
    ds_read_b64_tr_b16 a[28:29], v69 offset:8192
    ds_read_b64_tr_b16 a[30:31], v69 offset:12288
    s_waitcnt lgkmcnt(0)
    s_waitcnt vmcnt(4)
    s_barrier
    s_mov_b32 m0, 2048
    s_add_u32 s19, s36, 294912
    buffer_load_dwordx4 v64, s[24:27], s19 offen lds
    s_mov_b32 m0, 6144
    s_add_u32 s19, s36, 360448
    buffer_load_dwordx4 v64, s[24:27], s19 offen lds
    s_mov_b32 m0, 10240
    s_add_u32 s19, s36, 311296
    buffer_load_dwordx4 v64, s[24:27], s19 offen lds
    s_mov_b32 m0, 14336
    s_add_u32 s19, s36, 376832
    buffer_load_dwordx4 v64, s[24:27], s19 offen lds
    ds_read_b64_tr_b16 a[32:33], v72 offset:0
    ds_read_b64_tr_b16 a[34:35], v74 offset:0
    ds_read_b64_tr_b16 a[36:37], v76 offset:0
    ds_read_b64_tr_b16 a[38:39], v78 offset:0
    ds_read_b64_tr_b16 a[40:41], v73 offset:0
    ds_read_b64_tr_b16 a[42:43], v75 offset:0
    ds_read_b64_tr_b16 a[44:45], v77 offset:0
    ds_read_b64_tr_b16 a[46:47], v79 offset:0
    s_waitcnt lgkmcnt(0)
    s_waitcnt vmcnt(4)
    s_barrier
    s_mov_b32 m0, 47104
    s_add_u32 s19, s36, 1081344
    buffer_load_dwordx4 v64, s[24:27], s19 offen lds
    s_mov_b32 m0, 83968
    s_add_u32 s19, s36, 1146880
    buffer_load_dwordx4 v64, s[24:27], s19 offen lds
    s_mov_b32 m0, 120832
    s_add_u32 s19, s36, 1097728
    buffer_load_dwordx4 v64, s[24:27], s19 offen lds
    s_mov_b32 m0, 157696
    s_add_u32 s19, s36, 1163264
    buffer_load_dwordx4 v64, s[24:27], s19 offen lds
    ds_read_b64_tr_b16 v[0:1], v72 offset:4096
    ds_read_b64_tr_b16 v[2:3], v74 offset:4096
    ds_read_b64_tr_b16 v[4:5], v76 offset:4096
    ds_read_b64_tr_b16 v[6:7], v78 offset:4096
    ds_read_b64_tr_b16 v[8:9], v73 offset:4096
    ds_read_b64_tr_b16 v[10:11], v75 offset:4096
    ds_read_b64_tr_b16 v[12:13], v77 offset:4096
    ds_read_b64_tr_b16 v[14:15], v79 offset:4096
    s_waitcnt lgkmcnt(0)
    ds_write_b128 v118, v[0:3] offset:20480
    ds_write_b128 v118, v[4:7] offset:21504
    ds_write_b128 v118, v[8:11] offset:22528
    ds_write_b128 v118, v[12:15] offset:23552
    s_waitcnt lgkmcnt(0)
    s_waitcnt vmcnt(4)
    s_barrier
    s_mov_b32 m0, 51200
    s_add_u32 s19, s36, 1343488
    buffer_load_dwordx4 v64, s[24:27], s19 offen lds
    s_mov_b32 m0, 88064
    s_add_u32 s19, s36, 1409024
    buffer_load_dwordx4 v64, s[24:27], s19 offen lds
    s_mov_b32 m0, 124928
    s_add_u32 s19, s36, 1359872
    buffer_load_dwordx4 v64, s[24:27], s19 offen lds
    s_mov_b32 m0, 161792
    s_add_u32 s19, s36, 1425408
    buffer_load_dwordx4 v64, s[24:27], s19 offen lds
    ds_read_b64_tr_b16 a[128:129], v68 offset:0
    ds_read_b64_tr_b16 a[130:131], v68 offset:4096
    ds_read_b64_tr_b16 a[132:133], v68 offset:8192
    ds_read_b64_tr_b16 a[134:135], v68 offset:12288
    ds_read_b64_tr_b16 a[136:137], v69 offset:0
    ds_read_b64_tr_b16 a[138:139], v69 offset:4096
    ds_read_b64_tr_b16 a[140:141], v69 offset:8192
    ds_read_b64_tr_b16 a[142:143], v69 offset:12288
    s_waitcnt lgkmcnt(0)
    s_waitcnt vmcnt(4)
    s_barrier
    s_mov_b32 m0, 2048
    s_add_u32 s19, s36, 2129920
    buffer_load_dwordx4 v64, s[24:27], s19 offen lds
    s_mov_b32 m0, 6144
    s_add_u32 s19, s36, 2195456
    buffer_load_dwordx4 v64, s[24:27], s19 offen lds
    s_mov_b32 m0, 10240
    s_add_u32 s19, s36, 2146304
    buffer_load_dwordx4 v64, s[24:27], s19 offen lds
    s_mov_b32 m0, 14336
    s_add_u32 s19, s36, 2211840
    buffer_load_dwordx4 v64, s[24:27], s19 offen lds
    ds_read_b64_tr_b16 a[144:145], v72 offset:0
    ds_read_b64_tr_b16 a[146:147], v74 offset:0
    ds_read_b64_tr_b16 a[148:149], v76 offset:0
    ds_read_b64_tr_b16 a[150:151], v78 offset:0
    ds_read_b64_tr_b16 a[152:153], v73 offset:0
    ds_read_b64_tr_b16 a[154:155], v75 offset:0
    ds_read_b64_tr_b16 a[156:157], v77 offset:0
    ds_read_b64_tr_b16 a[158:159], v79 offset:0
    s_waitcnt lgkmcnt(0)
    s_waitcnt vmcnt(4)
    s_barrier
    s_mov_b32 m0, 47104
    s_add_u32 s19, s36, 2392064
    buffer_load_dwordx4 v64, s[24:27], s19 offen lds
    s_mov_b32 m0, 83968
    s_add_u32 s19, s36, 2457600
    buffer_load_dwordx4 v64, s[24:27], s19 offen lds
    s_mov_b32 m0, 120832
    s_add_u32 s19, s36, 2408448
    buffer_load_dwordx4 v64, s[24:27], s19 offen lds
    s_mov_b32 m0, 157696
    s_add_u32 s19, s36, 2473984
    buffer_load_dwordx4 v64, s[24:27], s19 offen lds
    ds_read_b64_tr_b16 v[0:1], v72 offset:4096
    ds_read_b64_tr_b16 v[2:3], v74 offset:4096
    ds_read_b64_tr_b16 v[4:5], v76 offset:4096
    ds_read_b64_tr_b16 v[6:7], v78 offset:4096
    ds_read_b64_tr_b16 v[8:9], v73 offset:4096
    ds_read_b64_tr_b16 v[10:11], v75 offset:4096
    ds_read_b64_tr_b16 v[12:13], v77 offset:4096
    ds_read_b64_tr_b16 v[14:15], v79 offset:4096
    s_waitcnt lgkmcnt(0)
    ds_write_b128 v118, v[0:3] offset:24576
    ds_write_b128 v118, v[4:7] offset:25600
    ds_write_b128 v118, v[8:11] offset:26624
    ds_write_b128 v118, v[12:15] offset:27648
    s_waitcnt lgkmcnt(0)
    s_waitcnt vmcnt(4)
    s_barrier
    s_mov_b32 m0, 51200
    s_add_u32 s19, s36, 3178496
    buffer_load_dwordx4 v64, s[24:27], s19 offen lds
    s_mov_b32 m0, 88064
    s_add_u32 s19, s36, 3244032
    buffer_load_dwordx4 v64, s[24:27], s19 offen lds
    s_mov_b32 m0, 124928
    s_add_u32 s19, s36, 3194880
    buffer_load_dwordx4 v64, s[24:27], s19 offen lds
    s_mov_b32 m0, 161792
    s_add_u32 s19, s36, 3260416
    buffer_load_dwordx4 v64, s[24:27], s19 offen lds
    ds_read_b64_tr_b16 v[0:1], v68 offset:0
    ds_read_b64_tr_b16 v[2:3], v68 offset:4096
    ds_read_b64_tr_b16 v[4:5], v68 offset:8192
    ds_read_b64_tr_b16 v[6:7], v68 offset:12288
    ds_read_b64_tr_b16 v[8:9], v69 offset:0
    ds_read_b64_tr_b16 v[10:11], v69 offset:4096
    ds_read_b64_tr_b16 v[12:13], v69 offset:8192
    ds_read_b64_tr_b16 v[14:15], v69 offset:12288
    s_waitcnt lgkmcnt(0)
    ds_write_b128 v118, v[0:3] offset:4096
    ds_write_b128 v118, v[4:7] offset:5120
    ds_write_b128 v118, v[8:11] offset:6144
    ds_write_b128 v118, v[12:15] offset:7168
    s_waitcnt lgkmcnt(0)
    s_waitcnt vmcnt(4)
    s_barrier
    s_mov_b32 m0, 2048
    s_add_u32 s19, s36, 3440640
    buffer_load_dwordx4 v64, s[24:27], s19 offen lds
    s_mov_b32 m0, 6144
    s_add_u32 s19, s36, 3506176
    buffer_load_dwordx4 v64, s[24:27], s19 offen lds
    s_mov_b32 m0, 10240
    s_add_u32 s19, s36, 3457024
    buffer_load_dwordx4 v64, s[24:27], s19 offen lds
    s_mov_b32 m0, 14336
    s_add_u32 s19, s36, 3522560
    buffer_load_dwordx4 v64, s[24:27], s19 offen lds
    ds_read_b64_tr_b16 a[80:81], v72 offset:0
    ds_read_b64_tr_b16 a[82:83], v74 offset:0
    ds_read_b64_tr_b16 a[84:85], v76 offset:0
    ds_read_b64_tr_b16 a[86:87], v78 offset:0
    ds_read_b64_tr_b16 a[88:89], v73 offset:0
    ds_read_b64_tr_b16 a[90:91], v75 offset:0
    ds_read_b64_tr_b16 a[92:93], v77 offset:0
    ds_read_b64_tr_b16 a[94:95], v79 offset:0
    s_waitcnt lgkmcnt(0)
    s_waitcnt vmcnt(4)
    s_barrier
    s_mov_b32 m0, 47104
    s_add_u32 s19, s36, 32768
    buffer_load_dwordx4 v64, s[28:31], s19 offen lds
    s_mov_b32 m0, 83968
    s_add_u32 s19, s36, 98304
    buffer_load_dwordx4 v64, s[28:31], s19 offen lds
    s_mov_b32 m0, 120832
    s_add_u32 s19, s36, 49152
    buffer_load_dwordx4 v64, s[28:31], s19 offen lds
    s_mov_b32 m0, 157696
    s_add_u32 s19, s36, 114688
    buffer_load_dwordx4 v64, s[28:31], s19 offen lds
    ds_read_b64_tr_b16 a[96:97], v72 offset:4096
    ds_read_b64_tr_b16 a[98:99], v74 offset:4096
    ds_read_b64_tr_b16 a[100:101], v76 offset:4096
    ds_read_b64_tr_b16 a[102:103], v78 offset:4096
    ds_read_b64_tr_b16 a[104:105], v73 offset:4096
    ds_read_b64_tr_b16 a[106:107], v75 offset:4096
    ds_read_b64_tr_b16 a[108:109], v77 offset:4096
    ds_read_b64_tr_b16 a[110:111], v79 offset:4096
    s_waitcnt lgkmcnt(0)
    s_waitcnt vmcnt(4)
    s_barrier
    s_mov_b32 m0, 51200
    s_add_u32 s19, s36, 294912
    buffer_load_dwordx4 v64, s[28:31], s19 offen lds
    s_mov_b32 m0, 88064
    s_add_u32 s19, s36, 360448
    buffer_load_dwordx4 v64, s[28:31], s19 offen lds
    s_mov_b32 m0, 124928
    s_add_u32 s19, s36, 311296
    buffer_load_dwordx4 v64, s[28:31], s19 offen lds
    s_mov_b32 m0, 161792
    s_add_u32 s19, s36, 376832
    buffer_load_dwordx4 v64, s[28:31], s19 offen lds
    ds_read_b64_tr_b16 a[112:113], v68 offset:0
    ds_read_b64_tr_b16 a[114:115], v68 offset:4096
    ds_read_b64_tr_b16 a[116:117], v68 offset:8192
    ds_read_b64_tr_b16 a[118:119], v68 offset:12288
    ds_read_b64_tr_b16 a[120:121], v69 offset:0
    ds_read_b64_tr_b16 a[122:123], v69 offset:4096
    ds_read_b64_tr_b16 a[124:125], v69 offset:8192
    ds_read_b64_tr_b16 a[126:127], v69 offset:12288
    s_waitcnt lgkmcnt(0)
    s_waitcnt vmcnt(4)
    s_barrier
    s_mov_b32 m0, 2048
    s_add_u32 s19, s36, 1081344
    buffer_load_dwordx4 v64, s[28:31], s19 offen lds
    s_mov_b32 m0, 6144
    s_add_u32 s19, s36, 1146880
    buffer_load_dwordx4 v64, s[28:31], s19 offen lds
    s_mov_b32 m0, 10240
    s_add_u32 s19, s36, 1097728
    buffer_load_dwordx4 v64, s[28:31], s19 offen lds
    s_mov_b32 m0, 14336
    s_add_u32 s19, s36, 1163264
    buffer_load_dwordx4 v64, s[28:31], s19 offen lds
    ds_read_b64_tr_b16 a[208:209], v72 offset:0
    ds_read_b64_tr_b16 a[210:211], v74 offset:0
    ds_read_b64_tr_b16 a[212:213], v76 offset:0
    ds_read_b64_tr_b16 a[214:215], v78 offset:0
    ds_read_b64_tr_b16 a[216:217], v73 offset:0
    ds_read_b64_tr_b16 a[218:219], v75 offset:0
    ds_read_b64_tr_b16 a[220:221], v77 offset:0
    ds_read_b64_tr_b16 a[222:223], v79 offset:0
    s_waitcnt lgkmcnt(0)
    s_waitcnt vmcnt(4)
    s_barrier
    s_mov_b32 m0, 47104
    s_add_u32 s19, s36, 1343488
    buffer_load_dwordx4 v64, s[28:31], s19 offen lds
    s_mov_b32 m0, 83968
    s_add_u32 s19, s36, 1409024
    buffer_load_dwordx4 v64, s[28:31], s19 offen lds
    s_mov_b32 m0, 120832
    s_add_u32 s19, s36, 1359872
    buffer_load_dwordx4 v64, s[28:31], s19 offen lds
    s_mov_b32 m0, 157696
    s_add_u32 s19, s36, 1425408
    buffer_load_dwordx4 v64, s[28:31], s19 offen lds
    ds_read_b64_tr_b16 a[224:225], v72 offset:4096
    ds_read_b64_tr_b16 a[226:227], v74 offset:4096
    ds_read_b64_tr_b16 a[228:229], v76 offset:4096
    ds_read_b64_tr_b16 a[230:231], v78 offset:4096
    ds_read_b64_tr_b16 a[232:233], v73 offset:4096
    ds_read_b64_tr_b16 a[234:235], v75 offset:4096
    ds_read_b64_tr_b16 a[236:237], v77 offset:4096
    ds_read_b64_tr_b16 a[238:239], v79 offset:4096
    s_waitcnt lgkmcnt(0)
    s_waitcnt vmcnt(4)
    s_barrier
    s_mov_b32 m0, 51200
    s_add_u32 s19, s36, 2129920
    buffer_load_dwordx4 v64, s[28:31], s19 offen lds
    s_mov_b32 m0, 88064
    s_add_u32 s19, s36, 2195456
    buffer_load_dwordx4 v64, s[28:31], s19 offen lds
    s_mov_b32 m0, 124928
    s_add_u32 s19, s36, 2146304
    buffer_load_dwordx4 v64, s[28:31], s19 offen lds
    s_mov_b32 m0, 161792
    s_add_u32 s19, s36, 2211840
    buffer_load_dwordx4 v64, s[28:31], s19 offen lds
    ds_read_b64_tr_b16 a[240:241], v68 offset:0
    ds_read_b64_tr_b16 a[242:243], v68 offset:4096
    ds_read_b64_tr_b16 a[244:245], v68 offset:8192
    ds_read_b64_tr_b16 a[246:247], v68 offset:12288
    ds_read_b64_tr_b16 a[248:249], v69 offset:0
    ds_read_b64_tr_b16 a[250:251], v69 offset:4096
    ds_read_b64_tr_b16 a[252:253], v69 offset:8192
    ds_read_b64_tr_b16 a[254:255], v69 offset:12288
    s_waitcnt lgkmcnt(0)
    s_waitcnt vmcnt(4)
    s_barrier
    s_mov_b32 m0, 2048
    s_add_u32 s19, s36, 2392064
    buffer_load_dwordx4 v64, s[28:31], s19 offen lds
    s_mov_b32 m0, 6144
    s_add_u32 s19, s36, 2457600
    buffer_load_dwordx4 v64, s[28:31], s19 offen lds
    s_mov_b32 m0, 10240
    s_add_u32 s19, s36, 2408448
    buffer_load_dwordx4 v64, s[28:31], s19 offen lds
    s_mov_b32 m0, 14336
    s_add_u32 s19, s36, 2473984
    buffer_load_dwordx4 v64, s[28:31], s19 offen lds
    ds_read_b64_tr_b16 v[144:145], v72 offset:0
    ds_read_b64_tr_b16 v[146:147], v74 offset:0
    ds_read_b64_tr_b16 v[148:149], v76 offset:0
    ds_read_b64_tr_b16 v[150:151], v78 offset:0
    ds_read_b64_tr_b16 v[152:153], v73 offset:0
    ds_read_b64_tr_b16 v[154:155], v75 offset:0
    ds_read_b64_tr_b16 v[156:157], v77 offset:0
    ds_read_b64_tr_b16 v[158:159], v79 offset:0
    s_waitcnt lgkmcnt(0)
    s_waitcnt vmcnt(4)
    s_barrier
    s_mov_b32 m0, 47104
    s_add_u32 s19, s36, 3178496
    buffer_load_dwordx4 v64, s[28:31], s19 offen lds
    s_mov_b32 m0, 83968
    s_add_u32 s19, s36, 3244032
    buffer_load_dwordx4 v64, s[28:31], s19 offen lds
    s_mov_b32 m0, 120832
    s_add_u32 s19, s36, 3194880
    buffer_load_dwordx4 v64, s[28:31], s19 offen lds
    s_mov_b32 m0, 157696
    s_add_u32 s19, s36, 3260416
    buffer_load_dwordx4 v64, s[28:31], s19 offen lds
    ds_read_b64_tr_b16 v[0:1], v72 offset:4096
    ds_read_b64_tr_b16 v[2:3], v74 offset:4096
    ds_read_b64_tr_b16 v[4:5], v76 offset:4096
    ds_read_b64_tr_b16 v[6:7], v78 offset:4096
    ds_read_b64_tr_b16 v[8:9], v73 offset:4096
    ds_read_b64_tr_b16 v[10:11], v75 offset:4096
    ds_read_b64_tr_b16 v[12:13], v77 offset:4096
    ds_read_b64_tr_b16 v[14:15], v79 offset:4096
    s_waitcnt lgkmcnt(0)
    ds_write_b128 v118, v[0:3] offset:8192
    ds_write_b128 v118, v[4:7] offset:9216
    ds_write_b128 v118, v[8:11] offset:10240
    ds_write_b128 v118, v[12:15] offset:11264
    s_waitcnt lgkmcnt(0)
    s_waitcnt vmcnt(4)
    s_barrier
    s_mov_b32 m0, 51200
    s_add_u32 s19, s36, 3440640
    buffer_load_dwordx4 v64, s[28:31], s19 offen lds
    s_mov_b32 m0, 88064
    s_add_u32 s19, s36, 3506176
    buffer_load_dwordx4 v64, s[28:31], s19 offen lds
    s_mov_b32 m0, 124928
    s_add_u32 s19, s36, 3457024
    buffer_load_dwordx4 v64, s[28:31], s19 offen lds
    s_mov_b32 m0, 161792
    s_add_u32 s19, s36, 3522560
    buffer_load_dwordx4 v64, s[28:31], s19 offen lds
    ds_read_b64_tr_b16 a[160:161], v68 offset:0
    ds_read_b64_tr_b16 a[162:163], v68 offset:4096
    ds_read_b64_tr_b16 a[164:165], v68 offset:8192
    ds_read_b64_tr_b16 a[166:167], v68 offset:12288
    ds_read_b64_tr_b16 a[168:169], v69 offset:0
    ds_read_b64_tr_b16 a[170:171], v69 offset:4096
    ds_read_b64_tr_b16 a[172:173], v69 offset:8192
    ds_read_b64_tr_b16 a[174:175], v69 offset:12288
    s_waitcnt lgkmcnt(0)
    s_waitcnt vmcnt(4)
    s_barrier
    ds_read_b64_tr_b16 a[176:177], v72 offset:0
    ds_read_b64_tr_b16 a[178:179], v74 offset:0
    ds_read_b64_tr_b16 a[180:181], v76 offset:0
    ds_read_b64_tr_b16 a[182:183], v78 offset:0
    ds_read_b64_tr_b16 a[184:185], v73 offset:0
    ds_read_b64_tr_b16 a[186:187], v75 offset:0
    ds_read_b64_tr_b16 a[188:189], v77 offset:0
    ds_read_b64_tr_b16 a[190:191], v79 offset:0
    s_waitcnt lgkmcnt(0)
    s_waitcnt vmcnt(0)
    s_barrier
    ds_read_b64_tr_b16 a[192:193], v72 offset:4096
    ds_read_b64_tr_b16 a[194:195], v74 offset:4096
    ds_read_b64_tr_b16 a[196:197], v76 offset:4096
    ds_read_b64_tr_b16 a[198:199], v78 offset:4096
    ds_read_b64_tr_b16 a[200:201], v73 offset:4096
    ds_read_b64_tr_b16 a[202:203], v75 offset:4096
    ds_read_b64_tr_b16 a[204:205], v77 offset:4096
    ds_read_b64_tr_b16 a[206:207], v79 offset:4096
    s_waitcnt lgkmcnt(0)
    s_barrier
    ds_write_b128 v118, v[32:35] offset:28672
    ds_write_b128 v118, v[36:39] offset:29696
    ds_write_b128 v118, v[40:43] offset:30720
    ds_write_b128 v118, v[44:47] offset:31744
    ds_write_b128 v118, v[48:51] offset:32768
    ds_write_b128 v118, v[52:55] offset:33792
    ds_write_b128 v118, v[56:59] offset:34816
    ds_write_b128 v118, v[60:63] offset:35840
    s_mov_b32 s35, s52
    s_lshl_b32 s34, s16, 6
    s_mov_b32 s52, 0
    v_and_b32 v113, 0xf0, v117
    v_bfe_u32 v64, v117, 9, 1
    v_lshl_add_u32 v113, v64, 8, v113
    v_bfe_u32 v64, v117, 8, 1
    v_lshl_add_u32 v113, v64, 2, v113
    s_lshl_b32 s19, s16, 14
    s_add_u32 s38, s19, 4096
    s_add_u32 s97, s19, 12288
    s_mov_b32 s39, 59836416
    s_mov_b32 s45, 59834368
    s_mov_b32 s18, 0
    s_mov_b32 s8, s72
    s_and_b32 s9, s73, 0xffff
    s_mov_b32 s10, 0x2000
    s_mov_b32 s11, 0x20000
    buffer_load_dword v8, v106, s[8:11], 0 offen offset:512
    buffer_load_dword v9, v106, s[8:11], 0 offen offset:640
    buffer_load_dword v10, v106, s[8:11], 0 offen offset:528
    buffer_load_dword v11, v106, s[8:11], 0 offen offset:656
    buffer_load_dword v12, v106, s[8:11], 0 offen offset:576
    buffer_load_dword v13, v106, s[8:11], 0 offen offset:704
    buffer_load_dword v14, v106, s[8:11], 0 offen offset:592
    buffer_load_dword v15, v106, s[8:11], 0 offen offset:720
    s_add_u32 s96, s36, 60817408
    v_bfe_u32 v85, v117, 4, 3
    v_lshlrev_b32 v85, 2, v85
C2_init:
    global_load_dword v84, v85, s[86:87] offset:0 sc1
    s_sub_u32 s48, s48, 1
    s_cbranch_scc1 C2_bail
    s_waitcnt vmcnt(0)
    v_cmp_ne_u32 vcc, -1, v84
    s_cbranch_vccnz C2_init
    global_load_dword v86, v127, s[86:87] offset:96 sc1
    v_and_b32 v85, 4, v85
C2_f01:
    buffer_load_dword v84, v85, s[4:7], s96 offen sc1
    s_sub_u32 s48, s48, 1
    s_cbranch_scc1 C2_bail
    s_waitcnt vmcnt(0)
    v_cmp_ne_u32 vcc, 1, v84
    s_cbranch_vccnz C2_f01
    s_add_u32 s96, s96, 8
    buffer_load_dwordx4 v[136:139], v124, s[4:7], s38 offen sc1
    buffer_load_dwordx4 v[128:131], v117, s[4:7], s97 offen sc1
    buffer_load_dwordx4 v[140:143], v124, s[4:7], s38 offen offset:2048 sc1
    buffer_load_dwordx4 v[132:135], v117, s[4:7], s97 offen offset:1024 sc1
    s_add_u32 s38, s38, 524288
    s_add_u32 s97, s97, 524288
    s_mov_b32 s8, 0x05040100
    s_mov_b32 s9, 0x07060302
    s_waitcnt vmcnt(0) lgkmcnt(0)
    v_cmp_ne_u32 s[58:59], 0, v86
    s_barrier
    v_perm_b32 v0, v9, v8, s8
    v_min_u32 v0, -2, v0
    v_perm_b32 v1, v11, v10, s8
    v_min_u32 v1, -2, v1
    v_perm_b32 v2, v9, v8, s9
    v_min_u32 v2, -2, v2
    v_perm_b32 v3, v11, v10, s9
    v_min_u32 v3, -2, v3
    v_perm_b32 v4, v13, v12, s8
    v_min_u32 v4, -2, v4
    v_perm_b32 v5, v15, v14, s8
    v_min_u32 v5, -2, v5
    v_perm_b32 v6, v13, v12, s9
    v_min_u32 v6, -2, v6
    v_perm_b32 v7, v15, v14, s9
    v_min_u32 v7, -2, v7
    ds_read_b128 v[64:67], v118 offset:0
    ds_read_b128 v[68:71], v118 offset:1024
    ds_read_b128 v[72:75], v118 offset:2048
    ds_read_b128 v[76:79], v118 offset:3072
    ds_read_b128 v[16:19], v118 offset:4096
    ds_read_b128 v[20:23], v118 offset:5120
    ds_read_b128 v[24:27], v118 offset:6144
    ds_read_b128 v[28:31], v118 offset:7168
    ds_read_b128 v[32:35], v118 offset:8192
    ds_read_b128 v[36:39], v118 offset:9216
    ds_read_b128 v[40:43], v118 offset:10240
    ds_read_b128 v[44:47], v118 offset:11264
    v_mov_b32 v48, v128
    v_mov_b32 v49, v129
    v_mov_b32 v50, v130
    v_mov_b32 v51, v131
    v_mov_b32 v52, v132
    v_mov_b32 v53, v133
    v_mov_b32 v54, v134
    v_mov_b32 v55, v135
    v_mov_b32 v56, v136
    v_mov_b32 v57, v137
    v_mov_b32 v58, v138
    v_mov_b32 v59, v139
    v_mov_b32 v60, v140
    v_mov_b32 v61, v141
    v_mov_b32 v62, v142
    v_mov_b32 v63, v143
    v_mov_b32 v80, 0
    v_mov_b32 v81, 0
    v_mov_b32 v82, 0
    v_mov_b32 v83, 0
    v_mov_b32 v84, 0
    v_mov_b32 v85, 0
    v_mov_b32 v86, 0
    v_mov_b32 v87, 0
    v_mov_b32 v88, 0
    v_mov_b32 v89, 0
    v_mov_b32 v90, 0
    v_mov_b32 v91, 0
    v_mov_b32 v92, 0
    v_mov_b32 v93, 0
    v_mov_b32 v94, 0
    v_mov_b32 v95, 0
    v_mov_b32 v96, 0
    v_mov_b32 v97, 0
    v_mov_b32 v98, 0
    v_mov_b32 v99, 0
    v_mov_b32 v100, 0
    v_mov_b32 v101, 0
    v_mov_b32 v102, 0
    v_mov_b32 v103, 0
    s_cmp_lg_u64 s[58:59], 0
    s_cbranch_scc1 D2_step
C2_step:
    s_waitcnt vmcnt(3)
    s_waitcnt lgkmcnt(0)
    v_max3_u32 v106, v0, v1, v2
    v_max_u32 v106, v106, v3
    v_smfmac_f32_16x16x64_bf16 v[80:83], v[0:3], v[64:71], v116
    ds_write_b128 v117, v[0:3] offset:4096
    v_smfmac_f32_16x16x64_bf16 v[84:87], v[0:3], v[72:79], v116
    s_waitcnt vmcnt(2)
    v_max3_u32 v106, v106, v4, v5
    v_max3_u32 v106, v106, v6, v7
    v_cmp_eq_u32 vcc, -1, v106
    v_smfmac_f32_16x16x64_bf16 v[88:91], v[0:3], v[16:23], v116
    ds_write_b128 v117, v[4:7] offset:5120
    v_smfmac_f32_16x16x64_bf16 v[92:95], v[0:3], v[24:31], v116
    s_cbranch_vccnz C2_re2
    ds_read_b128 v[64:67], v118 offset:12288
    v_smfmac_f32_16x16x64_bf16 v[96:99], v[0:3], v[32:39], v116
    ds_read_b128 v[68:71], v118 offset:13312
    v_smfmac_f32_16x16x64_bf16 v[100:103], v[0:3], v[40:47], v116
    ds_read_b128 v[72:75], v118 offset:14336
    v_smfmac_f32_16x16x64_bf16 v[80:83], v[4:7], a[0:7], v116
    ds_read_b128 v[76:79], v118 offset:15360
    buffer_load_dwordx4 v[136:139], v124, s[4:7], s38 offen sc1
    v_smfmac_f32_16x16x64_bf16 v[84:87], v[4:7], a[8:15], v116
    s_waitcnt lgkmcnt(4)
    s_barrier
    ds_read_b128 v[8:11], v117 offset:6144
    v_smfmac_f32_16x16x64_bf16 v[88:91], v[4:7], a[80:87], v116
    s_and_b32 s19, s18, 1
    ds_read_b128 v[12:15], v117 offset:7168
    buffer_load_dwordx4 v[128:131], v117, s[4:7], s97 offen sc1
    v_smfmac_f32_16x16x64_bf16 v[92:95], v[4:7], a[88:95], v116
    s_lshl_b32 s19, s19, 18
    s_add_u32 s40, s19, s34
    ds_read_b128 v[16:19], v117 offset:0
    v_smfmac_f32_16x16x64_bf16 v[96:99], v[4:7], a[160:167], v116
    s_add_u32 s40, s40, 58851328
    ds_read_b128 v[20:23], v117 offset:1024
    buffer_load_dwordx4 v[140:143], v124, s[4:7], s38 offen offset:2048 sc1
    v_smfmac_f32_16x16x64_bf16 v[100:103], v[4:7], a[168:175], v116
    s_waitcnt lgkmcnt(3)
    s_add_u32 s41, s40, 4096
    ds_read_b128 v[24:27], v117 offset:2048
    v_smfmac_f32_16x16x64_bf16 v[80:83], v[8:11], a[16:23], v116
    s_lshl_b32 s42, s16, 13
    ds_read_b128 v[28:31], v117 offset:3072
    buffer_load_dwordx4 v[132:135], v117, s[4:7], s97 offen offset:1024 sc1
    v_smfmac_f32_16x16x64_bf16 v[84:87], v[8:11], a[24:31], v116
    s_waitcnt lgkmcnt(4)
    s_add_u32 s42, s42, s19
    ds_read_b128 v[32:35], v118 offset:16384
    v_smfmac_f32_16x16x64_bf16 v[80:83], v[12:15], a[32:39], v116
    s_add_u32 s42, s42, 58720256
    s_bfe_u32 s46, s18, 0x10001
    ds_read_b128 v[36:39], v118 offset:17408
    v_smfmac_f32_16x16x64_bf16 v[84:87], v[12:15], a[40:47], v116
    s_waitcnt lgkmcnt(2)
    s_add_u32 s19, s18, 1
    ds_read_b128 v[40:43], v118 offset:18432
    v_smfmac_f32_16x16x64_bf16 v[80:83], v[16:19], v[64:71], v116
    s_waitcnt lgkmcnt(9)
    ds_read_b128 v[44:47], v118 offset:19456
    buffer_store_dwordx4 v[108:111], v117, s[4:7], s39 offen sc1
    v_smfmac_f32_16x16x64_bf16 v[84:87], v[16:19], v[72:79], v116
    s_and_b32 s19, s19, 3
    s_lshl_b32 s19, s19, 13
    ds_read_b128 v[64:67], v118 offset:20480
    v_smfmac_f32_16x16x64_bf16 v[80:83], v[20:23], a[48:55], v116
    s_add_u32 s45, s19, 59772928
    ds_read_b128 v[68:71], v118 offset:21504
    v_smfmac_f32_16x16x64_bf16 v[84:87], v[20:23], a[56:63], v116
    ds_read_b128 v[72:75], v118 offset:22528
    v_smfmac_f32_16x16x64_bf16 v[80:83], v[24:27], a[64:71], v116
    ds_read_b128 v[76:79], v118 offset:23552
    v_smfmac_f32_16x16x64_bf16 v[84:87], v[24:27], a[72:79], v116
    s_waitcnt lgkmcnt(4)
    v_smfmac_f32_16x16x64_bf16 v[80:83], v[28:31], v[32:39], v116
    s_nop 1
    v_smfmac_f32_16x16x64_bf16 v[84:87], v[28:31], v[40:47], v116
    s_nop 0
    ds_read_b128 v[32:35], v118 offset:24576
    v_smfmac_f32_16x16x64_bf16 v[88:91], v[8:11], a[96:103], v116
    s_nop 0
    ds_read_b128 v[36:39], v118 offset:25600
    v_add_f32 v80, v80, v82
    v_smfmac_f32_16x16x64_bf16 v[92:95], v[8:11], a[104:111], v116
    ds_read_b128 v[40:43], v118 offset:26624
    v_add_f32 v81, v81, v83
    v_add_f32 v84, v84, v86
    v_smfmac_f32_16x16x64_bf16 v[88:91], v[12:15], a[112:119], v116
    ds_read_b128 v[44:47], v118 offset:27648
    v_add_f32 v85, v85, v87
    v_cvt_pk_bf16_f32 v80, v80, v84
    v_smfmac_f32_16x16x64_bf16 v[92:95], v[12:15], a[120:127], v116
    s_waitcnt lgkmcnt(4)
    v_cvt_pk_bf16_f32 v81, v81, v85
    v_smfmac_f32_16x16x64_bf16 v[88:91], v[16:19], v[64:71], v116
    ds_write2_b32 v119, v80, v81 offset0:0 offset1:16
    v_smfmac_f32_16x16x64_bf16 v[92:95], v[16:19], v[72:79], v116
    v_smfmac_f32_16x16x64_bf16 v[88:91], v[20:23], a[128:135], v116
    v_smfmac_f32_16x16x64_bf16 v[92:95], v[20:23], a[136:143], v116
    v_smfmac_f32_16x16x64_bf16 v[88:91], v[24:27], a[144:151], v116
    s_waitcnt vmcnt(5) lgkmcnt(0)
    s_barrier
    ds_read_b128 v[0:3], v120 offset:0
    v_smfmac_f32_16x16x64_bf16 v[92:95], v[24:27], a[152:159], v116
    s_waitcnt lgkmcnt(2)
    ds_read_b128 v[4:7], v120 offset:2048
    v_smfmac_f32_16x16x64_bf16 v[88:91], v[28:31], v[32:39], v116
    s_nop 0
    ds_read_b128 v[72:75], v127 offset:15616
    v_smfmac_f32_16x16x64_bf16 v[92:95], v[28:31], v[40:47], v116
    s_nop 2
    v_smfmac_f32_16x16x64_bf16 v[96:99], v[8:11], a[176:183], v116
    s_waitcnt lgkmcnt(2)
    v_add_f32 v88, v88, v90
    v_mfma_f32_16x16x32_bf16 v[80:83], v[56:59], v[0:3], 0
    s_waitcnt lgkmcnt(1)
    v_add_f32 v89, v89, v91
    v_add_f32 v92, v92, v94
    v_mfma_f32_16x16x32_bf16 v[80:83], v[60:63], v[4:7], v[80:83]
    s_nop 0
    v_add_f32 v93, v93, v95
    v_cvt_pk_bf16_f32 v108, v88, v92
    v_smfmac_f32_16x16x64_bf16 v[100:103], v[8:11], a[184:191], v116
    s_nop 1
    v_cvt_pk_bf16_f32 v109, v89, v93
    ds_write2_b32 v119, v108, v109 offset0:128 offset1:144
    v_smfmac_f32_16x16x64_bf16 v[96:99], v[12:15], a[192:199], v116
    v_add_f32_dpp v80, v82, v80 row_ror:8 row_mask:0xf bank_mask:0xf
    v_add_f32_dpp v81, v83, v81 row_ror:8 row_mask:0xf bank_mask:0xf
    v_smfmac_f32_16x16x64_bf16 v[100:103], v[12:15], a[200:207], v116
    v_exp_f32 v82, v80
    v_smfmac_f32_16x16x64_bf16 v[96:99], v[16:19], a[208:215], v116
    v_exp_f32 v83, v81
    v_smfmac_f32_16x16x64_bf16 v[100:103], v[16:19], a[216:223], v116
    s_waitcnt lgkmcnt(0)
    s_barrier
    ds_read_b128 v[8:11], v121 offset:0
    v_cvt_pk_bf16_f32 v82, v82, v83
    s_mov_b64 exec, s[50:51]
    ds_write_b32 v113, v82 offset:14344
    s_mov_b64 exec, -1
    v_smfmac_f32_16x16x64_bf16 v[96:99], v[20:23], a[224:231], v116
    ds_read_b128 v[12:15], v121 offset:2048
    v_smfmac_f32_16x16x64_bf16 v[100:103], v[20:23], a[232:239], v116
    v_smfmac_f32_16x16x64_bf16 v[96:99], v[24:27], a[240:247], v116
    v_smfmac_f32_16x16x64_bf16 v[100:103], v[24:27], a[248:255], v116
    s_waitcnt lgkmcnt(2)
    s_waitcnt lgkmcnt(1)
    s_barrier
    ds_read_b128 v[88:91], v117 offset:14336
    v_mfma_f32_16x16x32_bf16 v[84:87], v[8:11], v[0:3], 0
    s_waitcnt lgkmcnt(1)
    ds_read_b128 v[92:95], v125 offset:14336
    v_mfma_f32_16x16x32_bf16 v[84:87], v[12:15], v[4:7], v[84:87]
    s_nop 1
    v_smfmac_f32_16x16x64_bf16 v[96:99], v[28:31], v[144:151], v116
    s_nop 1
    v_smfmac_f32_16x16x64_bf16 v[100:103], v[28:31], v[152:159], v116
    s_cmp_eq_u32 s18, 63
    s_waitcnt lgkmcnt(1)
    v_add_f32_dpp v84, v86, v84 row_ror:8 row_mask:0xf bank_mask:0xf
    v_add_f32_dpp v85, v87, v85 row_ror:8 row_mask:0xf bank_mask:0xf
    v_mfma_f32_16x16x32_bf16 v[68:71], v[72:75], v[88:91], 0
    s_cbranch_scc1 C2_fin
    v_mul_f32 v84, s49, v84
    v_mul_f32 v85, s49, v85
    v_mfma_f32_16x16x32_bf16 v[64:67], v[48:51], v[88:91], 0
    s_waitcnt lgkmcnt(0)
    v_exp_f32 v86, v84
    v_add_f32 v96, v96, v98
    v_mfma_f32_16x16x32_bf16 v[64:67], v[52:55], v[92:95], v[64:67]
    v_exp_f32 v87, v85
    v_add_f32 v97, v97, v99
    v_add_f32 v100, v100, v102
    s_mov_b64 exec, s[50:51]
    v_cvt_pk_bf16_f32 v104, v86, v87
    s_mov_b64 exec, -1
    v_add_f32 v101, v101, v103
    v_mfma_f32_16x16x16_bf16 v[68:71], v[72:73], v[104:105], v[68:71]
    v_mov_b32_dpp v105, v104 row_ror:8 row_mask:0xf bank_mask:0xf
    v_cvt_pk_bf16_f32 v110, v96, v97
    v_cvt_pk_bf16_f32 v111, v100, v101
    s_nop 1
    v_mfma_f32_16x16x16_bf16 v[64:67], v[110:111], v[104:105], v[64:67]
    s_nop 1
    v_rcp_f32 v106, v68
    v_subrev_u32 v107, s60, v68
    v_cmp_lt_u32 vcc, s61, v107
    v_mov_b32_dpp v106, v106 row_ror:8 row_mask:0xf bank_mask:0xc
    s_nop 1
    v_mul_f32 v64, v106, v64
    v_mul_f32 v65, v106, v65
    v_mul_f32 v66, v106, v66
    v_mul_f32 v67, v106, v67
    v_cvt_pk_bf16_f32 v96, v64, v65
    v_cvt_pk_bf16_f32 v97, v66, v67
    ds_write_b64 v126, v[96:97] offset:13312
    v_mfma_f32_16x16x1_4b_f32 v[32:47], v127, v127, 0
    s_and_b64 vcc, vcc, s[50:51]
    s_cbranch_scc1 C2_slow
C2_back:
    v_mov_b32 v107, 0
    v_mov_b32 v107, 0
    v_mov_b32 v107, 0
    s_waitcnt lgkmcnt(0)
    s_barrier
    ds_read_b128 v[80:83], v117 offset:12288
    ds_read_b128 v[84:87], v117 offset:13312
    v_mfma_f32_16x16x1_4b_f32 v[48:63], v127, v127, 0
    v_mov_b32 v107, 0
    s_waitcnt lgkmcnt(1)
    v_smfmac_f32_16x16x64_bf16 v[32:35], v[80:83], v[160:167], v116
    s_waitcnt lgkmcnt(0)
    ds_read_b128 v[0:3], v118 offset:28672
    v_smfmac_f32_16x16x64_bf16 v[32:35], v[84:87], v[192:199], v116
    s_lshl_b32 s39, s18, 5
    ds_read_b128 v[4:7], v118 offset:29696
    v_smfmac_f32_16x16x64_bf16 v[36:39], v[80:83], v[168:175], v116
    s_add_u32 s39, s39, s16
    ds_read_b128 v[8:11], v118 offset:30720
    v_smfmac_f32_16x16x64_bf16 v[36:39], v[84:87], v[200:207], v116
    s_lshl_b32 s39, s39, 12
    ds_read_b128 v[12:15], v118 offset:31744
    v_add_f32 v32, v32, v34
    v_smfmac_f32_16x16x64_bf16 v[40:43], v[80:83], v[176:183], v116
    s_add_u32 s39, s39, 50333696
    ds_read_b128 v[16:19], v118 offset:32768
    v_add_f32 v33, v33, v35
    v_cvt_pk_bf16_f32 v88, v32, v33
    v_smfmac_f32_16x16x64_bf16 v[40:43], v[84:87], v[208:215], v116
    s_cmp_lt_u32 s18, 62
    ds_read_b128 v[20:23], v118 offset:33792
    v_add_f32 v36, v36, v38
    v_smfmac_f32_16x16x64_bf16 v[44:47], v[80:83], v[184:191], v116
    s_cselect_b32 s19, 524288, 0
    ds_read_b128 v[24:27], v118 offset:34816
    v_add_f32 v37, v37, v39
    v_cvt_pk_bf16_f32 v89, v36, v37
    v_and_or_b32 v89, v89, -2, s46
    v_smfmac_f32_16x16x64_bf16 v[44:47], v[84:87], v[216:223], v116
    s_add_u32 s38, s38, s19
    ds_read_b128 v[28:31], v118 offset:35840
    buffer_store_dwordx2 v[88:89], v122, s[4:7], s40 offen offset:0
    v_add_f32 v40, v40, v42
    v_smfmac_f32_16x16x64_bf16 v[48:51], v[80:83], v[224:231], v116
    s_waitcnt lgkmcnt(6)
    ds_read_b128 v[64:67], v118 offset:0
    v_add_f32 v41, v41, v43
    v_cvt_pk_bf16_f32 v90, v40, v41
    v_smfmac_f32_16x16x64_bf16 v[48:51], v[84:87], v[0:7], v116
    s_add_u32 s97, s97, s19
    ds_read_b128 v[68:71], v118 offset:1024
    v_add_f32 v44, v44, v46
    v_smfmac_f32_16x16x64_bf16 v[52:55], v[80:83], v[232:239], v116
    s_waitcnt lgkmcnt(6)
    ds_read_b128 v[72:75], v118 offset:2048
    v_add_f32 v45, v45, v47
    v_cvt_pk_bf16_f32 v91, v44, v45
    v_and_or_b32 v91, v91, -2, s46
    v_smfmac_f32_16x16x64_bf16 v[52:55], v[84:87], v[8:15], v116
    s_nop 0
    buffer_store_dwordx2 v[90:91], v122, s[4:7], s40 offen offset:2048
    v_add_f32 v48, v48, v50
    v_smfmac_f32_16x16x64_bf16 v[56:59], v[80:83], v[240:247], v116
    s_waitcnt lgkmcnt(3)
    ds_read_b128 v[76:79], v118 offset:3072
    v_add_f32 v49, v49, v51
    v_cvt_pk_bf16_f32 v92, v48, v49
    v_smfmac_f32_16x16x64_bf16 v[56:59], v[84:87], v[16:23], v116
    s_nop 0
    v_add_f32 v52, v52, v54
    v_smfmac_f32_16x16x64_bf16 v[60:63], v[80:83], v[248:255], v116
    s_nop 0
    v_add_f32 v53, v53, v55
    v_cvt_pk_bf16_f32 v93, v52, v53
    v_and_or_b32 v93, v93, -2, s46
    v_smfmac_f32_16x16x64_bf16 v[60:63], v[84:87], v[24:31], v116
    buffer_store_dwordx2 v[92:93], v122, s[4:7], s41 offen offset:0
    v_add_f32 v56, v56, v58
    v_add_f32 v57, v57, v59
    v_cvt_pk_bf16_f32 v94, v56, v57
    s_nop 3
    v_add_f32 v60, v60, v62
    v_add_f32 v61, v61, v63
    v_cvt_pk_bf16_f32 v95, v60, v61
    v_and_or_b32 v95, v95, -2, s46
    buffer_store_dwordx2 v[94:95], v122, s[4:7], s41 offen offset:2048
    v_mov_b32 v96, 0
    v_mov_b32 v97, 0
    v_mov_b32 v98, 0
    ds_read_b128 v[16:19], v118 offset:4096
    v_mov_b32 v99, 0
    v_mov_b32 v100, 0
    v_mov_b32 v101, 0
    ds_read_b128 v[20:23], v118 offset:5120
    v_mov_b32 v102, 0
    v_mov_b32 v103, 0
    v_mov_b32 v80, 0
    ds_read_b128 v[24:27], v118 offset:6144
    v_mov_b32 v81, 0
    v_mov_b32 v82, 0
    v_mov_b32 v83, 0
    ds_read_b128 v[28:31], v118 offset:7168
    v_mov_b32 v84, 0
    v_mov_b32 v85, 0
    v_mov_b32 v86, 0
    ds_read_b128 v[32:35], v118 offset:8192
    v_mov_b32 v87, 0
    v_mov_b32 v88, 0
    v_mov_b32 v89, 0
    ds_read_b128 v[36:39], v118 offset:9216
    v_mov_b32 v90, 0
    v_mov_b32 v91, 0
    v_mov_b32 v92, 0
    ds_read_b128 v[40:43], v118 offset:10240
    v_mov_b32 v93, 0
    v_mov_b32 v94, 0
    v_mov_b32 v95, 0
    ds_read_b128 v[44:47], v118 offset:11264
    s_waitcnt vmcnt(5)
    v_mov_b32 v48, v128
    v_mov_b32 v49, v129
    v_mov_b32 v50, v130
    v_mov_b32 v51, v131
    v_mov_b32 v52, v132
    v_mov_b32 v53, v133
    v_mov_b32 v54, v134
    v_mov_b32 v55, v135
    v_mov_b32 v56, v136
    v_mov_b32 v57, v137
    v_mov_b32 v58, v138
    v_mov_b32 v59, v139
    v_mov_b32 v60, v140
    v_mov_b32 v61, v141
    v_mov_b32 v62, v142
    v_mov_b32 v63, v143
    s_barrier
    buffer_load_dwordx4 v[0:3], v117, s[4:7], s45 offen offset:0 sc1
    v_mov_b32 v107, 0
    s_add_u32 s18, s18, 1
    buffer_load_dwordx4 v[4:7], v117, s[4:7], s45 offen offset:1024 sc1
    v_mov_b32 v107, 0
    s_nop 2
    v_mov_b32 v107, 0
    s_nop 2
    v_mov_b32 v107, 0
    s_nop 2
    v_mov_b32 v107, 0
    s_nop 2
    v_mov_b32 v107, 0
    s_nop 2
    v_mov_b32 v107, 0
    s_nop 2
    v_mov_b32 v107, 0
    s_nop 2
    buffer_load_dwordx4 v[0:3], v117, s[4:7], s45 offen offset:0 sc1
    buffer_load_dwordx4 v[4:7], v117, s[4:7], s45 offen offset:1024 sc1
    v_mov_b32 v107, 0
    s_nop 2
    v_mov_b32 v107, 0
    s_nop 2
    v_mov_b32 v107, 0
    s_nop 2
    v_mov_b32 v107, 0
    s_nop 2
    s_branch C2_step
C2_re2:
    buffer_load_dwordx4 v[0:3], v117, s[4:7], s45 offen offset:0 sc1
    buffer_load_dwordx4 v[4:7], v117, s[4:7], s45 offen offset:1024 sc1
    s_add_u32 s55, s55, 1
    s_sub_u32 s48, s48, 1
    s_nop 0
    v_mfma_f32_16x16x1_4b_f32 v[80:95], v127, v127, 0
    s_cbranch_scc0 C2_step
C2_bail:
    s_endpgm
C2_slow:
    v_max3_f32 v106, v80, v81, v84
    v_max_f32 v106, v106, v85
    v_mov_b32 v107, v106
    s_nop 1
    v_permlane32_swap_b32 v107, v106
    v_max_f32 v106, v106, v107
    v_mov_b32 v107, v106
    s_nop 1
    v_permlane16_swap_b32 v107, v106
    v_max_f32 v106, v106, v107
    ds_write_b32 v117, v106 offset:8
    s_waitcnt lgkmcnt(0)
    s_barrier
    ds_read_b128 v[96:99], v117 offset:0
    s_waitcnt lgkmcnt(0)
    v_max3_f32 v106, v96, v97, v98
    v_max_f32 v106, v106, v99
    v_sub_f32 v82, v80, v106
    v_exp_f32 v82, v82
    v_sub_f32 v83, v81, v106
    v_exp_f32 v83, v83
    v_sub_f32 v86, v84, v106
    v_exp_f32 v86, v86
    v_sub_f32 v87, v85, v106
    v_exp_f32 v87, v87
    v_cvt_pk_bf16_f32 v82, v82, v83
    s_mov_b64 exec, s[50:51]
    ds_write_b32 v113, v82 offset:14344
    s_mov_b64 exec, -1
    s_waitcnt lgkmcnt(0)
    s_barrier
    ds_read_b128 v[88:91], v117 offset:14336
    ds_read_b128 v[92:95], v125 offset:14336
    s_waitcnt lgkmcnt(0)
    v_mfma_f32_16x16x32_bf16 v[68:71], v[72:75], v[88:91], 0
    v_mfma_f32_16x16x32_bf16 v[64:67], v[48:51], v[88:91], 0
    v_mfma_f32_16x16x32_bf16 v[64:67], v[52:55], v[92:95], v[64:67]
    s_mov_b64 exec, s[50:51]
    v_cvt_pk_bf16_f32 v104, v86, v87
    s_mov_b64 exec, -1
    s_nop 0
    v_mfma_f32_16x16x16_bf16 v[68:71], v[72:73], v[104:105], v[68:71]
    v_mov_b32_dpp v105, v104 row_ror:8 row_mask:0xf bank_mask:0xf
    s_nop 1
    v_mfma_f32_16x16x16_bf16 v[64:67], v[110:111], v[104:105], v[64:67]
    s_nop 1
    s_nop 1
    v_rcp_f32 v106, v68
    v_subrev_u32 v107, s60, v68
    v_cmp_lt_u32 vcc, s61, v107
    v_mov_b32_dpp v106, v106 row_ror:8 row_mask:0xf bank_mask:0xc
    v_mul_f32 v64, v106, v64
    v_mul_f32 v65, v106, v65
    v_mul_f32 v66, v106, v66
    v_mul_f32 v67, v106, v67
    v_cvt_pk_bf16_f32 v96, v64, v65
    v_cvt_pk_bf16_f32 v97, v66, v67
    ds_write_b64 v126, v[96:97] offset:13312
    s_branch C2_back
C2_fin:
    v_add_f32 v96, v96, v98
    v_add_f32 v97, v97, v99
    v_add_f32 v100, v100, v102
    v_add_f32 v101, v101, v103
    v_cvt_pk_bf16_f32 v110, v96, v97
    v_cvt_pk_bf16_f32 v111, v100, v101
    s_add_u32 s39, s39, 131072
    buffer_store_dwordx4 v[108:111], v117, s[4:7], s39 offen sc1
    s_endpgm
D2_step:
    s_waitcnt vmcnt(3)
    s_waitcnt lgkmcnt(0)
    v_max3_u32 v106, v0, v1, v2
    v_max_u32 v106, v106, v3
    v_smfmac_f32_16x16x64_bf16 v[80:83], v[0:3], v[64:71], v116
    ds_write_b128 v117, v[0:3] offset:4096
    v_smfmac_f32_16x16x64_bf16 v[84:87], v[0:3], v[72:79], v116
    s_waitcnt vmcnt(2)
    v_max3_u32 v106, v106, v4, v5
    v_max3_u32 v106, v106, v6, v7
    v_cmp_eq_u32 vcc, -1, v106
    v_smfmac_f32_16x16x64_bf16 v[88:91], v[0:3], v[16:23], v116
    ds_write_b128 v117, v[4:7] offset:5120
    v_smfmac_f32_16x16x64_bf16 v[92:95], v[0:3], v[24:31], v116
    s_cbranch_vccnz D2_re2
    ds_read_b128 v[64:67], v118 offset:12288
    v_smfmac_f32_16x16x64_bf16 v[96:99], v[0:3], v[32:39], v116
    ds_read_b128 v[68:71], v118 offset:13312
    v_smfmac_f32_16x16x64_bf16 v[100:103], v[0:3], v[40:47], v116
    ds_read_b128 v[72:75], v118 offset:14336
    v_smfmac_f32_16x16x64_bf16 v[80:83], v[4:7], a[0:7], v116
    ds_read_b128 v[76:79], v118 offset:15360
    buffer_load_dwordx4 v[136:139], v124, s[4:7], s38 offen sc1
    v_smfmac_f32_16x16x64_bf16 v[84:87], v[4:7], a[8:15], v116
    s_waitcnt lgkmcnt(4)
    s_barrier
    ds_read_b128 v[8:11], v117 offset:6144
    v_smfmac_f32_16x16x64_bf16 v[88:91], v[4:7], a[80:87], v116
    s_and_b32 s19, s18, 1
    ds_read_b128 v[12:15], v117 offset:7168
    buffer_load_dwordx4 v[128:131], v117, s[4:7], s97 offen sc1
    v_smfmac_f32_16x16x64_bf16 v[92:95], v[4:7], a[88:95], v116
    s_lshl_b32 s19, s19, 18
    s_add_u32 s40, s19, s34
    ds_read_b128 v[16:19], v117 offset:0
    v_smfmac_f32_16x16x64_bf16 v[96:99], v[4:7], a[160:167], v116
    s_add_u32 s40, s40, 58851328
    ds_read_b128 v[20:23], v117 offset:1024
    buffer_load_dwordx4 v[140:143], v124, s[4:7], s38 offen offset:2048 sc1
    v_smfmac_f32_16x16x64_bf16 v[100:103], v[4:7], a[168:175], v116
    s_waitcnt lgkmcnt(3)
    s_add_u32 s41, s40, 4096
    ds_read_b128 v[24:27], v117 offset:2048
    v_smfmac_f32_16x16x64_bf16 v[80:83], v[8:11], a[16:23], v116
    s_lshl_b32 s42, s16, 13
    ds_read_b128 v[28:31], v117 offset:3072
    buffer_load_dwordx4 v[132:135], v117, s[4:7], s97 offen offset:1024 sc1
    v_smfmac_f32_16x16x64_bf16 v[84:87], v[8:11], a[24:31], v116
    s_waitcnt lgkmcnt(4)
    s_add_u32 s42, s42, s19
    ds_read_b128 v[32:35], v118 offset:16384
    v_smfmac_f32_16x16x64_bf16 v[80:83], v[12:15], a[32:39], v116
    s_add_u32 s42, s42, 58720256
    s_bfe_u32 s46, s18, 0x10001
    ds_read_b128 v[36:39], v118 offset:17408
    v_smfmac_f32_16x16x64_bf16 v[84:87], v[12:15], a[40:47], v116
    s_waitcnt lgkmcnt(2)
    s_add_u32 s19, s18, 1
    ds_read_b128 v[40:43], v118 offset:18432
    v_smfmac_f32_16x16x64_bf16 v[80:83], v[16:19], v[64:71], v116
    s_waitcnt lgkmcnt(9)
    ds_read_b128 v[44:47], v118 offset:19456
    buffer_store_dwordx4 v[108:111], v117, s[4:7], s39 offen sc1
    v_smfmac_f32_16x16x64_bf16 v[84:87], v[16:19], v[72:79], v116
    s_and_b32 s19, s19, 3
    s_lshl_b32 s19, s19, 13
    ds_read_b128 v[64:67], v118 offset:20480
    v_smfmac_f32_16x16x64_bf16 v[80:83], v[20:23], a[48:55], v116
    s_add_u32 s45, s19, 59772928
    ds_read_b128 v[68:71], v118 offset:21504
    v_smfmac_f32_16x16x64_bf16 v[84:87], v[20:23], a[56:63], v116
    ds_read_b128 v[72:75], v118 offset:22528
    v_smfmac_f32_16x16x64_bf16 v[80:83], v[24:27], a[64:71], v116
    ds_read_b128 v[76:79], v118 offset:23552
    v_smfmac_f32_16x16x64_bf16 v[84:87], v[24:27], a[72:79], v116
    s_waitcnt lgkmcnt(4)
    v_smfmac_f32_16x16x64_bf16 v[80:83], v[28:31], v[32:39], v116
    s_nop 1
    v_smfmac_f32_16x16x64_bf16 v[84:87], v[28:31], v[40:47], v116
    s_nop 0
    ds_read_b128 v[32:35], v118 offset:24576
    v_smfmac_f32_16x16x64_bf16 v[88:91], v[8:11], a[96:103], v116
    s_nop 0
    ds_read_b128 v[36:39], v118 offset:25600
    v_add_f32 v80, v80, v82
    v_smfmac_f32_16x16x64_bf16 v[92:95], v[8:11], a[104:111], v116
    ds_read_b128 v[40:43], v118 offset:26624
    v_add_f32 v81, v81, v83
    v_add_f32 v84, v84, v86
    v_smfmac_f32_16x16x64_bf16 v[88:91], v[12:15], a[112:119], v116
    ds_read_b128 v[44:47], v118 offset:27648
    v_add_f32 v85, v85, v87
    v_cvt_pk_bf16_f32 v80, v80, v84
    v_smfmac_f32_16x16x64_bf16 v[92:95], v[12:15], a[120:127], v116
    s_waitcnt lgkmcnt(4)
    v_cvt_pk_bf16_f32 v81, v81, v85
    v_smfmac_f32_16x16x64_bf16 v[88:91], v[16:19], v[64:71], v116
    ds_write2_b32 v119, v80, v81 offset0:0 offset1:16
    v_smfmac_f32_16x16x64_bf16 v[92:95], v[16:19], v[72:79], v116
    v_smfmac_f32_16x16x64_bf16 v[88:91], v[20:23], a[128:135], v116
    v_smfmac_f32_16x16x64_bf16 v[92:95], v[20:23], a[136:143], v116
    v_smfmac_f32_16x16x64_bf16 v[88:91], v[24:27], a[144:151], v116
    s_waitcnt vmcnt(5) lgkmcnt(0)
    s_barrier
    ds_read_b128 v[0:3], v120 offset:0
    v_smfmac_f32_16x16x64_bf16 v[92:95], v[24:27], a[152:159], v116
    s_waitcnt lgkmcnt(2)
    ds_read_b128 v[4:7], v120 offset:2048
    v_smfmac_f32_16x16x64_bf16 v[88:91], v[28:31], v[32:39], v116
    s_nop 0
    ds_read_b128 v[72:75], v127 offset:15616
    v_smfmac_f32_16x16x64_bf16 v[92:95], v[28:31], v[40:47], v116
    s_nop 2
    v_smfmac_f32_16x16x64_bf16 v[96:99], v[8:11], a[176:183], v116
    s_waitcnt lgkmcnt(2)
    v_add_f32 v88, v88, v90
    v_mfma_f32_16x16x32_bf16 v[80:83], v[56:59], v[0:3], 0
    s_waitcnt lgkmcnt(1)
    v_add_f32 v89, v89, v91
    v_add_f32 v92, v92, v94
    v_mfma_f32_16x16x32_bf16 v[80:83], v[60:63], v[4:7], v[80:83]
    s_nop 0
    v_add_f32 v93, v93, v95
    v_cvt_pk_bf16_f32 v108, v88, v92
    v_smfmac_f32_16x16x64_bf16 v[100:103], v[8:11], a[184:191], v116
    s_nop 1
    v_cvt_pk_bf16_f32 v109, v89, v93
    ds_write2_b32 v119, v108, v109 offset0:128 offset1:144
    v_smfmac_f32_16x16x64_bf16 v[96:99], v[12:15], a[192:199], v116
    v_add_f32_dpp v80, v82, v80 row_ror:8 row_mask:0xf bank_mask:0xf
    v_add_f32_dpp v81, v83, v81 row_ror:8 row_mask:0xf bank_mask:0xf
    v_smfmac_f32_16x16x64_bf16 v[100:103], v[12:15], a[200:207], v116
    v_exp_f32 v82, v80
    v_smfmac_f32_16x16x64_bf16 v[96:99], v[16:19], a[208:215], v116
    v_exp_f32 v83, v81
    v_smfmac_f32_16x16x64_bf16 v[100:103], v[16:19], a[216:223], v116
    s_waitcnt lgkmcnt(0)
    s_barrier
    ds_read_b128 v[8:11], v121 offset:0
    v_cvt_pk_bf16_f32 v82, v82, v83
    s_mov_b64 exec, s[50:51]
    ds_write_b32 v113, v82 offset:14344
    s_mov_b64 exec, -1
    v_smfmac_f32_16x16x64_bf16 v[96:99], v[20:23], a[224:231], v116
    ds_read_b128 v[12:15], v121 offset:2048
    v_smfmac_f32_16x16x64_bf16 v[100:103], v[20:23], a[232:239], v116
    v_smfmac_f32_16x16x64_bf16 v[96:99], v[24:27], a[240:247], v116
    v_smfmac_f32_16x16x64_bf16 v[100:103], v[24:27], a[248:255], v116
    s_waitcnt lgkmcnt(2)
    s_waitcnt lgkmcnt(1)
    s_barrier
    ds_read_b128 v[88:91], v117 offset:14336
    v_mfma_f32_16x16x32_bf16 v[84:87], v[8:11], v[0:3], 0
    s_waitcnt lgkmcnt(1)
    ds_read_b128 v[92:95], v125 offset:14336
    v_mfma_f32_16x16x32_bf16 v[84:87], v[12:15], v[4:7], v[84:87]
    s_nop 1
    v_smfmac_f32_16x16x64_bf16 v[96:99], v[28:31], v[144:151], v116
    s_nop 1
    v_smfmac_f32_16x16x64_bf16 v[100:103], v[28:31], v[152:159], v116
    s_cmp_eq_u32 s18, 63
    s_waitcnt lgkmcnt(1)
    v_add_f32_dpp v84, v86, v84 row_ror:8 row_mask:0xf bank_mask:0xf
    v_add_f32_dpp v85, v87, v85 row_ror:8 row_mask:0xf bank_mask:0xf
    v_mfma_f32_16x16x32_bf16 v[68:71], v[72:75], v[88:91], 0
    s_cbranch_scc1 D2_fin
    v_mul_f32 v84, s49, v84
    v_mul_f32 v85, s49, v85
    v_mfma_f32_16x16x32_bf16 v[64:67], v[48:51], v[88:91], 0
    s_waitcnt lgkmcnt(0)
    v_exp_f32 v86, v84
    v_add_f32 v96, v96, v98
    v_mfma_f32_16x16x32_bf16 v[64:67], v[52:55], v[92:95], v[64:67]
    v_exp_f32 v87, v85
    v_add_f32 v97, v97, v99
    v_add_f32 v100, v100, v102
    s_mov_b64 exec, s[50:51]
    v_cvt_pk_bf16_f32 v104, v86, v87
    s_mov_b64 exec, -1
    v_add_f32 v101, v101, v103
    v_mfma_f32_16x16x16_bf16 v[68:71], v[72:73], v[104:105], v[68:71]
    v_mov_b32_dpp v105, v104 row_ror:8 row_mask:0xf bank_mask:0xf
    v_cvt_pk_bf16_f32 v110, v96, v97
    v_cvt_pk_bf16_f32 v111, v100, v101
    s_nop 1
    v_mfma_f32_16x16x16_bf16 v[64:67], v[110:111], v[104:105], v[64:67]
    s_nop 1
    v_rcp_f32 v106, v68
    v_subrev_u32 v107, s60, v68
    v_cmp_lt_u32 vcc, s61, v107
    v_mov_b32_dpp v106, v106 row_ror:8 row_mask:0xf bank_mask:0xc
    s_nop 1
    v_mul_f32 v64, v106, v64
    v_mul_f32 v65, v106, v65
    v_mul_f32 v66, v106, v66
    v_mul_f32 v67, v106, v67
    v_cvt_pk_bf16_f32 v96, v64, v65
    v_cvt_pk_bf16_f32 v97, v66, v67
    ds_write_b64 v126, v[96:97] offset:13312
    v_mfma_f32_16x16x1_4b_f32 v[32:47], v127, v127, 0
    s_and_b64 vcc, vcc, s[50:51]
    s_cbranch_scc1 D2_slow
D2_back:
    v_mov_b32 v107, 0
    v_mov_b32 v107, 0
    v_mov_b32 v107, 0
    s_waitcnt lgkmcnt(0)
    s_barrier
    ds_read_b128 v[80:83], v117 offset:12288
    ds_read_b128 v[84:87], v117 offset:13312
    v_mfma_f32_16x16x1_4b_f32 v[48:63], v127, v127, 0
    v_mov_b32 v107, 0
    s_waitcnt lgkmcnt(1)
    v_smfmac_f32_16x16x64_bf16 v[32:35], v[80:83], v[160:167], v116
    s_waitcnt lgkmcnt(0)
    ds_read_b128 v[0:3], v118 offset:28672
    v_smfmac_f32_16x16x64_bf16 v[32:35], v[84:87], v[192:199], v116
    s_lshl_b32 s39, s18, 5
    ds_read_b128 v[4:7], v118 offset:29696
    v_smfmac_f32_16x16x64_bf16 v[36:39], v[80:83], v[168:175], v116
    s_add_u32 s39, s39, s16
    ds_read_b128 v[8:11], v118 offset:30720
    v_smfmac_f32_16x16x64_bf16 v[36:39], v[84:87], v[200:207], v116
    s_lshl_b32 s39, s39, 12
    ds_read_b128 v[12:15], v118 offset:31744
    v_add_f32 v32, v32, v34
    v_smfmac_f32_16x16x64_bf16 v[40:43], v[80:83], v[176:183], v116
    s_add_u32 s39, s39, 50333696
    ds_read_b128 v[16:19], v118 offset:32768
    v_add_f32 v33, v33, v35
    v_cvt_pk_bf16_f32 v88, v32, v33
    v_smfmac_f32_16x16x64_bf16 v[40:43], v[84:87], v[208:215], v116
    s_cmp_lt_u32 s18, 62
    ds_read_b128 v[20:23], v118 offset:33792
    v_add_f32 v36, v36, v38
    v_smfmac_f32_16x16x64_bf16 v[44:47], v[80:83], v[184:191], v116
    s_cselect_b32 s19, 524288, 0
    ds_read_b128 v[24:27], v118 offset:34816
    v_add_f32 v37, v37, v39
    v_cvt_pk_bf16_f32 v89, v36, v37
    v_and_or_b32 v89, v89, -2, s46
    v_smfmac_f32_16x16x64_bf16 v[44:47], v[84:87], v[216:223], v116
    s_add_u32 s38, s38, s19
    ds_read_b128 v[28:31], v118 offset:35840
    buffer_store_dwordx2 v[88:89], v122, s[4:7], s40 offen offset:0 sc1
    v_add_f32 v40, v40, v42
    v_smfmac_f32_16x16x64_bf16 v[48:51], v[80:83], v[224:231], v116
    s_waitcnt lgkmcnt(6)
    ds_read_b128 v[64:67], v118 offset:0
    v_add_f32 v41, v41, v43
    v_cvt_pk_bf16_f32 v90, v40, v41
    v_smfmac_f32_16x16x64_bf16 v[48:51], v[84:87], v[0:7], v116
    s_add_u32 s97, s97, s19
    ds_read_b128 v[68:71], v118 offset:1024
    v_add_f32 v44, v44, v46
    v_smfmac_f32_16x16x64_bf16 v[52:55], v[80:83], v[232:239], v116
    s_waitcnt lgkmcnt(6)
    ds_read_b128 v[72:75], v118 offset:2048
    v_add_f32 v45, v45, v47
    v_cvt_pk_bf16_f32 v91, v44, v45
    v_and_or_b32 v91, v91, -2, s46
    v_smfmac_f32_16x16x64_bf16 v[52:55], v[84:87], v[8:15], v116
    s_nop 0
    buffer_store_dwordx2 v[90:91], v122, s[4:7], s40 offen offset:2048 sc1
    v_add_f32 v48, v48, v50
    v_smfmac_f32_16x16x64_bf16 v[56:59], v[80:83], v[240:247], v116
    s_waitcnt lgkmcnt(3)
    ds_read_b128 v[76:79], v118 offset:3072
    v_add_f32 v49, v49, v51
    v_cvt_pk_bf16_f32 v92, v48, v49
    v_smfmac_f32_16x16x64_bf16 v[56:59], v[84:87], v[16:23], v116
    s_nop 0
    v_add_f32 v52, v52, v54
    v_smfmac_f32_16x16x64_bf16 v[60:63], v[80:83], v[248:255], v116
    s_nop 0
    v_add_f32 v53, v53, v55
    v_cvt_pk_bf16_f32 v93, v52, v53
    v_and_or_b32 v93, v93, -2, s46
    v_smfmac_f32_16x16x64_bf16 v[60:63], v[84:87], v[24:31], v116
    buffer_store_dwordx2 v[92:93], v122, s[4:7], s41 offen offset:0 sc1
    v_add_f32 v56, v56, v58
    v_add_f32 v57, v57, v59
    v_cvt_pk_bf16_f32 v94, v56, v57
    s_nop 3
    v_add_f32 v60, v60, v62
    v_add_f32 v61, v61, v63
    v_cvt_pk_bf16_f32 v95, v60, v61
    v_and_or_b32 v95, v95, -2, s46
    buffer_store_dwordx2 v[94:95], v122, s[4:7], s41 offen offset:2048 sc1
    v_mov_b32 v96, 0
    v_mov_b32 v97, 0
    v_mov_b32 v98, 0
    ds_read_b128 v[16:19], v118 offset:4096
    v_mov_b32 v99, 0
    v_mov_b32 v100, 0
    v_mov_b32 v101, 0
    ds_read_b128 v[20:23], v118 offset:5120
    v_mov_b32 v102, 0
    v_mov_b32 v103, 0
    v_mov_b32 v80, 0
    ds_read_b128 v[24:27], v118 offset:6144
    v_mov_b32 v81, 0
    v_mov_b32 v82, 0
    v_mov_b32 v83, 0
    ds_read_b128 v[28:31], v118 offset:7168
    v_mov_b32 v84, 0
    v_mov_b32 v85, 0
    v_mov_b32 v86, 0
    ds_read_b128 v[32:35], v118 offset:8192
    v_mov_b32 v87, 0
    v_mov_b32 v88, 0
    v_mov_b32 v89, 0
    ds_read_b128 v[36:39], v118 offset:9216
    v_mov_b32 v90, 0
    v_mov_b32 v91, 0
    v_mov_b32 v92, 0
    ds_read_b128 v[40:43], v118 offset:10240
    v_mov_b32 v93, 0
    v_mov_b32 v94, 0
    v_mov_b32 v95, 0
    ds_read_b128 v[44:47], v118 offset:11264
    s_waitcnt vmcnt(5)
    v_mov_b32 v48, v128
    v_mov_b32 v49, v129
    v_mov_b32 v50, v130
    v_mov_b32 v51, v131
    v_mov_b32 v52, v132
    v_mov_b32 v53, v133
    v_mov_b32 v54, v134
    v_mov_b32 v55, v135
    v_mov_b32 v56, v136
    v_mov_b32 v57, v137
    v_mov_b32 v58, v138
    v_mov_b32 v59, v139
    v_mov_b32 v60, v140
    v_mov_b32 v61, v141
    v_mov_b32 v62, v142
    v_mov_b32 v63, v143
    s_barrier
    buffer_load_dwordx4 v[0:3], v117, s[4:7], s45 offen offset:0 sc1
    v_mov_b32 v107, 0
    s_add_u32 s18, s18, 1
    buffer_load_dwordx4 v[4:7], v117, s[4:7], s45 offen offset:1024 sc1
    v_mov_b32 v107, 0
    s_nop 2
    v_mov_b32 v107, 0
    s_nop 2
    v_mov_b32 v107, 0
    s_nop 2
    v_mov_b32 v107, 0
    s_nop 2
    v_mov_b32 v107, 0
    s_nop 2
    v_mov_b32 v107, 0
    s_nop 2
    v_mov_b32 v107, 0
    s_nop 2
    buffer_load_dwordx4 v[0:3], v117, s[4:7], s45 offen offset:0 sc1
    buffer_load_dwordx4 v[4:7], v117, s[4:7], s45 offen offset:1024 sc1
    v_mov_b32 v107, 0
    s_nop 2
    v_mov_b32 v107, 0
    s_nop 2
    v_mov_b32 v107, 0
    s_nop 2
    v_mov_b32 v107, 0
    s_nop 2
    s_branch D2_step
D2_re2:
    buffer_load_dwordx4 v[0:3], v117, s[4:7], s45 offen offset:0 sc1
    buffer_load_dwordx4 v[4:7], v117, s[4:7], s45 offen offset:1024 sc1
    s_add_u32 s55, s55, 1
    s_sub_u32 s48, s48, 1
    s_nop 0
    v_mfma_f32_16x16x1_4b_f32 v[80:95], v127, v127, 0
    s_cbranch_scc0 D2_step
D2_bail:
    s_endpgm
D2_slow:
    v_max3_f32 v106, v80, v81, v84
    v_max_f32 v106, v106, v85
    v_mov_b32 v107, v106
    s_nop 1
    v_permlane32_swap_b32 v107, v106
    v_max_f32 v106, v106, v107
    v_mov_b32 v107, v106
    s_nop 1
    v_permlane16_swap_b32 v107, v106
    v_max_f32 v106, v106, v107
    ds_write_b32 v117, v106 offset:8
    s_waitcnt lgkmcnt(0)
    s_barrier
    ds_read_b128 v[96:99], v117 offset:0
    s_waitcnt lgkmcnt(0)
    v_max3_f32 v106, v96, v97, v98
    v_max_f32 v106, v106, v99
    v_sub_f32 v82, v80, v106
    v_exp_f32 v82, v82
    v_sub_f32 v83, v81, v106
    v_exp_f32 v83, v83
    v_sub_f32 v86, v84, v106
    v_exp_f32 v86, v86
    v_sub_f32 v87, v85, v106
    v_exp_f32 v87, v87
    v_cvt_pk_bf16_f32 v82, v82, v83
    s_mov_b64 exec, s[50:51]
    ds_write_b32 v113, v82 offset:14344
    s_mov_b64 exec, -1
    s_waitcnt lgkmcnt(0)
    s_barrier
    ds_read_b128 v[88:91], v117 offset:14336
    ds_read_b128 v[92:95], v125 offset:14336
    s_waitcnt lgkmcnt(0)
    v_mfma_f32_16x16x32_bf16 v[68:71], v[72:75], v[88:91], 0
    v_mfma_f32_16x16x32_bf16 v[64:67], v[48:51], v[88:91], 0
    v_mfma_f32_16x16x32_bf16 v[64:67], v[52:55], v[92:95], v[64:67]
    s_mov_b64 exec, s[50:51]
    v_cvt_pk_bf16_f32 v104, v86, v87
    s_mov_b64 exec, -1
    s_nop 0
    v_mfma_f32_16x16x16_bf16 v[68:71], v[72:73], v[104:105], v[68:71]
    v_mov_b32_dpp v105, v104 row_ror:8 row_mask:0xf bank_mask:0xf
    s_nop 1
    v_mfma_f32_16x16x16_bf16 v[64:67], v[110:111], v[104:105], v[64:67]
    s_nop 1
    s_nop 1
    v_rcp_f32 v106, v68
    v_subrev_u32 v107, s60, v68
    v_cmp_lt_u32 vcc, s61, v107
    v_mov_b32_dpp v106, v106 row_ror:8 row_mask:0xf bank_mask:0xc
    v_mul_f32 v64, v106, v64
    v_mul_f32 v65, v106, v65
    v_mul_f32 v66, v106, v66
    v_mul_f32 v67, v106, v67
    v_cvt_pk_bf16_f32 v96, v64, v65
    v_cvt_pk_bf16_f32 v97, v66, v67
    ds_write_b64 v126, v[96:97] offset:13312
    s_branch D2_back
D2_fin:
    v_add_f32 v96, v96, v98
    v_add_f32 v97, v97, v99
    v_add_f32 v100, v100, v102
    v_add_f32 v101, v101, v103
    v_cvt_pk_bf16_f32 v110, v96, v97
    v_cvt_pk_bf16_f32 v111, v100, v101
    s_add_u32 s39, s39, 131072
    buffer_store_dwordx4 v[108:111], v117, s[4:7], s39 offen sc1
    s_endpgm
C3_entry:
    v_and_b32 v68, 63, v0
    v_lshlrev_b32 v117, 4, v68
    v_xor_b32 v125, 128, v117
    v_add_u32 v118, 126976, v117
    v_lshrrev_b32 v69, 4, v68
    v_and_b32 v70, 15, v68
    v_bfe_u32 v71, v68, 1, 1
    v_mul_u32_u24 v116, 0xaaaa, v71
    v_add_u32 v116, 0x4444, v116
    v_lshlrev_b32 v119, 2, v70
    v_xor_b32 v119, 32, v119
    v_lshl_add_u32 v119, v69, 7, v119
    v_add_u32 v119, 11264, v119
    v_lshrrev_b32 v64, 2, v70
    v_and_b32 v65, 1, v70
    v_lshl_add_u32 v66, v64, 1, v65
    v_lshlrev_b32 v67, 1, v71
    v_xor_b32 v67, v67, v69
    v_lshlrev_b32 v121, 4, v67
    v_lshl_add_u32 v121, v66, 6, v121
    v_lshl_add_u32 v121, v71, 10, v121
    v_add_u32 v121, 8704, v121
    v_lshrrev_b32 v72, 3, v70
    v_and_b32 v73, 7, v70
    v_lshlrev_b32 v67, 1, v72
    v_xor_b32 v67, v67, v69
    v_lshlrev_b32 v120, 4, v67
    v_lshl_add_u32 v120, v73, 6, v120
    v_lshl_add_u32 v120, v72, 10, v120
    v_add_u32 v120, 8192, v120
    v_lshrrev_b32 v67, 1, v73
    v_lshlrev_b32 v126, 6, v67
    v_lshl_add_u32 v126, v65, 4, v126
    v_lshl_add_u32 v126, v72, 3, v126
    v_lshl_add_u32 v126, v69, 8, v126
    v_lshrrev_b32 v67, 3, v68
    v_lshlrev_b32 v122, 13, v67
    v_lshl_add_u32 v122, v73, 3, v122
    v_lshlrev_b32 v123, 8, v69
    v_lshl_add_u32 v123, v70, 2, v123
    v_lshlrev_b32 v124, 8, v69
    v_lshl_add_u32 v124, v66, 4, v124
    v_lshl_add_u32 v124, v71, 10, v124
    v_lshlrev_b32 v106, 10, v66
    v_lshl_add_u32 v106, v71, 5, v106
    v_and_b32 v67, 1, v69
    v_lshl_add_u32 v106, v67, 3, v106
    v_lshrrev_b32 v67, 1, v69
    v_lshl_add_u32 v106, v67, 2, v106
    v_mov_b32 v104, 0
    v_mov_b32 v105, 0
    v_mov_b32 v127, 0
    v_mov_b32 v108, 0
    v_mov_b32 v109, 0
    v_mov_b32 v110, 0
    v_mov_b32 v111, 0
    v_mov_b32 v112, -1
    v_mov_b32 v113, -1
    v_mov_b32 v114, -1
    v_mov_b32 v115, -1
    s_mov_b32 s50, 0x00ff00ff
    s_mov_b32 s51, s50
    s_mov_b32 s49, 0x3e0293ee
    s_mov_b32 s60, 0x30800000
    s_mov_b32 s61, 0x1e000000
    s_mov_b32 s48, 400000
    s_mov_b32 s54, 0
    s_mov_b32 s55, 0
    s_lshl_b32 s36, s16, 8
    s_lshl_b32 s37, s16, 17
    s_lshr_b32 s52, s16, 3
    s_lshl_b32 s52, s52, 11
    s_and_b32 s19, s16, 1
    s_lshl_b32 s19, s19, 10
    s_add_u32 s52, s52, s19
    s_and_b32 s19, s16, 6
    s_lshl_b32 s19, s19, 5
    s_add_u32 s52, s52, s19
    s_lshl_b32 s19, s16, 13
    s_add_u32 s19, s19, 58986496
    buffer_store_dwordx4 v[112:115], v117, s[4:7], s19 offen offset:0 sc1
    buffer_store_dwordx4 v[112:115], v117, s[4:7], s19 offen offset:1024 sc1
    buffer_store_dwordx4 v[112:115], v117, s[4:7], s19 offen offset:2048 sc1
    buffer_store_dwordx4 v[112:115], v117, s[4:7], s19 offen offset:3072 sc1
    s_add_u32 s19, s52, 59793408
    buffer_store_dword v112, v123, s[4:7], s19 offen sc1
    s_mov_b32 s20, s74
    s_and_b32 s21, s75, 0xffff
    s_mov_b32 s22, 0x400000
    s_mov_b32 s23, 0x20000
    s_mov_b32 s24, s76
    s_and_b32 s25, s77, 0xffff
    s_mov_b32 s26, 0x400000
    s_mov_b32 s27, 0x20000
    s_mov_b32 s28, s78
    s_and_b32 s29, s79, 0xffff
    s_mov_b32 s30, 0x400000
    s_mov_b32 s31, 0x20000
    s_mov_b32 s32, s80
    s_and_b32 s33, s81, 0xffff
    s_mov_b32 s34, 0x400000
    s_mov_b32 s35, 0x20000
    v_lshrrev_b32 v80, 4, v117
    v_lshrrev_b32 v81, 4, v80
    v_and_b32 v82, 1, v81
    v_lshlrev_b32 v64, 6, v82
    v_lshrrev_b32 v82, 1, v81
    v_lshl_add_u32 v64, v82, 4, v64
    v_lshlrev_b32 v64, 13, v64
    v_add_u32 v82, 4, v81
    v_lshlrev_b32 v82, 1, v82
    v_and_b32 v83, 15, v80
    v_xor_b32 v82, v82, v83
    v_lshl_add_u32 v64, v82, 4, v64
    v_lshrrev_b32 v82, 5, v80
    v_lshlrev_b32 v65, 4, v82
    v_bfe_u32 v82, v80, 4, 1
    v_lshl_add_u32 v65, v82, 5, v65
    v_bfe_u32 v82, v80, 3, 1
    v_add_u32 v65, v82, v65
    v_lshlrev_b32 v65, 10, v65
    v_and_b32 v82, 7, v80
    v_lshl_add_u32 v65, v82, 4, v65
    v_lshrrev_b32 v81, 2, v80
    v_lshlrev_b32 v66, 7, v81
    v_bfe_u32 v82, v80, 1, 1
    v_lshl_add_u32 v66, v82, 6, v66
    v_and_b32 v82, 1, v80
    v_lshl_add_u32 v66, v82, 3, v66
    v_add_u32 v66, 126976, v66
    v_and_b32 v82, 7, v81
    v_xor_b32 v82, 6, v82
    v_lshlrev_b32 v68, 8, v81
    v_lshl_add_u32 v68, v82, 5, v68
    v_and_b32 v82, 3, v80
    v_lshl_add_u32 v68, v82, 3, v68
    v_xor_b32 v69, 32, v68
    v_add_u32 v72, 45056, v68
    v_add_u32 v73, 45056, v69
    v_add_u32 v74, 81920, v68
    v_add_u32 v75, 81920, v69
    v_add_u32 v76, 118784, v68
    v_add_u32 v77, 118784, v69
    v_add_u32 v78, 155648, v68
    v_add_u32 v79, 155648, v69
    s_mov_b32 m0, 126976
    s_add_u32 s19, s37, 768
    buffer_load_dwordx4 v65, s[32:35], s19 offen lds
    s_mov_b32 m0, 128000
    s_add_u32 s19, s37, 4864
    buffer_load_dwordx4 v65, s[32:35], s19 offen lds
    s_mov_b32 m0, 129024
    s_add_u32 s19, s37, 2816
    buffer_load_dwordx4 v65, s[32:35], s19 offen lds
    s_mov_b32 m0, 130048
    s_add_u32 s19, s37, 6912
    buffer_load_dwordx4 v65, s[32:35], s19 offen lds
    s_mov_b32 m0, 131072
    s_add_u32 s19, s37, 8960
    buffer_load_dwordx4 v65, s[32:35], s19 offen lds
    s_mov_b32 m0, 132096
    s_add_u32 s19, s37, 13056
    buffer_load_dwordx4 v65, s[32:35], s19 offen lds
    s_mov_b32 m0, 133120
    s_add_u32 s19, s37, 11008
    buffer_load_dwordx4 v65, s[32:35], s19 offen lds
    s_mov_b32 m0, 134144
    s_add_u32 s19, s37, 15104
    buffer_load_dwordx4 v65, s[32:35], s19 offen lds
    s_mov_b32 m0, 135168
    s_add_u32 s19, s37, 66304
    buffer_load_dwordx4 v65, s[32:35], s19 offen lds
    s_mov_b32 m0, 136192
    s_add_u32 s19, s37, 70400
    buffer_load_dwordx4 v65, s[32:35], s19 offen lds
    s_mov_b32 m0, 137216
    s_add_u32 s19, s37, 68352
    buffer_load_dwordx4 v65, s[32:35], s19 offen lds
    s_mov_b32 m0, 138240
    s_add_u32 s19, s37, 72448
    buffer_load_dwordx4 v65, s[32:35], s19 offen lds
    s_mov_b32 m0, 139264
    s_add_u32 s19, s37, 74496
    buffer_load_dwordx4 v65, s[32:35], s19 offen lds
    s_mov_b32 m0, 140288
    s_add_u32 s19, s37, 78592
    buffer_load_dwordx4 v65, s[32:35], s19 offen lds
    s_mov_b32 m0, 141312
    s_add_u32 s19, s37, 76544
    buffer_load_dwordx4 v65, s[32:35], s19 offen lds
    s_mov_b32 m0, 142336
    s_add_u32 s19, s37, 80640
    buffer_load_dwordx4 v65, s[32:35], s19 offen lds
    s_mov_b32 m0, 143360
    s_add_u32 s19, s37, 896
    buffer_load_dwordx4 v65, s[32:35], s19 offen lds
    s_mov_b32 m0, 144384
    s_add_u32 s19, s37, 4992
    buffer_load_dwordx4 v65, s[32:35], s19 offen lds
    s_mov_b32 m0, 145408
    s_add_u32 s19, s37, 2944
    buffer_load_dwordx4 v65, s[32:35], s19 offen lds
    s_mov_b32 m0, 146432
    s_add_u32 s19, s37, 7040
    buffer_load_dwordx4 v65, s[32:35], s19 offen lds
    s_mov_b32 m0, 147456
    s_add_u32 s19, s37, 9088
    buffer_load_dwordx4 v65, s[32:35], s19 offen lds
    s_mov_b32 m0, 148480
    s_add_u32 s19, s37, 13184
    buffer_load_dwordx4 v65, s[32:35], s19 offen lds
    s_mov_b32 m0, 149504
    s_add_u32 s19, s37, 11136
    buffer_load_dwordx4 v65, s[32:35], s19 offen lds
    s_mov_b32 m0, 150528
    s_add_u32 s19, s37, 15232
    buffer_load_dwordx4 v65, s[32:35], s19 offen lds
    s_waitcnt vmcnt(16)
    ds_read_b64_tr_b16 v[160:161], v66 offset:0
    ds_read_b64_tr_b16 v[162:163], v66 offset:2048
    ds_read_b64_tr_b16 v[164:165], v66 offset:4096
    ds_read_b64_tr_b16 v[166:167], v66 offset:6144
    ds_read_b64_tr_b16 v[168:169], v66 offset:16
    ds_read_b64_tr_b16 v[170:171], v66 offset:2064
    ds_read_b64_tr_b16 v[172:173], v66 offset:4112
    ds_read_b64_tr_b16 v[174:175], v66 offset:6160
    ds_read_b64_tr_b16 v[176:177], v66 offset:32
    ds_read_b64_tr_b16 v[178:179], v66 offset:2080
    ds_read_b64_tr_b16 v[180:181], v66 offset:4128
    ds_read_b64_tr_b16 v[182:183], v66 offset:6176
    ds_read_b64_tr_b16 v[184:185], v66 offset:48
    ds_read_b64_tr_b16 v[186:187], v66 offset:2096
    ds_read_b64_tr_b16 v[188:189], v66 offset:4144
    ds_read_b64_tr_b16 v[190:191], v66 offset:6192
    s_waitcnt lgkmcnt(0)
    s_mov_b32 m0, 126976
    s_add_u32 s19, s37, 66432
    buffer_load_dwordx4 v65, s[32:35], s19 offen lds
    s_mov_b32 m0, 128000
    s_add_u32 s19, s37, 70528
    buffer_load_dwordx4 v65, s[32:35], s19 offen lds
    s_mov_b32 m0, 129024
    s_add_u32 s19, s37, 68480
    buffer_load_dwordx4 v65, s[32:35], s19 offen lds
    s_mov_b32 m0, 130048
    s_add_u32 s19, s37, 72576
    buffer_load_dwordx4 v65, s[32:35], s19 offen lds
    s_mov_b32 m0, 131072
    s_add_u32 s19, s37, 74624
    buffer_load_dwordx4 v65, s[32:35], s19 offen lds
    s_mov_b32 m0, 132096
    s_add_u32 s19, s37, 78720
    buffer_load_dwordx4 v65, s[32:35], s19 offen lds
    s_mov_b32 m0, 133120
    s_add_u32 s19, s37, 76672
    buffer_load_dwordx4 v65, s[32:35], s19 offen lds
    s_mov_b32 m0, 134144
    s_add_u32 s19, s37, 80768
    buffer_load_dwordx4 v65, s[32:35], s19 offen lds
    s_mov_b32 m0, 3072
    s_add_u32 s19, s36, 40960
    buffer_load_dwordx4 v64, s[20:23], s19 offen lds
    s_mov_b32 m0, 7168
    s_add_u32 s19, s36, 106496
    buffer_load_dwordx4 v64, s[20:23], s19 offen lds
    s_mov_b32 m0, 11264
    s_add_u32 s19, s36, 57344
    buffer_load_dwordx4 v64, s[20:23], s19 offen lds
    s_mov_b32 m0, 15360
    s_add_u32 s19, s36, 122880
    buffer_load_dwordx4 v64, s[20:23], s19 offen lds
    s_mov_b32 m0, 48128
    s_add_u32 s19, s36, 303104
    buffer_load_dwordx4 v64, s[20:23], s19 offen lds
    s_mov_b32 m0, 84992
    s_add_u32 s19, s36, 368640
    buffer_load_dwordx4 v64, s[20:23], s19 offen lds
    s_mov_b32 m0, 121856
    s_add_u32 s19, s36, 319488
    buffer_load_dwordx4 v64, s[20:23], s19 offen lds
    s_mov_b32 m0, 158720
    s_add_u32 s19, s36, 385024
    buffer_load_dwordx4 v64, s[20:23], s19 offen lds
    s_waitcnt vmcnt(24)
    ds_read_b64_tr_b16 v[192:193], v66 offset:8192
    ds_read_b64_tr_b16 v[194:195], v66 offset:10240
    ds_read_b64_tr_b16 v[196:197], v66 offset:12288
    ds_read_b64_tr_b16 v[198:199], v66 offset:14336
    ds_read_b64_tr_b16 v[200:201], v66 offset:8208
    ds_read_b64_tr_b16 v[202:203], v66 offset:10256
    ds_read_b64_tr_b16 v[204:205], v66 offset:12304
    ds_read_b64_tr_b16 v[206:207], v66 offset:14352
    ds_read_b64_tr_b16 v[208:209], v66 offset:8224
    ds_read_b64_tr_b16 v[210:211], v66 offset:10272
    ds_read_b64_tr_b16 v[212:213], v66 offset:12320
    ds_read_b64_tr_b16 v[214:215], v66 offset:14368
    ds_read_b64_tr_b16 v[216:217], v66 offset:8240
    ds_read_b64_tr_b16 v[218:219], v66 offset:10288
    ds_read_b64_tr_b16 v[220:221], v66 offset:12336
    ds_read_b64_tr_b16 v[222:223], v66 offset:14384
    s_waitcnt vmcnt(16)
    ds_read_b64_tr_b16 v[224:225], v66 offset:16384
    ds_read_b64_tr_b16 v[226:227], v66 offset:18432
    ds_read_b64_tr_b16 v[228:229], v66 offset:20480
    ds_read_b64_tr_b16 v[230:231], v66 offset:22528
    ds_read_b64_tr_b16 v[232:233], v66 offset:16400
    ds_read_b64_tr_b16 v[234:235], v66 offset:18448
    ds_read_b64_tr_b16 v[236:237], v66 offset:20496
    ds_read_b64_tr_b16 v[238:239], v66 offset:22544
    ds_read_b64_tr_b16 v[240:241], v66 offset:16416
    ds_read_b64_tr_b16 v[242:243], v66 offset:18464
    ds_read_b64_tr_b16 v[244:245], v66 offset:20512
    ds_read_b64_tr_b16 v[246:247], v66 offset:22560
    ds_read_b64_tr_b16 v[248:249], v66 offset:16432
    ds_read_b64_tr_b16 v[250:251], v66 offset:18480
    ds_read_b64_tr_b16 v[252:253], v66 offset:20528
    ds_read_b64_tr_b16 v[254:255], v66 offset:22576
    s_waitcnt vmcnt(8)
    ds_read_b64_tr_b16 v[32:33], v66 offset:0
    ds_read_b64_tr_b16 v[34:35], v66 offset:2048
    ds_read_b64_tr_b16 v[36:37], v66 offset:4096
    ds_read_b64_tr_b16 v[38:39], v66 offset:6144
    ds_read_b64_tr_b16 v[40:41], v66 offset:16
    ds_read_b64_tr_b16 v[42:43], v66 offset:2064
    ds_read_b64_tr_b16 v[44:45], v66 offset:4112
    ds_read_b64_tr_b16 v[46:47], v66 offset:6160
    ds_read_b64_tr_b16 v[48:49], v66 offset:32
    ds_read_b64_tr_b16 v[50:51], v66 offset:2080
    ds_read_b64_tr_b16 v[52:53], v66 offset:4128
    ds_read_b64_tr_b16 v[54:55], v66 offset:6176
    ds_read_b64_tr_b16 v[56:57], v66 offset:48
    ds_read_b64_tr_b16 v[58:59], v66 offset:2096
    ds_read_b64_tr_b16 v[60:61], v66 offset:4144
    ds_read_b64_tr_b16 v[62:63], v66 offset:6192
    s_waitcnt lgkmcnt(0)
    s_waitcnt vmcnt(4)
    s_barrier
    s_mov_b32 m0, 52224
    s_add_u32 s19, s36, 1089536
    buffer_load_dwordx4 v64, s[20:23], s19 offen lds
    s_mov_b32 m0, 89088
    s_add_u32 s19, s36, 1155072
    buffer_load_dwordx4 v64, s[20:23], s19 offen lds
    s_mov_b32 m0, 125952
    s_add_u32 s19, s36, 1105920
    buffer_load_dwordx4 v64, s[20:23], s19 offen lds
    s_mov_b32 m0, 162816
    s_add_u32 s19, s36, 1171456
    buffer_load_dwordx4 v64, s[20:23], s19 offen lds
    ds_read_b64_tr_b16 a[16:17], v68 offset:0
    ds_read_b64_tr_b16 a[18:19], v68 offset:4096
    ds_read_b64_tr_b16 a[20:21], v68 offset:8192
    ds_read_b64_tr_b16 a[22:23], v68 offset:12288
    ds_read_b64_tr_b16 a[24:25], v69 offset:0
    ds_read_b64_tr_b16 a[26:27], v69 offset:4096
    ds_read_b64_tr_b16 a[28:29], v69 offset:8192
    ds_read_b64_tr_b16 a[30:31], v69 offset:12288
    s_waitcnt lgkmcnt(0)
    s_waitcnt vmcnt(4)
    s_barrier
    s_mov_b32 m0, 3072
    s_add_u32 s19, s36, 1351680
    buffer_load_dwordx4 v64, s[20:23], s19 offen lds
    s_mov_b32 m0, 7168
    s_add_u32 s19, s36, 1417216
    buffer_load_dwordx4 v64, s[20:23], s19 offen lds
    s_mov_b32 m0, 11264
    s_add_u32 s19, s36, 1368064
    buffer_load_dwordx4 v64, s[20:23], s19 offen lds
    s_mov_b32 m0, 15360
    s_add_u32 s19, s36, 1433600
    buffer_load_dwordx4 v64, s[20:23], s19 offen lds
    ds_read_b32 v84, v127 offset:40960
    s_waitcnt lgkmcnt(0)
    v_readfirstlane_b32 s19, v84
    s_nop 0
    s_bitcmp1_b32 s19, s93
    s_cbranch_scc1 L_lost
    ds_read_b64_tr_b16 a[32:33], v72 offset:0
    ds_read_b64_tr_b16 a[34:35], v74 offset:0
    ds_read_b64_tr_b16 a[36:37], v76 offset:0
    ds_read_b64_tr_b16 a[38:39], v78 offset:0
    ds_read_b64_tr_b16 a[40:41], v73 offset:0
    ds_read_b64_tr_b16 a[42:43], v75 offset:0
    ds_read_b64_tr_b16 a[44:45], v77 offset:0
    ds_read_b64_tr_b16 a[46:47], v79 offset:0
    s_waitcnt lgkmcnt(0)
    s_waitcnt vmcnt(4)
    s_barrier
    s_mov_b32 m0, 48128
    s_add_u32 s19, s36, 2138112
    buffer_load_dwordx4 v64, s[20:23], s19 offen lds
    s_mov_b32 m0, 84992
    s_add_u32 s19, s36, 2203648
    buffer_load_dwordx4 v64, s[20:23], s19 offen lds
    s_mov_b32 m0, 121856
    s_add_u32 s19, s36, 2154496
    buffer_load_dwordx4 v64, s[20:23], s19 offen lds
    s_mov_b32 m0, 158720
    s_add_u32 s19, s36, 2220032
    buffer_load_dwordx4 v64, s[20:23], s19 offen lds
    ds_read_b64_tr_b16 v[0:1], v72 offset:4096
    ds_read_b64_tr_b16 v[2:3], v74 offset:4096
    ds_read_b64_tr_b16 v[4:5], v76 offset:4096
    ds_read_b64_tr_b16 v[6:7], v78 offset:4096
    ds_read_b64_tr_b16 v[8:9], v73 offset:4096
    ds_read_b64_tr_b16 v[10:11], v75 offset:4096
    ds_read_b64_tr_b16 v[12:13], v77 offset:4096
    ds_read_b64_tr_b16 v[14:15], v79 offset:4096
    s_waitcnt lgkmcnt(0)
    ds_write_b128 v118, v[0:3] offset:12288
    ds_write_b128 v118, v[4:7] offset:13312
    ds_write_b128 v118, v[8:11] offset:14336
    ds_write_b128 v118, v[12:15] offset:15360
    s_waitcnt lgkmcnt(0)
    s_waitcnt vmcnt(4)
    s_barrier
    s_mov_b32 m0, 52224
    s_add_u32 s19, s36, 2400256
    buffer_load_dwordx4 v64, s[20:23], s19 offen lds
    s_mov_b32 m0, 89088
    s_add_u32 s19, s36, 2465792
    buffer_load_dwordx4 v64, s[20:23], s19 offen lds
    s_mov_b32 m0, 125952
    s_add_u32 s19, s36, 2416640
    buffer_load_dwordx4 v64, s[20:23], s19 offen lds
    s_mov_b32 m0, 162816
    s_add_u32 s19, s36, 2482176
    buffer_load_dwordx4 v64, s[20:23], s19 offen lds
    ds_read_b64_tr_b16 a[48:49], v68 offset:0
    ds_read_b64_tr_b16 a[50:51], v68 offset:4096
    ds_read_b64_tr_b16 a[52:53], v68 offset:8192
    ds_read_b64_tr_b16 a[54:55], v68 offset:12288
    ds_read_b64_tr_b16 a[56:57], v69 offset:0
    ds_read_b64_tr_b16 a[58:59], v69 offset:4096
    ds_read_b64_tr_b16 a[60:61], v69 offset:8192
    ds_read_b64_tr_b16 a[62:63], v69 offset:12288
    s_waitcnt lgkmcnt(0)
    s_waitcnt vmcnt(4)
    s_barrier
    s_mov_b32 m0, 3072
    s_add_u32 s19, s36, 3186688
    buffer_load_dwordx4 v64, s[20:23], s19 offen lds
    s_mov_b32 m0, 7168
    s_add_u32 s19, s36, 3252224
    buffer_load_dwordx4 v64, s[20:23], s19 offen lds
    s_mov_b32 m0, 11264
    s_add_u32 s19, s36, 3203072
    buffer_load_dwordx4 v64, s[20:23], s19 offen lds
    s_mov_b32 m0, 15360
    s_add_u32 s19, s36, 3268608
    buffer_load_dwordx4 v64, s[20:23], s19 offen lds
    ds_read_b64_tr_b16 a[64:65], v72 offset:0
    ds_read_b64_tr_b16 a[66:67], v74 offset:0
    ds_read_b64_tr_b16 a[68:69], v76 offset:0
    ds_read_b64_tr_b16 a[70:71], v78 offset:0
    ds_read_b64_tr_b16 a[72:73], v73 offset:0
    ds_read_b64_tr_b16 a[74:75], v75 offset:0
    ds_read_b64_tr_b16 a[76:77], v77 offset:0
    ds_read_b64_tr_b16 a[78:79], v79 offset:0
    s_waitcnt lgkmcnt(0)
    s_waitcnt vmcnt(4)
    s_barrier
    s_mov_b32 m0, 48128
    s_add_u32 s19, s36, 3448832
    buffer_load_dwordx4 v64, s[20:23], s19 offen lds
    s_mov_b32 m0, 84992
    s_add_u32 s19, s36, 3514368
    buffer_load_dwordx4 v64, s[20:23], s19 offen lds
    s_mov_b32 m0, 121856
    s_add_u32 s19, s36, 3465216
    buffer_load_dwordx4 v64, s[20:23], s19 offen lds
    s_mov_b32 m0, 158720
    s_add_u32 s19, s36, 3530752
    buffer_load_dwordx4 v64, s[20:23], s19 offen lds
    ds_read_b64_tr_b16 v[0:1], v72 offset:4096
    ds_read_b64_tr_b16 v[2:3], v74 offset:4096
    ds_read_b64_tr_b16 v[4:5], v76 offset:4096
    ds_read_b64_tr_b16 v[6:7], v78 offset:4096
    ds_read_b64_tr_b16 v[8:9], v73 offset:4096
    ds_read_b64_tr_b16 v[10:11], v75 offset:4096
    ds_read_b64_tr_b16 v[12:13], v77 offset:4096
    ds_read_b64_tr_b16 v[14:15], v79 offset:4096
    s_waitcnt lgkmcnt(0)
    ds_write_b128 v118, v[0:3] offset:16384
    ds_write_b128 v118, v[4:7] offset:17408
    ds_write_b128 v118, v[8:11] offset:18432
    ds_write_b128 v118, v[12:15] offset:19456
    s_waitcnt lgkmcnt(0)
    s_waitcnt vmcnt(4)
    s_barrier
    s_mov_b32 m0, 52224
    s_add_u32 s19, s36, 40960
    buffer_load_dwordx4 v64, s[24:27], s19 offen lds
    s_mov_b32 m0, 89088
    s_add_u32 s19, s36, 106496
    buffer_load_dwordx4 v64, s[24:27], s19 offen lds
    s_mov_b32 m0, 125952
    s_add_u32 s19, s36, 57344
    buffer_load_dwordx4 v64, s[24:27], s19 offen lds
    s_mov_b32 m0, 162816
    s_add_u32 s19, s36, 122880
    buffer_load_dwordx4 v64, s[24:27], s19 offen lds
    ds_read_b64_tr_b16 v[0:1], v68 offset:0
    ds_read_b64_tr_b16 v[2:3], v68 offset:4096
    ds_read_b64_tr_b16 v[4:5], v68 offset:8192
    ds_read_b64_tr_b16 v[6:7], v68 offset:12288
    ds_read_b64_tr_b16 v[8:9], v69 offset:0
    ds_read_b64_tr_b16 v[10:11], v69 offset:4096
    ds_read_b64_tr_b16 v[12:13], v69 offset:8192
    ds_read_b64_tr_b16 v[14:15], v69 offset:12288
    s_waitcnt lgkmcnt(0)
    ds_write_b128 v118, v[0:3] offset:0
    ds_write_b128 v118, v[4:7] offset:1024
    ds_write_b128 v118, v[8:11] offset:2048
    ds_write_b128 v118, v[12:15] offset:3072
    s_waitcnt lgkmcnt(0)
    s_waitcnt vmcnt(4)
    s_barrier
    s_mov_b32 m0, 3072
    s_add_u32 s19, s36, 303104
    buffer_load_dwordx4 v64, s[24:27], s19 offen lds
    s_mov_b32 m0, 7168
    s_add_u32 s19, s36, 368640
    buffer_load_dwordx4 v64, s[24:27], s19 offen lds
    s_mov_b32 m0, 11264
    s_add_u32 s19, s36, 319488
    buffer_load_dwordx4 v64, s[24:27], s19 offen lds
    s_mov_b32 m0, 15360
    s_add_u32 s19, s36, 385024
    buffer_load_dwordx4 v64, s[24:27], s19 offen lds
    ds_read_b64_tr_b16 a[0:1], v72 offset:0
    ds_read_b64_tr_b16 a[2:3], v74 offset:0
    ds_read_b64_tr_b16 a[4:5], v76 offset:0
    ds_read_b64_tr_b16 a[6:7], v78 offset:0
    ds_read_b64_tr_b16 a[8:9], v73 offset:0
    ds_read_b64_tr_b16 a[10:11], v75 offset:0
    ds_read_b64_tr_b16 a[12:13], v77 offset:0
    ds_read_b64_tr_b16 a[14:15], v79 offset:0
    s_waitcnt lgkmcnt(0)
    s_waitcnt vmcnt(4)
    s_barrier
    s_mov_b32 m0, 48128
    s_add_u32 s19, s36, 1089536
    buffer_load_dwordx4 v64, s[24:27], s19 offen lds
    s_mov_b32 m0, 84992
    s_add_u32 s19, s36, 1155072
    buffer_load_dwordx4 v64, s[24:27], s19 offen lds
    s_mov_b32 m0, 121856
    s_add_u32 s19, s36, 1105920
    buffer_load_dwordx4 v64, s[24:27], s19 offen lds
    s_mov_b32 m0, 158720
    s_add_u32 s19, s36, 1171456
    buffer_load_dwordx4 v64, s[24:27], s19 offen lds
    ds_read_b64_tr_b16 a[96:97], v72 offset:4096
    ds_read_b64_tr_b16 a[98:99], v74 offset:4096
    ds_read_b64_tr_b16 a[100:101], v76 offset:4096
    ds_read_b64_tr_b16 a[102:103], v78 offset:4096
    ds_read_b64_tr_b16 a[104:105], v73 offset:4096
    ds_read_b64_tr_b16 a[106:107], v75 offset:4096
    ds_read_b64_tr_b16 a[108:109], v77 offset:4096
    ds_read_b64_tr_b16 a[110:111], v79 offset:4096
    s_waitcnt lgkmcnt(0)
    s_waitcnt vmcnt(4)
    s_barrier
    s_mov_b32 m0, 52224
    s_add_u32 s19, s36, 1351680
    buffer_load_dwordx4 v64, s[24:27], s19 offen lds
    s_mov_b32 m0, 89088
    s_add_u32 s19, s36, 1417216
    buffer_load_dwordx4 v64, s[24:27], s19 offen lds
    s_mov_b32 m0, 125952
    s_add_u32 s19, s36, 1368064
    buffer_load_dwordx4 v64, s[24:27], s19 offen lds
    s_mov_b32 m0, 162816
    s_add_u32 s19, s36, 1433600
    buffer_load_dwordx4 v64, s[24:27], s19 offen lds
    ds_read_b64_tr_b16 a[112:113], v68 offset:0
    ds_read_b64_tr_b16 a[114:115], v68 offset:4096
    ds_read_b64_tr_b16 a[116:117], v68 offset:8192
    ds_read_b64_tr_b16 a[118:119], v68 offset:12288
    ds_read_b64_tr_b16 a[120:121], v69 offset:0
    ds_read_b64_tr_b16 a[122:123], v69 offset:4096
    ds_read_b64_tr_b16 a[124:125], v69 offset:8192
    ds_read_b64_tr_b16 a[126:127], v69 offset:12288
    s_waitcnt lgkmcnt(0)
    s_waitcnt vmcnt(4)
    s_barrier
    s_mov_b32 m0, 3072
    s_add_u32 s19, s36, 2138112
    buffer_load_dwordx4 v64, s[24:27], s19 offen lds
    s_mov_b32 m0, 7168
    s_add_u32 s19, s36, 2203648
    buffer_load_dwordx4 v64, s[24:27], s19 offen lds
    s_mov_b32 m0, 11264
    s_add_u32 s19, s36, 2154496
    buffer_load_dwordx4 v64, s[24:27], s19 offen lds
    s_mov_b32 m0, 15360
    s_add_u32 s19, s36, 2220032
    buffer_load_dwordx4 v64, s[24:27], s19 offen lds
    ds_read_b64_tr_b16 v[0:1], v72 offset:0
    ds_read_b64_tr_b16 v[2:3], v74 offset:0
    ds_read_b64_tr_b16 v[4:5], v76 offset:0
    ds_read_b64_tr_b16 v[6:7], v78 offset:0
    ds_read_b64_tr_b16 v[8:9], v73 offset:0
    ds_read_b64_tr_b16 v[10:11], v75 offset:0
    ds_read_b64_tr_b16 v[12:13], v77 offset:0
    ds_read_b64_tr_b16 v[14:15], v79 offset:0
    s_waitcnt lgkmcnt(0)
    ds_write_b128 v118, v[0:3] offset:20480
    ds_write_b128 v118, v[4:7] offset:21504
    ds_write_b128 v118, v[8:11] offset:22528
    ds_write_b128 v118, v[12:15] offset:23552
    s_waitcnt lgkmcnt(0)
    s_waitcnt vmcnt(4)
    s_barrier
    s_mov_b32 m0, 48128
    s_add_u32 s19, s36, 2400256
    buffer_load_dwordx4 v64, s[24:27], s19 offen lds
    s_mov_b32 m0, 84992
    s_add_u32 s19, s36, 2465792
    buffer_load_dwordx4 v64, s[24:27], s19 offen lds
    s_mov_b32 m0, 121856
    s_add_u32 s19, s36, 2416640
    buffer_load_dwordx4 v64, s[24:27], s19 offen lds
    s_mov_b32 m0, 158720
    s_add_u32 s19, s36, 2482176
    buffer_load_dwordx4 v64, s[24:27], s19 offen lds
    ds_read_b64_tr_b16 a[128:129], v72 offset:4096
    ds_read_b64_tr_b16 a[130:131], v74 offset:4096
    ds_read_b64_tr_b16 a[132:133], v76 offset:4096
    ds_read_b64_tr_b16 a[134:135], v78 offset:4096
    ds_read_b64_tr_b16 a[136:137], v73 offset:4096
    ds_read_b64_tr_b16 a[138:139], v75 offset:4096
    ds_read_b64_tr_b16 a[140:141], v77 offset:4096
    ds_read_b64_tr_b16 a[142:143], v79 offset:4096
    s_waitcnt lgkmcnt(0)
    s_waitcnt vmcnt(4)
    s_barrier
    s_mov_b32 m0, 52224
    s_add_u32 s19, s36, 3186688
    buffer_load_dwordx4 v64, s[24:27], s19 offen lds
    s_mov_b32 m0, 89088
    s_add_u32 s19, s36, 3252224
    buffer_load_dwordx4 v64, s[24:27], s19 offen lds
    s_mov_b32 m0, 125952
    s_add_u32 s19, s36, 3203072
    buffer_load_dwordx4 v64, s[24:27], s19 offen lds
    s_mov_b32 m0, 162816
    s_add_u32 s19, s36, 3268608
    buffer_load_dwordx4 v64, s[24:27], s19 offen lds
    ds_read_b64_tr_b16 a[144:145], v68 offset:0
    ds_read_b64_tr_b16 a[146:147], v68 offset:4096
    ds_read_b64_tr_b16 a[148:149], v68 offset:8192
    ds_read_b64_tr_b16 a[150:151], v68 offset:12288
    ds_read_b64_tr_b16 a[152:153], v69 offset:0
    ds_read_b64_tr_b16 a[154:155], v69 offset:4096
    ds_read_b64_tr_b16 a[156:157], v69 offset:8192
    ds_read_b64_tr_b16 a[158:159], v69 offset:12288
    s_waitcnt lgkmcnt(0)
    s_waitcnt vmcnt(4)
    s_barrier
    s_mov_b32 m0, 3072
    s_add_u32 s19, s36, 3448832
    buffer_load_dwordx4 v64, s[24:27], s19 offen lds
    s_mov_b32 m0, 7168
    s_add_u32 s19, s36, 3514368
    buffer_load_dwordx4 v64, s[24:27], s19 offen lds
    s_mov_b32 m0, 11264
    s_add_u32 s19, s36, 3465216
    buffer_load_dwordx4 v64, s[24:27], s19 offen lds
    s_mov_b32 m0, 15360
    s_add_u32 s19, s36, 3530752
    buffer_load_dwordx4 v64, s[24:27], s19 offen lds
    ds_read_b64_tr_b16 v[0:1], v72 offset:0
    ds_read_b64_tr_b16 v[2:3], v74 offset:0
    ds_read_b64_tr_b16 v[4:5], v76 offset:0
    ds_read_b64_tr_b16 v[6:7], v78 offset:0
    ds_read_b64_tr_b16 v[8:9], v73 offset:0
    ds_read_b64_tr_b16 v[10:11], v75 offset:0
    ds_read_b64_tr_b16 v[12:13], v77 offset:0
    ds_read_b64_tr_b16 v[14:15], v79 offset:0
    s_waitcnt lgkmcnt(0)
    ds_write_b128 v118, v[0:3] offset:24576
    ds_write_b128 v118, v[4:7] offset:25600
    ds_write_b128 v118, v[8:11] offset:26624
    ds_write_b128 v118, v[12:15] offset:27648
    s_waitcnt lgkmcnt(0)
    s_waitcnt vmcnt(4)
    s_barrier
    s_mov_b32 m0, 48128
    s_add_u32 s19, s36, 40960
    buffer_load_dwordx4 v64, s[28:31], s19 offen lds
    s_mov_b32 m0, 84992
    s_add_u32 s19, s36, 106496
    buffer_load_dwordx4 v64, s[28:31], s19 offen lds
    s_mov_b32 m0, 121856
    s_add_u32 s19, s36, 57344
    buffer_load_dwordx4 v64, s[28:31], s19 offen lds
    s_mov_b32 m0, 158720
    s_add_u32 s19, s36, 122880
    buffer_load_dwordx4 v64, s[28:31], s19 offen lds
    ds_read_b64_tr_b16 v[0:1], v72 offset:4096
    ds_read_b64_tr_b16 v[2:3], v74 offset:4096
    ds_read_b64_tr_b16 v[4:5], v76 offset:4096
    ds_read_b64_tr_b16 v[6:7], v78 offset:4096
    ds_read_b64_tr_b16 v[8:9], v73 offset:4096
    ds_read_b64_tr_b16 v[10:11], v75 offset:4096
    ds_read_b64_tr_b16 v[12:13], v77 offset:4096
    ds_read_b64_tr_b16 v[14:15], v79 offset:4096
    s_waitcnt lgkmcnt(0)
    ds_write_b128 v118, v[0:3] offset:4096
    ds_write_b128 v118, v[4:7] offset:5120
    ds_write_b128 v118, v[8:11] offset:6144
    ds_write_b128 v118, v[12:15] offset:7168
    s_waitcnt lgkmcnt(0)
    s_waitcnt vmcnt(4)
    s_barrier
    s_mov_b32 m0, 52224
    s_add_u32 s19, s36, 303104
    buffer_load_dwordx4 v64, s[28:31], s19 offen lds
    s_mov_b32 m0, 89088
    s_add_u32 s19, s36, 368640
    buffer_load_dwordx4 v64, s[28:31], s19 offen lds
    s_mov_b32 m0, 125952
    s_add_u32 s19, s36, 319488
    buffer_load_dwordx4 v64, s[28:31], s19 offen lds
    s_mov_b32 m0, 162816
    s_add_u32 s19, s36, 385024
    buffer_load_dwordx4 v64, s[28:31], s19 offen lds
    ds_read_b64_tr_b16 a[80:81], v68 offset:0
    ds_read_b64_tr_b16 a[82:83], v68 offset:4096
    ds_read_b64_tr_b16 a[84:85], v68 offset:8192
    ds_read_b64_tr_b16 a[86:87], v68 offset:12288
    ds_read_b64_tr_b16 a[88:89], v69 offset:0
    ds_read_b64_tr_b16 a[90:91], v69 offset:4096
    ds_read_b64_tr_b16 a[92:93], v69 offset:8192
    ds_read_b64_tr_b16 a[94:95], v69 offset:12288
    s_waitcnt lgkmcnt(0)
    s_waitcnt vmcnt(4)
    s_barrier
    s_mov_b32 m0, 3072
    s_add_u32 s19, s36, 1089536
    buffer_load_dwordx4 v64, s[28:31], s19 offen lds
    s_mov_b32 m0, 7168
    s_add_u32 s19, s36, 1155072
    buffer_load_dwordx4 v64, s[28:31], s19 offen lds
    s_mov_b32 m0, 11264
    s_add_u32 s19, s36, 1105920
    buffer_load_dwordx4 v64, s[28:31], s19 offen lds
    s_mov_b32 m0, 15360
    s_add_u32 s19, s36, 1171456
    buffer_load_dwordx4 v64, s[28:31], s19 offen lds
    ds_read_b64_tr_b16 a[176:177], v72 offset:0
    ds_read_b64_tr_b16 a[178:179], v74 offset:0
    ds_read_b64_tr_b16 a[180:181], v76 offset:0
    ds_read_b64_tr_b16 a[182:183], v78 offset:0
    ds_read_b64_tr_b16 a[184:185], v73 offset:0
    ds_read_b64_tr_b16 a[186:187], v75 offset:0
    ds_read_b64_tr_b16 a[188:189], v77 offset:0
    ds_read_b64_tr_b16 a[190:191], v79 offset:0
    s_waitcnt lgkmcnt(0)
    s_waitcnt vmcnt(4)
    s_barrier
    s_mov_b32 m0, 48128
    s_add_u32 s19, s36, 1351680
    buffer_load_dwordx4 v64, s[28:31], s19 offen lds
    s_mov_b32 m0, 84992
    s_add_u32 s19, s36, 1417216
    buffer_load_dwordx4 v64, s[28:31], s19 offen lds
    s_mov_b32 m0, 121856
    s_add_u32 s19, s36, 1368064
    buffer_load_dwordx4 v64, s[28:31], s19 offen lds
    s_mov_b32 m0, 158720
    s_add_u32 s19, s36, 1433600
    buffer_load_dwordx4 v64, s[28:31], s19 offen lds
    ds_read_b64_tr_b16 a[192:193], v72 offset:4096
    ds_read_b64_tr_b16 a[194:195], v74 offset:4096
    ds_read_b64_tr_b16 a[196:197], v76 offset:4096
    ds_read_b64_tr_b16 a[198:199], v78 offset:4096
    ds_read_b64_tr_b16 a[200:201], v73 offset:4096
    ds_read_b64_tr_b16 a[202:203], v75 offset:4096
    ds_read_b64_tr_b16 a[204:205], v77 offset:4096
    ds_read_b64_tr_b16 a[206:207], v79 offset:4096
    s_waitcnt lgkmcnt(0)
    s_waitcnt vmcnt(4)
    s_barrier
    s_mov_b32 m0, 52224
    s_add_u32 s19, s36, 2138112
    buffer_load_dwordx4 v64, s[28:31], s19 offen lds
    s_mov_b32 m0, 89088
    s_add_u32 s19, s36, 2203648
    buffer_load_dwordx4 v64, s[28:31], s19 offen lds
    s_mov_b32 m0, 125952
    s_add_u32 s19, s36, 2154496
    buffer_load_dwordx4 v64, s[28:31], s19 offen lds
    s_mov_b32 m0, 162816
    s_add_u32 s19, s36, 2220032
    buffer_load_dwordx4 v64, s[28:31], s19 offen lds
    ds_read_b64_tr_b16 a[208:209], v68 offset:0
    ds_read_b64_tr_b16 a[210:211], v68 offset:4096
    ds_read_b64_tr_b16 a[212:213], v68 offset:8192
    ds_read_b64_tr_b16 a[214:215], v68 offset:12288
    ds_read_b64_tr_b16 a[216:217], v69 offset:0
    ds_read_b64_tr_b16 a[218:219], v69 offset:4096
    ds_read_b64_tr_b16 a[220:221], v69 offset:8192
    ds_read_b64_tr_b16 a[222:223], v69 offset:12288
    s_waitcnt lgkmcnt(0)
    s_waitcnt vmcnt(4)
    s_barrier
    s_mov_b32 m0, 3072
    s_add_u32 s19, s36, 2400256
    buffer_load_dwordx4 v64, s[28:31], s19 offen lds
    s_mov_b32 m0, 7168
    s_add_u32 s19, s36, 2465792
    buffer_load_dwordx4 v64, s[28:31], s19 offen lds
    s_mov_b32 m0, 11264
    s_add_u32 s19, s36, 2416640
    buffer_load_dwordx4 v64, s[28:31], s19 offen lds
    s_mov_b32 m0, 15360
    s_add_u32 s19, s36, 2482176
    buffer_load_dwordx4 v64, s[28:31], s19 offen lds
    ds_read_b64_tr_b16 a[224:225], v72 offset:0
    ds_read_b64_tr_b16 a[226:227], v74 offset:0
    ds_read_b64_tr_b16 a[228:229], v76 offset:0
    ds_read_b64_tr_b16 a[230:231], v78 offset:0
    ds_read_b64_tr_b16 a[232:233], v73 offset:0
    ds_read_b64_tr_b16 a[234:235], v75 offset:0
    ds_read_b64_tr_b16 a[236:237], v77 offset:0
    ds_read_b64_tr_b16 a[238:239], v79 offset:0
    s_waitcnt lgkmcnt(0)
    s_waitcnt vmcnt(4)
    s_barrier
    s_mov_b32 m0, 48128
    s_add_u32 s19, s36, 3186688
    buffer_load_dwordx4 v64, s[28:31], s19 offen lds
    s_mov_b32 m0, 84992
    s_add_u32 s19, s36, 3252224
    buffer_load_dwordx4 v64, s[28:31], s19 offen lds
    s_mov_b32 m0, 121856
    s_add_u32 s19, s36, 3203072
    buffer_load_dwordx4 v64, s[28:31], s19 offen lds
    s_mov_b32 m0, 158720
    s_add_u32 s19, s36, 3268608
    buffer_load_dwordx4 v64, s[28:31], s19 offen lds
    ds_read_b64_tr_b16 a[240:241], v72 offset:4096
    ds_read_b64_tr_b16 a[242:243], v74 offset:4096
    ds_read_b64_tr_b16 a[244:245], v76 offset:4096
    ds_read_b64_tr_b16 a[246:247], v78 offset:4096
    ds_read_b64_tr_b16 a[248:249], v73 offset:4096
    ds_read_b64_tr_b16 a[250:251], v75 offset:4096
    ds_read_b64_tr_b16 a[252:253], v77 offset:4096
    ds_read_b64_tr_b16 a[254:255], v79 offset:4096
    s_waitcnt lgkmcnt(0)
    s_waitcnt vmcnt(4)
    s_barrier
    s_mov_b32 m0, 52224
    s_add_u32 s19, s36, 3448832
    buffer_load_dwordx4 v64, s[28:31], s19 offen lds
    s_mov_b32 m0, 89088
    s_add_u32 s19, s36, 3514368
    buffer_load_dwordx4 v64, s[28:31], s19 offen lds
    s_mov_b32 m0, 125952
    s_add_u32 s19, s36, 3465216
    buffer_load_dwordx4 v64, s[28:31], s19 offen lds
    s_mov_b32 m0, 162816
    s_add_u32 s19, s36, 3530752
    buffer_load_dwordx4 v64, s[28:31], s19 offen lds
    ds_read_b64_tr_b16 v[144:145], v68 offset:0
    ds_read_b64_tr_b16 v[146:147], v68 offset:4096
    ds_read_b64_tr_b16 v[148:149], v68 offset:8192
    ds_read_b64_tr_b16 v[150:151], v68 offset:12288
    ds_read_b64_tr_b16 v[152:153], v69 offset:0
    ds_read_b64_tr_b16 v[154:155], v69 offset:4096
    ds_read_b64_tr_b16 v[156:157], v69 offset:8192
    ds_read_b64_tr_b16 v[158:159], v69 offset:12288
    s_waitcnt lgkmcnt(0)
    s_waitcnt vmcnt(4)
    s_barrier
    ds_read_b64_tr_b16 v[0:1], v72 offset:0
    ds_read_b64_tr_b16 v[2:3], v74 offset:0
    ds_read_b64_tr_b16 v[4:5], v76 offset:0
    ds_read_b64_tr_b16 v[6:7], v78 offset:0
    ds_read_b64_tr_b16 v[8:9], v73 offset:0
    ds_read_b64_tr_b16 v[10:11], v75 offset:0
    ds_read_b64_tr_b16 v[12:13], v77 offset:0
    ds_read_b64_tr_b16 v[14:15], v79 offset:0
    s_waitcnt lgkmcnt(0)
    ds_write_b128 v118, v[0:3] offset:8192
    ds_write_b128 v118, v[4:7] offset:9216
    ds_write_b128 v118, v[8:11] offset:10240
    ds_write_b128 v118, v[12:15] offset:11264
    s_waitcnt lgkmcnt(0)
    s_waitcnt vmcnt(0)
    s_barrier
    ds_read_b64_tr_b16 a[160:161], v72 offset:4096
    ds_read_b64_tr_b16 a[162:163], v74 offset:4096
    ds_read_b64_tr_b16 a[164:165], v76 offset:4096
    ds_read_b64_tr_b16 a[166:167], v78 offset:4096
    ds_read_b64_tr_b16 a[168:169], v73 offset:4096
    ds_read_b64_tr_b16 a[170:171], v75 offset:4096
    ds_read_b64_tr_b16 a[172:173], v77 offset:4096
    ds_read_b64_tr_b16 a[174:175], v79 offset:4096
    s_waitcnt lgkmcnt(0)
    s_barrier
    ds_write_b128 v118, v[32:35] offset:28672
    ds_write_b128 v118, v[36:39] offset:29696
    ds_write_b128 v118, v[40:43] offset:30720
    ds_write_b128 v118, v[44:47] offset:31744
    ds_write_b128 v118, v[48:51] offset:32768
    ds_write_b128 v118, v[52:55] offset:33792
    ds_write_b128 v118, v[56:59] offset:34816
    ds_write_b128 v118, v[60:63] offset:35840
    s_mov_b32 s35, s52
    s_lshl_b32 s34, s16, 6
    s_mov_b32 s52, 0
    v_and_b32 v113, 0xf0, v117
    v_bfe_u32 v64, v117, 9, 1
    v_lshl_add_u32 v113, v64, 8, v113
    v_bfe_u32 v64, v117, 8, 1
    v_lshl_add_u32 v113, v64, 2, v113
    s_lshl_b32 s19, s16, 14
    s_add_u32 s38, s19, 4224
    s_add_u32 s97, s19, 14336
    s_mov_b32 s39, 59837440
    s_mov_b32 s45, 59834368
    s_mov_b32 s18, 0
    s_mov_b32 s8, s72
    s_and_b32 s9, s73, 0xffff
    s_mov_b32 s10, 0x2000
    s_mov_b32 s11, 0x20000
    buffer_load_dword v8, v106, s[8:11], 0 offen offset:768
    buffer_load_dword v9, v106, s[8:11], 0 offen offset:896
    buffer_load_dword v10, v106, s[8:11], 0 offen offset:784
    buffer_load_dword v11, v106, s[8:11], 0 offen offset:912
    buffer_load_dword v12, v106, s[8:11], 0 offen offset:832
    buffer_load_dword v13, v106, s[8:11], 0 offen offset:960
    buffer_load_dword v14, v106, s[8:11], 0 offen offset:848
    buffer_load_dword v15, v106, s[8:11], 0 offen offset:976
    s_add_u32 s96, s36, 60817408
    v_bfe_u32 v85, v117, 4, 3
    v_lshlrev_b32 v85, 2, v85
C3_init:
    global_load_dword v84, v85, s[86:87] offset:0 sc1
    s_sub_u32 s48, s48, 1
    s_cbranch_scc1 C3_bail
    s_waitcnt vmcnt(0)
    v_cmp_ne_u32 vcc, -1, v84
    s_cbranch_vccnz C3_init
    global_load_dword v86, v127, s[86:87] offset:96 sc1
    v_and_b32 v85, 4, v85
C3_f01:
    buffer_load_dword v84, v85, s[4:7], s96 offen sc1
    s_sub_u32 s48, s48, 1
    s_cbranch_scc1 C3_bail
    s_waitcnt vmcnt(0)
    v_cmp_ne_u32 vcc, 1, v84
    s_cbranch_vccnz C3_f01
    s_add_u32 s96, s96, 8
    buffer_load_dwordx4 v[136:139], v124, s[4:7], s38 offen sc1
    buffer_load_dwordx4 v[128:131], v117, s[4:7], s97 offen sc1
    buffer_load_dwordx4 v[140:143], v124, s[4:7], s38 offen offset:2048 sc1
    buffer_load_dwordx4 v[132:135], v117, s[4:7], s97 offen offset:1024 sc1
    s_add_u32 s38, s38, 524288
    s_add_u32 s97, s97, 524288
    s_mov_b32 s8, 0x05040100
    s_mov_b32 s9, 0x07060302
    s_waitcnt vmcnt(0) lgkmcnt(0)
    v_cmp_ne_u32 s[58:59], 0, v86
    s_barrier
    v_perm_b32 v0, v9, v8, s8
    v_min_u32 v0, -2, v0
    v_perm_b32 v1, v11, v10, s8
    v_min_u32 v1, -2, v1
    v_perm_b32 v2, v9, v8, s9
    v_min_u32 v2, -2, v2
    v_perm_b32 v3, v11, v10, s9
    v_min_u32 v3, -2, v3
    v_perm_b32 v4, v13, v12, s8
    v_min_u32 v4, -2, v4
    v_perm_b32 v5, v15, v14, s8
    v_min_u32 v5, -2, v5
    v_perm_b32 v6, v13, v12, s9
    v_min_u32 v6, -2, v6
    v_perm_b32 v7, v15, v14, s9
    v_min_u32 v7, -2, v7
    ds_read_b128 v[64:67], v118 offset:0
    ds_read_b128 v[68:71], v118 offset:1024
    ds_read_b128 v[72:75], v118 offset:2048
    ds_read_b128 v[76:79], v118 offset:3072
    ds_read_b128 v[16:19], v118 offset:4096
    ds_read_b128 v[20:23], v118 offset:5120
    ds_read_b128 v[24:27], v118 offset:6144
    ds_read_b128 v[28:31], v118 offset:7168
    ds_read_b128 v[32:35], v118 offset:8192
    ds_read_b128 v[36:39], v118 offset:9216
    ds_read_b128 v[40:43], v118 offset:10240
    ds_read_b128 v[44:47], v118 offset:11264
    v_mov_b32 v48, v128
    v_mov_b32 v49, v129
    v_mov_b32 v50, v130
    v_mov_b32 v51, v131
    v_mov_b32 v52, v132
    v_mov_b32 v53, v133
    v_mov_b32 v54, v134
    v_mov_b32 v55, v135
    v_mov_b32 v56, v136
    v_mov_b32 v57, v137
    v_mov_b32 v58, v138
    v_mov_b32 v59, v139
    v_mov_b32 v60, v140
    v_mov_b32 v61, v141
    v_mov_b32 v62, v142
    v_mov_b32 v63, v143
    v_mov_b32 v80, 0
    v_mov_b32 v81, 0
    v_mov_b32 v82, 0
    v_mov_b32 v83, 0
    v_mov_b32 v84, 0
    v_mov_b32 v85, 0
    v_mov_b32 v86, 0
    v_mov_b32 v87, 0
    v_mov_b32 v88, 0
    v_mov_b32 v89, 0
    v_mov_b32 v90, 0
    v_mov_b32 v91, 0
    v_mov_b32 v92, 0
    v_mov_b32 v93, 0
    v_mov_b32 v94, 0
    v_mov_b32 v95, 0
    v_mov_b32 v96, 0
    v_mov_b32 v97, 0
    v_mov_b32 v98, 0
    v_mov_b32 v99, 0
    v_mov_b32 v100, 0
    v_mov_b32 v101, 0
    v_mov_b32 v102, 0
    v_mov_b32 v103, 0
    s_cmp_lg_u64 s[58:59], 0
    s_cbranch_scc1 D3_step
C3_step:
    s_waitcnt vmcnt(3)
    s_waitcnt lgkmcnt(0)
    v_max3_u32 v106, v0, v1, v2
    v_max_u32 v106, v106, v3
    v_smfmac_f32_16x16x64_bf16 v[80:83], v[0:3], v[64:71], v116
    ds_write_b128 v117, v[0:3] offset:6144
    v_smfmac_f32_16x16x64_bf16 v[84:87], v[0:3], v[72:79], v116
    s_waitcnt vmcnt(2)
    v_max3_u32 v106, v106, v4, v5
    v_max3_u32 v106, v106, v6, v7
    v_cmp_eq_u32 vcc, -1, v106
    v_smfmac_f32_16x16x64_bf16 v[88:91], v[0:3], v[16:23], v116
    ds_write_b128 v117, v[4:7] offset:7168
    v_smfmac_f32_16x16x64_bf16 v[92:95], v[0:3], v[24:31], v116
    s_cbranch_vccnz C3_re2
    ds_read_b128 v[64:67], v118 offset:12288
    v_smfmac_f32_16x16x64_bf16 v[96:99], v[0:3], v[32:39], v116
    ds_read_b128 v[68:71], v118 offset:13312
    v_smfmac_f32_16x16x64_bf16 v[100:103], v[0:3], v[40:47], v116
    ds_read_b128 v[72:75], v118 offset:14336
    v_smfmac_f32_16x16x64_bf16 v[80:83], v[4:7], a[0:7], v116
    ds_read_b128 v[76:79], v118 offset:15360
    v_smfmac_f32_16x16x64_bf16 v[84:87], v[4:7], a[8:15], v116
    s_waitcnt lgkmcnt(4)
    s_barrier
    ds_read_b128 v[8:11], v117 offset:0
    buffer_load_dwordx4 v[136:139], v124, s[4:7], s38 offen sc1
    v_smfmac_f32_16x16x64_bf16 v[88:91], v[4:7], a[80:87], v116
    s_and_b32 s19, s18, 1
    s_lshl_b32 s19, s19, 18
    ds_read_b128 v[12:15], v117 offset:1024
    v_smfmac_f32_16x16x64_bf16 v[92:95], v[4:7], a[88:95], v116
    s_add_u32 s40, s19, s34
    ds_read_b128 v[16:19], v117 offset:2048
    buffer_load_dwordx4 v[128:131], v117, s[4:7], s97 offen sc1
    v_smfmac_f32_16x16x64_bf16 v[96:99], v[4:7], a[160:167], v116
    s_add_u32 s40, s40, 58916864
    s_add_u32 s41, s40, 4096
    ds_read_b128 v[20:23], v117 offset:3072
    v_smfmac_f32_16x16x64_bf16 v[100:103], v[4:7], a[168:175], v116
    s_waitcnt lgkmcnt(3)
    ds_read_b128 v[24:27], v117 offset:4096
    buffer_load_dwordx4 v[140:143], v124, s[4:7], s38 offen offset:2048 sc1
    v_smfmac_f32_16x16x64_bf16 v[80:83], v[8:11], a[16:23], v116
    s_lshl_b32 s42, s16, 13
    s_add_u32 s42, s42, s19
    ds_read_b128 v[28:31], v117 offset:5120
    v_smfmac_f32_16x16x64_bf16 v[84:87], v[8:11], a[24:31], v116
    s_waitcnt lgkmcnt(4)
    ds_read_b128 v[32:35], v118 offset:16384
    buffer_load_dwordx4 v[132:135], v117, s[4:7], s97 offen offset:1024 sc1
    v_smfmac_f32_16x16x64_bf16 v[80:83], v[12:15], a[32:39], v116
    s_add_u32 s42, s42, 58720256
    s_bfe_u32 s46, s18, 0x10001
    ds_read_b128 v[36:39], v118 offset:17408
    v_smfmac_f32_16x16x64_bf16 v[84:87], v[12:15], a[40:47], v116
    s_waitcnt lgkmcnt(2)
    s_add_u32 s19, s18, 1
    ds_read_b128 v[40:43], v118 offset:18432
    v_smfmac_f32_16x16x64_bf16 v[80:83], v[16:19], v[64:71], v116
    s_waitcnt lgkmcnt(9)
    s_and_b32 s19, s19, 3
    ds_read_b128 v[44:47], v118 offset:19456
    v_smfmac_f32_16x16x64_bf16 v[84:87], v[16:19], v[72:79], v116
    s_lshl_b32 s19, s19, 13
    ds_read_b128 v[64:67], v118 offset:20480
    buffer_store_dwordx4 v[108:111], v117, s[4:7], s39 offen sc1
    v_smfmac_f32_16x16x64_bf16 v[80:83], v[20:23], a[48:55], v116
    s_add_u32 s45, s19, 59774976
    s_add_u32 s19, s19, 8192
    ds_read_b128 v[68:71], v118 offset:21504
    v_smfmac_f32_16x16x64_bf16 v[84:87], v[20:23], a[56:63], v116
    s_and_b32 s19, s19, 24576
    s_add_u32 s47, s19, s35
    ds_read_b128 v[72:75], v118 offset:22528
    v_smfmac_f32_16x16x64_bf16 v[80:83], v[24:27], a[64:71], v116
    s_add_u32 s47, s47, 59768832
    ds_read_b128 v[76:79], v118 offset:23552
    v_smfmac_f32_16x16x64_bf16 v[84:87], v[24:27], a[72:79], v116
    s_waitcnt lgkmcnt(4)
    v_smfmac_f32_16x16x64_bf16 v[80:83], v[28:31], v[32:39], v116
    s_nop 1
    v_smfmac_f32_16x16x64_bf16 v[84:87], v[28:31], v[40:47], v116
    s_nop 0
    ds_read_b128 v[32:35], v118 offset:24576
    v_smfmac_f32_16x16x64_bf16 v[88:91], v[8:11], a[96:103], v116
    s_nop 0
    ds_read_b128 v[36:39], v118 offset:25600
    v_add_f32 v80, v80, v82
    v_smfmac_f32_16x16x64_bf16 v[92:95], v[8:11], a[104:111], v116
    ds_read_b128 v[40:43], v118 offset:26624
    v_add_f32 v81, v81, v83
    v_add_f32 v84, v84, v86
    v_smfmac_f32_16x16x64_bf16 v[88:91], v[12:15], a[112:119], v116
    ds_read_b128 v[44:47], v118 offset:27648
    v_add_f32 v85, v85, v87
    v_cvt_pk_bf16_f32 v80, v80, v84
    v_smfmac_f32_16x16x64_bf16 v[92:95], v[12:15], a[120:127], v116
    s_waitcnt lgkmcnt(4)
    v_cvt_pk_bf16_f32 v81, v81, v85
    v_smfmac_f32_16x16x64_bf16 v[88:91], v[16:19], v[64:71], v116
    ds_write2_b32 v119, v80, v81 offset0:0 offset1:16
    v_smfmac_f32_16x16x64_bf16 v[92:95], v[16:19], v[72:79], v116
    v_smfmac_f32_16x16x64_bf16 v[88:91], v[20:23], a[128:135], v116
    buffer_store_dword v112, v123, s[4:7], s47 offen
    v_smfmac_f32_16x16x64_bf16 v[92:95], v[20:23], a[136:143], v116
    v_smfmac_f32_16x16x64_bf16 v[88:91], v[24:27], a[144:151], v116
    s_waitcnt vmcnt(6) lgkmcnt(0)
    s_barrier
    ds_read_b128 v[0:3], v120 offset:0
    v_smfmac_f32_16x16x64_bf16 v[92:95], v[24:27], a[152:159], v116
    s_waitcnt lgkmcnt(2)
    ds_read_b128 v[4:7], v120 offset:2048
    v_smfmac_f32_16x16x64_bf16 v[88:91], v[28:31], v[32:39], v116
    s_nop 0
    ds_read_b128 v[72:75], v127 offset:15616
    v_smfmac_f32_16x16x64_bf16 v[92:95], v[28:31], v[40:47], v116
    s_nop 2
    v_smfmac_f32_16x16x64_bf16 v[96:99], v[8:11], a[176:183], v116
    s_waitcnt lgkmcnt(2)
    v_add_f32 v88, v88, v90
    v_mfma_f32_16x16x32_bf16 v[80:83], v[56:59], v[0:3], 0
    s_waitcnt lgkmcnt(1)
    v_add_f32 v89, v89, v91
    v_add_f32 v92, v92, v94
    v_mfma_f32_16x16x32_bf16 v[80:83], v[60:63], v[4:7], v[80:83]
    s_nop 0
    v_add_f32 v93, v93, v95
    v_cvt_pk_bf16_f32 v108, v88, v92
    v_smfmac_f32_16x16x64_bf16 v[100:103], v[8:11], a[184:191], v116
    s_nop 1
    v_cvt_pk_bf16_f32 v109, v89, v93
    ds_write2_b32 v119, v108, v109 offset0:128 offset1:144
    v_smfmac_f32_16x16x64_bf16 v[96:99], v[12:15], a[192:199], v116
    v_add_f32_dpp v80, v82, v80 row_ror:8 row_mask:0xf bank_mask:0xf
    v_add_f32_dpp v81, v83, v81 row_ror:8 row_mask:0xf bank_mask:0xf
    v_smfmac_f32_16x16x64_bf16 v[100:103], v[12:15], a[200:207], v116
    v_exp_f32 v82, v80
    v_smfmac_f32_16x16x64_bf16 v[96:99], v[16:19], a[208:215], v116
    v_exp_f32 v83, v81
    v_smfmac_f32_16x16x64_bf16 v[100:103], v[16:19], a[216:223], v116
    s_waitcnt lgkmcnt(0)
    s_barrier
    ds_read_b128 v[8:11], v121 offset:0
    v_cvt_pk_bf16_f32 v82, v82, v83
    s_mov_b64 exec, s[50:51]
    ds_write_b32 v113, v82 offset:14856
    s_mov_b64 exec, -1
    v_smfmac_f32_16x16x64_bf16 v[96:99], v[20:23], a[224:231], v116
    ds_read_b128 v[12:15], v121 offset:2048
    v_smfmac_f32_16x16x64_bf16 v[100:103], v[20:23], a[232:239], v116
    v_smfmac_f32_16x16x64_bf16 v[96:99], v[24:27], a[240:247], v116
    v_smfmac_f32_16x16x64_bf16 v[100:103], v[24:27], a[248:255], v116
    s_waitcnt lgkmcnt(2)
    s_waitcnt lgkmcnt(1)
    s_barrier
    ds_read_b128 v[88:91], v117 offset:14336
    v_mfma_f32_16x16x32_bf16 v[84:87], v[8:11], v[0:3], 0
    s_waitcnt lgkmcnt(1)
    ds_read_b128 v[92:95], v125 offset:14336
    v_mfma_f32_16x16x32_bf16 v[84:87], v[12:15], v[4:7], v[84:87]
    s_nop 1
    v_smfmac_f32_16x16x64_bf16 v[96:99], v[28:31], v[144:151], v116
    s_nop 1
    v_smfmac_f32_16x16x64_bf16 v[100:103], v[28:31], v[152:159], v116
    s_cmp_eq_u32 s18, 63
    s_waitcnt lgkmcnt(1)
    v_add_f32_dpp v84, v86, v84 row_ror:8 row_mask:0xf bank_mask:0xf
    v_add_f32_dpp v85, v87, v85 row_ror:8 row_mask:0xf bank_mask:0xf
    v_mfma_f32_16x16x32_bf16 v[68:71], v[72:75], v[88:91], 0
    s_cbranch_scc1 C3_fin
    v_mul_f32 v84, s49, v84
    v_mul_f32 v85, s49, v85
    v_mfma_f32_16x16x32_bf16 v[64:67], v[48:51], v[88:91], 0
    s_waitcnt lgkmcnt(0)
    v_exp_f32 v86, v84
    v_add_f32 v96, v96, v98
    v_mfma_f32_16x16x32_bf16 v[64:67], v[52:55], v[92:95], v[64:67]
    v_exp_f32 v87, v85
    v_add_f32 v97, v97, v99
    v_add_f32 v100, v100, v102
    s_mov_b64 exec, s[50:51]
    v_cvt_pk_bf16_f32 v104, v86, v87
    s_mov_b64 exec, -1
    v_add_f32 v101, v101, v103
    v_mfma_f32_16x16x16_bf16 v[68:71], v[72:73], v[104:105], v[68:71]
    v_mov_b32_dpp v105, v104 row_ror:8 row_mask:0xf bank_mask:0xf
    v_cvt_pk_bf16_f32 v110, v96, v97
    v_cvt_pk_bf16_f32 v111, v100, v101
    s_nop 1
    v_mfma_f32_16x16x16_bf16 v[64:67], v[110:111], v[104:105], v[64:67]
    s_nop 1
    v_rcp_f32 v106, v68
    v_subrev_u32 v107, s60, v68
    v_cmp_lt_u32 vcc, s61, v107
    v_mov_b32_dpp v106, v106 row_ror:8 row_mask:0xf bank_mask:0xc
    s_nop 1
    v_mul_f32 v64, v106, v64
    v_mul_f32 v65, v106, v65
    v_mul_f32 v66, v106, v66
    v_mul_f32 v67, v106, v67
    v_cvt_pk_bf16_f32 v96, v64, v65
    v_cvt_pk_bf16_f32 v97, v66, v67
    ds_write_b64 v126, v[96:97] offset:13344
    v_mfma_f32_16x16x1_4b_f32 v[32:47], v127, v127, 0
    s_and_b64 vcc, vcc, s[50:51]
    s_cbranch_scc1 C3_slow
C3_back:
    v_mov_b32 v107, 0
    v_mov_b32 v107, 0
    v_mov_b32 v107, 0
    s_waitcnt lgkmcnt(0)
    s_barrier
    ds_read_b128 v[80:83], v117 offset:12288
    ds_read_b128 v[84:87], v117 offset:13312
    v_mfma_f32_16x16x1_4b_f32 v[48:63], v127, v127, 0
    v_mov_b32 v107, 0
    s_waitcnt lgkmcnt(1)
    v_smfmac_f32_16x16x64_bf16 v[32:35], v[80:83], v[160:167], v116
    s_waitcnt lgkmcnt(0)
    ds_read_b128 v[0:3], v118 offset:28672
    v_smfmac_f32_16x16x64_bf16 v[32:35], v[84:87], v[192:199], v116
    s_lshl_b32 s39, s18, 5
    ds_read_b128 v[4:7], v118 offset:29696
    v_smfmac_f32_16x16x64_bf16 v[36:39], v[80:83], v[168:175], v116
    s_add_u32 s39, s39, s16
    ds_read_b128 v[8:11], v118 offset:30720
    v_smfmac_f32_16x16x64_bf16 v[36:39], v[84:87], v[200:207], v116
    s_lshl_b32 s39, s39, 12
    ds_read_b128 v[12:15], v118 offset:31744
    v_add_f32 v32, v32, v34
    v_smfmac_f32_16x16x64_bf16 v[40:43], v[80:83], v[176:183], v116
    s_add_u32 s39, s39, 50334720
    ds_read_b128 v[16:19], v118 offset:32768
    v_add_f32 v33, v33, v35
    v_cvt_pk_bf16_f32 v88, v32, v33
    v_smfmac_f32_16x16x64_bf16 v[40:43], v[84:87], v[208:215], v116
    s_cmp_lt_u32 s18, 62
    ds_read_b128 v[20:23], v118 offset:33792
    v_add_f32 v36, v36, v38
    v_smfmac_f32_16x16x64_bf16 v[44:47], v[80:83], v[184:191], v116
    s_cselect_b32 s19, 524288, 0
    ds_read_b128 v[24:27], v118 offset:34816
    v_add_f32 v37, v37, v39
    v_cvt_pk_bf16_f32 v89, v36, v37
    v_and_or_b32 v89, v89, -2, s46
    v_smfmac_f32_16x16x64_bf16 v[44:47], v[84:87], v[216:223], v116
    s_add_u32 s38, s38, s19
    ds_read_b128 v[28:31], v118 offset:35840
    buffer_store_dwordx2 v[88:89], v122, s[4:7], s40 offen offset:0
    v_add_f32 v40, v40, v42
    v_smfmac_f32_16x16x64_bf16 v[48:51], v[80:83], v[224:231], v116
    s_waitcnt lgkmcnt(6)
    ds_read_b128 v[64:67], v118 offset:0
    v_add_f32 v41, v41, v43
    v_cvt_pk_bf16_f32 v90, v40, v41
    v_smfmac_f32_16x16x64_bf16 v[48:51], v[84:87], v[0:7], v116
    s_add_u32 s97, s97, s19
    ds_read_b128 v[68:71], v118 offset:1024
    v_add_f32 v44, v44, v46
    v_smfmac_f32_16x16x64_bf16 v[52:55], v[80:83], v[232:239], v116
    s_waitcnt lgkmcnt(6)
    ds_read_b128 v[72:75], v118 offset:2048
    v_add_f32 v45, v45, v47
    v_cvt_pk_bf16_f32 v91, v44, v45
    v_and_or_b32 v91, v91, -2, s46
    v_smfmac_f32_16x16x64_bf16 v[52:55], v[84:87], v[8:15], v116
    s_nop 0
    buffer_store_dwordx2 v[90:91], v122, s[4:7], s40 offen offset:2048
    v_add_f32 v48, v48, v50
    v_smfmac_f32_16x16x64_bf16 v[56:59], v[80:83], v[240:247], v116
    s_waitcnt lgkmcnt(3)
    ds_read_b128 v[76:79], v118 offset:3072
    v_add_f32 v49, v49, v51
    v_cvt_pk_bf16_f32 v92, v48, v49
    v_smfmac_f32_16x16x64_bf16 v[56:59], v[84:87], v[16:23], v116
    s_nop 0
    v_add_f32 v52, v52, v54
    v_smfmac_f32_16x16x64_bf16 v[60:63], v[80:83], v[248:255], v116
    s_nop 0
    v_add_f32 v53, v53, v55
    v_cvt_pk_bf16_f32 v93, v52, v53
    v_and_or_b32 v93, v93, -2, s46
    v_smfmac_f32_16x16x64_bf16 v[60:63], v[84:87], v[24:31], v116
    buffer_store_dwordx2 v[92:93], v122, s[4:7], s41 offen offset:0
    v_add_f32 v56, v56, v58
    v_add_f32 v57, v57, v59
    v_cvt_pk_bf16_f32 v94, v56, v57
    s_nop 3
    v_add_f32 v60, v60, v62
    v_add_f32 v61, v61, v63
    v_cvt_pk_bf16_f32 v95, v60, v61
    v_and_or_b32 v95, v95, -2, s46
    buffer_store_dwordx2 v[94:95], v122, s[4:7], s41 offen offset:2048
    v_mov_b32 v96, 0
    v_mov_b32 v97, 0
    v_mov_b32 v98, 0
    ds_read_b128 v[16:19], v118 offset:4096
    v_mov_b32 v99, 0
    v_mov_b32 v100, 0
    v_mov_b32 v101, 0
    ds_read_b128 v[20:23], v118 offset:5120
    v_mov_b32 v102, 0
    v_mov_b32 v103, 0
    v_mov_b32 v80, 0
    ds_read_b128 v[24:27], v118 offset:6144
    v_mov_b32 v81, 0
    v_mov_b32 v82, 0
    v_mov_b32 v83, 0
    ds_read_b128 v[28:31], v118 offset:7168
    v_mov_b32 v84, 0
    v_mov_b32 v85, 0
    v_mov_b32 v86, 0
    ds_read_b128 v[32:35], v118 offset:8192
    v_mov_b32 v87, 0
    v_mov_b32 v88, 0
    v_mov_b32 v89, 0
    ds_read_b128 v[36:39], v118 offset:9216
    v_mov_b32 v90, 0
    v_mov_b32 v91, 0
    v_mov_b32 v92, 0
    ds_read_b128 v[40:43], v118 offset:10240
    v_mov_b32 v93, 0
    v_mov_b32 v94, 0
    v_mov_b32 v95, 0
    ds_read_b128 v[44:47], v118 offset:11264
    s_waitcnt vmcnt(6)
    v_mov_b32 v48, v128
    v_mov_b32 v49, v129
    v_mov_b32 v50, v130
    v_mov_b32 v51, v131
    v_mov_b32 v52, v132
    v_mov_b32 v53, v133
    v_mov_b32 v54, v134
    v_mov_b32 v55, v135
    v_mov_b32 v56, v136
    v_mov_b32 v57, v137
    v_mov_b32 v58, v138
    v_mov_b32 v59, v139
    v_mov_b32 v60, v140
    v_mov_b32 v61, v141
    v_mov_b32 v62, v142
    v_mov_b32 v63, v143
    s_barrier
    buffer_load_dwordx4 v[0:3], v117, s[4:7], s45 offen offset:0 sc1
    v_mov_b32 v107, 0
    s_add_u32 s18, s18, 1
    buffer_load_dwordx4 v[4:7], v117, s[4:7], s45 offen offset:1024 sc1
    v_mov_b32 v107, 0
    s_nop 2
    v_mov_b32 v107, 0
    s_nop 2
    v_mov_b32 v107, 0
    s_nop 2
    v_mov_b32 v107, 0
    s_nop 2
    v_mov_b32 v107, 0
    s_nop 2
    v_mov_b32 v107, 0
    s_nop 2
    v_mov_b32 v107, 0
    s_nop 2
    buffer_load_dwordx4 v[0:3], v117, s[4:7], s45 offen offset:0 sc1
    buffer_load_dwordx4 v[4:7], v117, s[4:7], s45 offen offset:1024 sc1
    v_mov_b32 v107, 0
    s_nop 2
    v_mov_b32 v107, 0
    s_nop 2
    v_mov_b32 v107, 0
    s_nop 2
    v_mov_b32 v107, 0
    s_nop 2
    s_branch C3_step
C3_re2:
    buffer_load_dwordx4 v[0:3], v117, s[4:7], s45 offen offset:0 sc1
    buffer_load_dwordx4 v[4:7], v117, s[4:7], s45 offen offset:1024 sc1
    s_add_u32 s55, s55, 1
    s_sub_u32 s48, s48, 1
    s_nop 0
    v_mfma_f32_16x16x1_4b_f32 v[80:95], v127, v127, 0
    s_cbranch_scc0 C3_step
C3_bail:
    s_endpgm
C3_slow:
    v_max3_f32 v106, v80, v81, v84
    v_max_f32 v106, v106, v85
    v_mov_b32 v107, v106
    s_nop 1
    v_permlane32_swap_b32 v107, v106
    v_max_f32 v106, v106, v107
    v_mov_b32 v107, v106
    s_nop 1
    v_permlane16_swap_b32 v107, v106
    v_max_f32 v106, v106, v107
    ds_write_b32 v117, v106 offset:12
    s_waitcnt lgkmcnt(0)
    s_barrier
    ds_read_b128 v[96:99], v117 offset:0
    s_waitcnt lgkmcnt(0)
    v_max3_f32 v106, v96, v97, v98
    v_max_f32 v106, v106, v99
    v_sub_f32 v82, v80, v106
    v_exp_f32 v82, v82
    v_sub_f32 v83, v81, v106
    v_exp_f32 v83, v83
    v_sub_f32 v86, v84, v106
    v_exp_f32 v86, v86
    v_sub_f32 v87, v85, v106
    v_exp_f32 v87, v87
    v_cvt_pk_bf16_f32 v82, v82, v83
    s_mov_b64 exec, s[50:51]
    ds_write_b32 v113, v82 offset:14856
    s_mov_b64 exec, -1
    s_waitcnt lgkmcnt(0)
    s_barrier
    ds_read_b128 v[88:91], v117 offset:14336
    ds_read_b128 v[92:95], v125 offset:14336
    s_waitcnt lgkmcnt(0)
    v_mfma_f32_16x16x32_bf16 v[68:71], v[72:75], v[88:91], 0
    v_mfma_f32_16x16x32_bf16 v[64:67], v[48:51], v[88:91], 0
    v_mfma_f32_16x16x32_bf16 v[64:67], v[52:55], v[92:95], v[64:67]
    s_mov_b64 exec, s[50:51]
    v_cvt_pk_bf16_f32 v104, v86, v87
    s_mov_b64 exec, -1
    s_nop 0
    v_mfma_f32_16x16x16_bf16 v[68:71], v[72:73], v[104:105], v[68:71]
    v_mov_b32_dpp v105, v104 row_ror:8 row_mask:0xf bank_mask:0xf
    s_nop 1
    v_mfma_f32_16x16x16_bf16 v[64:67], v[110:111], v[104:105], v[64:67]
    s_nop 1
    s_nop 1
    v_rcp_f32 v106, v68
    v_subrev_u32 v107, s60, v68
    v_cmp_lt_u32 vcc, s61, v107
    v_mov_b32_dpp v106, v106 row_ror:8 row_mask:0xf bank_mask:0xc
    v_mul_f32 v64, v106, v64
    v_mul_f32 v65, v106, v65
    v_mul_f32 v66, v106, v66
    v_mul_f32 v67, v106, v67
    v_cvt_pk_bf16_f32 v96, v64, v65
    v_cvt_pk_bf16_f32 v97, v66, v67
    ds_write_b64 v126, v[96:97] offset:13344
    s_branch C3_back
C3_fin:
    v_add_f32 v96, v96, v98
    v_add_f32 v97, v97, v99
    v_add_f32 v100, v100, v102
    v_add_f32 v101, v101, v103
    v_cvt_pk_bf16_f32 v110, v96, v97
    v_cvt_pk_bf16_f32 v111, v100, v101
    s_add_u32 s39, s39, 131072
    buffer_store_dwordx4 v[108:111], v117, s[4:7], s39 offen sc1
    s_endpgm
D3_step:
    s_waitcnt vmcnt(3)
    s_waitcnt lgkmcnt(0)
    v_max3_u32 v106, v0, v1, v2
    v_max_u32 v106, v106, v3
    v_smfmac_f32_16x16x64_bf16 v[80:83], v[0:3], v[64:71], v116
    ds_write_b128 v117, v[0:3] offset:6144
    v_smfmac_f32_16x16x64_bf16 v[84:87], v[0:3], v[72:79], v116
    s_waitcnt vmcnt(2)
    v_max3_u32 v106, v106, v4, v5
    v_max3_u32 v106, v106, v6, v7
    v_cmp_eq_u32 vcc, -1, v106
    v_smfmac_f32_16x16x64_bf16 v[88:91], v[0:3], v[16:23], v116
    ds_write_b128 v117, v[4:7] offset:7168
    v_smfmac_f32_16x16x64_bf16 v[92:95], v[0:3], v[24:31], v116
    s_cbranch_vccnz D3_re2
    ds_read_b128 v[64:67], v118 offset:12288
    v_smfmac_f32_16x16x64_bf16 v[96:99], v[0:3], v[32:39], v116
    ds_read_b128 v[68:71], v118 offset:13312
    v_smfmac_f32_16x16x64_bf16 v[100:103], v[0:3], v[40:47], v116
    ds_read_b128 v[72:75], v118 offset:14336
    v_smfmac_f32_16x16x64_bf16 v[80:83], v[4:7], a[0:7], v116
    ds_read_b128 v[76:79], v118 offset:15360
    v_smfmac_f32_16x16x64_bf16 v[84:87], v[4:7], a[8:15], v116
    s_waitcnt lgkmcnt(4)
    s_barrier
    ds_read_b128 v[8:11], v117 offset:0
    buffer_load_dwordx4 v[136:139], v124, s[4:7], s38 offen sc1
    v_smfmac_f32_16x16x64_bf16 v[88:91], v[4:7], a[80:87], v116
    s_and_b32 s19, s18, 1
    s_lshl_b32 s19, s19, 18
    ds_read_b128 v[12:15], v117 offset:1024
    v_smfmac_f32_16x16x64_bf16 v[92:95], v[4:7], a[88:95], v116
    s_add_u32 s40, s19, s34
    ds_read_b128 v[16:19], v117 offset:2048
    buffer_load_dwordx4 v[128:131], v117, s[4:7], s97 offen sc1
    v_smfmac_f32_16x16x64_bf16 v[96:99], v[4:7], a[160:167], v116
    s_add_u32 s40, s40, 58916864
    s_add_u32 s41, s40, 4096
    ds_read_b128 v[20:23], v117 offset:3072
    v_smfmac_f32_16x16x64_bf16 v[100:103], v[4:7], a[168:175], v116
    s_waitcnt lgkmcnt(3)
    ds_read_b128 v[24:27], v117 offset:4096
    buffer_load_dwordx4 v[140:143], v124, s[4:7], s38 offen offset:2048 sc1
    v_smfmac_f32_16x16x64_bf16 v[80:83], v[8:11], a[16:23], v116
    s_lshl_b32 s42, s16, 13
    s_add_u32 s42, s42, s19
    ds_read_b128 v[28:31], v117 offset:5120
    v_smfmac_f32_16x16x64_bf16 v[84:87], v[8:11], a[24:31], v116
    s_waitcnt lgkmcnt(4)
    ds_read_b128 v[32:35], v118 offset:16384
    buffer_load_dwordx4 v[132:135], v117, s[4:7], s97 offen offset:1024 sc1
    v_smfmac_f32_16x16x64_bf16 v[80:83], v[12:15], a[32:39], v116
    s_add_u32 s42, s42, 58720256
    s_bfe_u32 s46, s18, 0x10001
    ds_read_b128 v[36:39], v118 offset:17408
    v_smfmac_f32_16x16x64_bf16 v[84:87], v[12:15], a[40:47], v116
    s_waitcnt lgkmcnt(2)
    s_add_u32 s19, s18, 1
    ds_read_b128 v[40:43], v118 offset:18432
    v_smfmac_f32_16x16x64_bf16 v[80:83], v[16:19], v[64:71], v116
    s_waitcnt lgkmcnt(9)
    s_and_b32 s19, s19, 3
    ds_read_b128 v[44:47], v118 offset:19456
    v_smfmac_f32_16x16x64_bf16 v[84:87], v[16:19], v[72:79], v116
    s_lshl_b32 s19, s19, 13
    ds_read_b128 v[64:67], v118 offset:20480
    buffer_store_dwordx4 v[108:111], v117, s[4:7], s39 offen sc1
    v_smfmac_f32_16x16x64_bf16 v[80:83], v[20:23], a[48:55], v116
    s_add_u32 s45, s19, 59774976
    s_add_u32 s19, s19, 8192
    ds_read_b128 v[68:71], v118 offset:21504
    v_smfmac_f32_16x16x64_bf16 v[84:87], v[20:23], a[56:63], v116
    s_and_b32 s19, s19, 24576
    s_add_u32 s47, s19, s35
    ds_read_b128 v[72:75], v118 offset:22528
    v_smfmac_f32_16x16x64_bf16 v[80:83], v[24:27], a[64:71], v116
    s_add_u32 s47, s47, 59768832
    ds_read_b128 v[76:79], v118 offset:23552
    v_smfmac_f32_16x16x64_bf16 v[84:87], v[24:27], a[72:79], v116
    s_waitcnt lgkmcnt(4)
    v_smfmac_f32_16x16x64_bf16 v[80:83], v[28:31], v[32:39], v116
    s_nop 1
    v_smfmac_f32_16x16x64_bf16 v[84:87], v[28:31], v[40:47], v116
    s_nop 0
    ds_read_b128 v[32:35], v118 offset:24576
    v_smfmac_f32_16x16x64_bf16 v[88:91], v[8:11], a[96:103], v116
    s_nop 0
    ds_read_b128 v[36:39], v118 offset:25600
    v_add_f32 v80, v80, v82
    v_smfmac_f32_16x16x64_bf16 v[92:95], v[8:11], a[104:111], v116
    ds_read_b128 v[40:43], v118 offset:26624
    v_add_f32 v81, v81, v83
    v_add_f32 v84, v84, v86
    v_smfmac_f32_16x16x64_bf16 v[88:91], v[12:15], a[112:119], v116
    ds_read_b128 v[44:47], v118 offset:27648
    v_add_f32 v85, v85, v87
    v_cvt_pk_bf16_f32 v80, v80, v84
    v_smfmac_f32_16x16x64_bf16 v[92:95], v[12:15], a[120:127], v116
    s_waitcnt lgkmcnt(4)
    v_cvt_pk_bf16_f32 v81, v81, v85
    v_smfmac_f32_16x16x64_bf16 v[88:91], v[16:19], v[64:71], v116
    ds_write2_b32 v119, v80, v81 offset0:0 offset1:16
    v_smfmac_f32_16x16x64_bf16 v[92:95], v[16:19], v[72:79], v116
    v_smfmac_f32_16x16x64_bf16 v[88:91], v[20:23], a[128:135], v116
    buffer_store_dword v112, v123, s[4:7], s47 offen sc1
    v_smfmac_f32_16x16x64_bf16 v[92:95], v[20:23], a[136:143], v116
    v_smfmac_f32_16x16x64_bf16 v[88:91], v[24:27], a[144:151], v116
    s_waitcnt vmcnt(6) lgkmcnt(0)
    s_barrier
    ds_read_b128 v[0:3], v120 offset:0
    v_smfmac_f32_16x16x64_bf16 v[92:95], v[24:27], a[152:159], v116
    s_waitcnt lgkmcnt(2)
    ds_read_b128 v[4:7], v120 offset:2048
    v_smfmac_f32_16x16x64_bf16 v[88:91], v[28:31], v[32:39], v116
    s_nop 0
    ds_read_b128 v[72:75], v127 offset:15616
    v_smfmac_f32_16x16x64_bf16 v[92:95], v[28:31], v[40:47], v116
    s_nop 2
    v_smfmac_f32_16x16x64_bf16 v[96:99], v[8:11], a[176:183], v116
    s_waitcnt lgkmcnt(2)
    v_add_f32 v88, v88, v90
    v_mfma_f32_16x16x32_bf16 v[80:83], v[56:59], v[0:3], 0
    s_waitcnt lgkmcnt(1)
    v_add_f32 v89, v89, v91
    v_add_f32 v92, v92, v94
    v_mfma_f32_16x16x32_bf16 v[80:83], v[60:63], v[4:7], v[80:83]
    s_nop 0
    v_add_f32 v93, v93, v95
    v_cvt_pk_bf16_f32 v108, v88, v92
    v_smfmac_f32_16x16x64_bf16 v[100:103], v[8:11], a[184:191], v116
    s_nop 1
    v_cvt_pk_bf16_f32 v109, v89, v93
    ds_write2_b32 v119, v108, v109 offset0:128 offset1:144
    v_smfmac_f32_16x16x64_bf16 v[96:99], v[12:15], a[192:199], v116
    v_add_f32_dpp v80, v82, v80 row_ror:8 row_mask:0xf bank_mask:0xf
    v_add_f32_dpp v81, v83, v81 row_ror:8 row_mask:0xf bank_mask:0xf
    v_smfmac_f32_16x16x64_bf16 v[100:103], v[12:15], a[200:207], v116
    v_exp_f32 v82, v80
    v_smfmac_f32_16x16x64_bf16 v[96:99], v[16:19], a[208:215], v116
    v_exp_f32 v83, v81
    v_smfmac_f32_16x16x64_bf16 v[100:103], v[16:19], a[216:223], v116
    s_waitcnt lgkmcnt(0)
    s_barrier
    ds_read_b128 v[8:11], v121 offset:0
    v_cvt_pk_bf16_f32 v82, v82, v83
    s_mov_b64 exec, s[50:51]
    ds_write_b32 v113, v82 offset:14856
    s_mov_b64 exec, -1
    v_smfmac_f32_16x16x64_bf16 v[96:99], v[20:23], a[224:231], v116
    ds_read_b128 v[12:15], v121 offset:2048
    v_smfmac_f32_16x16x64_bf16 v[100:103], v[20:23], a[232:239], v116
    v_smfmac_f32_16x16x64_bf16 v[96:99], v[24:27], a[240:247], v116
    v_smfmac_f32_16x16x64_bf16 v[100:103], v[24:27], a[248:255], v116
    s_waitcnt lgkmcnt(2)
    s_waitcnt lgkmcnt(1)
    s_barrier
    ds_read_b128 v[88:91], v117 offset:14336
    v_mfma_f32_16x16x32_bf16 v[84:87], v[8:11], v[0:3], 0
    s_waitcnt lgkmcnt(1)
    ds_read_b128 v[92:95], v125 offset:14336
    v_mfma_f32_16x16x32_bf16 v[84:87], v[12:15], v[4:7], v[84:87]
    s_nop 1
    v_smfmac_f32_16x16x64_bf16 v[96:99], v[28:31], v[144:151], v116
    s_nop 1
    v_smfmac_f32_16x16x64_bf16 v[100:103], v[28:31], v[152:159], v116
    s_cmp_eq_u32 s18, 63
    s_waitcnt lgkmcnt(1)
    v_add_f32_dpp v84, v86, v84 row_ror:8 row_mask:0xf bank_mask:0xf
    v_add_f32_dpp v85, v87, v85 row_ror:8 row_mask:0xf bank_mask:0xf
    v_mfma_f32_16x16x32_bf16 v[68:71], v[72:75], v[88:91], 0
    s_cbranch_scc1 D3_fin
    v_mul_f32 v84, s49, v84
    v_mul_f32 v85, s49, v85
    v_mfma_f32_16x16x32_bf16 v[64:67], v[48:51], v[88:91], 0
    s_waitcnt lgkmcnt(0)
    v_exp_f32 v86, v84
    v_add_f32 v96, v96, v98
    v_mfma_f32_16x16x32_bf16 v[64:67], v[52:55], v[92:95], v[64:67]
    v_exp_f32 v87, v85
    v_add_f32 v97, v97, v99
    v_add_f32 v100, v100, v102
    s_mov_b64 exec, s[50:51]
    v_cvt_pk_bf16_f32 v104, v86, v87
    s_mov_b64 exec, -1
    v_add_f32 v101, v101, v103
    v_mfma_f32_16x16x16_bf16 v[68:71], v[72:73], v[104:105], v[68:71]
    v_mov_b32_dpp v105, v104 row_ror:8 row_mask:0xf bank_mask:0xf
    v_cvt_pk_bf16_f32 v110, v96, v97
    v_cvt_pk_bf16_f32 v111, v100, v101
    s_nop 1
    v_mfma_f32_16x16x16_bf16 v[64:67], v[110:111], v[104:105], v[64:67]
    s_nop 1
    v_rcp_f32 v106, v68
    v_subrev_u32 v107, s60, v68
    v_cmp_lt_u32 vcc, s61, v107
    v_mov_b32_dpp v106, v106 row_ror:8 row_mask:0xf bank_mask:0xc
    s_nop 1
    v_mul_f32 v64, v106, v64
    v_mul_f32 v65, v106, v65
    v_mul_f32 v66, v106, v66
    v_mul_f32 v67, v106, v67
    v_cvt_pk_bf16_f32 v96, v64, v65
    v_cvt_pk_bf16_f32 v97, v66, v67
    ds_write_b64 v126, v[96:97] offset:13344
    v_mfma_f32_16x16x1_4b_f32 v[32:47], v127, v127, 0
    s_and_b64 vcc, vcc, s[50:51]
    s_cbranch_scc1 D3_slow
D3_back:
    v_mov_b32 v107, 0
    v_mov_b32 v107, 0
    v_mov_b32 v107, 0
    s_waitcnt lgkmcnt(0)
    s_barrier
    ds_read_b128 v[80:83], v117 offset:12288
    ds_read_b128 v[84:87], v117 offset:13312
    v_mfma_f32_16x16x1_4b_f32 v[48:63], v127, v127, 0
    v_mov_b32 v107, 0
    s_waitcnt lgkmcnt(1)
    v_smfmac_f32_16x16x64_bf16 v[32:35], v[80:83], v[160:167], v116
    s_waitcnt lgkmcnt(0)
    ds_read_b128 v[0:3], v118 offset:28672
    v_smfmac_f32_16x16x64_bf16 v[32:35], v[84:87], v[192:199], v116
    s_lshl_b32 s39, s18, 5
    ds_read_b128 v[4:7], v118 offset:29696
    v_smfmac_f32_16x16x64_bf16 v[36:39], v[80:83], v[168:175], v116
    s_add_u32 s39, s39, s16
    ds_read_b128 v[8:11], v118 offset:30720
    v_smfmac_f32_16x16x64_bf16 v[36:39], v[84:87], v[200:207], v116
    s_lshl_b32 s39, s39, 12
    ds_read_b128 v[12:15], v118 offset:31744
    v_add_f32 v32, v32, v34
    v_smfmac_f32_16x16x64_bf16 v[40:43], v[80:83], v[176:183], v116
    s_add_u32 s39, s39, 50334720
    ds_read_b128 v[16:19], v118 offset:32768
    v_add_f32 v33, v33, v35
    v_cvt_pk_bf16_f32 v88, v32, v33
    v_smfmac_f32_16x16x64_bf16 v[40:43], v[84:87], v[208:215], v116
    s_cmp_lt_u32 s18, 62
    ds_read_b128 v[20:23], v118 offset:33792
    v_add_f32 v36, v36, v38
    v_smfmac_f32_16x16x64_bf16 v[44:47], v[80:83], v[184:191], v116
    s_cselect_b32 s19, 524288, 0
    ds_read_b128 v[24:27], v118 offset:34816
    v_add_f32 v37, v37, v39
    v_cvt_pk_bf16_f32 v89, v36, v37
    v_and_or_b32 v89, v89, -2, s46
    v_smfmac_f32_16x16x64_bf16 v[44:47], v[84:87], v[216:223], v116
    s_add_u32 s38, s38, s19
    ds_read_b128 v[28:31], v118 offset:35840
    buffer_store_dwordx2 v[88:89], v122, s[4:7], s40 offen offset:0 sc1
    v_add_f32 v40, v40, v42
    v_smfmac_f32_16x16x64_bf16 v[48:51], v[80:83], v[224:231], v116
    s_waitcnt lgkmcnt(6)
    ds_read_b128 v[64:67], v118 offset:0
    v_add_f32 v41, v41, v43
    v_cvt_pk_bf16_f32 v90, v40, v41
    v_smfmac_f32_16x16x64_bf16 v[48:51], v[84:87], v[0:7], v116
    s_add_u32 s97, s97, s19
    ds_read_b128 v[68:71], v118 offset:1024
    v_add_f32 v44, v44, v46
    v_smfmac_f32_16x16x64_bf16 v[52:55], v[80:83], v[232:239], v116
    s_waitcnt lgkmcnt(6)
    ds_read_b128 v[72:75], v118 offset:2048
    v_add_f32 v45, v45, v47
    v_cvt_pk_bf16_f32 v91, v44, v45
    v_and_or_b32 v91, v91, -2, s46
    v_smfmac_f32_16x16x64_bf16 v[52:55], v[84:87], v[8:15], v116
    s_nop 0
    buffer_store_dwordx2 v[90:91], v122, s[4:7], s40 offen offset:2048 sc1
    v_add_f32 v48, v48, v50
    v_smfmac_f32_16x16x64_bf16 v[56:59], v[80:83], v[240:247], v116
    s_waitcnt lgkmcnt(3)
    ds_read_b128 v[76:79], v118 offset:3072
    v_add_f32 v49, v49, v51
    v_cvt_pk_bf16_f32 v92, v48, v49
    v_smfmac_f32_16x16x64_bf16 v[56:59], v[84:87], v[16:23], v116
    s_nop 0
    v_add_f32 v52, v52, v54
    v_smfmac_f32_16x16x64_bf16 v[60:63], v[80:83], v[248:255], v116
    s_nop 0
    v_add_f32 v53, v53, v55
    v_cvt_pk_bf16_f32 v93, v52, v53
    v_and_or_b32 v93, v93, -2, s46
    v_smfmac_f32_16x16x64_bf16 v[60:63], v[84:87], v[24:31], v116
    buffer_store_dwordx2 v[92:93], v122, s[4:7], s41 offen offset:0 sc1
    v_add_f32 v56, v56, v58
    v_add_f32 v57, v57, v59
    v_cvt_pk_bf16_f32 v94, v56, v57
    s_nop 3
    v_add_f32 v60, v60, v62
    v_add_f32 v61, v61, v63
    v_cvt_pk_bf16_f32 v95, v60, v61
    v_and_or_b32 v95, v95, -2, s46
    buffer_store_dwordx2 v[94:95], v122, s[4:7], s41 offen offset:2048 sc1
    v_mov_b32 v96, 0
    v_mov_b32 v97, 0
    v_mov_b32 v98, 0
    ds_read_b128 v[16:19], v118 offset:4096
    v_mov_b32 v99, 0
    v_mov_b32 v100, 0
    v_mov_b32 v101, 0
    ds_read_b128 v[20:23], v118 offset:5120
    v_mov_b32 v102, 0
    v_mov_b32 v103, 0
    v_mov_b32 v80, 0
    ds_read_b128 v[24:27], v118 offset:6144
    v_mov_b32 v81, 0
    v_mov_b32 v82, 0
    v_mov_b32 v83, 0
    ds_read_b128 v[28:31], v118 offset:7168
    v_mov_b32 v84, 0
    v_mov_b32 v85, 0
    v_mov_b32 v86, 0
    ds_read_b128 v[32:35], v118 offset:8192
    v_mov_b32 v87, 0
    v_mov_b32 v88, 0
    v_mov_b32 v89, 0
    ds_read_b128 v[36:39], v118 offset:9216
    v_mov_b32 v90, 0
    v_mov_b32 v91, 0
    v_mov_b32 v92, 0
    ds_read_b128 v[40:43], v118 offset:10240
    v_mov_b32 v93, 0
    v_mov_b32 v94, 0
    v_mov_b32 v95, 0
    ds_read_b128 v[44:47], v118 offset:11264
    s_waitcnt vmcnt(6)
    v_mov_b32 v48, v128
    v_mov_b32 v49, v129
    v_mov_b32 v50, v130
    v_mov_b32 v51, v131
    v_mov_b32 v52, v132
    v_mov_b32 v53, v133
    v_mov_b32 v54, v134
    v_mov_b32 v55, v135
    v_mov_b32 v56, v136
    v_mov_b32 v57, v137
    v_mov_b32 v58, v138
    v_mov_b32 v59, v139
    v_mov_b32 v60, v140
    v_mov_b32 v61, v141
    v_mov_b32 v62, v142
    v_mov_b32 v63, v143
    s_barrier
    buffer_load_dwordx4 v[0:3], v117, s[4:7], s45 offen offset:0 sc1
    v_mov_b32 v107, 0
    s_add_u32 s18, s18, 1
    buffer_load_dwordx4 v[4:7], v117, s[4:7], s45 offen offset:1024 sc1
    v_mov_b32 v107, 0
    s_nop 2
    v_mov_b32 v107, 0
    s_nop 2
    v_mov_b32 v107, 0
    s_nop 2
    v_mov_b32 v107, 0
    s_nop 2
    v_mov_b32 v107, 0
    s_nop 2
    v_mov_b32 v107, 0
    s_nop 2
    v_mov_b32 v107, 0
    s_nop 2
    buffer_load_dwordx4 v[0:3], v117, s[4:7], s45 offen offset:0 sc1
    buffer_load_dwordx4 v[4:7], v117, s[4:7], s45 offen offset:1024 sc1
    v_mov_b32 v107, 0
    s_nop 2
    v_mov_b32 v107, 0
    s_nop 2
    v_mov_b32 v107, 0
    s_nop 2
    v_mov_b32 v107, 0
    s_nop 2
    s_branch D3_step
D3_re2:
    buffer_load_dwordx4 v[0:3], v117, s[4:7], s45 offen offset:0 sc1
    buffer_load_dwordx4 v[4:7], v117, s[4:7], s45 offen offset:1024 sc1
    s_add_u32 s55, s55, 1
    s_sub_u32 s48, s48, 1
    s_nop 0
    v_mfma_f32_16x16x1_4b_f32 v[80:95], v127, v127, 0
    s_cbranch_scc0 D3_step
D3_bail:
    s_endpgm
D3_slow:
    v_max3_f32 v106, v80, v81, v84
    v_max_f32 v106, v106, v85
    v_mov_b32 v107, v106
    s_nop 1
    v_permlane32_swap_b32 v107, v106
    v_max_f32 v106, v106, v107
    v_mov_b32 v107, v106
    s_nop 1
    v_permlane16_swap_b32 v107, v106
    v_max_f32 v106, v106, v107
    ds_write_b32 v117, v106 offset:12
    s_waitcnt lgkmcnt(0)
    s_barrier
    ds_read_b128 v[96:99], v117 offset:0
    s_waitcnt lgkmcnt(0)
    v_max3_f32 v106, v96, v97, v98
    v_max_f32 v106, v106, v99
    v_sub_f32 v82, v80, v106
    v_exp_f32 v82, v82
    v_sub_f32 v83, v81, v106
    v_exp_f32 v83, v83
    v_sub_f32 v86, v84, v106
    v_exp_f32 v86, v86
    v_sub_f32 v87, v85, v106
    v_exp_f32 v87, v87
    v_cvt_pk_bf16_f32 v82, v82, v83
    s_mov_b64 exec, s[50:51]
    ds_write_b32 v113, v82 offset:14856
    s_mov_b64 exec, -1
    s_waitcnt lgkmcnt(0)
    s_barrier
    ds_read_b128 v[88:91], v117 offset:14336
    ds_read_b128 v[92:95], v125 offset:14336
    s_waitcnt lgkmcnt(0)
    v_mfma_f32_16x16x32_bf16 v[68:71], v[72:75], v[88:91], 0
    v_mfma_f32_16x16x32_bf16 v[64:67], v[48:51], v[88:91], 0
    v_mfma_f32_16x16x32_bf16 v[64:67], v[52:55], v[92:95], v[64:67]
    s_mov_b64 exec, s[50:51]
    v_cvt_pk_bf16_f32 v104, v86, v87
    s_mov_b64 exec, -1
    s_nop 0
    v_mfma_f32_16x16x16_bf16 v[68:71], v[72:73], v[104:105], v[68:71]
    v_mov_b32_dpp v105, v104 row_ror:8 row_mask:0xf bank_mask:0xf
    s_nop 1
    v_mfma_f32_16x16x16_bf16 v[64:67], v[110:111], v[104:105], v[64:67]
    s_nop 1
    s_nop 1
    v_rcp_f32 v106, v68
    v_subrev_u32 v107, s60, v68
    v_cmp_lt_u32 vcc, s61, v107
    v_mov_b32_dpp v106, v106 row_ror:8 row_mask:0xf bank_mask:0xc
    v_mul_f32 v64, v106, v64
    v_mul_f32 v65, v106, v65
    v_mul_f32 v66, v106, v66
    v_mul_f32 v67, v106, v67
    v_cvt_pk_bf16_f32 v96, v64, v65
    v_cvt_pk_bf16_f32 v97, v66, v67
    ds_write_b64 v126, v[96:97] offset:13344
    s_branch D3_back
D3_fin:
    v_add_f32 v96, v96, v98
    v_add_f32 v97, v97, v99
    v_add_f32 v100, v100, v102
    v_add_f32 v101, v101, v103
    v_cvt_pk_bf16_f32 v110, v96, v97
    v_cvt_pk_bf16_f32 v111, v100, v101
    s_add_u32 s39, s39, 131072
    buffer_store_dwordx4 v[108:111], v117, s[4:7], s39 offen sc1
    s_endpgm
L_worker:
    v_and_b32 v104, 63, v0
    v_lshlrev_b32 v105, 4, v104
    v_mov_b32 v106, 0
    s_mov_b32 s49, 0x3e0293ee
    s_mov_b32 s48, 400000
    s_lshl_b32 s36, s16, 8
    s_lshl_b32 s37, s16, 17
    s_mov_b32 s20, s74
    s_and_b32 s21, s75, 0xffff
    s_mov_b32 s22, 0x400000
    s_mov_b32 s23, 0x20000
    s_mov_b32 s24, s76
    s_and_b32 s25, s77, 0xffff
    s_mov_b32 s26, 0x400000
    s_mov_b32 s27, 0x20000
    s_mov_b32 s28, s78
    s_and_b32 s29, s79, 0xffff
    s_mov_b32 s30, 0x400000
    s_mov_b32 s31, 0x20000
    s_mov_b32 s32, s80
    s_and_b32 s33, s81, 0xffff
    s_mov_b32 s34, 0x400000
    s_mov_b32 s35, 0x20000
    s_mov_b32 s8, s70
    s_and_b32 s9, s71, 0xffff
    s_mov_b32 s10, 0x200000
    s_mov_b32 s11, 0x20000
    s_cmp_ge_u32 s18, 4
    s_cbranch_scc1 W_a
    s_cmp_ge_u32 s18, 2
    s_cbranch_scc1 W_b2
    v_lshrrev_b32 v1, 4, v104
    s_and_b32 s19, s17, 1
    s_lshl_b32 s19, s19, 2
    v_add_u32 v2, s19, v1
    v_lshlrev_b32 v2, 1, v2
    v_and_b32 v3, 15, v104
    v_xor_b32 v2, v2, v3
    v_lshlrev_b32 v100, 13, v1
    v_lshl_add_u32 v100, v2, 4, v100
    s_lshl_b32 s19, s17, 16
    v_add_u32 v100, s19, v100
    v_lshrrev_b32 v2, 2, v104
    v_and_b32 v3, 7, v2
    s_lshl_b32 s19, s17, 1
    v_xor_b32 v3, s19, v3
    v_lshlrev_b32 v101, 8, v2
    v_lshl_add_u32 v101, v3, 5, v101
    v_and_b32 v3, 3, v104
    v_lshl_add_u32 v101, v3, 3, v101
    v_add_u32 v101, 32768, v101
    v_xor_b32 v102, 32, v101
    v_add_u32 v103, 0x10000, v101
    v_add_u32 v98, 0x10000, v102
    s_lshl_b32 s44, s17, 10
    s_add_u32 m0, s44, 32768
    s_add_u32 s19, s36, 0
    buffer_load_dwordx4 v100, s[24:27], s19 offen lds
    s_add_u32 m0, s44, 36864
    s_add_u32 s19, s36, 32768
    buffer_load_dwordx4 v100, s[24:27], s19 offen lds
    s_add_u32 m0, s44, 40960
    s_add_u32 s19, s36, 262144
    buffer_load_dwordx4 v100, s[24:27], s19 offen lds
    s_add_u32 m0, s44, 45056
    s_add_u32 s19, s36, 294912
    buffer_load_dwordx4 v100, s[24:27], s19 offen lds
    s_add_u32 m0, s44, 49152
    s_add_u32 s19, s36, 524288
    buffer_load_dwordx4 v100, s[24:27], s19 offen lds
    s_add_u32 m0, s44, 53248
    s_add_u32 s19, s36, 557056
    buffer_load_dwordx4 v100, s[24:27], s19 offen lds
    s_add_u32 m0, s44, 57344
    s_add_u32 s19, s36, 786432
    buffer_load_dwordx4 v100, s[24:27], s19 offen lds
    s_add_u32 m0, s44, 61440
    s_add_u32 s19, s36, 819200
    buffer_load_dwordx4 v100, s[24:27], s19 offen lds
    s_add_u32 m0, s44, 65536
    s_add_u32 s19, s36, 1048576
    buffer_load_dwordx4 v100, s[24:27], s19 offen lds
    s_add_u32 m0, s44, 69632
    s_add_u32 s19, s36, 1081344
    buffer_load_dwordx4 v100, s[24:27], s19 offen lds
    s_add_u32 m0, s44, 73728
    s_add_u32 s19, s36, 1310720
    buffer_load_dwordx4 v100, s[24:27], s19 offen lds
    s_add_u32 m0, s44, 77824
    s_add_u32 s19, s36, 1343488
    buffer_load_dwordx4 v100, s[24:27], s19 offen lds
    s_add_u32 m0, s44, 81920
    s_add_u32 s19, s36, 1572864
    buffer_load_dwordx4 v100, s[24:27], s19 offen lds
    s_add_u32 m0, s44, 86016
    s_add_u32 s19, s36, 1605632
    buffer_load_dwordx4 v100, s[24:27], s19 offen lds
    s_add_u32 m0, s44, 90112
    s_add_u32 s19, s36, 1835008
    buffer_load_dwordx4 v100, s[24:27], s19 offen lds
    s_add_u32 m0, s44, 94208
    s_add_u32 s19, s36, 1867776
    buffer_load_dwordx4 v100, s[24:27], s19 offen lds
    s_add_u32 m0, s44, 98304
    s_add_u32 s19, s36, 2097152
    buffer_load_dwordx4 v100, s[24:27], s19 offen lds
    s_add_u32 m0, s44, 102400
    s_add_u32 s19, s36, 2129920
    buffer_load_dwordx4 v100, s[24:27], s19 offen lds
    s_add_u32 m0, s44, 106496
    s_add_u32 s19, s36, 2359296
    buffer_load_dwordx4 v100, s[24:27], s19 offen lds
    s_add_u32 m0, s44, 110592
    s_add_u32 s19, s36, 2392064
    buffer_load_dwordx4 v100, s[24:27], s19 offen lds
    s_add_u32 m0, s44, 114688
    s_add_u32 s19, s36, 2621440
    buffer_load_dwordx4 v100, s[24:27], s19 offen lds
    s_add_u32 m0, s44, 118784
    s_add_u32 s19, s36, 2654208
    buffer_load_dwordx4 v100, s[24:27], s19 offen lds
    s_add_u32 m0, s44, 122880
    s_add_u32 s19, s36, 2883584
    buffer_load_dwordx4 v100, s[24:27], s19 offen lds
    s_add_u32 m0, s44, 126976
    s_add_u32 s19, s36, 2916352
    buffer_load_dwordx4 v100, s[24:27], s19 offen lds
    s_add_u32 m0, s44, 131072
    s_add_u32 s19, s36, 3145728
    buffer_load_dwordx4 v100, s[24:27], s19 offen lds
    s_add_u32 m0, s44, 135168
    s_add_u32 s19, s36, 3178496
    buffer_load_dwordx4 v100, s[24:27], s19 offen lds
    s_add_u32 m0, s44, 139264
    s_add_u32 s19, s36, 3407872
    buffer_load_dwordx4 v100, s[24:27], s19 offen lds
    s_add_u32 m0, s44, 143360
    s_add_u32 s19, s36, 3440640
    buffer_load_dwordx4 v100, s[24:27], s19 offen lds
    s_cmp_lg_u32 s17, 0
    s_cbranch_scc1 L_w0_1
    s_waitcnt vmcnt(28)
    s_lshr_b32 s95, s93, 5
    s_lshl_b32 s95, s95, 2
    s_lshl_b32 s94, 1, s93
    s_atomic_or s94, s[86:87], s95 glc
L_w0_1:
    s_cmp_lg_u32 s17, 0
    s_cbranch_scc1 L_w0_2
    s_waitcnt lgkmcnt(0)
    v_mov_b32 v92, s94
    ds_write_b32 v106, v92 offset:0
    s_waitcnt lgkmcnt(0)
L_w0_2:
    s_waitcnt vmcnt(24) lgkmcnt(0)
    s_barrier
    s_add_u32 m0, s44, 147456
    s_add_u32 s19, s36, 3670016
    buffer_load_dwordx4 v100, s[24:27], s19 offen lds
    s_add_u32 m0, s44, 151552
    s_add_u32 s19, s36, 3702784
    buffer_load_dwordx4 v100, s[24:27], s19 offen lds
    s_add_u32 m0, s44, 155648
    s_add_u32 s19, s36, 3932160
    buffer_load_dwordx4 v100, s[24:27], s19 offen lds
    s_add_u32 m0, s44, 159744
    s_add_u32 s19, s36, 3964928
    buffer_load_dwordx4 v100, s[24:27], s19 offen lds
    ds_read_b32 v92, v106 offset:0
    s_waitcnt lgkmcnt(0)
    v_readfirstlane_b32 s19, v92
    s_nop 0
    s_bitcmp1_b32 s19, s93
    s_cbranch_scc1 L_lost
    ds_read_b64_tr_b16 a[0:1], v101 offset:0
    ds_read_b64_tr_b16 a[2:3], v101 offset:4096
    ds_read_b64_tr_b16 a[4:5], v101 offset:8192
    ds_read_b64_tr_b16 a[6:7], v101 offset:12288
    ds_read_b64_tr_b16 a[64:65], v102 offset:0
    ds_read_b64_tr_b16 a[66:67], v102 offset:4096
    ds_read_b64_tr_b16 a[68:69], v102 offset:8192
    ds_read_b64_tr_b16 a[70:71], v102 offset:12288
    s_waitcnt vmcnt(24) lgkmcnt(0)
    s_barrier
    s_add_u32 m0, s44, 32768
    s_add_u32 s19, s36, 0
    buffer_load_dwordx4 v100, s[28:31], s19 offen lds
    s_add_u32 m0, s44, 36864
    s_add_u32 s19, s36, 32768
    buffer_load_dwordx4 v100, s[28:31], s19 offen lds
    s_add_u32 m0, s44, 40960
    s_add_u32 s19, s36, 262144
    buffer_load_dwordx4 v100, s[28:31], s19 offen lds
    s_add_u32 m0, s44, 45056
    s_add_u32 s19, s36, 294912
    buffer_load_dwordx4 v100, s[28:31], s19 offen lds
    ds_read_b64_tr_b16 a[8:9], v101 offset:16384
    ds_read_b64_tr_b16 a[10:11], v101 offset:20480
    ds_read_b64_tr_b16 a[12:13], v101 offset:24576
    ds_read_b64_tr_b16 a[14:15], v101 offset:28672
    ds_read_b64_tr_b16 a[72:73], v102 offset:16384
    ds_read_b64_tr_b16 a[74:75], v102 offset:20480
    ds_read_b64_tr_b16 a[76:77], v102 offset:24576
    ds_read_b64_tr_b16 a[78:79], v102 offset:28672
    s_waitcnt vmcnt(24) lgkmcnt(0)
    s_barrier
    s_add_u32 m0, s44, 49152
    s_add_u32 s19, s36, 524288
    buffer_load_dwordx4 v100, s[28:31], s19 offen lds
    s_add_u32 m0, s44, 53248
    s_add_u32 s19, s36, 557056
    buffer_load_dwordx4 v100, s[28:31], s19 offen lds
    s_add_u32 m0, s44, 57344
    s_add_u32 s19, s36, 786432
    buffer_load_dwordx4 v100, s[28:31], s19 offen lds
    s_add_u32 m0, s44, 61440
    s_add_u32 s19, s36, 819200
    buffer_load_dwordx4 v100, s[28:31], s19 offen lds
    ds_read_b64_tr_b16 a[16:17], v101 offset:32768
    ds_read_b64_tr_b16 a[18:19], v101 offset:36864
    ds_read_b64_tr_b16 a[20:21], v101 offset:40960
    ds_read_b64_tr_b16 a[22:23], v101 offset:45056
    ds_read_b64_tr_b16 a[80:81], v102 offset:32768
    ds_read_b64_tr_b16 a[82:83], v102 offset:36864
    ds_read_b64_tr_b16 a[84:85], v102 offset:40960
    ds_read_b64_tr_b16 a[86:87], v102 offset:45056
    s_waitcnt vmcnt(24) lgkmcnt(0)
    s_barrier
    s_add_u32 m0, s44, 65536
    s_add_u32 s19, s36, 1048576
    buffer_load_dwordx4 v100, s[28:31], s19 offen lds
    s_add_u32 m0, s44, 69632
    s_add_u32 s19, s36, 1081344
    buffer_load_dwordx4 v100, s[28:31], s19 offen lds
    s_add_u32 m0, s44, 73728
    s_add_u32 s19, s36, 1310720
    buffer_load_dwordx4 v100, s[28:31], s19 offen lds
    s_add_u32 m0, s44, 77824
    s_add_u32 s19, s36, 1343488
    buffer_load_dwordx4 v100, s[28:31], s19 offen lds
    ds_read_b64_tr_b16 a[24:25], v101 offset:49152
    ds_read_b64_tr_b16 a[26:27], v101 offset:53248
    ds_read_b64_tr_b16 a[28:29], v101 offset:57344
    ds_read_b64_tr_b16 a[30:31], v101 offset:61440
    ds_read_b64_tr_b16 a[88:89], v102 offset:49152
    ds_read_b64_tr_b16 a[90:91], v102 offset:53248
    ds_read_b64_tr_b16 a[92:93], v102 offset:57344
    ds_read_b64_tr_b16 a[94:95], v102 offset:61440
    s_waitcnt vmcnt(24) lgkmcnt(0)
    s_barrier
    s_add_u32 m0, s44, 81920
    s_add_u32 s19, s36, 1572864
    buffer_load_dwordx4 v100, s[28:31], s19 offen lds
    s_add_u32 m0, s44, 86016
    s_add_u32 s19, s36, 1605632
    buffer_load_dwordx4 v100, s[28:31], s19 offen lds
    s_add_u32 m0, s44, 90112
    s_add_u32 s19, s36, 1835008
    buffer_load_dwordx4 v100, s[28:31], s19 offen lds
    s_add_u32 m0, s44, 94208
    s_add_u32 s19, s36, 1867776
    buffer_load_dwordx4 v100, s[28:31], s19 offen lds
    ds_read_b64_tr_b16 a[32:33], v103 offset:0
    ds_read_b64_tr_b16 a[34:35], v103 offset:4096
    ds_read_b64_tr_b16 a[36:37], v103 offset:8192
    ds_read_b64_tr_b16 a[38:39], v103 offset:12288
    ds_read_b64_tr_b16 a[96:97], v98 offset:0
    ds_read_b64_tr_b16 a[98:99], v98 offset:4096
    ds_read_b64_tr_b16 a[100:101], v98 offset:8192
    ds_read_b64_tr_b16 a[102:103], v98 offset:12288
    s_waitcnt vmcnt(24) lgkmcnt(0)
    s_barrier
    s_add_u32 m0, s44, 98304
    s_add_u32 s19, s36, 2097152
    buffer_load_dwordx4 v100, s[28:31], s19 offen lds
    s_add_u32 m0, s44, 102400
    s_add_u32 s19, s36, 2129920
    buffer_load_dwordx4 v100, s[28:31], s19 offen lds
    s_add_u32 m0, s44, 106496
    s_add_u32 s19, s36, 2359296
    buffer_load_dwordx4 v100, s[28:31], s19 offen lds
    s_add_u32 m0, s44, 110592
    s_add_u32 s19, s36, 2392064
    buffer_load_dwordx4 v100, s[28:31], s19 offen lds
    ds_read_b64_tr_b16 a[40:41], v103 offset:16384
    ds_read_b64_tr_b16 a[42:43], v103 offset:20480
    ds_read_b64_tr_b16 a[44:45], v103 offset:24576
    ds_read_b64_tr_b16 a[46:47], v103 offset:28672
    ds_read_b64_tr_b16 a[104:105], v98 offset:16384
    ds_read_b64_tr_b16 a[106:107], v98 offset:20480
    ds_read_b64_tr_b16 a[108:109], v98 offset:24576
    ds_read_b64_tr_b16 a[110:111], v98 offset:28672
    s_waitcnt vmcnt(24) lgkmcnt(0)
    s_barrier
    s_add_u32 m0, s44, 114688
    s_add_u32 s19, s36, 2621440
    buffer_load_dwordx4 v100, s[28:31], s19 offen lds
    s_add_u32 m0, s44, 118784
    s_add_u32 s19, s36, 2654208
    buffer_load_dwordx4 v100, s[28:31], s19 offen lds
    s_add_u32 m0, s44, 122880
    s_add_u32 s19, s36, 2883584
    buffer_load_dwordx4 v100, s[28:31], s19 offen lds
    s_add_u32 m0, s44, 126976
    s_add_u32 s19, s36, 2916352
    buffer_load_dwordx4 v100, s[28:31], s19 offen lds
    ds_read_b64_tr_b16 a[48:49], v103 offset:32768
    ds_read_b64_tr_b16 a[50:51], v103 offset:36864
    ds_read_b64_tr_b16 a[52:53], v103 offset:40960
    ds_read_b64_tr_b16 a[54:55], v103 offset:45056
    ds_read_b64_tr_b16 a[112:113], v98 offset:32768
    ds_read_b64_tr_b16 a[114:115], v98 offset:36864
    ds_read_b64_tr_b16 a[116:117], v98 offset:40960
    ds_read_b64_tr_b16 a[118:119], v98 offset:45056
    s_waitcnt vmcnt(24) lgkmcnt(0)
    s_barrier
    s_add_u32 m0, s44, 131072
    s_add_u32 s19, s36, 3145728
    buffer_load_dwordx4 v100, s[28:31], s19 offen lds
    s_add_u32 m0, s44, 135168
    s_add_u32 s19, s36, 3178496
    buffer_load_dwordx4 v100, s[28:31], s19 offen lds
    s_add_u32 m0, s44, 139264
    s_add_u32 s19, s36, 3407872
    buffer_load_dwordx4 v100, s[28:31], s19 offen lds
    s_add_u32 m0, s44, 143360
    s_add_u32 s19, s36, 3440640
    buffer_load_dwordx4 v100, s[28:31], s19 offen lds
    ds_read_b64_tr_b16 a[56:57], v103 offset:49152
    ds_read_b64_tr_b16 a[58:59], v103 offset:53248
    ds_read_b64_tr_b16 a[60:61], v103 offset:57344
    ds_read_b64_tr_b16 a[62:63], v103 offset:61440
    ds_read_b64_tr_b16 a[120:121], v98 offset:49152
    ds_read_b64_tr_b16 a[122:123], v98 offset:53248
    ds_read_b64_tr_b16 a[124:125], v98 offset:57344
    ds_read_b64_tr_b16 a[126:127], v98 offset:61440
    s_waitcnt vmcnt(24) lgkmcnt(0)
    s_barrier
    s_add_u32 m0, s44, 147456
    s_add_u32 s19, s36, 3670016
    buffer_load_dwordx4 v100, s[28:31], s19 offen lds
    s_add_u32 m0, s44, 151552
    s_add_u32 s19, s36, 3702784
    buffer_load_dwordx4 v100, s[28:31], s19 offen lds
    s_add_u32 m0, s44, 155648
    s_add_u32 s19, s36, 3932160
    buffer_load_dwordx4 v100, s[28:31], s19 offen lds
    s_add_u32 m0, s44, 159744
    s_add_u32 s19, s36, 3964928
    buffer_load_dwordx4 v100, s[28:31], s19 offen lds
    ds_read_b64_tr_b16 a[128:129], v101 offset:0
    ds_read_b64_tr_b16 a[130:131], v101 offset:4096
    ds_read_b64_tr_b16 a[132:133], v101 offset:8192
    ds_read_b64_tr_b16 a[134:135], v101 offset:12288
    ds_read_b64_tr_b16 a[192:193], v102 offset:0
    ds_read_b64_tr_b16 a[194:195], v102 offset:4096
    ds_read_b64_tr_b16 a[196:197], v102 offset:8192
    ds_read_b64_tr_b16 a[198:199], v102 offset:12288
    s_waitcnt vmcnt(24) lgkmcnt(0)
    s_barrier
    ds_read_b64_tr_b16 a[136:137], v101 offset:16384
    ds_read_b64_tr_b16 a[138:139], v101 offset:20480
    ds_read_b64_tr_b16 a[140:141], v101 offset:24576
    ds_read_b64_tr_b16 a[142:143], v101 offset:28672
    ds_read_b64_tr_b16 a[200:201], v102 offset:16384
    ds_read_b64_tr_b16 a[202:203], v102 offset:20480
    ds_read_b64_tr_b16 a[204:205], v102 offset:24576
    ds_read_b64_tr_b16 a[206:207], v102 offset:28672
    s_waitcnt vmcnt(20) lgkmcnt(0)
    s_barrier
    ds_read_b64_tr_b16 a[144:145], v101 offset:32768
    ds_read_b64_tr_b16 a[146:147], v101 offset:36864
    ds_read_b64_tr_b16 a[148:149], v101 offset:40960
    ds_read_b64_tr_b16 a[150:151], v101 offset:45056
    ds_read_b64_tr_b16 a[208:209], v102 offset:32768
    ds_read_b64_tr_b16 a[210:211], v102 offset:36864
    ds_read_b64_tr_b16 a[212:213], v102 offset:40960
    ds_read_b64_tr_b16 a[214:215], v102 offset:45056
    s_waitcnt vmcnt(16) lgkmcnt(0)
    s_barrier
    ds_read_b64_tr_b16 a[152:153], v101 offset:49152
    ds_read_b64_tr_b16 a[154:155], v101 offset:53248
    ds_read_b64_tr_b16 a[156:157], v101 offset:57344
    ds_read_b64_tr_b16 a[158:159], v101 offset:61440
    ds_read_b64_tr_b16 a[216:217], v102 offset:49152
    ds_read_b64_tr_b16 a[218:219], v102 offset:53248
    ds_read_b64_tr_b16 a[220:221], v102 offset:57344
    ds_read_b64_tr_b16 a[222:223], v102 offset:61440
    s_waitcnt vmcnt(12) lgkmcnt(0)
    s_barrier
    ds_read_b64_tr_b16 a[160:161], v103 offset:0
    ds_read_b64_tr_b16 a[162:163], v103 offset:4096
    ds_read_b64_tr_b16 a[164:165], v103 offset:8192
    ds_read_b64_tr_b16 a[166:167], v103 offset:12288
    ds_read_b64_tr_b16 a[224:225], v98 offset:0
    ds_read_b64_tr_b16 a[226:227], v98 offset:4096
    ds_read_b64_tr_b16 a[228:229], v98 offset:8192
    ds_read_b64_tr_b16 a[230:231], v98 offset:12288
    s_waitcnt vmcnt(8) lgkmcnt(0)
    s_barrier
    ds_read_b64_tr_b16 a[168:169], v103 offset:16384
    ds_read_b64_tr_b16 a[170:171], v103 offset:20480
    ds_read_b64_tr_b16 a[172:173], v103 offset:24576
    ds_read_b64_tr_b16 a[174:175], v103 offset:28672
    ds_read_b64_tr_b16 a[232:233], v98 offset:16384
    ds_read_b64_tr_b16 a[234:235], v98 offset:20480
    ds_read_b64_tr_b16 a[236:237], v98 offset:24576
    ds_read_b64_tr_b16 a[238:239], v98 offset:28672
    s_waitcnt vmcnt(4) lgkmcnt(0)
    s_barrier
    ds_read_b64_tr_b16 a[176:177], v103 offset:32768
    ds_read_b64_tr_b16 a[178:179], v103 offset:36864
    ds_read_b64_tr_b16 a[180:181], v103 offset:40960
    ds_read_b64_tr_b16 a[182:183], v103 offset:45056
    ds_read_b64_tr_b16 a[240:241], v98 offset:32768
    ds_read_b64_tr_b16 a[242:243], v98 offset:36864
    ds_read_b64_tr_b16 a[244:245], v98 offset:40960
    ds_read_b64_tr_b16 a[246:247], v98 offset:45056
    s_waitcnt vmcnt(0) lgkmcnt(0)
    s_barrier
    ds_read_b64_tr_b16 a[184:185], v103 offset:49152
    ds_read_b64_tr_b16 a[186:187], v103 offset:53248
    ds_read_b64_tr_b16 a[188:189], v103 offset:57344
    ds_read_b64_tr_b16 a[190:191], v103 offset:61440
    ds_read_b64_tr_b16 a[248:249], v98 offset:49152
    ds_read_b64_tr_b16 a[250:251], v98 offset:53248
    ds_read_b64_tr_b16 a[252:253], v98 offset:57344
    ds_read_b64_tr_b16 a[254:255], v98 offset:61440
    s_waitcnt lgkmcnt(0)
    s_barrier
    v_and_b32 v1, 15, v104
    v_mul_u32_u24 v108, 1056, v1
    v_lshrrev_b32 v1, 4, v104
    v_lshl_add_u32 v108, v1, 4, v108
    v_add_u32 v109, 33792, v108
    s_mov_b32 s38, s18
    s_mul_i32 s44, s17, 8448
    s_lshl_b32 s39, s38, 15
    s_lshl_b32 s19, s17, 13
    s_add_u32 s39, s39, s19
    s_mov_b32 s45, 0
    s_mov_b32 s56, 33792
    v_and_b32 v1, 7, v104
    v_lshlrev_b32 v1, 2, v1
    s_mov_b32 s40, 0x7ff00000
    s_mov_b32 s42, 0x7ff00000
    s_mov_b32 s43, 0x7ff00000
    v_mov_b32 v112, -1
    v_mov_b32 v113, -1
    v_mov_b32 v114, -1
    v_mov_b32 v115, -1
    s_add_u32 m0, s44, 0
    s_add_u32 s19, s39, 0
    buffer_load_dwordx4 v105, s[8:11], s19 offen lds
    s_add_u32 m0, s44, 1056
    s_add_u32 s19, s39, 1024
    buffer_load_dwordx4 v105, s[8:11], s19 offen lds
    s_add_u32 m0, s44, 2112
    s_add_u32 s19, s39, 2048
    buffer_load_dwordx4 v105, s[8:11], s19 offen lds
    s_add_u32 m0, s44, 3168
    s_add_u32 s19, s39, 3072
    buffer_load_dwordx4 v105, s[8:11], s19 offen lds
    s_add_u32 m0, s44, 4224
    s_add_u32 s19, s39, 4096
    buffer_load_dwordx4 v105, s[8:11], s19 offen lds
    s_add_u32 m0, s44, 5280
    s_add_u32 s19, s39, 5120
    buffer_load_dwordx4 v105, s[8:11], s19 offen lds
    s_add_u32 m0, s44, 6336
    s_add_u32 s19, s39, 6144
    buffer_load_dwordx4 v105, s[8:11], s19 offen lds
    s_add_u32 m0, s44, 7392
    s_add_u32 s19, s39, 7168
    buffer_load_dwordx4 v105, s[8:11], s19 offen lds
    s_mul_i32 s47, s17, 2
    s_add_u32 s47, s47, s18
    s_lshl_b32 s47, s47, 5
    s_add_u32 s47, s47, s16
    s_lshl_b32 s47, s47, 10
    buffer_load_dwordx4 v[116:119], v105, s[8:11], s47 offen
    s_add_u32 s47, s47, 262144
    buffer_load_dwordx4 v[116:119], v105, s[8:11], s47 offen
    s_add_u32 s47, s47, 262144
    buffer_load_dwordx4 v[116:119], v105, s[8:11], s47 offen
    s_add_u32 s47, s47, 262144
    buffer_load_dwordx4 v[116:119], v105, s[8:11], s47 offen
    s_add_u32 s47, s47, 262144
    buffer_load_dwordx4 v[116:119], v105, s[8:11], s47 offen
    s_add_u32 s47, s47, 262144
    buffer_load_dwordx4 v[116:119], v105, s[8:11], s47 offen
    s_add_u32 s47, s47, 262144
    buffer_load_dwordx4 v[116:119], v105, s[8:11], s47 offen
    s_add_u32 s47, s47, 262144
    buffer_load_dwordx4 v[116:119], v105, s[8:11], s47 offen
    s_add_u32 s47, s47, 262144
L_init_3:
    global_load_dword v107, v1, s[86:87] offset:0 sc1
    s_sub_u32 s48, s48, 1
    s_cbranch_scc1 W_bail
    s_waitcnt vmcnt(0)
    v_cmp_ne_u32 vcc, -1, v107
    s_cbranch_vccz L_init_3_ok
    s_sleep 16
    s_branch L_init_3
L_init_3_ok:
    s_barrier
    ds_read_b128 v[32:35], v108 offset:0
    ds_read_b128 v[36:39], v108 offset:64
    ds_read_b128 v[40:43], v108 offset:128
    ds_read_b128 v[44:47], v108 offset:192
L_b1_104:
    s_waitcnt lgkmcnt(3)
    v_mfma_f32_16x16x32_bf16 v[0:3], a[0:3], v[32:35], 0
    s_barrier
    s_add_u32 s39, s39, 65536
    v_mfma_f32_16x16x32_bf16 v[16:19], v[32:35], a[128:131], 0
    s_add_u32 s44, s44, s56
    ds_read_b128 v[48:51], v108 offset:256
    v_mfma_f32_16x16x32_bf16 v[8:11], a[64:67], v[32:35], 0
    s_sub_u32 s56, 0, s56
    v_mfma_f32_16x16x32_bf16 v[24:27], v[32:35], a[192:195], 0
    s_waitcnt lgkmcnt(3)
    v_mfma_f32_16x16x32_bf16 v[0:3], a[4:7], v[36:39], v[0:3]
    s_add_u32 m0, s44, 0
    v_mfma_f32_16x16x32_bf16 v[16:19], v[36:39], a[132:135], v[16:19]
    s_add_u32 s19, s39, 0
    ds_read_b128 v[52:55], v108 offset:320
    v_mfma_f32_16x16x32_bf16 v[8:11], a[68:71], v[36:39], v[8:11]
    buffer_load_dwordx4 v105, s[8:11], s19 offen lds
    v_mfma_f32_16x16x32_bf16 v[24:27], v[36:39], a[196:199], v[24:27]
    s_waitcnt lgkmcnt(3)
    v_mfma_f32_16x16x32_bf16 v[0:3], a[8:11], v[40:43], v[0:3]
    s_add_u32 m0, s44, 1056
    v_cvt_pk_bf16_f32 v74, v20, v21
    v_mfma_f32_16x16x32_bf16 v[16:19], v[40:43], a[136:139], v[16:19]
    s_add_u32 s19, s39, 1024
    ds_read_b128 v[56:59], v108 offset:384
    v_mfma_f32_16x16x32_bf16 v[8:11], a[72:75], v[40:43], v[8:11]
    buffer_load_dwordx4 v105, s[8:11], s19 offen lds
    v_cvt_pk_bf16_f32 v75, v22, v23
    v_mfma_f32_16x16x32_bf16 v[24:27], v[40:43], a[200:203], v[24:27]
    s_waitcnt lgkmcnt(3)
    v_mfma_f32_16x16x32_bf16 v[0:3], a[12:15], v[44:47], v[0:3]
    s_add_u32 m0, s44, 2112
    buffer_store_dwordx4 v[72:75], v105, s[4:7], s43 offen offset:0 sc1
    v_mfma_f32_16x16x32_bf16 v[16:19], v[44:47], a[140:143], v[16:19]
    s_add_u32 s19, s39, 2048
    ds_read_b128 v[60:63], v108 offset:448
    v_mfma_f32_16x16x32_bf16 v[8:11], a[76:79], v[44:47], v[8:11]
    buffer_load_dwordx4 v105, s[8:11], s19 offen lds
    v_mfma_f32_16x16x32_bf16 v[24:27], v[44:47], a[204:207], v[24:27]
    s_waitcnt lgkmcnt(3)
    v_mfma_f32_16x16x32_bf16 v[0:3], a[16:19], v[48:51], v[0:3]
    s_add_u32 m0, s44, 3168
    v_cvt_pk_bf16_f32 v78, v28, v29
    v_mfma_f32_16x16x32_bf16 v[16:19], v[48:51], a[144:147], v[16:19]
    s_add_u32 s19, s39, 3072
    ds_read_b128 v[32:35], v108 offset:512
    v_mfma_f32_16x16x32_bf16 v[8:11], a[80:83], v[48:51], v[8:11]
    buffer_load_dwordx4 v105, s[8:11], s19 offen lds
    v_cvt_pk_bf16_f32 v79, v30, v31
    v_mfma_f32_16x16x32_bf16 v[24:27], v[48:51], a[208:211], v[24:27]
    s_waitcnt lgkmcnt(3)
    v_mfma_f32_16x16x32_bf16 v[0:3], a[20:23], v[52:55], v[0:3]
    s_add_u32 m0, s44, 4224
    buffer_store_dwordx4 v[76:79], v105, s[4:7], s43 offen offset:1024 sc1
    v_mfma_f32_16x16x32_bf16 v[16:19], v[52:55], a[148:151], v[16:19]
    s_add_u32 s19, s39, 4096
    ds_read_b128 v[36:39], v108 offset:576
    v_mfma_f32_16x16x32_bf16 v[8:11], a[84:87], v[52:55], v[8:11]
    buffer_load_dwordx4 v105, s[8:11], s19 offen lds
    v_mfma_f32_16x16x32_bf16 v[24:27], v[52:55], a[212:215], v[24:27]
    s_waitcnt lgkmcnt(3)
    v_mfma_f32_16x16x32_bf16 v[0:3], a[24:27], v[56:59], v[0:3]
    s_add_u32 m0, s44, 5280
    v_mul_f32 v4, s49, v4
    v_mfma_f32_16x16x32_bf16 v[16:19], v[56:59], a[152:155], v[16:19]
    s_add_u32 s19, s39, 5120
    ds_read_b128 v[40:43], v108 offset:640
    v_mfma_f32_16x16x32_bf16 v[8:11], a[88:91], v[56:59], v[8:11]
    buffer_load_dwordx4 v105, s[8:11], s19 offen lds
    v_mul_f32 v5, s49, v5
    v_mfma_f32_16x16x32_bf16 v[24:27], v[56:59], a[216:219], v[24:27]
    s_waitcnt lgkmcnt(3)
    v_mfma_f32_16x16x32_bf16 v[0:3], a[28:31], v[60:63], v[0:3]
    s_add_u32 m0, s44, 6336
    v_mul_f32 v6, s49, v6
    v_mfma_f32_16x16x32_bf16 v[16:19], v[60:63], a[156:159], v[16:19]
    s_add_u32 s19, s39, 6144
    ds_read_b128 v[44:47], v108 offset:704
    v_mfma_f32_16x16x32_bf16 v[8:11], a[92:95], v[60:63], v[8:11]
    buffer_load_dwordx4 v105, s[8:11], s19 offen lds
    v_mul_f32 v7, s49, v7
    v_mfma_f32_16x16x32_bf16 v[24:27], v[60:63], a[220:223], v[24:27]
    s_waitcnt lgkmcnt(3)
    v_mfma_f32_16x16x32_bf16 v[0:3], a[32:35], v[32:35], v[0:3]
    s_add_u32 m0, s44, 7392
    v_mul_f32 v12, s49, v12
    v_mfma_f32_16x16x32_bf16 v[16:19], v[32:35], a[160:163], v[16:19]
    s_add_u32 s19, s39, 7168
    ds_read_b128 v[48:51], v108 offset:768
    v_mfma_f32_16x16x32_bf16 v[8:11], a[96:99], v[32:35], v[8:11]
    buffer_load_dwordx4 v105, s[8:11], s19 offen lds
    v_mul_f32 v13, s49, v13
    v_mfma_f32_16x16x32_bf16 v[24:27], v[32:35], a[224:227], v[24:27]
    s_waitcnt lgkmcnt(3)
    v_mfma_f32_16x16x32_bf16 v[0:3], a[36:39], v[36:39], v[0:3]
    v_mul_f32 v14, s49, v14
    v_mfma_f32_16x16x32_bf16 v[16:19], v[36:39], a[164:167], v[16:19]
    ds_read_b128 v[52:55], v108 offset:832
    v_mfma_f32_16x16x32_bf16 v[8:11], a[100:103], v[36:39], v[8:11]
    v_mul_f32 v15, s49, v15
    v_mfma_f32_16x16x32_bf16 v[24:27], v[36:39], a[228:231], v[24:27]
    s_waitcnt lgkmcnt(3)
    v_mfma_f32_16x16x32_bf16 v[0:3], a[40:43], v[40:43], v[0:3]
    v_cvt_pk_bf16_f32 v68, v4, v12
    v_mfma_f32_16x16x32_bf16 v[16:19], v[40:43], a[168:171], v[16:19]
    ds_read_b128 v[56:59], v108 offset:896
    v_mfma_f32_16x16x32_bf16 v[8:11], a[104:107], v[40:43], v[8:11]
    v_cvt_pk_bf16_f32 v69, v5, v13
    v_mfma_f32_16x16x32_bf16 v[24:27], v[40:43], a[232:235], v[24:27]
    s_waitcnt lgkmcnt(3)
    v_mfma_f32_16x16x32_bf16 v[0:3], a[44:47], v[44:47], v[0:3]
    v_cvt_pk_bf16_f32 v70, v6, v14
    v_mfma_f32_16x16x32_bf16 v[16:19], v[44:47], a[172:175], v[16:19]
    ds_read_b128 v[60:63], v108 offset:960
    v_mfma_f32_16x16x32_bf16 v[8:11], a[108:111], v[44:47], v[8:11]
    v_cvt_pk_bf16_f32 v71, v7, v15
    v_mfma_f32_16x16x32_bf16 v[24:27], v[44:47], a[236:239], v[24:27]
    s_waitcnt lgkmcnt(3)
    v_mfma_f32_16x16x32_bf16 v[0:3], a[48:51], v[48:51], v[0:3]
    buffer_store_dwordx4 v[68:71], v105, s[4:7], s42 offen sc1
    v_mfma_f32_16x16x32_bf16 v[16:19], v[48:51], a[176:179], v[16:19]
    ds_read_b128 v[32:35], v108 offset:16896
    v_mfma_f32_16x16x32_bf16 v[8:11], a[112:115], v[48:51], v[8:11]
    v_mfma_f32_16x16x32_bf16 v[24:27], v[48:51], a[240:243], v[24:27]
    s_waitcnt lgkmcnt(3)
    v_mfma_f32_16x16x32_bf16 v[0:3], a[52:55], v[52:55], v[0:3]
    v_mfma_f32_16x16x32_bf16 v[16:19], v[52:55], a[180:183], v[16:19]
    ds_read_b128 v[36:39], v108 offset:16960
    v_mfma_f32_16x16x32_bf16 v[8:11], a[116:119], v[52:55], v[8:11]
    s_lshl_b32 s40, s38, 5
    v_mfma_f32_16x16x32_bf16 v[24:27], v[52:55], a[244:247], v[24:27]
    s_waitcnt lgkmcnt(3)
    s_add_u32 s40, s40, s16
    v_mfma_f32_16x16x32_bf16 v[0:3], a[56:59], v[56:59], v[0:3]
    s_lshl_b32 s47, s17, 10
    v_mfma_f32_16x16x32_bf16 v[16:19], v[56:59], a[184:187], v[16:19]
    s_lshl_b32 s42, s40, 14
    ds_read_b128 v[40:43], v108 offset:17024
    v_mfma_f32_16x16x32_bf16 v[8:11], a[120:123], v[56:59], v[8:11]
    s_add_u32 s42, s42, s47
    v_mfma_f32_16x16x32_bf16 v[24:27], v[56:59], a[248:251], v[24:27]
    s_waitcnt lgkmcnt(3)
    s_lshl_b32 s40, s40, 12
    v_mfma_f32_16x16x32_bf16 v[0:3], a[60:63], v[60:63], v[0:3]
    s_add_u32 s40, s40, s47
    v_mfma_f32_16x16x32_bf16 v[16:19], v[60:63], a[188:191], v[16:19]
    s_add_u32 s40, s40, 50331648
    ds_read_b128 v[44:47], v108 offset:17088
    v_mfma_f32_16x16x32_bf16 v[8:11], a[124:127], v[60:63], v[8:11]
    s_add_u32 s43, s42, s47
    v_mfma_f32_16x16x32_bf16 v[24:27], v[60:63], a[252:255], v[24:27]
    s_waitcnt lgkmcnt(3)
    s_add_u32 s43, s43, 8192
    v_mfma_f32_16x16x32_bf16 v[4:7], a[0:3], v[32:35], 0
    v_mfma_f32_16x16x32_bf16 v[20:23], v[32:35], a[128:131], 0
    ds_read_b128 v[48:51], v108 offset:17152
    v_mfma_f32_16x16x32_bf16 v[12:15], a[64:67], v[32:35], 0
    v_mfma_f32_16x16x32_bf16 v[28:31], v[32:35], a[192:195], 0
    s_waitcnt lgkmcnt(3)
    v_mfma_f32_16x16x32_bf16 v[4:7], a[4:7], v[36:39], v[4:7]
    v_mfma_f32_16x16x32_bf16 v[20:23], v[36:39], a[132:135], v[20:23]
    ds_read_b128 v[52:55], v108 offset:17216
    v_mfma_f32_16x16x32_bf16 v[12:15], a[68:71], v[36:39], v[12:15]
    v_mfma_f32_16x16x32_bf16 v[28:31], v[36:39], a[196:199], v[28:31]
    s_waitcnt lgkmcnt(3)
    v_mfma_f32_16x16x32_bf16 v[4:7], a[8:11], v[40:43], v[4:7]
    v_cvt_pk_bf16_f32 v72, v16, v17
    v_mfma_f32_16x16x32_bf16 v[20:23], v[40:43], a[136:139], v[20:23]
    ds_read_b128 v[56:59], v108 offset:17280
    v_cvt_pk_bf16_f32 v73, v18, v19
    v_mfma_f32_16x16x32_bf16 v[12:15], a[72:75], v[40:43], v[12:15]
    v_cvt_pk_bf16_f32 v76, v24, v25
    v_mfma_f32_16x16x32_bf16 v[28:31], v[40:43], a[200:203], v[28:31]
    s_waitcnt lgkmcnt(3)
    v_cvt_pk_bf16_f32 v77, v26, v27
    v_mfma_f32_16x16x32_bf16 v[4:7], a[12:15], v[44:47], v[4:7]
    v_mul_f32 v0, s49, v0
    v_mfma_f32_16x16x32_bf16 v[20:23], v[44:47], a[140:143], v[20:23]
    ds_read_b128 v[60:63], v108 offset:17344
    v_mul_f32 v1, s49, v1
    v_mfma_f32_16x16x32_bf16 v[12:15], a[76:79], v[44:47], v[12:15]
    v_mul_f32 v2, s49, v2
    v_mfma_f32_16x16x32_bf16 v[28:31], v[44:47], a[204:207], v[28:31]
    s_waitcnt lgkmcnt(3)
    v_mul_f32 v3, s49, v3
    v_mfma_f32_16x16x32_bf16 v[4:7], a[16:19], v[48:51], v[4:7]
    v_mul_f32 v8, s49, v8
    v_mfma_f32_16x16x32_bf16 v[20:23], v[48:51], a[144:147], v[20:23]
    ds_read_b128 v[32:35], v108 offset:17408
    v_mul_f32 v9, s49, v9
    v_mfma_f32_16x16x32_bf16 v[12:15], a[80:83], v[48:51], v[12:15]
    v_mul_f32 v10, s49, v10
    v_mfma_f32_16x16x32_bf16 v[28:31], v[48:51], a[208:211], v[28:31]
    s_waitcnt lgkmcnt(3)
    v_mul_f32 v11, s49, v11
    v_mfma_f32_16x16x32_bf16 v[4:7], a[20:23], v[52:55], v[4:7]
    v_cvt_pk_bf16_f32 v68, v0, v8
    v_mfma_f32_16x16x32_bf16 v[20:23], v[52:55], a[148:151], v[20:23]
    ds_read_b128 v[36:39], v108 offset:17472
    v_cvt_pk_bf16_f32 v69, v1, v9
    v_mfma_f32_16x16x32_bf16 v[12:15], a[84:87], v[52:55], v[12:15]
    v_cvt_pk_bf16_f32 v70, v2, v10
    v_mfma_f32_16x16x32_bf16 v[28:31], v[52:55], a[212:215], v[28:31]
    s_waitcnt lgkmcnt(3)
    v_cvt_pk_bf16_f32 v71, v3, v11
    v_mfma_f32_16x16x32_bf16 v[4:7], a[24:27], v[56:59], v[4:7]
    buffer_store_dwordx4 v[68:71], v105, s[4:7], s42 offen sc1
    v_mfma_f32_16x16x32_bf16 v[20:23], v[56:59], a[152:155], v[20:23]
    ds_read_b128 v[40:43], v108 offset:17536
    v_mfma_f32_16x16x32_bf16 v[12:15], a[88:91], v[56:59], v[12:15]
    v_mfma_f32_16x16x32_bf16 v[28:31], v[56:59], a[216:219], v[28:31]
    s_waitcnt lgkmcnt(3)
    v_mfma_f32_16x16x32_bf16 v[4:7], a[28:31], v[60:63], v[4:7]
    buffer_store_dwordx4 v[112:115], v105, s[4:7], s40 offen sc1
    v_mfma_f32_16x16x32_bf16 v[20:23], v[60:63], a[156:159], v[20:23]
    ds_read_b128 v[44:47], v108 offset:17600
    v_mfma_f32_16x16x32_bf16 v[12:15], a[92:95], v[60:63], v[12:15]
    v_mfma_f32_16x16x32_bf16 v[28:31], v[60:63], a[220:223], v[28:31]
    s_waitcnt lgkmcnt(3)
    v_mfma_f32_16x16x32_bf16 v[4:7], a[32:35], v[32:35], v[4:7]
    s_add_u32 s42, s42, 4096
    v_mfma_f32_16x16x32_bf16 v[20:23], v[32:35], a[160:163], v[20:23]
    ds_read_b128 v[48:51], v108 offset:17664
    v_mfma_f32_16x16x32_bf16 v[12:15], a[96:99], v[32:35], v[12:15]
    v_mfma_f32_16x16x32_bf16 v[28:31], v[32:35], a[224:227], v[28:31]
    s_waitcnt lgkmcnt(3)
    v_mfma_f32_16x16x32_bf16 v[4:7], a[36:39], v[36:39], v[4:7]
    v_mfma_f32_16x16x32_bf16 v[20:23], v[36:39], a[164:167], v[20:23]
    ds_read_b128 v[52:55], v108 offset:17728
    v_mfma_f32_16x16x32_bf16 v[12:15], a[100:103], v[36:39], v[12:15]
    v_mfma_f32_16x16x32_bf16 v[28:31], v[36:39], a[228:231], v[28:31]
    s_waitcnt lgkmcnt(3)
    v_mfma_f32_16x16x32_bf16 v[4:7], a[40:43], v[40:43], v[4:7]
    v_mfma_f32_16x16x32_bf16 v[20:23], v[40:43], a[168:171], v[20:23]
    ds_read_b128 v[56:59], v108 offset:17792
    v_mfma_f32_16x16x32_bf16 v[12:15], a[104:107], v[40:43], v[12:15]
    v_mfma_f32_16x16x32_bf16 v[28:31], v[40:43], a[232:235], v[28:31]
    s_waitcnt lgkmcnt(3)
    v_mfma_f32_16x16x32_bf16 v[4:7], a[44:47], v[44:47], v[4:7]
    v_mfma_f32_16x16x32_bf16 v[20:23], v[44:47], a[172:175], v[20:23]
    ds_read_b128 v[60:63], v108 offset:17856
    v_mfma_f32_16x16x32_bf16 v[12:15], a[108:111], v[44:47], v[12:15]
    v_mfma_f32_16x16x32_bf16 v[28:31], v[44:47], a[236:239], v[28:31]
    s_waitcnt lgkmcnt(3)
    v_mfma_f32_16x16x32_bf16 v[4:7], a[48:51], v[48:51], v[4:7]
    s_waitcnt vmcnt(2)
    s_barrier
    v_mfma_f32_16x16x32_bf16 v[20:23], v[48:51], a[176:179], v[20:23]
    ds_read_b128 v[32:35], v109 offset:0
    v_mfma_f32_16x16x32_bf16 v[12:15], a[112:115], v[48:51], v[12:15]
    s_lshl_b32 s47, s38, 2
    v_mov_b32 v107, 1
    v_mfma_f32_16x16x32_bf16 v[28:31], v[48:51], a[240:243], v[28:31]
    s_waitcnt lgkmcnt(3)
    s_add_u32 s47, s47, s36
    v_mfma_f32_16x16x32_bf16 v[4:7], a[52:55], v[52:55], v[4:7]
    s_add_u32 s47, s47, 60817400
    v_mfma_f32_16x16x32_bf16 v[20:23], v[52:55], a[180:183], v[20:23]
    s_cmp_eq_u32 s45, 0
    ds_read_b128 v[36:39], v109 offset:64
    v_mfma_f32_16x16x32_bf16 v[12:15], a[116:119], v[52:55], v[12:15]
    s_cselect_b32 s47, 0x7ff00000, s47
    v_mfma_f32_16x16x32_bf16 v[28:31], v[52:55], a[244:247], v[28:31]
    s_waitcnt lgkmcnt(3)
    v_mfma_f32_16x16x32_bf16 v[4:7], a[56:59], v[56:59], v[4:7]
    s_cmp_lg_u32 s17, 0
    v_mfma_f32_16x16x32_bf16 v[20:23], v[56:59], a[184:187], v[20:23]
    s_cselect_b32 s47, 0x7ff00000, s47
    ds_read_b128 v[40:43], v109 offset:128
    v_mfma_f32_16x16x32_bf16 v[12:15], a[120:123], v[56:59], v[12:15]
    buffer_store_dword v107, v106, s[4:7], s47 offen sc1
    v_mfma_f32_16x16x32_bf16 v[28:31], v[56:59], a[248:251], v[28:31]
    s_waitcnt lgkmcnt(3)
    v_mfma_f32_16x16x32_bf16 v[4:7], a[60:63], v[60:63], v[4:7]
    s_add_u32 s45, s45, 1
    v_mfma_f32_16x16x32_bf16 v[20:23], v[60:63], a[188:191], v[20:23]
    s_add_u32 s38, s38, 2
    ds_read_b128 v[44:47], v109 offset:192
    v_mfma_f32_16x16x32_bf16 v[12:15], a[124:127], v[60:63], v[12:15]
    s_cmp_lt_u32 s38, 64
    v_swap_b32 v108, v109
    v_mfma_f32_16x16x32_bf16 v[28:31], v[60:63], a[252:255], v[28:31]
    s_cbranch_scc1 L_b1_104
    s_nop 0
    v_cvt_pk_bf16_f32 v74, v20, v21
    v_cvt_pk_bf16_f32 v75, v22, v23
    buffer_store_dwordx4 v[72:75], v105, s[4:7], s43 offen offset:0 sc1
    s_nop 2
    v_cvt_pk_bf16_f32 v78, v28, v29
    v_cvt_pk_bf16_f32 v79, v30, v31
    buffer_store_dwordx4 v[76:79], v105, s[4:7], s43 offen offset:1024 sc1
    v_mul_f32 v4, s49, v4
    v_mul_f32 v5, s49, v5
    v_mul_f32 v6, s49, v6
    v_mul_f32 v7, s49, v7
    v_mul_f32 v12, s49, v12
    v_mul_f32 v13, s49, v13
    v_mul_f32 v14, s49, v14
    v_mul_f32 v15, s49, v15
    v_cvt_pk_bf16_f32 v68, v4, v12
    v_cvt_pk_bf16_f32 v69, v5, v13
    v_cvt_pk_bf16_f32 v70, v6, v14
    v_cvt_pk_bf16_f32 v71, v7, v15
    buffer_store_dwordx4 v[68:71], v105, s[4:7], s42 offen sc1
    s_lshl_b32 s40, s38, 2
    s_add_u32 s40, s40, s36
    s_add_u32 s40, s40, 60817400
    s_waitcnt vmcnt(0) lgkmcnt(0)
    s_barrier
    s_cmp_lg_u32 s17, 0
    s_cbranch_scc1 L_flag_105
    v_mov_b32 v107, 1
    s_mov_b64 exec, 1
    buffer_store_dword v107, v106, s[4:7], s40 offen sc1
    s_mov_b64 exec, -1
L_flag_105:
W_b2:
    s_cmp_ge_u32 s18, 2
    s_cbranch_scc1 L_fq_106
    v_lshrrev_b32 v1, 4, v104
    s_and_b32 s19, s17, 1
    s_lshl_b32 s19, s19, 2
    v_add_u32 v2, s19, v1
    v_lshlrev_b32 v2, 1, v2
    v_and_b32 v3, 15, v104
    v_xor_b32 v2, v2, v3
    v_lshlrev_b32 v100, 13, v1
    v_lshl_add_u32 v100, v2, 4, v100
    s_lshl_b32 s19, s17, 16
    v_add_u32 v100, s19, v100
    v_lshrrev_b32 v2, 2, v104
    v_and_b32 v3, 7, v2
    s_lshl_b32 s19, s17, 1
    v_xor_b32 v3, s19, v3
    v_lshlrev_b32 v101, 8, v2
    v_lshl_add_u32 v101, v3, 5, v101
    v_and_b32 v3, 3, v104
    v_lshl_add_u32 v101, v3, 3, v101
    v_add_u32 v101, 32768, v101
    v_xor_b32 v102, 32, v101
    v_add_u32 v103, 0x10000, v101
    v_add_u32 v98, 0x10000, v102
    s_lshl_b32 s44, s17, 10
    s_add_u32 m0, s44, 32768
    s_add_u32 s19, s36, 0
    buffer_load_dwordx4 v100, s[20:23], s19 offen lds
    s_add_u32 m0, s44, 36864
    s_add_u32 s19, s36, 32768
    buffer_load_dwordx4 v100, s[20:23], s19 offen lds
    s_add_u32 m0, s44, 40960
    s_add_u32 s19, s36, 262144
    buffer_load_dwordx4 v100, s[20:23], s19 offen lds
    s_add_u32 m0, s44, 45056
    s_add_u32 s19, s36, 294912
    buffer_load_dwordx4 v100, s[20:23], s19 offen lds
    s_add_u32 m0, s44, 49152
    s_add_u32 s19, s36, 524288
    buffer_load_dwordx4 v100, s[20:23], s19 offen lds
    s_add_u32 m0, s44, 53248
    s_add_u32 s19, s36, 557056
    buffer_load_dwordx4 v100, s[20:23], s19 offen lds
    s_add_u32 m0, s44, 57344
    s_add_u32 s19, s36, 786432
    buffer_load_dwordx4 v100, s[20:23], s19 offen lds
    s_add_u32 m0, s44, 61440
    s_add_u32 s19, s36, 819200
    buffer_load_dwordx4 v100, s[20:23], s19 offen lds
    s_add_u32 m0, s44, 65536
    s_add_u32 s19, s36, 1048576
    buffer_load_dwordx4 v100, s[20:23], s19 offen lds
    s_add_u32 m0, s44, 69632
    s_add_u32 s19, s36, 1081344
    buffer_load_dwordx4 v100, s[20:23], s19 offen lds
    s_add_u32 m0, s44, 73728
    s_add_u32 s19, s36, 1310720
    buffer_load_dwordx4 v100, s[20:23], s19 offen lds
    s_add_u32 m0, s44, 77824
    s_add_u32 s19, s36, 1343488
    buffer_load_dwordx4 v100, s[20:23], s19 offen lds
    s_add_u32 m0, s44, 81920
    s_add_u32 s19, s36, 1572864
    buffer_load_dwordx4 v100, s[20:23], s19 offen lds
    s_add_u32 m0, s44, 86016
    s_add_u32 s19, s36, 1605632
    buffer_load_dwordx4 v100, s[20:23], s19 offen lds
    s_add_u32 m0, s44, 90112
    s_add_u32 s19, s36, 1835008
    buffer_load_dwordx4 v100, s[20:23], s19 offen lds
    s_add_u32 m0, s44, 94208
    s_add_u32 s19, s36, 1867776
    buffer_load_dwordx4 v100, s[20:23], s19 offen lds
    s_add_u32 m0, s44, 98304
    s_add_u32 s19, s36, 2097152
    buffer_load_dwordx4 v100, s[20:23], s19 offen lds
    s_add_u32 m0, s44, 102400
    s_add_u32 s19, s36, 2129920
    buffer_load_dwordx4 v100, s[20:23], s19 offen lds
    s_add_u32 m0, s44, 106496
    s_add_u32 s19, s36, 2359296
    buffer_load_dwordx4 v100, s[20:23], s19 offen lds
    s_add_u32 m0, s44, 110592
    s_add_u32 s19, s36, 2392064
    buffer_load_dwordx4 v100, s[20:23], s19 offen lds
    s_add_u32 m0, s44, 114688
    s_add_u32 s19, s36, 2621440
    buffer_load_dwordx4 v100, s[20:23], s19 offen lds
    s_add_u32 m0, s44, 118784
    s_add_u32 s19, s36, 2654208
    buffer_load_dwordx4 v100, s[20:23], s19 offen lds
    s_add_u32 m0, s44, 122880
    s_add_u32 s19, s36, 2883584
    buffer_load_dwordx4 v100, s[20:23], s19 offen lds
    s_add_u32 m0, s44, 126976
    s_add_u32 s19, s36, 2916352
    buffer_load_dwordx4 v100, s[20:23], s19 offen lds
    s_add_u32 m0, s44, 131072
    s_add_u32 s19, s36, 3145728
    buffer_load_dwordx4 v100, s[20:23], s19 offen lds
    s_add_u32 m0, s44, 135168
    s_add_u32 s19, s36, 3178496
    buffer_load_dwordx4 v100, s[20:23], s19 offen lds
    s_add_u32 m0, s44, 139264
    s_add_u32 s19, s36, 3407872
    buffer_load_dwordx4 v100, s[20:23], s19 offen lds
    s_add_u32 m0, s44, 143360
    s_add_u32 s19, s36, 3440640
    buffer_load_dwordx4 v100, s[20:23], s19 offen lds
    s_waitcnt vmcnt(24) lgkmcnt(0)
    s_barrier
    s_add_u32 m0, s44, 147456
    s_add_u32 s19, s36, 3670016
    buffer_load_dwordx4 v100, s[20:23], s19 offen lds
    s_add_u32 m0, s44, 151552
    s_add_u32 s19, s36, 3702784
    buffer_load_dwordx4 v100, s[20:23], s19 offen lds
    s_add_u32 m0, s44, 155648
    s_add_u32 s19, s36, 3932160
    buffer_load_dwordx4 v100, s[20:23], s19 offen lds
    s_add_u32 m0, s44, 159744
    s_add_u32 s19, s36, 3964928
    buffer_load_dwordx4 v100, s[20:23], s19 offen lds
    ds_read_b64_tr_b16 a[128:129], v101 offset:0
    ds_read_b64_tr_b16 a[130:131], v101 offset:4096
    ds_read_b64_tr_b16 a[132:133], v101 offset:8192
    ds_read_b64_tr_b16 a[134:135], v101 offset:12288
    ds_read_b64_tr_b16 a[192:193], v102 offset:0
    ds_read_b64_tr_b16 a[194:195], v102 offset:4096
    ds_read_b64_tr_b16 a[196:197], v102 offset:8192
    ds_read_b64_tr_b16 a[198:199], v102 offset:12288
    s_waitcnt vmcnt(24) lgkmcnt(0)
    s_barrier
    ds_read_b64_tr_b16 a[136:137], v101 offset:16384
    ds_read_b64_tr_b16 a[138:139], v101 offset:20480
    ds_read_b64_tr_b16 a[140:141], v101 offset:24576
    ds_read_b64_tr_b16 a[142:143], v101 offset:28672
    ds_read_b64_tr_b16 a[200:201], v102 offset:16384
    ds_read_b64_tr_b16 a[202:203], v102 offset:20480
    ds_read_b64_tr_b16 a[204:205], v102 offset:24576
    ds_read_b64_tr_b16 a[206:207], v102 offset:28672
    s_waitcnt vmcnt(20) lgkmcnt(0)
    s_barrier
    ds_read_b64_tr_b16 a[144:145], v101 offset:32768
    ds_read_b64_tr_b16 a[146:147], v101 offset:36864
    ds_read_b64_tr_b16 a[148:149], v101 offset:40960
    ds_read_b64_tr_b16 a[150:151], v101 offset:45056
    ds_read_b64_tr_b16 a[208:209], v102 offset:32768
    ds_read_b64_tr_b16 a[210:211], v102 offset:36864
    ds_read_b64_tr_b16 a[212:213], v102 offset:40960
    ds_read_b64_tr_b16 a[214:215], v102 offset:45056
    s_waitcnt vmcnt(16) lgkmcnt(0)
    s_barrier
    ds_read_b64_tr_b16 a[152:153], v101 offset:49152
    ds_read_b64_tr_b16 a[154:155], v101 offset:53248
    ds_read_b64_tr_b16 a[156:157], v101 offset:57344
    ds_read_b64_tr_b16 a[158:159], v101 offset:61440
    ds_read_b64_tr_b16 a[216:217], v102 offset:49152
    ds_read_b64_tr_b16 a[218:219], v102 offset:53248
    ds_read_b64_tr_b16 a[220:221], v102 offset:57344
    ds_read_b64_tr_b16 a[222:223], v102 offset:61440
    s_waitcnt vmcnt(12) lgkmcnt(0)
    s_barrier
    ds_read_b64_tr_b16 a[160:161], v103 offset:0
    ds_read_b64_tr_b16 a[162:163], v103 offset:4096
    ds_read_b64_tr_b16 a[164:165], v103 offset:8192
    ds_read_b64_tr_b16 a[166:167], v103 offset:12288
    ds_read_b64_tr_b16 a[224:225], v98 offset:0
    ds_read_b64_tr_b16 a[226:227], v98 offset:4096
    ds_read_b64_tr_b16 a[228:229], v98 offset:8192
    ds_read_b64_tr_b16 a[230:231], v98 offset:12288
    s_waitcnt vmcnt(8) lgkmcnt(0)
    s_barrier
    ds_read_b64_tr_b16 a[168:169], v103 offset:16384
    ds_read_b64_tr_b16 a[170:171], v103 offset:20480
    ds_read_b64_tr_b16 a[172:173], v103 offset:24576
    ds_read_b64_tr_b16 a[174:175], v103 offset:28672
    ds_read_b64_tr_b16 a[232:233], v98 offset:16384
    ds_read_b64_tr_b16 a[234:235], v98 offset:20480
    ds_read_b64_tr_b16 a[236:237], v98 offset:24576
    ds_read_b64_tr_b16 a[238:239], v98 offset:28672
    s_waitcnt vmcnt(4) lgkmcnt(0)
    s_barrier
    ds_read_b64_tr_b16 a[176:177], v103 offset:32768
    ds_read_b64_tr_b16 a[178:179], v103 offset:36864
    ds_read_b64_tr_b16 a[180:181], v103 offset:40960
    ds_read_b64_tr_b16 a[182:183], v103 offset:45056
    ds_read_b64_tr_b16 a[240:241], v98 offset:32768
    ds_read_b64_tr_b16 a[242:243], v98 offset:36864
    ds_read_b64_tr_b16 a[244:245], v98 offset:40960
    ds_read_b64_tr_b16 a[246:247], v98 offset:45056
    s_waitcnt vmcnt(0) lgkmcnt(0)
    s_barrier
    ds_read_b64_tr_b16 a[184:185], v103 offset:49152
    ds_read_b64_tr_b16 a[186:187], v103 offset:53248
    ds_read_b64_tr_b16 a[188:189], v103 offset:57344
    ds_read_b64_tr_b16 a[190:191], v103 offset:61440
    ds_read_b64_tr_b16 a[248:249], v98 offset:49152
    ds_read_b64_tr_b16 a[250:251], v98 offset:53248
    ds_read_b64_tr_b16 a[252:253], v98 offset:57344
    ds_read_b64_tr_b16 a[254:255], v98 offset:61440
    s_waitcnt lgkmcnt(0)
    s_barrier
    s_branch L_fj_107
L_fq_106:
    v_lshrrev_b32 v1, 4, v104
    s_and_b32 s19, s17, 1
    s_lshl_b32 s19, s19, 2
    v_add_u32 v2, s19, v1
    v_lshlrev_b32 v2, 1, v2
    v_and_b32 v3, 15, v104
    v_xor_b32 v2, v2, v3
    v_lshlrev_b32 v100, 13, v1
    v_lshl_add_u32 v100, v2, 4, v100
    s_lshl_b32 s19, s17, 16
    v_add_u32 v100, s19, v100
    v_lshrrev_b32 v2, 2, v104
    v_and_b32 v3, 7, v2
    s_lshl_b32 s19, s17, 1
    v_xor_b32 v3, s19, v3
    v_lshlrev_b32 v101, 8, v2
    v_lshl_add_u32 v101, v3, 5, v101
    v_and_b32 v3, 3, v104
    v_lshl_add_u32 v101, v3, 3, v101
    v_add_u32 v101, 32768, v101
    v_xor_b32 v102, 32, v101
    v_add_u32 v103, 0x10000, v101
    v_add_u32 v98, 0x10000, v102
    s_lshl_b32 s44, s17, 10
    s_add_u32 m0, s44, 32768
    s_add_u32 s19, s36, 0
    buffer_load_dwordx4 v100, s[20:23], s19 offen lds
    s_add_u32 m0, s44, 36864
    s_add_u32 s19, s36, 32768
    buffer_load_dwordx4 v100, s[20:23], s19 offen lds
    s_add_u32 m0, s44, 40960
    s_add_u32 s19, s36, 262144
    buffer_load_dwordx4 v100, s[20:23], s19 offen lds
    s_add_u32 m0, s44, 45056
    s_add_u32 s19, s36, 294912
    buffer_load_dwordx4 v100, s[20:23], s19 offen lds
    s_add_u32 m0, s44, 49152
    s_add_u32 s19, s36, 524288
    buffer_load_dwordx4 v100, s[20:23], s19 offen lds
    s_add_u32 m0, s44, 53248
    s_add_u32 s19, s36, 557056
    buffer_load_dwordx4 v100, s[20:23], s19 offen lds
    s_add_u32 m0, s44, 57344
    s_add_u32 s19, s36, 786432
    buffer_load_dwordx4 v100, s[20:23], s19 offen lds
    s_add_u32 m0, s44, 61440
    s_add_u32 s19, s36, 819200
    buffer_load_dwordx4 v100, s[20:23], s19 offen lds
    s_add_u32 m0, s44, 65536
    s_add_u32 s19, s36, 1048576
    buffer_load_dwordx4 v100, s[20:23], s19 offen lds
    s_add_u32 m0, s44, 69632
    s_add_u32 s19, s36, 1081344
    buffer_load_dwordx4 v100, s[20:23], s19 offen lds
    s_add_u32 m0, s44, 73728
    s_add_u32 s19, s36, 1310720
    buffer_load_dwordx4 v100, s[20:23], s19 offen lds
    s_add_u32 m0, s44, 77824
    s_add_u32 s19, s36, 1343488
    buffer_load_dwordx4 v100, s[20:23], s19 offen lds
    s_add_u32 m0, s44, 81920
    s_add_u32 s19, s36, 1572864
    buffer_load_dwordx4 v100, s[20:23], s19 offen lds
    s_add_u32 m0, s44, 86016
    s_add_u32 s19, s36, 1605632
    buffer_load_dwordx4 v100, s[20:23], s19 offen lds
    s_add_u32 m0, s44, 90112
    s_add_u32 s19, s36, 1835008
    buffer_load_dwordx4 v100, s[20:23], s19 offen lds
    s_add_u32 m0, s44, 94208
    s_add_u32 s19, s36, 1867776
    buffer_load_dwordx4 v100, s[20:23], s19 offen lds
    s_add_u32 m0, s44, 98304
    s_add_u32 s19, s36, 2097152
    buffer_load_dwordx4 v100, s[20:23], s19 offen lds
    s_add_u32 m0, s44, 102400
    s_add_u32 s19, s36, 2129920
    buffer_load_dwordx4 v100, s[20:23], s19 offen lds
    s_add_u32 m0, s44, 106496
    s_add_u32 s19, s36, 2359296
    buffer_load_dwordx4 v100, s[20:23], s19 offen lds
    s_add_u32 m0, s44, 110592
    s_add_u32 s19, s36, 2392064
    buffer_load_dwordx4 v100, s[20:23], s19 offen lds
    s_add_u32 m0, s44, 114688
    s_add_u32 s19, s36, 2621440
    buffer_load_dwordx4 v100, s[20:23], s19 offen lds
    s_add_u32 m0, s44, 118784
    s_add_u32 s19, s36, 2654208
    buffer_load_dwordx4 v100, s[20:23], s19 offen lds
    s_add_u32 m0, s44, 122880
    s_add_u32 s19, s36, 2883584
    buffer_load_dwordx4 v100, s[20:23], s19 offen lds
    s_add_u32 m0, s44, 126976
    s_add_u32 s19, s36, 2916352
    buffer_load_dwordx4 v100, s[20:23], s19 offen lds
    s_add_u32 m0, s44, 131072
    s_add_u32 s19, s36, 3145728
    buffer_load_dwordx4 v100, s[20:23], s19 offen lds
    s_add_u32 m0, s44, 135168
    s_add_u32 s19, s36, 3178496
    buffer_load_dwordx4 v100, s[20:23], s19 offen lds
    s_add_u32 m0, s44, 139264
    s_add_u32 s19, s36, 3407872
    buffer_load_dwordx4 v100, s[20:23], s19 offen lds
    s_add_u32 m0, s44, 143360
    s_add_u32 s19, s36, 3440640
    buffer_load_dwordx4 v100, s[20:23], s19 offen lds
    s_cmp_lg_u32 s17, 0
    s_cbranch_scc1 L_w0_108
    s_waitcnt vmcnt(28)
    s_lshr_b32 s95, s93, 5
    s_lshl_b32 s95, s95, 2
    s_lshl_b32 s94, 1, s93
    s_atomic_or s94, s[86:87], s95 glc
L_w0_108:
    s_cmp_lg_u32 s17, 0
    s_cbranch_scc1 L_w0_109
    s_waitcnt lgkmcnt(0)
    v_mov_b32 v92, s94
    ds_write_b32 v106, v92 offset:0
    s_waitcnt lgkmcnt(0)
L_w0_109:
    s_waitcnt vmcnt(24) lgkmcnt(0)
    s_barrier
    s_add_u32 m0, s44, 147456
    s_add_u32 s19, s36, 3670016
    buffer_load_dwordx4 v100, s[20:23], s19 offen lds
    s_add_u32 m0, s44, 151552
    s_add_u32 s19, s36, 3702784
    buffer_load_dwordx4 v100, s[20:23], s19 offen lds
    s_add_u32 m0, s44, 155648
    s_add_u32 s19, s36, 3932160
    buffer_load_dwordx4 v100, s[20:23], s19 offen lds
    s_add_u32 m0, s44, 159744
    s_add_u32 s19, s36, 3964928
    buffer_load_dwordx4 v100, s[20:23], s19 offen lds
    ds_read_b32 v92, v106 offset:0
    s_waitcnt lgkmcnt(0)
    v_readfirstlane_b32 s19, v92
    s_nop 0
    s_bitcmp1_b32 s19, s93
    s_cbranch_scc1 L_lost
    ds_read_b64_tr_b16 a[128:129], v101 offset:0
    ds_read_b64_tr_b16 a[130:131], v101 offset:4096
    ds_read_b64_tr_b16 a[132:133], v101 offset:8192
    ds_read_b64_tr_b16 a[134:135], v101 offset:12288
    ds_read_b64_tr_b16 a[192:193], v102 offset:0
    ds_read_b64_tr_b16 a[194:195], v102 offset:4096
    ds_read_b64_tr_b16 a[196:197], v102 offset:8192
    ds_read_b64_tr_b16 a[198:199], v102 offset:12288
    s_waitcnt vmcnt(24) lgkmcnt(0)
    s_barrier
    ds_read_b64_tr_b16 a[136:137], v101 offset:16384
    ds_read_b64_tr_b16 a[138:139], v101 offset:20480
    ds_read_b64_tr_b16 a[140:141], v101 offset:24576
    ds_read_b64_tr_b16 a[142:143], v101 offset:28672
    ds_read_b64_tr_b16 a[200:201], v102 offset:16384
    ds_read_b64_tr_b16 a[202:203], v102 offset:20480
    ds_read_b64_tr_b16 a[204:205], v102 offset:24576
    ds_read_b64_tr_b16 a[206:207], v102 offset:28672
    s_waitcnt vmcnt(20) lgkmcnt(0)
    s_barrier
    ds_read_b64_tr_b16 a[144:145], v101 offset:32768
    ds_read_b64_tr_b16 a[146:147], v101 offset:36864
    ds_read_b64_tr_b16 a[148:149], v101 offset:40960
    ds_read_b64_tr_b16 a[150:151], v101 offset:45056
    ds_read_b64_tr_b16 a[208:209], v102 offset:32768
    ds_read_b64_tr_b16 a[210:211], v102 offset:36864
    ds_read_b64_tr_b16 a[212:213], v102 offset:40960
    ds_read_b64_tr_b16 a[214:215], v102 offset:45056
    s_waitcnt vmcnt(16) lgkmcnt(0)
    s_barrier
    ds_read_b64_tr_b16 a[152:153], v101 offset:49152
    ds_read_b64_tr_b16 a[154:155], v101 offset:53248
    ds_read_b64_tr_b16 a[156:157], v101 offset:57344
    ds_read_b64_tr_b16 a[158:159], v101 offset:61440
    ds_read_b64_tr_b16 a[216:217], v102 offset:49152
    ds_read_b64_tr_b16 a[218:219], v102 offset:53248
    ds_read_b64_tr_b16 a[220:221], v102 offset:57344
    ds_read_b64_tr_b16 a[222:223], v102 offset:61440
    s_waitcnt vmcnt(12) lgkmcnt(0)
    s_barrier
    ds_read_b64_tr_b16 a[160:161], v103 offset:0
    ds_read_b64_tr_b16 a[162:163], v103 offset:4096
    ds_read_b64_tr_b16 a[164:165], v103 offset:8192
    ds_read_b64_tr_b16 a[166:167], v103 offset:12288
    ds_read_b64_tr_b16 a[224:225], v98 offset:0
    ds_read_b64_tr_b16 a[226:227], v98 offset:4096
    ds_read_b64_tr_b16 a[228:229], v98 offset:8192
    ds_read_b64_tr_b16 a[230:231], v98 offset:12288
    s_waitcnt vmcnt(8) lgkmcnt(0)
    s_barrier
    ds_read_b64_tr_b16 a[168:169], v103 offset:16384
    ds_read_b64_tr_b16 a[170:171], v103 offset:20480
    ds_read_b64_tr_b16 a[172:173], v103 offset:24576
    ds_read_b64_tr_b16 a[174:175], v103 offset:28672
    ds_read_b64_tr_b16 a[232:233], v98 offset:16384
    ds_read_b64_tr_b16 a[234:235], v98 offset:20480
    ds_read_b64_tr_b16 a[236:237], v98 offset:24576
    ds_read_b64_tr_b16 a[238:239], v98 offset:28672
    s_waitcnt vmcnt(4) lgkmcnt(0)
    s_barrier
    ds_read_b64_tr_b16 a[176:177], v103 offset:32768
    ds_read_b64_tr_b16 a[178:179], v103 offset:36864
    ds_read_b64_tr_b16 a[180:181], v103 offset:40960
    ds_read_b64_tr_b16 a[182:183], v103 offset:45056
    ds_read_b64_tr_b16 a[240:241], v98 offset:32768
    ds_read_b64_tr_b16 a[242:243], v98 offset:36864
    ds_read_b64_tr_b16 a[244:245], v98 offset:40960
    ds_read_b64_tr_b16 a[246:247], v98 offset:45056
    s_waitcnt vmcnt(0) lgkmcnt(0)
    s_barrier
    ds_read_b64_tr_b16 a[184:185], v103 offset:49152
    ds_read_b64_tr_b16 a[186:187], v103 offset:53248
    ds_read_b64_tr_b16 a[188:189], v103 offset:57344
    ds_read_b64_tr_b16 a[190:191], v103 offset:61440
    ds_read_b64_tr_b16 a[248:249], v98 offset:49152
    ds_read_b64_tr_b16 a[250:251], v98 offset:53248
    ds_read_b64_tr_b16 a[252:253], v98 offset:57344
    ds_read_b64_tr_b16 a[254:255], v98 offset:61440
    s_waitcnt lgkmcnt(0)
    s_barrier
L_fj_107:
    s_mov_b32 s12, s84
    s_and_b32 s13, s85, 0xffff
    s_mov_b32 s14, 0x400000
    s_mov_b32 s15, 0x20000
    v_lshrrev_b32 v1, 4, v104
    v_and_b32 v2, 15, v104
    v_lshlrev_b32 v3, 10, v1
    v_lshl_add_u32 v3, v2, 4, v3
    s_lshl_b32 s19, s17, 8
    s_add_u32 s39, s37, s19
    s_lshl_b32 s44, s17, 15
    s_add_u32 m0, s44, 0
    s_add_u32 s19, s39, 0
    buffer_load_dwordx4 v3, s[32:35], s19 offen lds
    s_add_u32 m0, s44, 1024
    s_add_u32 s19, s39, 4096
    buffer_load_dwordx4 v3, s[32:35], s19 offen lds
    s_add_u32 m0, s44, 2048
    s_add_u32 s19, s39, 8192
    buffer_load_dwordx4 v3, s[32:35], s19 offen lds
    s_add_u32 m0, s44, 3072
    s_add_u32 s19, s39, 12288
    buffer_load_dwordx4 v3, s[32:35], s19 offen lds
    s_add_u32 m0, s44, 4096
    s_add_u32 s19, s39, 16384
    buffer_load_dwordx4 v3, s[32:35], s19 offen lds
    s_add_u32 m0, s44, 5120
    s_add_u32 s19, s39, 20480
    buffer_load_dwordx4 v3, s[32:35], s19 offen lds
    s_add_u32 m0, s44, 6144
    s_add_u32 s19, s39, 24576
    buffer_load_dwordx4 v3, s[32:35], s19 offen lds
    s_add_u32 m0, s44, 7168
    s_add_u32 s19, s39, 28672
    buffer_load_dwordx4 v3, s[32:35], s19 offen lds
    s_add_u32 m0, s44, 8192
    s_add_u32 s19, s39, 32768
    buffer_load_dwordx4 v3, s[32:35], s19 offen lds
    s_add_u32 m0, s44, 9216
    s_add_u32 s19, s39, 36864
    buffer_load_dwordx4 v3, s[32:35], s19 offen lds
    s_add_u32 m0, s44, 10240
    s_add_u32 s19, s39, 40960
    buffer_load_dwordx4 v3, s[32:35], s19 offen lds
    s_add_u32 m0, s44, 11264
    s_add_u32 s19, s39, 45056
    buffer_load_dwordx4 v3, s[32:35], s19 offen lds
    s_add_u32 m0, s44, 12288
    s_add_u32 s19, s39, 49152
    buffer_load_dwordx4 v3, s[32:35], s19 offen lds
    s_add_u32 m0, s44, 13312
    s_add_u32 s19, s39, 53248
    buffer_load_dwordx4 v3, s[32:35], s19 offen lds
    s_add_u32 m0, s44, 14336
    s_add_u32 s19, s39, 57344
    buffer_load_dwordx4 v3, s[32:35], s19 offen lds
    s_add_u32 m0, s44, 15360
    s_add_u32 s19, s39, 61440
    buffer_load_dwordx4 v3, s[32:35], s19 offen lds
    s_add_u32 m0, s44, 16384
    s_add_u32 s19, s39, 65536
    buffer_load_dwordx4 v3, s[32:35], s19 offen lds
    s_add_u32 m0, s44, 17408
    s_add_u32 s19, s39, 69632
    buffer_load_dwordx4 v3, s[32:35], s19 offen lds
    s_add_u32 m0, s44, 18432
    s_add_u32 s19, s39, 73728
    buffer_load_dwordx4 v3, s[32:35], s19 offen lds
    s_add_u32 m0, s44, 19456
    s_add_u32 s19, s39, 77824
    buffer_load_dwordx4 v3, s[32:35], s19 offen lds
    s_add_u32 m0, s44, 20480
    s_add_u32 s19, s39, 81920
    buffer_load_dwordx4 v3, s[32:35], s19 offen lds
    s_add_u32 m0, s44, 21504
    s_add_u32 s19, s39, 86016
    buffer_load_dwordx4 v3, s[32:35], s19 offen lds
    s_add_u32 m0, s44, 22528
    s_add_u32 s19, s39, 90112
    buffer_load_dwordx4 v3, s[32:35], s19 offen lds
    s_add_u32 m0, s44, 23552
    s_add_u32 s19, s39, 94208
    buffer_load_dwordx4 v3, s[32:35], s19 offen lds
    s_add_u32 m0, s44, 24576
    s_add_u32 s19, s39, 98304
    buffer_load_dwordx4 v3, s[32:35], s19 offen lds
    s_add_u32 m0, s44, 25600
    s_add_u32 s19, s39, 102400
    buffer_load_dwordx4 v3, s[32:35], s19 offen lds
    s_add_u32 m0, s44, 26624
    s_add_u32 s19, s39, 106496
    buffer_load_dwordx4 v3, s[32:35], s19 offen lds
    s_add_u32 m0, s44, 27648
    s_add_u32 s19, s39, 110592
    buffer_load_dwordx4 v3, s[32:35], s19 offen lds
    s_add_u32 m0, s44, 28672
    s_add_u32 s19, s39, 114688
    buffer_load_dwordx4 v3, s[32:35], s19 offen lds
    s_add_u32 m0, s44, 29696
    s_add_u32 s19, s39, 118784
    buffer_load_dwordx4 v3, s[32:35], s19 offen lds
    s_add_u32 m0, s44, 30720
    s_add_u32 s19, s39, 122880
    buffer_load_dwordx4 v3, s[32:35], s19 offen lds
    s_add_u32 m0, s44, 31744
    s_add_u32 s19, s39, 126976
    buffer_load_dwordx4 v3, s[32:35], s19 offen lds
    s_mov_b32 s8, s70
    s_and_b32 s9, s71, 0xffff
    s_mov_b32 s10, 0x200000
    s_mov_b32 s11, 0x20000
    v_mov_b32 v95, v3
    v_lshrrev_b32 v4, 2, v104
    v_lshlrev_b32 v4, 8, v4
    v_and_b32 v5, 3, v104
    v_lshl_add_u32 v4, v5, 6, v4
    v_add_u32 v4, s44, v4
    s_lshl_b32 s19, s17, 9
    s_add_u32 s19, s19, 50176
    v_lshlrev_b32 v92, 7, v1
    v_lshl_add_u32 v92, v2, 2, v92
    v_add_u32 v92, s19, v92
    v_lshrrev_b32 v6, 2, v2
    v_and_b32 v7, 1, v2
    v_lshl_add_u32 v6, v6, 1, v7
    v_lshlrev_b32 v93, 6, v6
    v_lshl_add_u32 v93, v1, 4, v93
    v_add_u32 v93, 50176, v93
    v_lshlrev_b32 v94, 17, v1
    v_lshl_add_u32 v94, v2, 4, v94
    v_lshlrev_b32 v96, 6, v1
    v_lshl_add_u32 v96, v2, 3, v96
    v_lshlrev_b32 v6, 2, v1
    v_sub_u32 v97, v2, v6
    v_mul_u32_u24 v108, 1056, v2
    v_lshl_add_u32 v108, v1, 4, v108
    s_lshl_b32 s19, s17, 10
    v_add_u32 v110, s19, v105
    v_lshrrev_b32 v6, 1, v2
    v_mov_b32 v8, 0x3f80
    v_lshlrev_b32 v7, 4, v7
    v_lshlrev_b32 v8, v7, v8
    s_mov_b32 s50, 0x00ff00ff
    s_mov_b32 s51, 0x00ff00ff
    v_cmp_eq_u32 vcc, 0, v6
    s_nop 1
    v_cndmask_b32 v100, v106, v8, vcc
    v_cmp_eq_u32 vcc, 1, v6
    s_nop 1
    v_cndmask_b32 v101, v106, v8, vcc
    v_cmp_eq_u32 vcc, 2, v6
    s_nop 1
    v_cndmask_b32 v102, v106, v8, vcc
    v_cmp_eq_u32 vcc, 3, v6
    s_nop 1
    v_cndmask_b32 v103, v106, v8, vcc
    s_waitcnt vmcnt(24)
    ds_read_b64_tr_b16 a[0:1], v4 offset:0
    ds_read_b64_tr_b16 a[2:3], v4 offset:4096
    ds_read_b64_tr_b16 a[16:17], v4 offset:8
    ds_read_b64_tr_b16 a[18:19], v4 offset:4104
    ds_read_b64_tr_b16 a[32:33], v4 offset:16
    ds_read_b64_tr_b16 a[34:35], v4 offset:4112
    ds_read_b64_tr_b16 a[48:49], v4 offset:24
    ds_read_b64_tr_b16 a[50:51], v4 offset:4120
    ds_read_b64_tr_b16 a[64:65], v4 offset:32
    ds_read_b64_tr_b16 a[66:67], v4 offset:4128
    ds_read_b64_tr_b16 a[80:81], v4 offset:40
    ds_read_b64_tr_b16 a[82:83], v4 offset:4136
    ds_read_b64_tr_b16 a[96:97], v4 offset:48
    ds_read_b64_tr_b16 a[98:99], v4 offset:4144
    ds_read_b64_tr_b16 a[112:113], v4 offset:56
    ds_read_b64_tr_b16 a[114:115], v4 offset:4152
    s_waitcnt vmcnt(16)
    ds_read_b64_tr_b16 a[4:5], v4 offset:8192
    ds_read_b64_tr_b16 a[6:7], v4 offset:12288
    ds_read_b64_tr_b16 a[20:21], v4 offset:8200
    ds_read_b64_tr_b16 a[22:23], v4 offset:12296
    ds_read_b64_tr_b16 a[36:37], v4 offset:8208
    ds_read_b64_tr_b16 a[38:39], v4 offset:12304
    ds_read_b64_tr_b16 a[52:53], v4 offset:8216
    ds_read_b64_tr_b16 a[54:55], v4 offset:12312
    ds_read_b64_tr_b16 a[68:69], v4 offset:8224
    ds_read_b64_tr_b16 a[70:71], v4 offset:12320
    ds_read_b64_tr_b16 a[84:85], v4 offset:8232
    ds_read_b64_tr_b16 a[86:87], v4 offset:12328
    ds_read_b64_tr_b16 a[100:101], v4 offset:8240
    ds_read_b64_tr_b16 a[102:103], v4 offset:12336
    ds_read_b64_tr_b16 a[116:117], v4 offset:8248
    ds_read_b64_tr_b16 a[118:119], v4 offset:12344
    s_waitcnt vmcnt(8)
    ds_read_b64_tr_b16 a[8:9], v4 offset:16384
    ds_read_b64_tr_b16 a[10:11], v4 offset:20480
    ds_read_b64_tr_b16 a[24:25], v4 offset:16392
    ds_read_b64_tr_b16 a[26:27], v4 offset:20488
    ds_read_b64_tr_b16 a[40:41], v4 offset:16400
    ds_read_b64_tr_b16 a[42:43], v4 offset:20496
    ds_read_b64_tr_b16 a[56:57], v4 offset:16408
    ds_read_b64_tr_b16 a[58:59], v4 offset:20504
    ds_read_b64_tr_b16 a[72:73], v4 offset:16416
    ds_read_b64_tr_b16 a[74:75], v4 offset:20512
    ds_read_b64_tr_b16 a[88:89], v4 offset:16424
    ds_read_b64_tr_b16 a[90:91], v4 offset:20520
    ds_read_b64_tr_b16 a[104:105], v4 offset:16432
    ds_read_b64_tr_b16 a[106:107], v4 offset:20528
    ds_read_b64_tr_b16 a[120:121], v4 offset:16440
    ds_read_b64_tr_b16 a[122:123], v4 offset:20536
    s_waitcnt vmcnt(0)
    ds_read_b64_tr_b16 a[12:13], v4 offset:24576
    ds_read_b64_tr_b16 a[14:15], v4 offset:28672
    ds_read_b64_tr_b16 a[28:29], v4 offset:24584
    ds_read_b64_tr_b16 a[30:31], v4 offset:28680
    ds_read_b64_tr_b16 a[44:45], v4 offset:24592
    ds_read_b64_tr_b16 a[46:47], v4 offset:28688
    ds_read_b64_tr_b16 a[60:61], v4 offset:24600
    ds_read_b64_tr_b16 a[62:63], v4 offset:28696
    ds_read_b64_tr_b16 a[76:77], v4 offset:24608
    ds_read_b64_tr_b16 a[78:79], v4 offset:28704
    ds_read_b64_tr_b16 a[92:93], v4 offset:24616
    ds_read_b64_tr_b16 a[94:95], v4 offset:28712
    ds_read_b64_tr_b16 a[108:109], v4 offset:24624
    ds_read_b64_tr_b16 a[110:111], v4 offset:28720
    ds_read_b64_tr_b16 a[124:125], v4 offset:24632
    ds_read_b64_tr_b16 a[126:127], v4 offset:28728
    v_and_b32 v2, 7, v104
    v_lshlrev_b32 v2, 2, v2
L_init_110:
    global_load_dword v107, v2, s[86:87] offset:0 sc1
    s_sub_u32 s48, s48, 1
    s_cbranch_scc1 W_bail
    s_waitcnt vmcnt(0)
    v_cmp_ne_u32 vcc, -1, v107
    s_cbranch_vccz L_init_110_ok
    s_sleep 16
    s_branch L_init_110
L_init_110_ok:
    s_xor_b32 s38, s18, 2
    s_cmp_lt_u32 s18, 2
    s_cselect_b32 s19, 40, 0
    s_add_u32 s38, s38, s19
    s_mov_b32 s45, 0
    s_lshl_b32 s39, s38, 2
    s_add_u32 s39, s39, s36
    s_add_u32 s39, s39, 60817408
L_f1_111:
    buffer_load_dword v107, v106, s[4:7], s39 offen sc1
    s_sub_u32 s48, s48, 1
    s_cbranch_scc1 W_bail
    s_waitcnt vmcnt(0)
    v_cmp_ne_u32 vcc, 1, v107
    s_cbranch_vccz L_f1_111_ok
    s_sleep 8
    s_branch L_f1_111
L_f1_111_ok:
    s_waitcnt lgkmcnt(0)
    s_barrier
    s_lshl_b32 s39, s38, 15
    s_lshl_b32 s19, s17, 13
    s_add_u32 s39, s39, s19
    s_mul_i32 s44, s17, 8448
    s_add_u32 m0, s44, 0
    s_add_u32 s19, s39, 0
    buffer_load_dwordx4 v105, s[8:11], s19 offen lds
    s_add_u32 m0, s44, 1056
    s_add_u32 s19, s39, 1024
    buffer_load_dwordx4 v105, s[8:11], s19 offen lds
    s_add_u32 m0, s44, 2112
    s_add_u32 s19, s39, 2048
    buffer_load_dwordx4 v105, s[8:11], s19 offen lds
    s_add_u32 m0, s44, 3168
    s_add_u32 s19, s39, 3072
    buffer_load_dwordx4 v105, s[8:11], s19 offen lds
    s_add_u32 m0, s44, 4224
    s_add_u32 s19, s39, 4096
    buffer_load_dwordx4 v105, s[8:11], s19 offen lds
    s_add_u32 m0, s44, 5280
    s_add_u32 s19, s39, 5120
    buffer_load_dwordx4 v105, s[8:11], s19 offen lds
    s_add_u32 m0, s44, 6336
    s_add_u32 s19, s39, 6144
    buffer_load_dwordx4 v105, s[8:11], s19 offen lds
    s_add_u32 m0, s44, 7392
    s_add_u32 s19, s39, 7168
    buffer_load_dwordx4 v105, s[8:11], s19 offen lds
    s_lshl_b32 s39, s38, 5
    s_add_u32 s39, s39, s16
    s_lshl_b32 s39, s39, 14
    s_lshl_b32 s19, s17, 11
    s_add_u32 s39, s39, s19
    s_add_u32 m0, s19, 33792
    s_cmp_lt_u32 s38, 64
    s_cselect_b32 s39, s39, 0x7ff00000
    buffer_load_dwordx4 v105, s[4:7], s39 offen sc1 lds
    buffer_load_dwordx4 v105, s[4:7], s39 offen offset:1024 sc1 lds
    s_add_u32 s39, s39, 8192
    buffer_load_dwordx4 v[112:115], v105, s[4:7], s39 offen sc1
    buffer_load_dwordx4 v[116:119], v105, s[4:7], s39 offen offset:1024 sc1
    global_load_dword v107, v106, s[86:87] offset:96 sc1
    v_mov_b32 v8, -1
    v_mov_b32 v9, -1
    v_mov_b32 v10, -1
    v_mov_b32 v11, -1
    s_waitcnt vmcnt(0)
    v_cmp_ne_u32 vcc, 0, v107
    s_cbranch_vccnz W_b2far
    s_lshl_b32 s41, s18, 21
    s_lshl_b32 s19, s16, 15
    s_add_u32 s41, s41, s19
    s_lshl_b32 s19, s17, 13
    s_add_u32 s41, s41, s19
    s_add_u32 s41, s41, 83886080
    buffer_store_dwordx4 v[8:11], v105, s[4:7], s41 offen offset:0
    buffer_store_dwordx4 v[8:11], v105, s[4:7], s41 offen offset:1024
    buffer_store_dwordx4 v[8:11], v105, s[4:7], s41 offen offset:2048
    buffer_store_dwordx4 v[8:11], v105, s[4:7], s41 offen offset:3072
    s_add_u32 s41, s41, 4096
    buffer_store_dwordx4 v[8:11], v105, s[4:7], s41 offen offset:0
    buffer_store_dwordx4 v[8:11], v105, s[4:7], s41 offen offset:1024
    buffer_store_dwordx4 v[8:11], v105, s[4:7], s41 offen offset:2048
    buffer_store_dwordx4 v[8:11], v105, s[4:7], s41 offen offset:3072
    s_add_u32 s41, s41, 1044480
    buffer_store_dwordx4 v[8:11], v105, s[4:7], s41 offen offset:0
    buffer_store_dwordx4 v[8:11], v105, s[4:7], s41 offen offset:1024
    buffer_store_dwordx4 v[8:11], v105, s[4:7], s41 offen offset:2048
    buffer_store_dwordx4 v[8:11], v105, s[4:7], s41 offen offset:3072
    s_add_u32 s41, s41, 4096
    buffer_store_dwordx4 v[8:11], v105, s[4:7], s41 offen offset:0
    buffer_store_dwordx4 v[8:11], v105, s[4:7], s41 offen offset:1024
    buffer_store_dwordx4 v[8:11], v105, s[4:7], s41 offen offset:2048
    buffer_store_dwordx4 v[8:11], v105, s[4:7], s41 offen offset:3072
    s_add_u32 s41, s41, 4096
    s_waitcnt vmcnt(0)
    s_barrier
    s_lshl_b32 s43, s18, 7
    s_add_u32 s43, s43, 60825600
    s_lshl_b32 s19, s16, 2
    s_add_u32 s40, s43, s19
    s_cmp_lg_u32 s17, 0
    s_cbranch_scc1 L_flag_112
    v_mov_b32 v107, 1
    s_mov_b64 exec, 1
    buffer_store_dword v107, v106, s[4:7], s40 offen sc1
    s_mov_b64 exec, -1
L_flag_112:
    v_and_b32 v2, 31, v104
    v_lshlrev_b32 v2, 2, v2
L_fo_113:
    buffer_load_dword v107, v2, s[4:7], s43 offen sc1
    s_sub_u32 s48, s48, 1
    s_cbranch_scc1 W_bail
    s_waitcnt vmcnt(0)
    v_cmp_ne_u32 vcc, 1, v107
    s_cbranch_vccz L_fo_113_ok
    s_sleep 2
    s_branch L_fo_113
L_fo_113_ok:
L_b2_114:
    s_barrier
    s_lshl_b32 s40, s38, 5
    s_add_u32 s40, s40, s16
    s_lshl_b32 s19, s17, 10
    s_lshl_b32 s40, s40, 12
    s_add_u32 s40, s40, s19
    s_add_u32 s40, s40, 50331648
    ds_read_b128 v[192:195], v108 offset:0
    ds_read_b128 v[196:199], v108 offset:16896
    ds_read_b128 v[200:203], v108 offset:64
    ds_read_b128 v[204:207], v108 offset:16960
    ds_read_b128 v[208:211], v108 offset:128
    ds_read_b128 v[212:215], v108 offset:17024
    s_waitcnt lgkmcnt(5)
    v_mfma_f32_16x16x32_bf16 v[128:131], a[128:131], v[192:195], 0
    ds_read_b128 v[216:219], v108 offset:192
    v_mfma_f32_16x16x32_bf16 v[136:139], a[192:195], v[192:195], 0
    v_mov_b32 v64, v112
    s_waitcnt lgkmcnt(5)
    v_mfma_f32_16x16x32_bf16 v[132:135], a[128:131], v[196:199], 0
    ds_read_b128 v[220:223], v108 offset:17088
    v_mfma_f32_16x16x32_bf16 v[140:143], a[192:195], v[196:199], 0
    v_mov_b32 v65, v113
    s_waitcnt lgkmcnt(5)
    v_mfma_f32_16x16x32_bf16 v[128:131], a[132:135], v[200:203], v[128:131]
    ds_read_b128 v[192:195], v108 offset:256
    v_mfma_f32_16x16x32_bf16 v[136:139], a[196:199], v[200:203], v[136:139]
    v_mov_b32 v66, v114
    s_waitcnt lgkmcnt(5)
    v_mfma_f32_16x16x32_bf16 v[132:135], a[132:135], v[204:207], v[132:135]
    ds_read_b128 v[196:199], v108 offset:17152
    v_mfma_f32_16x16x32_bf16 v[140:143], a[196:199], v[204:207], v[140:143]
    v_mov_b32 v67, v115
    s_waitcnt lgkmcnt(5)
    v_mfma_f32_16x16x32_bf16 v[128:131], a[136:139], v[208:211], v[128:131]
    ds_read_b128 v[200:203], v108 offset:320
    v_mfma_f32_16x16x32_bf16 v[136:139], a[200:203], v[208:211], v[136:139]
    v_mov_b32 v68, v116
    s_waitcnt lgkmcnt(5)
    v_mfma_f32_16x16x32_bf16 v[132:135], a[136:139], v[212:215], v[132:135]
    ds_read_b128 v[204:207], v108 offset:17216
    v_mfma_f32_16x16x32_bf16 v[140:143], a[200:203], v[212:215], v[140:143]
    v_mov_b32 v69, v117
    s_waitcnt lgkmcnt(5)
    v_mfma_f32_16x16x32_bf16 v[128:131], a[140:143], v[216:219], v[128:131]
    ds_read_b128 v[208:211], v108 offset:384
    v_mfma_f32_16x16x32_bf16 v[136:139], a[204:207], v[216:219], v[136:139]
    v_mov_b32 v70, v118
    s_waitcnt lgkmcnt(5)
    v_mfma_f32_16x16x32_bf16 v[132:135], a[140:143], v[220:223], v[132:135]
    ds_read_b128 v[212:215], v108 offset:17280
    v_mfma_f32_16x16x32_bf16 v[140:143], a[204:207], v[220:223], v[140:143]
    v_mov_b32 v71, v119
    s_waitcnt lgkmcnt(5)
    v_mfma_f32_16x16x32_bf16 v[128:131], a[144:147], v[192:195], v[128:131]
    ds_read_b128 v[216:219], v108 offset:448
    v_mfma_f32_16x16x32_bf16 v[136:139], a[208:211], v[192:195], v[136:139]
    s_waitcnt lgkmcnt(5)
    v_mfma_f32_16x16x32_bf16 v[132:135], a[144:147], v[196:199], v[132:135]
    ds_read_b128 v[220:223], v108 offset:17344
    v_mfma_f32_16x16x32_bf16 v[140:143], a[208:211], v[196:199], v[140:143]
    s_waitcnt lgkmcnt(5)
    v_mfma_f32_16x16x32_bf16 v[128:131], a[148:151], v[200:203], v[128:131]
    ds_read_b128 v[192:195], v108 offset:512
    v_mfma_f32_16x16x32_bf16 v[136:139], a[212:215], v[200:203], v[136:139]
    s_waitcnt lgkmcnt(5)
    v_mfma_f32_16x16x32_bf16 v[132:135], a[148:151], v[204:207], v[132:135]
    ds_read_b128 v[196:199], v108 offset:17408
    v_mfma_f32_16x16x32_bf16 v[140:143], a[212:215], v[204:207], v[140:143]
    s_waitcnt lgkmcnt(5)
    v_mfma_f32_16x16x32_bf16 v[128:131], a[152:155], v[208:211], v[128:131]
    ds_read_b128 v[200:203], v108 offset:576
    v_mfma_f32_16x16x32_bf16 v[136:139], a[216:219], v[208:211], v[136:139]
    s_waitcnt lgkmcnt(5)
    v_mfma_f32_16x16x32_bf16 v[132:135], a[152:155], v[212:215], v[132:135]
    ds_read_b128 v[204:207], v108 offset:17472
    v_mfma_f32_16x16x32_bf16 v[140:143], a[216:219], v[212:215], v[140:143]
    s_waitcnt lgkmcnt(5)
    v_mfma_f32_16x16x32_bf16 v[128:131], a[156:159], v[216:219], v[128:131]
    ds_read_b128 v[208:211], v108 offset:640
    v_mfma_f32_16x16x32_bf16 v[136:139], a[220:223], v[216:219], v[136:139]
    s_waitcnt lgkmcnt(5)
    v_mfma_f32_16x16x32_bf16 v[132:135], a[156:159], v[220:223], v[132:135]
    ds_read_b128 v[212:215], v108 offset:17536
    v_mfma_f32_16x16x32_bf16 v[140:143], a[220:223], v[220:223], v[140:143]
    s_waitcnt lgkmcnt(5)
    v_mfma_f32_16x16x32_bf16 v[128:131], a[160:163], v[192:195], v[128:131]
    ds_read_b128 v[216:219], v108 offset:704
    v_mfma_f32_16x16x32_bf16 v[136:139], a[224:227], v[192:195], v[136:139]
    s_waitcnt lgkmcnt(5)
    v_mfma_f32_16x16x32_bf16 v[132:135], a[160:163], v[196:199], v[132:135]
    ds_read_b128 v[220:223], v108 offset:17600
    v_mfma_f32_16x16x32_bf16 v[140:143], a[224:227], v[196:199], v[140:143]
    s_waitcnt lgkmcnt(5)
    v_mfma_f32_16x16x32_bf16 v[128:131], a[164:167], v[200:203], v[128:131]
    ds_read_b128 v[192:195], v108 offset:768
    v_mfma_f32_16x16x32_bf16 v[136:139], a[228:231], v[200:203], v[136:139]
    s_waitcnt lgkmcnt(5)
    v_mfma_f32_16x16x32_bf16 v[132:135], a[164:167], v[204:207], v[132:135]
    ds_read_b128 v[196:199], v108 offset:17664
    v_mfma_f32_16x16x32_bf16 v[140:143], a[228:231], v[204:207], v[140:143]
    s_waitcnt lgkmcnt(5)
    v_mfma_f32_16x16x32_bf16 v[128:131], a[168:171], v[208:211], v[128:131]
    ds_read_b128 v[200:203], v108 offset:832
    v_mfma_f32_16x16x32_bf16 v[136:139], a[232:235], v[208:211], v[136:139]
    s_waitcnt lgkmcnt(5)
    v_mfma_f32_16x16x32_bf16 v[132:135], a[168:171], v[212:215], v[132:135]
    ds_read_b128 v[204:207], v108 offset:17728
    v_mfma_f32_16x16x32_bf16 v[140:143], a[232:235], v[212:215], v[140:143]
    s_waitcnt lgkmcnt(5)
    v_mfma_f32_16x16x32_bf16 v[128:131], a[172:175], v[216:219], v[128:131]
    ds_read_b128 v[208:211], v108 offset:896
    v_mfma_f32_16x16x32_bf16 v[136:139], a[236:239], v[216:219], v[136:139]
    s_waitcnt lgkmcnt(5)
    v_mfma_f32_16x16x32_bf16 v[132:135], a[172:175], v[220:223], v[132:135]
    ds_read_b128 v[212:215], v108 offset:17792
    v_mfma_f32_16x16x32_bf16 v[140:143], a[236:239], v[220:223], v[140:143]
    s_waitcnt lgkmcnt(5)
    v_mfma_f32_16x16x32_bf16 v[128:131], a[176:179], v[192:195], v[128:131]
    ds_read_b128 v[216:219], v108 offset:960
    v_mfma_f32_16x16x32_bf16 v[136:139], a[240:243], v[192:195], v[136:139]
    buffer_load_dwordx4 v[88:91], v105, s[4:7], s40 offen sc1
    s_waitcnt lgkmcnt(5)
    v_mfma_f32_16x16x32_bf16 v[132:135], a[176:179], v[196:199], v[132:135]
    ds_read_b128 v[220:223], v108 offset:17856
    v_mfma_f32_16x16x32_bf16 v[140:143], a[240:243], v[196:199], v[140:143]
    s_waitcnt lgkmcnt(5)
    v_mfma_f32_16x16x32_bf16 v[128:131], a[180:183], v[200:203], v[128:131]
    v_mfma_f32_16x16x32_bf16 v[136:139], a[244:247], v[200:203], v[136:139]
    s_waitcnt lgkmcnt(4)
    v_mfma_f32_16x16x32_bf16 v[132:135], a[180:183], v[204:207], v[132:135]
    v_mfma_f32_16x16x32_bf16 v[140:143], a[244:247], v[204:207], v[140:143]
    s_waitcnt lgkmcnt(3)
    v_mfma_f32_16x16x32_bf16 v[128:131], a[184:187], v[208:211], v[128:131]
    v_mfma_f32_16x16x32_bf16 v[136:139], a[248:251], v[208:211], v[136:139]
    s_waitcnt lgkmcnt(2)
    v_mfma_f32_16x16x32_bf16 v[132:135], a[184:187], v[212:215], v[132:135]
    v_mfma_f32_16x16x32_bf16 v[140:143], a[248:251], v[212:215], v[140:143]
    s_waitcnt lgkmcnt(1)
    v_mfma_f32_16x16x32_bf16 v[128:131], a[188:191], v[216:219], v[128:131]
    v_mfma_f32_16x16x32_bf16 v[136:139], a[252:255], v[216:219], v[136:139]
    s_waitcnt lgkmcnt(0)
    v_mfma_f32_16x16x32_bf16 v[132:135], a[188:191], v[220:223], v[132:135]
    v_mfma_f32_16x16x32_bf16 v[140:143], a[252:255], v[220:223], v[140:143]
    ds_read_b128 v[32:35], v105 offset:33792
    ds_read_b128 v[36:39], v105 offset:34816
    ds_read_b128 v[40:43], v105 offset:35840
    ds_read_b128 v[44:47], v105 offset:36864
    ds_read_b128 v[48:51], v105 offset:37888
    ds_read_b128 v[52:55], v105 offset:38912
    ds_read_b128 v[56:59], v105 offset:39936
    ds_read_b128 v[60:63], v105 offset:40960
    v_cvt_pk_bf16_f32 v192, v128, v136
    v_cvt_pk_bf16_f32 v193, v129, v137
    v_cvt_pk_bf16_f32 v194, v130, v138
    v_cvt_pk_bf16_f32 v195, v131, v139
    ds_write_b128 v110, v[192:195] offset:41984
    v_cvt_pk_bf16_f32 v196, v132, v140
    v_cvt_pk_bf16_f32 v197, v133, v141
    v_cvt_pk_bf16_f32 v198, v134, v142
    v_cvt_pk_bf16_f32 v199, v135, v143
    ds_write_b128 v110, v[196:199] offset:46080
    v_mov_b32 v164, 0x3f803f80
    v_mov_b32 v165, 0x3f803f80
    v_mov_b32 v166, 0x3f803f80
    v_mov_b32 v167, 0x3f803f80
    v_mov_b32 v150, 0
    v_mov_b32 v151, 0
    v_mov_b32 v157, 0
    v_mov_b32 v158, 0
    v_mov_b32 v161, 0
    v_mov_b32 v162, 0
    v_mov_b32 v99, 0xff800000
    s_waitcnt lgkmcnt(0)
    s_barrier
    ds_read_b128 v[0:3], v105 offset:41984
    ds_read_b128 v[4:7], v105 offset:43008
    ds_read_b128 v[8:11], v105 offset:44032
    ds_read_b128 v[12:15], v105 offset:45056
    ds_read_b128 v[16:19], v105 offset:46080
    ds_read_b128 v[20:23], v105 offset:47104
    ds_read_b128 v[24:27], v105 offset:48128
    ds_read_b128 v[28:31], v105 offset:49152
    s_waitcnt lgkmcnt(4)
    v_mfma_f32_16x16x32_bf16 v[128:131], v[32:35], v[0:3], 0
    v_mfma_f32_16x16x32_bf16 v[128:131], v[36:39], v[4:7], v[128:131]
    v_mfma_f32_16x16x32_bf16 v[128:131], v[40:43], v[8:11], v[128:131]
    v_mfma_f32_16x16x32_bf16 v[128:131], v[44:47], v[12:15], v[128:131]
    s_waitcnt lgkmcnt(0)
    v_mfma_f32_16x16x32_bf16 v[136:139], v[48:51], v[16:19], 0
    v_mfma_f32_16x16x32_bf16 v[136:139], v[52:55], v[20:23], v[136:139]
    v_mfma_f32_16x16x32_bf16 v[136:139], v[56:59], v[24:27], v[136:139]
    v_mfma_f32_16x16x32_bf16 v[136:139], v[60:63], v[28:31], v[136:139]
    v_mfma_f32_16x16x32_bf16 v[132:135], v[32:35], v[16:19], 0
    v_mfma_f32_16x16x32_bf16 v[132:135], v[36:39], v[20:23], v[132:135]
    v_mfma_f32_16x16x32_bf16 v[132:135], v[40:43], v[24:27], v[132:135]
    v_mfma_f32_16x16x32_bf16 v[132:135], v[44:47], v[28:31], v[132:135]
    v_cmp_le_i32 vcc, 0, v97
    s_nop 1
    v_cndmask_b32 v128, v99, v128, vcc
    v_cndmask_b32 v136, v99, v136, vcc
    v_cmp_le_i32 vcc, 1, v97
    s_nop 1
    v_cndmask_b32 v129, v99, v129, vcc
    v_cndmask_b32 v137, v99, v137, vcc
    v_cmp_le_i32 vcc, 2, v97
    s_nop 1
    v_cndmask_b32 v130, v99, v130, vcc
    v_cndmask_b32 v138, v99, v138, vcc
    v_cmp_le_i32 vcc, 3, v97
    s_nop 1
    v_cndmask_b32 v131, v99, v131, vcc
    v_cndmask_b32 v139, v99, v139, vcc
L_b2w_115:
    s_waitcnt vmcnt(0)
    v_max3_u32 v98, v88, v89, v90
    v_max_u32 v98, v98, v91
    v_cmp_eq_u32 vcc, -1, v98
    s_cbranch_vccz L_b2w_115_ok
    buffer_load_dwordx4 v[88:91], v105, s[4:7], s40 offen sc1
    s_sub_u32 s48, s48, 1
    s_cbranch_scc0 L_b2w_115
    s_branch W_bail
L_b2w_115_ok:
    ds_write2_b32 v92, v88, v89 offset0:0 offset1:16
    s_cmp_lt_u32 s38, 40
    s_cselect_b32 s47, 2, 4
    s_add_u32 s47, s47, s38
    s_waitcnt lgkmcnt(0)
    s_barrier
    ds_read_b128 v[72:75], v93 offset:0
    ds_read_b128 v[76:79], v93 offset:512
    ds_read_b128 v[80:83], v93 offset:1024
    ds_read_b128 v[84:87], v93 offset:1536
    s_cmp_ge_u32 s47, 64
    s_cbranch_scc1 L_b2nf_116
    s_lshl_b32 s39, s47, 2
    s_add_u32 s39, s39, s36
    s_add_u32 s39, s39, 60817408
L_f1_117:
    buffer_load_dword v107, v106, s[4:7], s39 offen sc1
    s_sub_u32 s48, s48, 1
    s_cbranch_scc1 W_bail
    s_waitcnt vmcnt(0)
    v_cmp_ne_u32 vcc, 1, v107
    s_cbranch_vccz L_f1_117_ok
    s_sleep 8
    s_branch L_f1_117
L_f1_117_ok:
    s_lshl_b32 s39, s47, 15
    s_lshl_b32 s19, s17, 13
    s_add_u32 s39, s39, s19
    s_mul_i32 s44, s17, 8448
    s_add_u32 m0, s44, 0
    s_add_u32 s19, s39, 0
    buffer_load_dwordx4 v105, s[8:11], s19 offen lds
    s_add_u32 m0, s44, 1056
    s_add_u32 s19, s39, 1024
    buffer_load_dwordx4 v105, s[8:11], s19 offen lds
    s_add_u32 m0, s44, 2112
    s_add_u32 s19, s39, 2048
    buffer_load_dwordx4 v105, s[8:11], s19 offen lds
    s_add_u32 m0, s44, 3168
    s_add_u32 s19, s39, 3072
    buffer_load_dwordx4 v105, s[8:11], s19 offen lds
    s_add_u32 m0, s44, 4224
    s_add_u32 s19, s39, 4096
    buffer_load_dwordx4 v105, s[8:11], s19 offen lds
    s_add_u32 m0, s44, 5280
    s_add_u32 s19, s39, 5120
    buffer_load_dwordx4 v105, s[8:11], s19 offen lds
    s_add_u32 m0, s44, 6336
    s_add_u32 s19, s39, 6144
    buffer_load_dwordx4 v105, s[8:11], s19 offen lds
    s_add_u32 m0, s44, 7392
    s_add_u32 s19, s39, 7168
    buffer_load_dwordx4 v105, s[8:11], s19 offen lds
    s_lshl_b32 s39, s47, 5
    s_add_u32 s39, s39, s16
    s_lshl_b32 s39, s39, 14
    s_lshl_b32 s19, s17, 11
    s_add_u32 s39, s39, s19
    s_add_u32 m0, s19, 33792
    s_cmp_lt_u32 s47, 64
    s_cselect_b32 s39, s39, 0x7ff00000
    buffer_load_dwordx4 v105, s[4:7], s39 offen sc1 lds
    buffer_load_dwordx4 v105, s[4:7], s39 offen offset:1024 sc1 lds
    s_add_u32 s39, s39, 8192
    buffer_load_dwordx4 v[112:115], v105, s[4:7], s39 offen sc1
    buffer_load_dwordx4 v[116:119], v105, s[4:7], s39 offen offset:1024 sc1
L_b2nf_116:
    s_waitcnt lgkmcnt(3)
    v_mfma_f32_16x16x32_bf16 v[140:143], v[72:75], v[0:3], 0
    v_mfma_f32_16x16x32_bf16 v[144:147], v[72:75], v[16:19], 0
    s_waitcnt lgkmcnt(2)
    v_mfma_f32_16x16x32_bf16 v[140:143], v[76:79], v[4:7], v[140:143]
    v_mfma_f32_16x16x32_bf16 v[144:147], v[76:79], v[20:23], v[144:147]
    s_waitcnt lgkmcnt(1)
    v_mfma_f32_16x16x32_bf16 v[140:143], v[80:83], v[8:11], v[140:143]
    v_mfma_f32_16x16x32_bf16 v[144:147], v[80:83], v[24:27], v[144:147]
    s_waitcnt lgkmcnt(0)
    v_mfma_f32_16x16x32_bf16 v[140:143], v[84:87], v[12:15], v[140:143]
    v_mfma_f32_16x16x32_bf16 v[144:147], v[84:87], v[28:31], v[144:147]
    s_nop 6
    v_mul_f32 v140, s49, v140
    v_mul_f32 v141, s49, v141
    v_max_f32 v98, v140, v141
    v_max3_f32 v98, v98, v128, v129
    v_max3_f32 v98, v98, v130, v131
    v_mov_b32 v99, v98
    s_nop 1
    v_permlane32_swap_b32 v99, v98
    v_max_f32 v98, v98, v99
    v_mov_b32 v99, v98
    s_nop 1
    v_permlane16_swap_b32 v99, v98
    v_max_f32 v98, v98, v99
    v_sub_f32 v128, v128, v98
    v_sub_f32 v129, v129, v98
    v_sub_f32 v130, v130, v98
    v_sub_f32 v131, v131, v98
    v_sub_f32 v140, v140, v98
    v_sub_f32 v141, v141, v98
    v_exp_f32 v128, v128
    v_exp_f32 v129, v129
    v_exp_f32 v130, v130
    v_exp_f32 v131, v131
    v_exp_f32 v140, v140
    v_exp_f32 v141, v141
    v_cvt_pk_bf16_f32 v148, v128, v129
    v_cvt_pk_bf16_f32 v149, v130, v131
    v_cvt_pk_bf16_f32 v156, v140, v141
    v_cvt_pk_bf16_f32 v159, v140, v141
    v_mfma_f32_16x16x32_bf16 v[168:171], v[164:167], v[148:151], 0
    v_mfma_f32_16x16x32_bf16 v[176:179], v[64:67], v[148:151], 0
    v_mfma_f32_16x16x32_bf16 v[180:183], v[68:71], v[148:151], 0
    v_mfma_f32_16x16x16_bf16 v[168:171], v[164:165], v[156:157], v[168:171]
    v_mfma_f32_16x16x16_bf16 v[176:179], v[90:91], v[156:157], v[176:179]
    v_mfma_f32_16x16x16_bf16 v[180:183], v[90:91], v[158:159], v[180:183]
    v_mul_f32 v144, s49, v144
    v_mul_f32 v145, s49, v145
    v_max_f32 v98, v144, v145
    v_max3_f32 v98, v98, v132, v133
    v_max3_f32 v98, v98, v134, v135
    v_max3_f32 v98, v98, v136, v137
    v_max3_f32 v98, v98, v138, v139
    v_mov_b32 v99, v98
    s_nop 1
    v_permlane32_swap_b32 v99, v98
    v_max_f32 v98, v98, v99
    v_mov_b32 v99, v98
    s_nop 1
    v_permlane16_swap_b32 v99, v98
    v_max_f32 v98, v98, v99
    v_sub_f32 v132, v132, v98
    v_sub_f32 v133, v133, v98
    v_sub_f32 v134, v134, v98
    v_sub_f32 v135, v135, v98
    v_sub_f32 v136, v136, v98
    v_sub_f32 v137, v137, v98
    v_sub_f32 v138, v138, v98
    v_sub_f32 v139, v139, v98
    v_sub_f32 v144, v144, v98
    v_sub_f32 v145, v145, v98
    v_exp_f32 v132, v132
    v_exp_f32 v133, v133
    v_exp_f32 v134, v134
    v_exp_f32 v135, v135
    v_exp_f32 v136, v136
    v_exp_f32 v137, v137
    v_exp_f32 v138, v138
    v_exp_f32 v139, v139
    v_exp_f32 v144, v144
    v_exp_f32 v145, v145
    v_cvt_pk_bf16_f32 v152, v132, v133
    v_cvt_pk_bf16_f32 v153, v134, v135
    v_cvt_pk_bf16_f32 v154, v136, v137
    v_cvt_pk_bf16_f32 v155, v138, v139
    v_cvt_pk_bf16_f32 v160, v144, v145
    v_cvt_pk_bf16_f32 v163, v144, v145
    v_mfma_f32_16x16x32_bf16 v[172:175], v[164:167], v[152:155], 0
    v_mfma_f32_16x16x32_bf16 v[184:187], v[64:67], v[152:155], 0
    v_mfma_f32_16x16x32_bf16 v[188:191], v[68:71], v[152:155], 0
    v_mfma_f32_16x16x16_bf16 v[172:175], v[164:165], v[160:161], v[172:175]
    v_mfma_f32_16x16x16_bf16 v[184:187], v[90:91], v[160:161], v[184:187]
    v_mfma_f32_16x16x16_bf16 v[188:191], v[90:91], v[162:163], v[188:191]
    v_rcp_f32 v98, v168
    s_nop 0
    v_mul_f32 v176, v98, v176
    v_mul_f32 v177, v98, v177
    v_mul_f32 v178, v98, v178
    v_mul_f32 v179, v98, v179
    v_mul_f32 v180, v98, v180
    v_mul_f32 v181, v98, v181
    v_mul_f32 v182, v98, v182
    v_mul_f32 v183, v98, v183
    v_cvt_pk_bf16_f32 v192, v176, v177
    v_cvt_pk_bf16_f32 v193, v178, v179
    v_cvt_pk_bf16_f32 v194, v180, v181
    v_cvt_pk_bf16_f32 v195, v182, v183
    ds_write_b128 v110, v[192:195] offset:41984
    v_rcp_f32 v98, v172
    s_nop 0
    v_mul_f32 v184, v98, v184
    v_mul_f32 v185, v98, v185
    v_mul_f32 v186, v98, v186
    v_mul_f32 v187, v98, v187
    v_mul_f32 v188, v98, v188
    v_mul_f32 v189, v98, v189
    v_mul_f32 v190, v98, v190
    v_mul_f32 v191, v98, v191
    v_cvt_pk_bf16_f32 v196, v184, v185
    v_cvt_pk_bf16_f32 v197, v186, v187
    v_cvt_pk_bf16_f32 v198, v188, v189
    v_cvt_pk_bf16_f32 v199, v190, v191
    ds_write_b128 v110, v[196:199] offset:46080
    s_and_b32 s41, s45, 1
    s_lshl_b32 s19, s18, 1
    s_add_u32 s41, s41, s19
    s_lshl_b32 s41, s41, 20
    s_add_u32 s41, s41, 83886080
    s_lshl_b32 s19, s17, 8
    s_add_u32 s41, s41, s19
    s_lshl_b32 s19, s16, 10
    s_add_u32 s42, s41, s19
    s_lshl_b32 s19, s16, 15
    s_add_u32 s41, s41, s19
    s_bfe_u32 s56, s45, 0x10001
    s_waitcnt lgkmcnt(0)
    s_barrier
    ds_read_b128 v[0:3], v105 offset:41984
    ds_read_b128 v[4:7], v105 offset:43008
    ds_read_b128 v[8:11], v105 offset:44032
    ds_read_b128 v[12:15], v105 offset:45056
    ds_read_b128 v[16:19], v105 offset:46080
    ds_read_b128 v[20:23], v105 offset:47104
    ds_read_b128 v[24:27], v105 offset:48128
    ds_read_b128 v[28:31], v105 offset:49152
    s_waitcnt lgkmcnt(4)
    v_mfma_f32_16x16x32_bf16 v[128:131], v[0:3], a[0:3], 0
    v_mfma_f32_16x16x32_bf16 v[132:135], v[0:3], a[16:19], 0
    v_mfma_f32_16x16x32_bf16 v[136:139], v[0:3], a[32:35], 0
    v_mfma_f32_16x16x32_bf16 v[140:143], v[0:3], a[48:51], 0
    v_mfma_f32_16x16x32_bf16 v[144:147], v[0:3], a[64:67], 0
    v_mfma_f32_16x16x32_bf16 v[148:151], v[0:3], a[80:83], 0
    v_mfma_f32_16x16x32_bf16 v[152:155], v[0:3], a[96:99], 0
    v_mfma_f32_16x16x32_bf16 v[156:159], v[0:3], a[112:115], 0
    v_mfma_f32_16x16x32_bf16 v[128:131], v[4:7], a[4:7], v[128:131]
    v_mfma_f32_16x16x32_bf16 v[132:135], v[4:7], a[20:23], v[132:135]
    v_mfma_f32_16x16x32_bf16 v[136:139], v[4:7], a[36:39], v[136:139]
    v_mfma_f32_16x16x32_bf16 v[140:143], v[4:7], a[52:55], v[140:143]
    v_mfma_f32_16x16x32_bf16 v[144:147], v[4:7], a[68:71], v[144:147]
    v_mfma_f32_16x16x32_bf16 v[148:151], v[4:7], a[84:87], v[148:151]
    v_mfma_f32_16x16x32_bf16 v[152:155], v[4:7], a[100:103], v[152:155]
    v_mfma_f32_16x16x32_bf16 v[156:159], v[4:7], a[116:119], v[156:159]
    v_mfma_f32_16x16x32_bf16 v[128:131], v[8:11], a[8:11], v[128:131]
    v_mfma_f32_16x16x32_bf16 v[132:135], v[8:11], a[24:27], v[132:135]
    v_mfma_f32_16x16x32_bf16 v[136:139], v[8:11], a[40:43], v[136:139]
    v_mfma_f32_16x16x32_bf16 v[140:143], v[8:11], a[56:59], v[140:143]
    v_mfma_f32_16x16x32_bf16 v[144:147], v[8:11], a[72:75], v[144:147]
    v_mfma_f32_16x16x32_bf16 v[148:151], v[8:11], a[88:91], v[148:151]
    v_mfma_f32_16x16x32_bf16 v[152:155], v[8:11], a[104:107], v[152:155]
    v_mfma_f32_16x16x32_bf16 v[156:159], v[8:11], a[120:123], v[156:159]
    v_mfma_f32_16x16x32_bf16 v[128:131], v[12:15], a[12:15], v[128:131]
    v_mfma_f32_16x16x32_bf16 v[132:135], v[12:15], a[28:31], v[132:135]
    v_mfma_f32_16x16x32_bf16 v[136:139], v[12:15], a[44:47], v[136:139]
    v_mfma_f32_16x16x32_bf16 v[140:143], v[12:15], a[60:63], v[140:143]
    v_mfma_f32_16x16x32_bf16 v[144:147], v[12:15], a[76:79], v[144:147]
    v_mfma_f32_16x16x32_bf16 v[148:151], v[12:15], a[92:95], v[148:151]
    v_mfma_f32_16x16x32_bf16 v[152:155], v[12:15], a[108:111], v[152:155]
    v_mfma_f32_16x16x32_bf16 v[156:159], v[12:15], a[124:127], v[156:159]
    s_waitcnt lgkmcnt(0)
    v_mfma_f32_16x16x32_bf16 v[160:163], v[16:19], a[0:3], 0
    v_mfma_f32_16x16x32_bf16 v[164:167], v[16:19], a[16:19], 0
    v_mfma_f32_16x16x32_bf16 v[168:171], v[16:19], a[32:35], 0
    v_mfma_f32_16x16x32_bf16 v[172:175], v[16:19], a[48:51], 0
    v_mfma_f32_16x16x32_bf16 v[176:179], v[16:19], a[64:67], 0
    v_mfma_f32_16x16x32_bf16 v[180:183], v[16:19], a[80:83], 0
    v_mfma_f32_16x16x32_bf16 v[184:187], v[16:19], a[96:99], 0
    v_mfma_f32_16x16x32_bf16 v[188:191], v[16:19], a[112:115], 0
    v_cvt_pk_bf16_f32 v32, v128, v132
    v_mfma_f32_16x16x32_bf16 v[160:163], v[20:23], a[4:7], v[160:163]
    v_cvt_pk_bf16_f32 v33, v136, v140
    v_mfma_f32_16x16x32_bf16 v[164:167], v[20:23], a[20:23], v[164:167]
    v_cvt_pk_bf16_f32 v34, v144, v148
    v_mfma_f32_16x16x32_bf16 v[168:171], v[20:23], a[36:39], v[168:171]
    v_cvt_pk_bf16_f32 v35, v152, v156
    v_mfma_f32_16x16x32_bf16 v[172:175], v[20:23], a[52:55], v[172:175]
    v_and_or_b32 v35, v35, -2, s56
    v_mfma_f32_16x16x32_bf16 v[176:179], v[20:23], a[68:71], v[176:179]
    s_add_u32 s19, s42, 0
    buffer_store_dwordx4 v[32:35], v94, s[4:7], s19 offen
    v_mfma_f32_16x16x32_bf16 v[180:183], v[20:23], a[84:87], v[180:183]
    v_cvt_pk_bf16_f32 v36, v129, v133
    v_mfma_f32_16x16x32_bf16 v[184:187], v[20:23], a[100:103], v[184:187]
    v_cvt_pk_bf16_f32 v37, v137, v141
    v_mfma_f32_16x16x32_bf16 v[188:191], v[20:23], a[116:119], v[188:191]
    v_cvt_pk_bf16_f32 v38, v145, v149
    v_mfma_f32_16x16x32_bf16 v[160:163], v[24:27], a[8:11], v[160:163]
    v_cvt_pk_bf16_f32 v39, v153, v157
    v_mfma_f32_16x16x32_bf16 v[164:167], v[24:27], a[24:27], v[164:167]
    v_and_or_b32 v39, v39, -2, s56
    v_mfma_f32_16x16x32_bf16 v[168:171], v[24:27], a[40:43], v[168:171]
    s_add_u32 s19, s42, 32768
    buffer_store_dwordx4 v[36:39], v94, s[4:7], s19 offen
    v_mfma_f32_16x16x32_bf16 v[172:175], v[24:27], a[56:59], v[172:175]
    v_cvt_pk_bf16_f32 v40, v130, v134
    v_mfma_f32_16x16x32_bf16 v[176:179], v[24:27], a[72:75], v[176:179]
    v_cvt_pk_bf16_f32 v41, v138, v142
    v_mfma_f32_16x16x32_bf16 v[180:183], v[24:27], a[88:91], v[180:183]
    v_cvt_pk_bf16_f32 v42, v146, v150
    v_mfma_f32_16x16x32_bf16 v[184:187], v[24:27], a[104:107], v[184:187]
    v_cvt_pk_bf16_f32 v43, v154, v158
    v_mfma_f32_16x16x32_bf16 v[188:191], v[24:27], a[120:123], v[188:191]
    v_and_or_b32 v43, v43, -2, s56
    v_mfma_f32_16x16x32_bf16 v[160:163], v[28:31], a[12:15], v[160:163]
    s_add_u32 s19, s42, 65536
    buffer_store_dwordx4 v[40:43], v94, s[4:7], s19 offen
    v_mfma_f32_16x16x32_bf16 v[164:167], v[28:31], a[28:31], v[164:167]
    v_cvt_pk_bf16_f32 v44, v131, v135
    v_mfma_f32_16x16x32_bf16 v[168:171], v[28:31], a[44:47], v[168:171]
    v_cvt_pk_bf16_f32 v45, v139, v143
    v_mfma_f32_16x16x32_bf16 v[172:175], v[28:31], a[60:63], v[172:175]
    v_cvt_pk_bf16_f32 v46, v147, v151
    v_mfma_f32_16x16x32_bf16 v[176:179], v[28:31], a[76:79], v[176:179]
    v_cvt_pk_bf16_f32 v47, v155, v159
    v_mfma_f32_16x16x32_bf16 v[180:183], v[28:31], a[92:95], v[180:183]
    v_and_or_b32 v47, v47, -2, s56
    v_mfma_f32_16x16x32_bf16 v[184:187], v[28:31], a[108:111], v[184:187]
    s_add_u32 s19, s42, 98304
    buffer_store_dwordx4 v[44:47], v94, s[4:7], s19 offen
    v_mfma_f32_16x16x32_bf16 v[188:191], v[28:31], a[124:127], v[188:191]
    v_cvt_pk_bf16_f32 v48, v160, v164
    v_cvt_pk_bf16_f32 v49, v168, v172
    s_nop 0
    v_cvt_pk_bf16_f32 v50, v176, v180
    s_nop 3
    v_cvt_pk_bf16_f32 v51, v184, v188
    v_and_or_b32 v51, v51, -2, s56
    s_add_u32 s19, s42, 524288
    buffer_store_dwordx4 v[48:51], v94, s[4:7], s19 offen
    v_cvt_pk_bf16_f32 v52, v161, v165
    v_cvt_pk_bf16_f32 v53, v169, v173
    v_cvt_pk_bf16_f32 v54, v177, v181
    v_cvt_pk_bf16_f32 v55, v185, v189
    v_and_or_b32 v55, v55, -2, s56
    s_add_u32 s19, s42, 557056
    buffer_store_dwordx4 v[52:55], v94, s[4:7], s19 offen
    v_cvt_pk_bf16_f32 v56, v162, v166
    v_cvt_pk_bf16_f32 v57, v170, v174
    v_cvt_pk_bf16_f32 v58, v178, v182
    v_cvt_pk_bf16_f32 v59, v186, v190
    v_and_or_b32 v59, v59, -2, s56
    s_add_u32 s19, s42, 589824
    buffer_store_dwordx4 v[56:59], v94, s[4:7], s19 offen
    v_cvt_pk_bf16_f32 v60, v163, v167
    v_cvt_pk_bf16_f32 v61, v171, v175
    v_cvt_pk_bf16_f32 v62, v179, v183
    v_cvt_pk_bf16_f32 v63, v187, v191
    v_and_or_b32 v63, v63, -2, s56
    s_add_u32 s19, s42, 622592
    buffer_store_dwordx4 v[60:63], v94, s[4:7], s19 offen
    s_lshl_b32 s40, s38, 5
    s_add_u32 s40, s40, s16
    s_lshl_b32 s40, s40, 11
    s_lshl_b32 s19, s17, 8
    s_add_u32 s40, s40, s19
    s_waitcnt vmcnt(0)
L_b2r_118:
    s_mov_b32 s39, s41
    buffer_load_dwordx4 v[0:3], v95, s[4:7], s39 offen sc1
    s_add_u32 s39, s39, 4096
    buffer_load_dwordx4 v[4:7], v95, s[4:7], s39 offen sc1
    s_add_u32 s39, s39, 4096
    buffer_load_dwordx4 v[8:11], v95, s[4:7], s39 offen sc1
    s_add_u32 s39, s39, 4096
    buffer_load_dwordx4 v[12:15], v95, s[4:7], s39 offen sc1
    s_add_u32 s39, s39, 4096
    buffer_load_dwordx4 v[16:19], v95, s[4:7], s39 offen sc1
    s_add_u32 s39, s39, 4096
    buffer_load_dwordx4 v[20:23], v95, s[4:7], s39 offen sc1
    s_add_u32 s39, s39, 4096
    buffer_load_dwordx4 v[24:27], v95, s[4:7], s39 offen sc1
    s_add_u32 s39, s39, 4096
    buffer_load_dwordx4 v[28:31], v95, s[4:7], s39 offen sc1
    s_add_u32 s39, s39, 4096
    s_sub_u32 s48, s48, 1
    s_cbranch_scc1 W_bail
    s_waitcnt vmcnt(7)
    v_mfma_f32_16x16x32_bf16 v[128:131], v[0:3], v[100:103], 0
    v_xor_b32 v98, s56, v3
    s_waitcnt vmcnt(6)
    v_mfma_f32_16x16x32_bf16 v[128:131], v[4:7], v[100:103], v[128:131]
    v_bitop3_b32 v98, s56, v7, v98 bitop3:0xbe
    s_waitcnt vmcnt(5)
    v_mfma_f32_16x16x32_bf16 v[128:131], v[8:11], v[100:103], v[128:131]
    v_bitop3_b32 v98, s56, v11, v98 bitop3:0xbe
    s_waitcnt vmcnt(4)
    v_mfma_f32_16x16x32_bf16 v[128:131], v[12:15], v[100:103], v[128:131]
    v_bitop3_b32 v98, s56, v15, v98 bitop3:0xbe
    s_waitcnt vmcnt(3)
    v_mfma_f32_16x16x32_bf16 v[128:131], v[16:19], v[100:103], v[128:131]
    v_bitop3_b32 v98, s56, v19, v98 bitop3:0xbe
    s_waitcnt vmcnt(2)
    v_mfma_f32_16x16x32_bf16 v[128:131], v[20:23], v[100:103], v[128:131]
    v_bitop3_b32 v98, s56, v23, v98 bitop3:0xbe
    s_waitcnt vmcnt(1)
    v_mfma_f32_16x16x32_bf16 v[128:131], v[24:27], v[100:103], v[128:131]
    v_bitop3_b32 v98, s56, v27, v98 bitop3:0xbe
    s_waitcnt vmcnt(0)
    v_mfma_f32_16x16x32_bf16 v[128:131], v[28:31], v[100:103], v[128:131]
    v_bitop3_b32 v98, s56, v31, v98 bitop3:0xbe
    v_and_b32 v98, 1, v98
    v_cmp_ne_u32 vcc, 0, v98
    s_cbranch_vccnz L_b2r_118
    s_nop 3
    v_cvt_pk_bf16_f32 v128, v128, v129
    v_cvt_pk_bf16_f32 v129, v130, v131
    s_mov_b64 exec, s[50:51]
    buffer_store_dwordx2 v[128:129], v96, s[12:15], s40 offen offset:1024
    s_mov_b64 exec, -1
    s_add_u32 s45, s45, 1
    s_mov_b32 s38, s47
    s_cmp_lt_u32 s38, 64
    s_cbranch_scc1 L_b2_114
    s_endpgm
W_b2far:
    s_lshl_b32 s41, s18, 21
    s_lshl_b32 s19, s16, 15
    s_add_u32 s41, s41, s19
    s_lshl_b32 s19, s17, 13
    s_add_u32 s41, s41, s19
    s_add_u32 s41, s41, 83886080
    buffer_store_dwordx4 v[8:11], v105, s[4:7], s41 offen offset:0 sc1
    buffer_store_dwordx4 v[8:11], v105, s[4:7], s41 offen offset:1024 sc1
    buffer_store_dwordx4 v[8:11], v105, s[4:7], s41 offen offset:2048 sc1
    buffer_store_dwordx4 v[8:11], v105, s[4:7], s41 offen offset:3072 sc1
    s_add_u32 s41, s41, 4096
    buffer_store_dwordx4 v[8:11], v105, s[4:7], s41 offen offset:0 sc1
    buffer_store_dwordx4 v[8:11], v105, s[4:7], s41 offen offset:1024 sc1
    buffer_store_dwordx4 v[8:11], v105, s[4:7], s41 offen offset:2048 sc1
    buffer_store_dwordx4 v[8:11], v105, s[4:7], s41 offen offset:3072 sc1
    s_add_u32 s41, s41, 1044480
    buffer_store_dwordx4 v[8:11], v105, s[4:7], s41 offen offset:0 sc1
    buffer_store_dwordx4 v[8:11], v105, s[4:7], s41 offen offset:1024 sc1
    buffer_store_dwordx4 v[8:11], v105, s[4:7], s41 offen offset:2048 sc1
    buffer_store_dwordx4 v[8:11], v105, s[4:7], s41 offen offset:3072 sc1
    s_add_u32 s41, s41, 4096
    buffer_store_dwordx4 v[8:11], v105, s[4:7], s41 offen offset:0 sc1
    buffer_store_dwordx4 v[8:11], v105, s[4:7], s41 offen offset:1024 sc1
    buffer_store_dwordx4 v[8:11], v105, s[4:7], s41 offen offset:2048 sc1
    buffer_store_dwordx4 v[8:11], v105, s[4:7], s41 offen offset:3072 sc1
    s_add_u32 s41, s41, 4096
    s_waitcnt vmcnt(0)
    s_barrier
    s_lshl_b32 s43, s18, 7
    s_add_u32 s43, s43, 60825600
    s_lshl_b32 s19, s16, 2
    s_add_u32 s40, s43, s19
    s_cmp_lg_u32 s17, 0
    s_cbranch_scc1 L_flag_119
    v_mov_b32 v107, 1
    s_mov_b64 exec, 1
    buffer_store_dword v107, v106, s[4:7], s40 offen sc1
    s_mov_b64 exec, -1
L_flag_119:
    v_and_b32 v2, 31, v104
    v_lshlrev_b32 v2, 2, v2
L_fo_120:
    buffer_load_dword v107, v2, s[4:7], s43 offen sc1
    s_sub_u32 s48, s48, 1
    s_cbranch_scc1 W_bail
    s_waitcnt vmcnt(0)
    v_cmp_ne_u32 vcc, 1, v107
    s_cbranch_vccz L_fo_120_ok
    s_sleep 2
    s_branch L_fo_120
L_fo_120_ok:
L_b2_121:
    s_barrier
    s_lshl_b32 s40, s38, 5
    s_add_u32 s40, s40, s16
    s_lshl_b32 s19, s17, 10
    s_lshl_b32 s40, s40, 12
    s_add_u32 s40, s40, s19
    s_add_u32 s40, s40, 50331648
    ds_read_b128 v[192:195], v108 offset:0
    ds_read_b128 v[196:199], v108 offset:16896
    ds_read_b128 v[200:203], v108 offset:64
    ds_read_b128 v[204:207], v108 offset:16960
    ds_read_b128 v[208:211], v108 offset:128
    ds_read_b128 v[212:215], v108 offset:17024
    s_waitcnt lgkmcnt(5)
    v_mfma_f32_16x16x32_bf16 v[128:131], a[128:131], v[192:195], 0
    ds_read_b128 v[216:219], v108 offset:192
    v_mfma_f32_16x16x32_bf16 v[136:139], a[192:195], v[192:195], 0
    v_mov_b32 v64, v112
    s_waitcnt lgkmcnt(5)
    v_mfma_f32_16x16x32_bf16 v[132:135], a[128:131], v[196:199], 0
    ds_read_b128 v[220:223], v108 offset:17088
    v_mfma_f32_16x16x32_bf16 v[140:143], a[192:195], v[196:199], 0
    v_mov_b32 v65, v113
    s_waitcnt lgkmcnt(5)
    v_mfma_f32_16x16x32_bf16 v[128:131], a[132:135], v[200:203], v[128:131]
    ds_read_b128 v[192:195], v108 offset:256
    v_mfma_f32_16x16x32_bf16 v[136:139], a[196:199], v[200:203], v[136:139]
    v_mov_b32 v66, v114
    s_waitcnt lgkmcnt(5)
    v_mfma_f32_16x16x32_bf16 v[132:135], a[132:135], v[204:207], v[132:135]
    ds_read_b128 v[196:199], v108 offset:17152
    v_mfma_f32_16x16x32_bf16 v[140:143], a[196:199], v[204:207], v[140:143]
    v_mov_b32 v67, v115
    s_waitcnt lgkmcnt(5)
    v_mfma_f32_16x16x32_bf16 v[128:131], a[136:139], v[208:211], v[128:131]
    ds_read_b128 v[200:203], v108 offset:320
    v_mfma_f32_16x16x32_bf16 v[136:139], a[200:203], v[208:211], v[136:139]
    v_mov_b32 v68, v116
    s_waitcnt lgkmcnt(5)
    v_mfma_f32_16x16x32_bf16 v[132:135], a[136:139], v[212:215], v[132:135]
    ds_read_b128 v[204:207], v108 offset:17216
    v_mfma_f32_16x16x32_bf16 v[140:143], a[200:203], v[212:215], v[140:143]
    v_mov_b32 v69, v117
    s_waitcnt lgkmcnt(5)
    v_mfma_f32_16x16x32_bf16 v[128:131], a[140:143], v[216:219], v[128:131]
    ds_read_b128 v[208:211], v108 offset:384
    v_mfma_f32_16x16x32_bf16 v[136:139], a[204:207], v[216:219], v[136:139]
    v_mov_b32 v70, v118
    s_waitcnt lgkmcnt(5)
    v_mfma_f32_16x16x32_bf16 v[132:135], a[140:143], v[220:223], v[132:135]
    ds_read_b128 v[212:215], v108 offset:17280
    v_mfma_f32_16x16x32_bf16 v[140:143], a[204:207], v[220:223], v[140:143]
    v_mov_b32 v71, v119
    s_waitcnt lgkmcnt(5)
    v_mfma_f32_16x16x32_bf16 v[128:131], a[144:147], v[192:195], v[128:131]
    ds_read_b128 v[216:219], v108 offset:448
    v_mfma_f32_16x16x32_bf16 v[136:139], a[208:211], v[192:195], v[136:139]
    s_waitcnt lgkmcnt(5)
    v_mfma_f32_16x16x32_bf16 v[132:135], a[144:147], v[196:199], v[132:135]
    ds_read_b128 v[220:223], v108 offset:17344
    v_mfma_f32_16x16x32_bf16 v[140:143], a[208:211], v[196:199], v[140:143]
    s_waitcnt lgkmcnt(5)
    v_mfma_f32_16x16x32_bf16 v[128:131], a[148:151], v[200:203], v[128:131]
    ds_read_b128 v[192:195], v108 offset:512
    v_mfma_f32_16x16x32_bf16 v[136:139], a[212:215], v[200:203], v[136:139]
    s_waitcnt lgkmcnt(5)
    v_mfma_f32_16x16x32_bf16 v[132:135], a[148:151], v[204:207], v[132:135]
    ds_read_b128 v[196:199], v108 offset:17408
    v_mfma_f32_16x16x32_bf16 v[140:143], a[212:215], v[204:207], v[140:143]
    s_waitcnt lgkmcnt(5)
    v_mfma_f32_16x16x32_bf16 v[128:131], a[152:155], v[208:211], v[128:131]
    ds_read_b128 v[200:203], v108 offset:576
    v_mfma_f32_16x16x32_bf16 v[136:139], a[216:219], v[208:211], v[136:139]
    s_waitcnt lgkmcnt(5)
    v_mfma_f32_16x16x32_bf16 v[132:135], a[152:155], v[212:215], v[132:135]
    ds_read_b128 v[204:207], v108 offset:17472
    v_mfma_f32_16x16x32_bf16 v[140:143], a[216:219], v[212:215], v[140:143]
    s_waitcnt lgkmcnt(5)
    v_mfma_f32_16x16x32_bf16 v[128:131], a[156:159], v[216:219], v[128:131]
    ds_read_b128 v[208:211], v108 offset:640
    v_mfma_f32_16x16x32_bf16 v[136:139], a[220:223], v[216:219], v[136:139]
    s_waitcnt lgkmcnt(5)
    v_mfma_f32_16x16x32_bf16 v[132:135], a[156:159], v[220:223], v[132:135]
    ds_read_b128 v[212:215], v108 offset:17536
    v_mfma_f32_16x16x32_bf16 v[140:143], a[220:223], v[220:223], v[140:143]
    s_waitcnt lgkmcnt(5)
    v_mfma_f32_16x16x32_bf16 v[128:131], a[160:163], v[192:195], v[128:131]
    ds_read_b128 v[216:219], v108 offset:704
    v_mfma_f32_16x16x32_bf16 v[136:139], a[224:227], v[192:195], v[136:139]
    s_waitcnt lgkmcnt(5)
    v_mfma_f32_16x16x32_bf16 v[132:135], a[160:163], v[196:199], v[132:135]
    ds_read_b128 v[220:223], v108 offset:17600
    v_mfma_f32_16x16x32_bf16 v[140:143], a[224:227], v[196:199], v[140:143]
    s_waitcnt lgkmcnt(5)
    v_mfma_f32_16x16x32_bf16 v[128:131], a[164:167], v[200:203], v[128:131]
    ds_read_b128 v[192:195], v108 offset:768
    v_mfma_f32_16x16x32_bf16 v[136:139], a[228:231], v[200:203], v[136:139]
    s_waitcnt lgkmcnt(5)
    v_mfma_f32_16x16x32_bf16 v[132:135], a[164:167], v[204:207], v[132:135]
    ds_read_b128 v[196:199], v108 offset:17664
    v_mfma_f32_16x16x32_bf16 v[140:143], a[228:231], v[204:207], v[140:143]
    s_waitcnt lgkmcnt(5)
    v_mfma_f32_16x16x32_bf16 v[128:131], a[168:171], v[208:211], v[128:131]
    ds_read_b128 v[200:203], v108 offset:832
    v_mfma_f32_16x16x32_bf16 v[136:139], a[232:235], v[208:211], v[136:139]
    s_waitcnt lgkmcnt(5)
    v_mfma_f32_16x16x32_bf16 v[132:135], a[168:171], v[212:215], v[132:135]
    ds_read_b128 v[204:207], v108 offset:17728
    v_mfma_f32_16x16x32_bf16 v[140:143], a[232:235], v[212:215], v[140:143]
    s_waitcnt lgkmcnt(5)
    v_mfma_f32_16x16x32_bf16 v[128:131], a[172:175], v[216:219], v[128:131]
    ds_read_b128 v[208:211], v108 offset:896
    v_mfma_f32_16x16x32_bf16 v[136:139], a[236:239], v[216:219], v[136:139]
    s_waitcnt lgkmcnt(5)
    v_mfma_f32_16x16x32_bf16 v[132:135], a[172:175], v[220:223], v[132:135]
    ds_read_b128 v[212:215], v108 offset:17792
    v_mfma_f32_16x16x32_bf16 v[140:143], a[236:239], v[220:223], v[140:143]
    s_waitcnt lgkmcnt(5)
    v_mfma_f32_16x16x32_bf16 v[128:131], a[176:179], v[192:195], v[128:131]
    ds_read_b128 v[216:219], v108 offset:960
    v_mfma_f32_16x16x32_bf16 v[136:139], a[240:243], v[192:195], v[136:139]
    buffer_load_dwordx4 v[88:91], v105, s[4:7], s40 offen sc1
    s_waitcnt lgkmcnt(5)
    v_mfma_f32_16x16x32_bf16 v[132:135], a[176:179], v[196:199], v[132:135]
    ds_read_b128 v[220:223], v108 offset:17856
    v_mfma_f32_16x16x32_bf16 v[140:143], a[240:243], v[196:199], v[140:143]
    s_waitcnt lgkmcnt(5)
    v_mfma_f32_16x16x32_bf16 v[128:131], a[180:183], v[200:203], v[128:131]
    v_mfma_f32_16x16x32_bf16 v[136:139], a[244:247], v[200:203], v[136:139]
    s_waitcnt lgkmcnt(4)
    v_mfma_f32_16x16x32_bf16 v[132:135], a[180:183], v[204:207], v[132:135]
    v_mfma_f32_16x16x32_bf16 v[140:143], a[244:247], v[204:207], v[140:143]
    s_waitcnt lgkmcnt(3)
    v_mfma_f32_16x16x32_bf16 v[128:131], a[184:187], v[208:211], v[128:131]
    v_mfma_f32_16x16x32_bf16 v[136:139], a[248:251], v[208:211], v[136:139]
    s_waitcnt lgkmcnt(2)
    v_mfma_f32_16x16x32_bf16 v[132:135], a[184:187], v[212:215], v[132:135]
    v_mfma_f32_16x16x32_bf16 v[140:143], a[248:251], v[212:215], v[140:143]
    s_waitcnt lgkmcnt(1)
    v_mfma_f32_16x16x32_bf16 v[128:131], a[188:191], v[216:219], v[128:131]
    v_mfma_f32_16x16x32_bf16 v[136:139], a[252:255], v[216:219], v[136:139]
    s_waitcnt lgkmcnt(0)
    v_mfma_f32_16x16x32_bf16 v[132:135], a[188:191], v[220:223], v[132:135]
    v_mfma_f32_16x16x32_bf16 v[140:143], a[252:255], v[220:223], v[140:143]
    ds_read_b128 v[32:35], v105 offset:33792
    ds_read_b128 v[36:39], v105 offset:34816
    ds_read_b128 v[40:43], v105 offset:35840
    ds_read_b128 v[44:47], v105 offset:36864
    ds_read_b128 v[48:51], v105 offset:37888
    ds_read_b128 v[52:55], v105 offset:38912
    ds_read_b128 v[56:59], v105 offset:39936
    ds_read_b128 v[60:63], v105 offset:40960
    v_cvt_pk_bf16_f32 v192, v128, v136
    v_cvt_pk_bf16_f32 v193, v129, v137
    v_cvt_pk_bf16_f32 v194, v130, v138
    v_cvt_pk_bf16_f32 v195, v131, v139
    ds_write_b128 v110, v[192:195] offset:41984
    v_cvt_pk_bf16_f32 v196, v132, v140
    v_cvt_pk_bf16_f32 v197, v133, v141
    v_cvt_pk_bf16_f32 v198, v134, v142
    v_cvt_pk_bf16_f32 v199, v135, v143
    ds_write_b128 v110, v[196:199] offset:46080
    v_mov_b32 v164, 0x3f803f80
    v_mov_b32 v165, 0x3f803f80
    v_mov_b32 v166, 0x3f803f80
    v_mov_b32 v167, 0x3f803f80
    v_mov_b32 v150, 0
    v_mov_b32 v151, 0
    v_mov_b32 v157, 0
    v_mov_b32 v158, 0
    v_mov_b32 v161, 0
    v_mov_b32 v162, 0
    v_mov_b32 v99, 0xff800000
    s_waitcnt lgkmcnt(0)
    s_barrier
    ds_read_b128 v[0:3], v105 offset:41984
    ds_read_b128 v[4:7], v105 offset:43008
    ds_read_b128 v[8:11], v105 offset:44032
    ds_read_b128 v[12:15], v105 offset:45056
    ds_read_b128 v[16:19], v105 offset:46080
    ds_read_b128 v[20:23], v105 offset:47104
    ds_read_b128 v[24:27], v105 offset:48128
    ds_read_b128 v[28:31], v105 offset:49152
    s_waitcnt lgkmcnt(4)
    v_mfma_f32_16x16x32_bf16 v[128:131], v[32:35], v[0:3], 0
    v_mfma_f32_16x16x32_bf16 v[128:131], v[36:39], v[4:7], v[128:131]
    v_mfma_f32_16x16x32_bf16 v[128:131], v[40:43], v[8:11], v[128:131]
    v_mfma_f32_16x16x32_bf16 v[128:131], v[44:47], v[12:15], v[128:131]
    s_waitcnt lgkmcnt(0)
    v_mfma_f32_16x16x32_bf16 v[136:139], v[48:51], v[16:19], 0
    v_mfma_f32_16x16x32_bf16 v[136:139], v[52:55], v[20:23], v[136:139]
    v_mfma_f32_16x16x32_bf16 v[136:139], v[56:59], v[24:27], v[136:139]
    v_mfma_f32_16x16x32_bf16 v[136:139], v[60:63], v[28:31], v[136:139]
    v_mfma_f32_16x16x32_bf16 v[132:135], v[32:35], v[16:19], 0
    v_mfma_f32_16x16x32_bf16 v[132:135], v[36:39], v[20:23], v[132:135]
    v_mfma_f32_16x16x32_bf16 v[132:135], v[40:43], v[24:27], v[132:135]
    v_mfma_f32_16x16x32_bf16 v[132:135], v[44:47], v[28:31], v[132:135]
    v_cmp_le_i32 vcc, 0, v97
    s_nop 1
    v_cndmask_b32 v128, v99, v128, vcc
    v_cndmask_b32 v136, v99, v136, vcc
    v_cmp_le_i32 vcc, 1, v97
    s_nop 1
    v_cndmask_b32 v129, v99, v129, vcc
    v_cndmask_b32 v137, v99, v137, vcc
    v_cmp_le_i32 vcc, 2, v97
    s_nop 1
    v_cndmask_b32 v130, v99, v130, vcc
    v_cndmask_b32 v138, v99, v138, vcc
    v_cmp_le_i32 vcc, 3, v97
    s_nop 1
    v_cndmask_b32 v131, v99, v131, vcc
    v_cndmask_b32 v139, v99, v139, vcc
L_b2w_122:
    s_waitcnt vmcnt(0)
    v_max3_u32 v98, v88, v89, v90
    v_max_u32 v98, v98, v91
    v_cmp_eq_u32 vcc, -1, v98
    s_cbranch_vccz L_b2w_122_ok
    buffer_load_dwordx4 v[88:91], v105, s[4:7], s40 offen sc1
    s_sub_u32 s48, s48, 1
    s_cbranch_scc0 L_b2w_122
    s_branch W_bail
L_b2w_122_ok:
    ds_write2_b32 v92, v88, v89 offset0:0 offset1:16
    s_cmp_lt_u32 s38, 40
    s_cselect_b32 s47, 2, 4
    s_add_u32 s47, s47, s38
    s_waitcnt lgkmcnt(0)
    s_barrier
    ds_read_b128 v[72:75], v93 offset:0
    ds_read_b128 v[76:79], v93 offset:512
    ds_read_b128 v[80:83], v93 offset:1024
    ds_read_b128 v[84:87], v93 offset:1536
    s_cmp_ge_u32 s47, 64
    s_cbranch_scc1 L_b2nf_123
    s_lshl_b32 s39, s47, 2
    s_add_u32 s39, s39, s36
    s_add_u32 s39, s39, 60817408
L_f1_124:
    buffer_load_dword v107, v106, s[4:7], s39 offen sc1
    s_sub_u32 s48, s48, 1
    s_cbranch_scc1 W_bail
    s_waitcnt vmcnt(0)
    v_cmp_ne_u32 vcc, 1, v107
    s_cbranch_vccz L_f1_124_ok
    s_sleep 8
    s_branch L_f1_124
L_f1_124_ok:
    s_lshl_b32 s39, s47, 15
    s_lshl_b32 s19, s17, 13
    s_add_u32 s39, s39, s19
    s_mul_i32 s44, s17, 8448
    s_add_u32 m0, s44, 0
    s_add_u32 s19, s39, 0
    buffer_load_dwordx4 v105, s[8:11], s19 offen lds
    s_add_u32 m0, s44, 1056
    s_add_u32 s19, s39, 1024
    buffer_load_dwordx4 v105, s[8:11], s19 offen lds
    s_add_u32 m0, s44, 2112
    s_add_u32 s19, s39, 2048
    buffer_load_dwordx4 v105, s[8:11], s19 offen lds
    s_add_u32 m0, s44, 3168
    s_add_u32 s19, s39, 3072
    buffer_load_dwordx4 v105, s[8:11], s19 offen lds
    s_add_u32 m0, s44, 4224
    s_add_u32 s19, s39, 4096
    buffer_load_dwordx4 v105, s[8:11], s19 offen lds
    s_add_u32 m0, s44, 5280
    s_add_u32 s19, s39, 5120
    buffer_load_dwordx4 v105, s[8:11], s19 offen lds
    s_add_u32 m0, s44, 6336
    s_add_u32 s19, s39, 6144
    buffer_load_dwordx4 v105, s[8:11], s19 offen lds
    s_add_u32 m0, s44, 7392
    s_add_u32 s19, s39, 7168
    buffer_load_dwordx4 v105, s[8:11], s19 offen lds
    s_lshl_b32 s39, s47, 5
    s_add_u32 s39, s39, s16
    s_lshl_b32 s39, s39, 14
    s_lshl_b32 s19, s17, 11
    s_add_u32 s39, s39, s19
    s_add_u32 m0, s19, 33792
    s_cmp_lt_u32 s47, 64
    s_cselect_b32 s39, s39, 0x7ff00000
    buffer_load_dwordx4 v105, s[4:7], s39 offen sc1 lds
    buffer_load_dwordx4 v105, s[4:7], s39 offen offset:1024 sc1 lds
    s_add_u32 s39, s39, 8192
    buffer_load_dwordx4 v[112:115], v105, s[4:7], s39 offen sc1
    buffer_load_dwordx4 v[116:119], v105, s[4:7], s39 offen offset:1024 sc1
L_b2nf_123:
    s_waitcnt lgkmcnt(3)
    v_mfma_f32_16x16x32_bf16 v[140:143], v[72:75], v[0:3], 0
    v_mfma_f32_16x16x32_bf16 v[144:147], v[72:75], v[16:19], 0
    s_waitcnt lgkmcnt(2)
    v_mfma_f32_16x16x32_bf16 v[140:143], v[76:79], v[4:7], v[140:143]
    v_mfma_f32_16x16x32_bf16 v[144:147], v[76:79], v[20:23], v[144:147]
    s_waitcnt lgkmcnt(1)
    v_mfma_f32_16x16x32_bf16 v[140:143], v[80:83], v[8:11], v[140:143]
    v_mfma_f32_16x16x32_bf16 v[144:147], v[80:83], v[24:27], v[144:147]
    s_waitcnt lgkmcnt(0)
    v_mfma_f32_16x16x32_bf16 v[140:143], v[84:87], v[12:15], v[140:143]
    v_mfma_f32_16x16x32_bf16 v[144:147], v[84:87], v[28:31], v[144:147]
    s_nop 6
    v_mul_f32 v140, s49, v140
    v_mul_f32 v141, s49, v141
    v_max_f32 v98, v140, v141
    v_max3_f32 v98, v98, v128, v129
    v_max3_f32 v98, v98, v130, v131
    v_mov_b32 v99, v98
    s_nop 1
    v_permlane32_swap_b32 v99, v98
    v_max_f32 v98, v98, v99
    v_mov_b32 v99, v98
    s_nop 1
    v_permlane16_swap_b32 v99, v98
    v_max_f32 v98, v98, v99
    v_sub_f32 v128, v128, v98
    v_sub_f32 v129, v129, v98
    v_sub_f32 v130, v130, v98
    v_sub_f32 v131, v131, v98
    v_sub_f32 v140, v140, v98
    v_sub_f32 v141, v141, v98
    v_exp_f32 v128, v128
    v_exp_f32 v129, v129
    v_exp_f32 v130, v130
    v_exp_f32 v131, v131
    v_exp_f32 v140, v140
    v_exp_f32 v141, v141
    v_cvt_pk_bf16_f32 v148, v128, v129
    v_cvt_pk_bf16_f32 v149, v130, v131
    v_cvt_pk_bf16_f32 v156, v140, v141
    v_cvt_pk_bf16_f32 v159, v140, v141
    v_mfma_f32_16x16x32_bf16 v[168:171], v[164:167], v[148:151], 0
    v_mfma_f32_16x16x32_bf16 v[176:179], v[64:67], v[148:151], 0
    v_mfma_f32_16x16x32_bf16 v[180:183], v[68:71], v[148:151], 0
    v_mfma_f32_16x16x16_bf16 v[168:171], v[164:165], v[156:157], v[168:171]
    v_mfma_f32_16x16x16_bf16 v[176:179], v[90:91], v[156:157], v[176:179]
    v_mfma_f32_16x16x16_bf16 v[180:183], v[90:91], v[158:159], v[180:183]
    v_mul_f32 v144, s49, v144
    v_mul_f32 v145, s49, v145
    v_max_f32 v98, v144, v145
    v_max3_f32 v98, v98, v132, v133
    v_max3_f32 v98, v98, v134, v135
    v_max3_f32 v98, v98, v136, v137
    v_max3_f32 v98, v98, v138, v139
    v_mov_b32 v99, v98
    s_nop 1
    v_permlane32_swap_b32 v99, v98
    v_max_f32 v98, v98, v99
    v_mov_b32 v99, v98
    s_nop 1
    v_permlane16_swap_b32 v99, v98
    v_max_f32 v98, v98, v99
    v_sub_f32 v132, v132, v98
    v_sub_f32 v133, v133, v98
    v_sub_f32 v134, v134, v98
    v_sub_f32 v135, v135, v98
    v_sub_f32 v136, v136, v98
    v_sub_f32 v137, v137, v98
    v_sub_f32 v138, v138, v98
    v_sub_f32 v139, v139, v98
    v_sub_f32 v144, v144, v98
    v_sub_f32 v145, v145, v98
    v_exp_f32 v132, v132
    v_exp_f32 v133, v133
    v_exp_f32 v134, v134
    v_exp_f32 v135, v135
    v_exp_f32 v136, v136
    v_exp_f32 v137, v137
    v_exp_f32 v138, v138
    v_exp_f32 v139, v139
    v_exp_f32 v144, v144
    v_exp_f32 v145, v145
    v_cvt_pk_bf16_f32 v152, v132, v133
    v_cvt_pk_bf16_f32 v153, v134, v135
    v_cvt_pk_bf16_f32 v154, v136, v137
    v_cvt_pk_bf16_f32 v155, v138, v139
    v_cvt_pk_bf16_f32 v160, v144, v145
    v_cvt_pk_bf16_f32 v163, v144, v145
    v_mfma_f32_16x16x32_bf16 v[172:175], v[164:167], v[152:155], 0
    v_mfma_f32_16x16x32_bf16 v[184:187], v[64:67], v[152:155], 0
    v_mfma_f32_16x16x32_bf16 v[188:191], v[68:71], v[152:155], 0
    v_mfma_f32_16x16x16_bf16 v[172:175], v[164:165], v[160:161], v[172:175]
    v_mfma_f32_16x16x16_bf16 v[184:187], v[90:91], v[160:161], v[184:187]
    v_mfma_f32_16x16x16_bf16 v[188:191], v[90:91], v[162:163], v[188:191]
    v_rcp_f32 v98, v168
    s_nop 0
    v_mul_f32 v176, v98, v176
    v_mul_f32 v177, v98, v177
    v_mul_f32 v178, v98, v178
    v_mul_f32 v179, v98, v179
    v_mul_f32 v180, v98, v180
    v_mul_f32 v181, v98, v181
    v_mul_f32 v182, v98, v182
    v_mul_f32 v183, v98, v183
    v_cvt_pk_bf16_f32 v192, v176, v177
    v_cvt_pk_bf16_f32 v193, v178, v179
    v_cvt_pk_bf16_f32 v194, v180, v181
    v_cvt_pk_bf16_f32 v195, v182, v183
    ds_write_b128 v110, v[192:195] offset:41984
    v_rcp_f32 v98, v172
    s_nop 0
    v_mul_f32 v184, v98, v184
    v_mul_f32 v185, v98, v185
    v_mul_f32 v186, v98, v186
    v_mul_f32 v187, v98, v187
    v_mul_f32 v188, v98, v188
    v_mul_f32 v189, v98, v189
    v_mul_f32 v190, v98, v190
    v_mul_f32 v191, v98, v191
    v_cvt_pk_bf16_f32 v196, v184, v185
    v_cvt_pk_bf16_f32 v197, v186, v187
    v_cvt_pk_bf16_f32 v198, v188, v189
    v_cvt_pk_bf16_f32 v199, v190, v191
    ds_write_b128 v110, v[196:199] offset:46080
    s_and_b32 s41, s45, 1
    s_lshl_b32 s19, s18, 1
    s_add_u32 s41, s41, s19
    s_lshl_b32 s41, s41, 20
    s_add_u32 s41, s41, 83886080
    s_lshl_b32 s19, s17, 8
    s_add_u32 s41, s41, s19
    s_lshl_b32 s19, s16, 10
    s_add_u32 s42, s41, s19
    s_lshl_b32 s19, s16, 15
    s_add_u32 s41, s41, s19
    s_bfe_u32 s56, s45, 0x10001
    s_waitcnt lgkmcnt(0)
    s_barrier
    ds_read_b128 v[0:3], v105 offset:41984
    ds_read_b128 v[4:7], v105 offset:43008
    ds_read_b128 v[8:11], v105 offset:44032
    ds_read_b128 v[12:15], v105 offset:45056
    ds_read_b128 v[16:19], v105 offset:46080
    ds_read_b128 v[20:23], v105 offset:47104
    ds_read_b128 v[24:27], v105 offset:48128
    ds_read_b128 v[28:31], v105 offset:49152
    s_waitcnt lgkmcnt(4)
    v_mfma_f32_16x16x32_bf16 v[128:131], v[0:3], a[0:3], 0
    v_mfma_f32_16x16x32_bf16 v[132:135], v[0:3], a[16:19], 0
    v_mfma_f32_16x16x32_bf16 v[136:139], v[0:3], a[32:35], 0
    v_mfma_f32_16x16x32_bf16 v[140:143], v[0:3], a[48:51], 0
    v_mfma_f32_16x16x32_bf16 v[144:147], v[0:3], a[64:67], 0
    v_mfma_f32_16x16x32_bf16 v[148:151], v[0:3], a[80:83], 0
    v_mfma_f32_16x16x32_bf16 v[152:155], v[0:3], a[96:99], 0
    v_mfma_f32_16x16x32_bf16 v[156:159], v[0:3], a[112:115], 0
    v_mfma_f32_16x16x32_bf16 v[128:131], v[4:7], a[4:7], v[128:131]
    v_mfma_f32_16x16x32_bf16 v[132:135], v[4:7], a[20:23], v[132:135]
    v_mfma_f32_16x16x32_bf16 v[136:139], v[4:7], a[36:39], v[136:139]
    v_mfma_f32_16x16x32_bf16 v[140:143], v[4:7], a[52:55], v[140:143]
    v_mfma_f32_16x16x32_bf16 v[144:147], v[4:7], a[68:71], v[144:147]
    v_mfma_f32_16x16x32_bf16 v[148:151], v[4:7], a[84:87], v[148:151]
    v_mfma_f32_16x16x32_bf16 v[152:155], v[4:7], a[100:103], v[152:155]
    v_mfma_f32_16x16x32_bf16 v[156:159], v[4:7], a[116:119], v[156:159]
    v_mfma_f32_16x16x32_bf16 v[128:131], v[8:11], a[8:11], v[128:131]
    v_mfma_f32_16x16x32_bf16 v[132:135], v[8:11], a[24:27], v[132:135]
    v_mfma_f32_16x16x32_bf16 v[136:139], v[8:11], a[40:43], v[136:139]
    v_mfma_f32_16x16x32_bf16 v[140:143], v[8:11], a[56:59], v[140:143]
    v_mfma_f32_16x16x32_bf16 v[144:147], v[8:11], a[72:75], v[144:147]
    v_mfma_f32_16x16x32_bf16 v[148:151], v[8:11], a[88:91], v[148:151]
    v_mfma_f32_16x16x32_bf16 v[152:155], v[8:11], a[104:107], v[152:155]
    v_mfma_f32_16x16x32_bf16 v[156:159], v[8:11], a[120:123], v[156:159]
    v_mfma_f32_16x16x32_bf16 v[128:131], v[12:15], a[12:15], v[128:131]
    v_mfma_f32_16x16x32_bf16 v[132:135], v[12:15], a[28:31], v[132:135]
    v_mfma_f32_16x16x32_bf16 v[136:139], v[12:15], a[44:47], v[136:139]
    v_mfma_f32_16x16x32_bf16 v[140:143], v[12:15], a[60:63], v[140:143]
    v_mfma_f32_16x16x32_bf16 v[144:147], v[12:15], a[76:79], v[144:147]
    v_mfma_f32_16x16x32_bf16 v[148:151], v[12:15], a[92:95], v[148:151]
    v_mfma_f32_16x16x32_bf16 v[152:155], v[12:15], a[108:111], v[152:155]
    v_mfma_f32_16x16x32_bf16 v[156:159], v[12:15], a[124:127], v[156:159]
    s_waitcnt lgkmcnt(0)
    v_mfma_f32_16x16x32_bf16 v[160:163], v[16:19], a[0:3], 0
    v_mfma_f32_16x16x32_bf16 v[164:167], v[16:19], a[16:19], 0
    v_mfma_f32_16x16x32_bf16 v[168:171], v[16:19], a[32:35], 0
    v_mfma_f32_16x16x32_bf16 v[172:175], v[16:19], a[48:51], 0
    v_mfma_f32_16x16x32_bf16 v[176:179], v[16:19], a[64:67], 0
    v_mfma_f32_16x16x32_bf16 v[180:183], v[16:19], a[80:83], 0
    v_mfma_f32_16x16x32_bf16 v[184:187], v[16:19], a[96:99], 0
    v_mfma_f32_16x16x32_bf16 v[188:191], v[16:19], a[112:115], 0
    v_cvt_pk_bf16_f32 v32, v128, v132
    v_mfma_f32_16x16x32_bf16 v[160:163], v[20:23], a[4:7], v[160:163]
    v_cvt_pk_bf16_f32 v33, v136, v140
    v_mfma_f32_16x16x32_bf16 v[164:167], v[20:23], a[20:23], v[164:167]
    v_cvt_pk_bf16_f32 v34, v144, v148
    v_mfma_f32_16x16x32_bf16 v[168:171], v[20:23], a[36:39], v[168:171]
    v_cvt_pk_bf16_f32 v35, v152, v156
    v_mfma_f32_16x16x32_bf16 v[172:175], v[20:23], a[52:55], v[172:175]
    v_and_or_b32 v35, v35, -2, s56
    v_mfma_f32_16x16x32_bf16 v[176:179], v[20:23], a[68:71], v[176:179]
    s_add_u32 s19, s42, 0
    buffer_store_dwordx4 v[32:35], v94, s[4:7], s19 offen sc1
    v_mfma_f32_16x16x32_bf16 v[180:183], v[20:23], a[84:87], v[180:183]
    v_cvt_pk_bf16_f32 v36, v129, v133
    v_mfma_f32_16x16x32_bf16 v[184:187], v[20:23], a[100:103], v[184:187]
    v_cvt_pk_bf16_f32 v37, v137, v141
    v_mfma_f32_16x16x32_bf16 v[188:191], v[20:23], a[116:119], v[188:191]
    v_cvt_pk_bf16_f32 v38, v145, v149
    v_mfma_f32_16x16x32_bf16 v[160:163], v[24:27], a[8:11], v[160:163]
    v_cvt_pk_bf16_f32 v39, v153, v157
    v_mfma_f32_16x16x32_bf16 v[164:167], v[24:27], a[24:27], v[164:167]
    v_and_or_b32 v39, v39, -2, s56
    v_mfma_f32_16x16x32_bf16 v[168:171], v[24:27], a[40:43], v[168:171]
    s_add_u32 s19, s42, 32768
    buffer_store_dwordx4 v[36:39], v94, s[4:7], s19 offen sc1
    v_mfma_f32_16x16x32_bf16 v[172:175], v[24:27], a[56:59], v[172:175]
    v_cvt_pk_bf16_f32 v40, v130, v134
    v_mfma_f32_16x16x32_bf16 v[176:179], v[24:27], a[72:75], v[176:179]
    v_cvt_pk_bf16_f32 v41, v138, v142
    v_mfma_f32_16x16x32_bf16 v[180:183], v[24:27], a[88:91], v[180:183]
    v_cvt_pk_bf16_f32 v42, v146, v150
    v_mfma_f32_16x16x32_bf16 v[184:187], v[24:27], a[104:107], v[184:187]
    v_cvt_pk_bf16_f32 v43, v154, v158
    v_mfma_f32_16x16x32_bf16 v[188:191], v[24:27], a[120:123], v[188:191]
    v_and_or_b32 v43, v43, -2, s56
    v_mfma_f32_16x16x32_bf16 v[160:163], v[28:31], a[12:15], v[160:163]
    s_add_u32 s19, s42, 65536
    buffer_store_dwordx4 v[40:43], v94, s[4:7], s19 offen sc1
    v_mfma_f32_16x16x32_bf16 v[164:167], v[28:31], a[28:31], v[164:167]
    v_cvt_pk_bf16_f32 v44, v131, v135
    v_mfma_f32_16x16x32_bf16 v[168:171], v[28:31], a[44:47], v[168:171]
    v_cvt_pk_bf16_f32 v45, v139, v143
    v_mfma_f32_16x16x32_bf16 v[172:175], v[28:31], a[60:63], v[172:175]
    v_cvt_pk_bf16_f32 v46, v147, v151
    v_mfma_f32_16x16x32_bf16 v[176:179], v[28:31], a[76:79], v[176:179]
    v_cvt_pk_bf16_f32 v47, v155, v159
    v_mfma_f32_16x16x32_bf16 v[180:183], v[28:31], a[92:95], v[180:183]
    v_and_or_b32 v47, v47, -2, s56
    v_mfma_f32_16x16x32_bf16 v[184:187], v[28:31], a[108:111], v[184:187]
    s_add_u32 s19, s42, 98304
    buffer_store_dwordx4 v[44:47], v94, s[4:7], s19 offen sc1
    v_mfma_f32_16x16x32_bf16 v[188:191], v[28:31], a[124:127], v[188:191]
    v_cvt_pk_bf16_f32 v48, v160, v164
    v_cvt_pk_bf16_f32 v49, v168, v172
    s_nop 0
    v_cvt_pk_bf16_f32 v50, v176, v180
    s_nop 3
    v_cvt_pk_bf16_f32 v51, v184, v188
    v_and_or_b32 v51, v51, -2, s56
    s_add_u32 s19, s42, 524288
    buffer_store_dwordx4 v[48:51], v94, s[4:7], s19 offen sc1
    v_cvt_pk_bf16_f32 v52, v161, v165
    v_cvt_pk_bf16_f32 v53, v169, v173
    v_cvt_pk_bf16_f32 v54, v177, v181
    v_cvt_pk_bf16_f32 v55, v185, v189
    v_and_or_b32 v55, v55, -2, s56
    s_add_u32 s19, s42, 557056
    buffer_store_dwordx4 v[52:55], v94, s[4:7], s19 offen sc1
    v_cvt_pk_bf16_f32 v56, v162, v166
    v_cvt_pk_bf16_f32 v57, v170, v174
    v_cvt_pk_bf16_f32 v58, v178, v182
    v_cvt_pk_bf16_f32 v59, v186, v190
    v_and_or_b32 v59, v59, -2, s56
    s_add_u32 s19, s42, 589824
    buffer_store_dwordx4 v[56:59], v94, s[4:7], s19 offen sc1
    v_cvt_pk_bf16_f32 v60, v163, v167
    v_cvt_pk_bf16_f32 v61, v171, v175
    v_cvt_pk_bf16_f32 v62, v179, v183
    v_cvt_pk_bf16_f32 v63, v187, v191
    v_and_or_b32 v63, v63, -2, s56
    s_add_u32 s19, s42, 622592
    buffer_store_dwordx4 v[60:63], v94, s[4:7], s19 offen sc1
    s_lshl_b32 s40, s38, 5
    s_add_u32 s40, s40, s16
    s_lshl_b32 s40, s40, 11
    s_lshl_b32 s19, s17, 8
    s_add_u32 s40, s40, s19
    s_waitcnt vmcnt(0)
L_b2r_125:
    s_mov_b32 s39, s41
    buffer_load_dwordx4 v[0:3], v95, s[4:7], s39 offen sc1
    s_add_u32 s39, s39, 4096
    buffer_load_dwordx4 v[4:7], v95, s[4:7], s39 offen sc1
    s_add_u32 s39, s39, 4096
    buffer_load_dwordx4 v[8:11], v95, s[4:7], s39 offen sc1
    s_add_u32 s39, s39, 4096
    buffer_load_dwordx4 v[12:15], v95, s[4:7], s39 offen sc1
    s_add_u32 s39, s39, 4096
    buffer_load_dwordx4 v[16:19], v95, s[4:7], s39 offen sc1
    s_add_u32 s39, s39, 4096
    buffer_load_dwordx4 v[20:23], v95, s[4:7], s39 offen sc1
    s_add_u32 s39, s39, 4096
    buffer_load_dwordx4 v[24:27], v95, s[4:7], s39 offen sc1
    s_add_u32 s39, s39, 4096
    buffer_load_dwordx4 v[28:31], v95, s[4:7], s39 offen sc1
    s_add_u32 s39, s39, 4096
    s_sub_u32 s48, s48, 1
    s_cbranch_scc1 W_bail
    s_waitcnt vmcnt(7)
    v_mfma_f32_16x16x32_bf16 v[128:131], v[0:3], v[100:103], 0
    v_xor_b32 v98, s56, v3
    s_waitcnt vmcnt(6)
    v_mfma_f32_16x16x32_bf16 v[128:131], v[4:7], v[100:103], v[128:131]
    v_bitop3_b32 v98, s56, v7, v98 bitop3:0xbe
    s_waitcnt vmcnt(5)
    v_mfma_f32_16x16x32_bf16 v[128:131], v[8:11], v[100:103], v[128:131]
    v_bitop3_b32 v98, s56, v11, v98 bitop3:0xbe
    s_waitcnt vmcnt(4)
    v_mfma_f32_16x16x32_bf16 v[128:131], v[12:15], v[100:103], v[128:131]
    v_bitop3_b32 v98, s56, v15, v98 bitop3:0xbe
    s_waitcnt vmcnt(3)
    v_mfma_f32_16x16x32_bf16 v[128:131], v[16:19], v[100:103], v[128:131]
    v_bitop3_b32 v98, s56, v19, v98 bitop3:0xbe
    s_waitcnt vmcnt(2)
    v_mfma_f32_16x16x32_bf16 v[128:131], v[20:23], v[100:103], v[128:131]
    v_bitop3_b32 v98, s56, v23, v98 bitop3:0xbe
    s_waitcnt vmcnt(1)
    v_mfma_f32_16x16x32_bf16 v[128:131], v[24:27], v[100:103], v[128:131]
    v_bitop3_b32 v98, s56, v27, v98 bitop3:0xbe
    s_waitcnt vmcnt(0)
    v_mfma_f32_16x16x32_bf16 v[128:131], v[28:31], v[100:103], v[128:131]
    v_bitop3_b32 v98, s56, v31, v98 bitop3:0xbe
    v_and_b32 v98, 1, v98
    v_cmp_ne_u32 vcc, 0, v98
    s_cbranch_vccnz L_b2r_125
    s_nop 3
    v_cvt_pk_bf16_f32 v128, v128, v129
    v_cvt_pk_bf16_f32 v129, v130, v131
    s_mov_b64 exec, s[50:51]
    buffer_store_dwordx2 v[128:129], v96, s[12:15], s40 offen offset:1024
    s_mov_b64 exec, -1
    s_add_u32 s45, s45, 1
    s_mov_b32 s38, s47
    s_cmp_lt_u32 s38, 64
    s_cbranch_scc1 L_b2_121
W_bail:
    s_endpgm
W_a:
    s_mov_b32 s12, s66
    s_and_b32 s13, s67, 0xffff
    s_mov_b32 s14, 0x180000
    s_mov_b32 s15, 0x20000
    s_mov_b32 s8, s64
    s_and_b32 s9, s65, 0xffff
    s_mov_b32 s10, 0x200000
    s_mov_b32 s11, 0x20000
    s_sub_u32 s57, s18, 4
    v_lshlrev_b32 v2, 4, v0
    s_mul_i32 s39, s16, 49152
    buffer_load_dwordx4 v[8:11], v2, s[12:15], s39 offen
    s_add_u32 s39, s39, 4096
    buffer_load_dwordx4 v[8:11], v2, s[12:15], s39 offen
    s_add_u32 s39, s39, 4096
    buffer_load_dwordx4 v[8:11], v2, s[12:15], s39 offen
    s_add_u32 s39, s39, 4096
    buffer_load_dwordx4 v[8:11], v2, s[12:15], s39 offen
    s_add_u32 s39, s39, 4096
    buffer_load_dwordx4 v[8:11], v2, s[12:15], s39 offen
    s_add_u32 s39, s39, 4096
    buffer_load_dwordx4 v[8:11], v2, s[12:15], s39 offen
    s_add_u32 s39, s39, 4096
    buffer_load_dwordx4 v[8:11], v2, s[12:15], s39 offen
    s_add_u32 s39, s39, 4096
    buffer_load_dwordx4 v[8:11], v2, s[12:15], s39 offen
    s_add_u32 s39, s39, 4096
    buffer_load_dwordx4 v[8:11], v2, s[12:15], s39 offen
    s_add_u32 s39, s39, 4096
    buffer_load_dwordx4 v[8:11], v2, s[12:15], s39 offen
    s_add_u32 s39, s39, 4096
    buffer_load_dwordx4 v[8:11], v2, s[12:15], s39 offen
    s_add_u32 s39, s39, 4096
    buffer_load_dwordx4 v[8:11], v2, s[12:15], s39 offen
    s_add_u32 s39, s39, 4096
    s_mul_i32 s39, s17, 3
    s_add_u32 s39, s39, s57
    s_lshl_b32 s39, s39, 5
    s_add_u32 s39, s39, s16
    s_lshl_b32 s39, s39, 10
    buffer_load_dwordx4 v[8:11], v105, s[8:11], s39 offen
    s_add_u32 s39, s39, 393216
    buffer_load_dwordx4 v[8:11], v105, s[8:11], s39 offen
    s_add_u32 s39, s39, 393216
    buffer_load_dwordx4 v[8:11], v105, s[8:11], s39 offen
    s_add_u32 s39, s39, 393216
    buffer_load_dwordx4 v[8:11], v105, s[8:11], s39 offen
    s_add_u32 s39, s39, 393216
    buffer_load_dwordx4 v[8:11], v105, s[8:11], s39 offen
    s_add_u32 s39, s39, 393216
    buffer_load_dwordx4 v[8:11], v105, s[8:11], s39 offen
    s_add_u32 s39, s39, 393216
    v_lshrrev_b32 v2, 1, v104
    v_mul_u32_u24 v96, 3072, v2
    v_and_b32 v2, 1, v104
    v_lshl_add_u32 v96, v2, 4, v96
    s_lshl_b32 s44, s17, 12
    s_mul_i32 s39, s17, 393216
    s_lshr_b32 s19, s36, 3
    s_add_u32 s39, s39, s19
    s_cmp_lg_u32 s17, 0
    s_cbranch_scc1 L_w0_126
    s_waitcnt vmcnt(18)
    s_lshr_b32 s95, s93, 5
    s_lshl_b32 s95, s95, 2
    s_lshl_b32 s94, 1, s93
    s_atomic_or s94, s[86:87], s95 glc
L_w0_126:
    s_add_u32 m0, s44, 67584
    s_add_u32 s19, s39, 0
    buffer_load_dwordx4 v96, s[12:15], s19 offen lds
    s_add_u32 m0, s44, 68608
    s_add_u32 s19, s39, 98304
    buffer_load_dwordx4 v96, s[12:15], s19 offen lds
    s_add_u32 m0, s44, 69632
    s_add_u32 s19, s39, 196608
    buffer_load_dwordx4 v96, s[12:15], s19 offen lds
    s_add_u32 m0, s44, 70656
    s_add_u32 s19, s39, 294912
    buffer_load_dwordx4 v96, s[12:15], s19 offen lds
    s_add_u32 m0, s44, 84096
    s_add_u32 s19, s39, 1024
    buffer_load_dwordx4 v96, s[12:15], s19 offen lds
    s_add_u32 m0, s44, 85120
    s_add_u32 s19, s39, 99328
    buffer_load_dwordx4 v96, s[12:15], s19 offen lds
    s_add_u32 m0, s44, 86144
    s_add_u32 s19, s39, 197632
    buffer_load_dwordx4 v96, s[12:15], s19 offen lds
    s_add_u32 m0, s44, 87168
    s_add_u32 s19, s39, 295936
    buffer_load_dwordx4 v96, s[12:15], s19 offen lds
    s_add_u32 m0, s44, 100608
    s_add_u32 s19, s39, 2048
    buffer_load_dwordx4 v96, s[12:15], s19 offen lds
    s_add_u32 m0, s44, 101632
    s_add_u32 s19, s39, 100352
    buffer_load_dwordx4 v96, s[12:15], s19 offen lds
    s_add_u32 m0, s44, 102656
    s_add_u32 s19, s39, 198656
    buffer_load_dwordx4 v96, s[12:15], s19 offen lds
    s_add_u32 m0, s44, 103680
    s_add_u32 s19, s39, 296960
    buffer_load_dwordx4 v96, s[12:15], s19 offen lds
    s_cmp_lg_u32 s17, 0
    s_cbranch_scc1 L_w0_127
    s_waitcnt lgkmcnt(0)
    v_mov_b32 v97, s94
    ds_write_b32 v106, v97 offset:0
    s_waitcnt lgkmcnt(0)
L_w0_127:
    s_waitcnt vmcnt(0)
    s_barrier
    ds_read_b32 v97, v106 offset:0
    s_waitcnt lgkmcnt(0)
    v_readfirstlane_b32 s19, v97
    s_nop 0
    s_bitcmp1_b32 s19, s93
    s_cbranch_scc1 L_lost
    v_bfe_u32 v2, v104, 4, 1
    v_mul_u32_u24 v0, 16512, v2
    v_lshrrev_b32 v2, 5, v104
    v_lshlrev_b32 v3, 8, v2
    v_and_b32 v4, 15, v104
    v_lshl_add_u32 v3, v4, 3, v3
    v_add_u32 v3, 67584, v3
    v_add_u32 v0, v3, v0
    v_add_u32 v3, 33024, v3
    ds_read_b64_tr_b16 a[0:1], v0 offset:0
    ds_read_b64_tr_b16 a[128:129], v3 offset:0
    ds_read_b64_tr_b16 a[2:3], v0 offset:128
    ds_read_b64_tr_b16 a[130:131], v3 offset:128
    ds_read_b64_tr_b16 a[4:5], v0 offset:512
    ds_read_b64_tr_b16 a[132:133], v3 offset:512
    ds_read_b64_tr_b16 a[6:7], v0 offset:640
    ds_read_b64_tr_b16 a[134:135], v3 offset:640
    ds_read_b64_tr_b16 a[8:9], v0 offset:1024
    ds_read_b64_tr_b16 a[136:137], v3 offset:1024
    ds_read_b64_tr_b16 a[10:11], v0 offset:1152
    ds_read_b64_tr_b16 a[138:139], v3 offset:1152
    ds_read_b64_tr_b16 a[12:13], v0 offset:1536
    ds_read_b64_tr_b16 a[140:141], v3 offset:1536
    ds_read_b64_tr_b16 a[14:15], v0 offset:1664
    ds_read_b64_tr_b16 a[142:143], v3 offset:1664
    ds_read_b64_tr_b16 a[16:17], v0 offset:2048
    ds_read_b64_tr_b16 a[144:145], v3 offset:2048
    ds_read_b64_tr_b16 a[18:19], v0 offset:2176
    ds_read_b64_tr_b16 a[146:147], v3 offset:2176
    ds_read_b64_tr_b16 a[20:21], v0 offset:2560
    ds_read_b64_tr_b16 a[148:149], v3 offset:2560
    ds_read_b64_tr_b16 a[22:23], v0 offset:2688
    ds_read_b64_tr_b16 a[150:151], v3 offset:2688
    ds_read_b64_tr_b16 a[24:25], v0 offset:3072
    ds_read_b64_tr_b16 a[152:153], v3 offset:3072
    ds_read_b64_tr_b16 a[26:27], v0 offset:3200
    ds_read_b64_tr_b16 a[154:155], v3 offset:3200
    ds_read_b64_tr_b16 a[28:29], v0 offset:3584
    ds_read_b64_tr_b16 a[156:157], v3 offset:3584
    ds_read_b64_tr_b16 a[30:31], v0 offset:3712
    ds_read_b64_tr_b16 a[158:159], v3 offset:3712
    ds_read_b64_tr_b16 a[32:33], v0 offset:4096
    ds_read_b64_tr_b16 a[160:161], v3 offset:4096
    ds_read_b64_tr_b16 a[34:35], v0 offset:4224
    ds_read_b64_tr_b16 a[162:163], v3 offset:4224
    ds_read_b64_tr_b16 a[36:37], v0 offset:4608
    ds_read_b64_tr_b16 a[164:165], v3 offset:4608
    ds_read_b64_tr_b16 a[38:39], v0 offset:4736
    ds_read_b64_tr_b16 a[166:167], v3 offset:4736
    ds_read_b64_tr_b16 a[40:41], v0 offset:5120
    ds_read_b64_tr_b16 a[168:169], v3 offset:5120
    ds_read_b64_tr_b16 a[42:43], v0 offset:5248
    ds_read_b64_tr_b16 a[170:171], v3 offset:5248
    ds_read_b64_tr_b16 a[44:45], v0 offset:5632
    ds_read_b64_tr_b16 a[172:173], v3 offset:5632
    ds_read_b64_tr_b16 a[46:47], v0 offset:5760
    ds_read_b64_tr_b16 a[174:175], v3 offset:5760
    ds_read_b64_tr_b16 a[48:49], v0 offset:6144
    ds_read_b64_tr_b16 a[176:177], v3 offset:6144
    ds_read_b64_tr_b16 a[50:51], v0 offset:6272
    ds_read_b64_tr_b16 a[178:179], v3 offset:6272
    ds_read_b64_tr_b16 a[52:53], v0 offset:6656
    ds_read_b64_tr_b16 a[180:181], v3 offset:6656
    ds_read_b64_tr_b16 a[54:55], v0 offset:6784
    ds_read_b64_tr_b16 a[182:183], v3 offset:6784
    ds_read_b64_tr_b16 a[56:57], v0 offset:7168
    ds_read_b64_tr_b16 a[184:185], v3 offset:7168
    ds_read_b64_tr_b16 a[58:59], v0 offset:7296
    ds_read_b64_tr_b16 a[186:187], v3 offset:7296
    ds_read_b64_tr_b16 a[60:61], v0 offset:7680
    ds_read_b64_tr_b16 a[188:189], v3 offset:7680
    ds_read_b64_tr_b16 a[62:63], v0 offset:7808
    ds_read_b64_tr_b16 a[190:191], v3 offset:7808
    ds_read_b64_tr_b16 a[64:65], v0 offset:8192
    ds_read_b64_tr_b16 a[192:193], v3 offset:8192
    ds_read_b64_tr_b16 a[66:67], v0 offset:8320
    ds_read_b64_tr_b16 a[194:195], v3 offset:8320
    ds_read_b64_tr_b16 a[68:69], v0 offset:8704
    ds_read_b64_tr_b16 a[196:197], v3 offset:8704
    ds_read_b64_tr_b16 a[70:71], v0 offset:8832
    ds_read_b64_tr_b16 a[198:199], v3 offset:8832
    ds_read_b64_tr_b16 a[72:73], v0 offset:9216
    ds_read_b64_tr_b16 a[200:201], v3 offset:9216
    ds_read_b64_tr_b16 a[74:75], v0 offset:9344
    ds_read_b64_tr_b16 a[202:203], v3 offset:9344
    ds_read_b64_tr_b16 a[76:77], v0 offset:9728
    ds_read_b64_tr_b16 a[204:205], v3 offset:9728
    ds_read_b64_tr_b16 a[78:79], v0 offset:9856
    ds_read_b64_tr_b16 a[206:207], v3 offset:9856
    ds_read_b64_tr_b16 a[80:81], v0 offset:10240
    ds_read_b64_tr_b16 a[208:209], v3 offset:10240
    ds_read_b64_tr_b16 a[82:83], v0 offset:10368
    ds_read_b64_tr_b16 a[210:211], v3 offset:10368
    ds_read_b64_tr_b16 a[84:85], v0 offset:10752
    ds_read_b64_tr_b16 a[212:213], v3 offset:10752
    ds_read_b64_tr_b16 a[86:87], v0 offset:10880
    ds_read_b64_tr_b16 a[214:215], v3 offset:10880
    ds_read_b64_tr_b16 a[88:89], v0 offset:11264
    ds_read_b64_tr_b16 a[216:217], v3 offset:11264
    ds_read_b64_tr_b16 a[90:91], v0 offset:11392
    ds_read_b64_tr_b16 a[218:219], v3 offset:11392
    ds_read_b64_tr_b16 a[92:93], v0 offset:11776
    ds_read_b64_tr_b16 a[220:221], v3 offset:11776
    ds_read_b64_tr_b16 a[94:95], v0 offset:11904
    ds_read_b64_tr_b16 a[222:223], v3 offset:11904
    ds_read_b64_tr_b16 a[96:97], v0 offset:12288
    ds_read_b64_tr_b16 a[224:225], v3 offset:12288
    ds_read_b64_tr_b16 a[98:99], v0 offset:12416
    ds_read_b64_tr_b16 a[226:227], v3 offset:12416
    ds_read_b64_tr_b16 a[100:101], v0 offset:12800
    ds_read_b64_tr_b16 a[228:229], v3 offset:12800
    ds_read_b64_tr_b16 a[102:103], v0 offset:12928
    ds_read_b64_tr_b16 a[230:231], v3 offset:12928
    ds_read_b64_tr_b16 a[104:105], v0 offset:13312
    ds_read_b64_tr_b16 a[232:233], v3 offset:13312
    ds_read_b64_tr_b16 a[106:107], v0 offset:13440
    ds_read_b64_tr_b16 a[234:235], v3 offset:13440
    ds_read_b64_tr_b16 a[108:109], v0 offset:13824
    ds_read_b64_tr_b16 a[236:237], v3 offset:13824
    ds_read_b64_tr_b16 a[110:111], v0 offset:13952
    ds_read_b64_tr_b16 a[238:239], v3 offset:13952
    ds_read_b64_tr_b16 a[112:113], v0 offset:14336
    ds_read_b64_tr_b16 a[240:241], v3 offset:14336
    ds_read_b64_tr_b16 a[114:115], v0 offset:14464
    ds_read_b64_tr_b16 a[242:243], v3 offset:14464
    ds_read_b64_tr_b16 a[116:117], v0 offset:14848
    ds_read_b64_tr_b16 a[244:245], v3 offset:14848
    ds_read_b64_tr_b16 a[118:119], v0 offset:14976
    ds_read_b64_tr_b16 a[246:247], v3 offset:14976
    ds_read_b64_tr_b16 a[120:121], v0 offset:15360
    ds_read_b64_tr_b16 a[248:249], v3 offset:15360
    ds_read_b64_tr_b16 a[122:123], v0 offset:15488
    ds_read_b64_tr_b16 a[250:251], v3 offset:15488
    ds_read_b64_tr_b16 a[124:125], v0 offset:15872
    ds_read_b64_tr_b16 a[252:253], v3 offset:15872
    ds_read_b64_tr_b16 a[126:127], v0 offset:16000
    ds_read_b64_tr_b16 a[254:255], v3 offset:16000
    s_mov_b32 s8, s64
    s_and_b32 s9, s65, 0xffff
    s_mov_b32 s10, 0x200000
    s_mov_b32 s11, 0x20000
    v_and_b32 v4, 31, v104
    v_mul_u32_u24 v1, 1040, v4
    v_lshl_add_u32 v1, v2, 4, v1
    s_mul_i32 s44, s17, 33280
    s_add_u32 s44, s44, 22528
    v_add_u32 v1, s44, v1
    s_mov_b32 s50, 0xffff0000
    s_mov_b32 s51, 0xffff0000
    s_mov_b32 s42, 0x3eb8aa3b
    s_mov_b32 s45, s17
    s_waitcnt lgkmcnt(0)
    s_barrier
L_a1_128:
    s_mul_i32 s38, s45, 3
    s_add_u32 s38, s38, s57
    s_cmp_ge_u32 s38, 64
    s_cbranch_scc1 L_a1d_129
    s_lshl_b32 s39, s38, 15
    s_add_u32 m0, s44, 0
    s_add_u32 s19, s39, 0
    buffer_load_dwordx4 v105, s[8:11], s19 offen lds
    s_add_u32 m0, s44, 1040
    s_add_u32 s19, s39, 1024
    buffer_load_dwordx4 v105, s[8:11], s19 offen lds
    s_add_u32 m0, s44, 2080
    s_add_u32 s19, s39, 2048
    buffer_load_dwordx4 v105, s[8:11], s19 offen lds
    s_add_u32 m0, s44, 3120
    s_add_u32 s19, s39, 3072
    buffer_load_dwordx4 v105, s[8:11], s19 offen lds
    s_add_u32 m0, s44, 4160
    s_add_u32 s19, s39, 4096
    buffer_load_dwordx4 v105, s[8:11], s19 offen lds
    s_add_u32 m0, s44, 5200
    s_add_u32 s19, s39, 5120
    buffer_load_dwordx4 v105, s[8:11], s19 offen lds
    s_add_u32 m0, s44, 6240
    s_add_u32 s19, s39, 6144
    buffer_load_dwordx4 v105, s[8:11], s19 offen lds
    s_add_u32 m0, s44, 7280
    s_add_u32 s19, s39, 7168
    buffer_load_dwordx4 v105, s[8:11], s19 offen lds
    s_add_u32 m0, s44, 8320
    s_add_u32 s19, s39, 8192
    buffer_load_dwordx4 v105, s[8:11], s19 offen lds
    s_add_u32 m0, s44, 9360
    s_add_u32 s19, s39, 9216
    buffer_load_dwordx4 v105, s[8:11], s19 offen lds
    s_add_u32 m0, s44, 10400
    s_add_u32 s19, s39, 10240
    buffer_load_dwordx4 v105, s[8:11], s19 offen lds
    s_add_u32 m0, s44, 11440
    s_add_u32 s19, s39, 11264
    buffer_load_dwordx4 v105, s[8:11], s19 offen lds
    s_add_u32 m0, s44, 12480
    s_add_u32 s19, s39, 12288
    buffer_load_dwordx4 v105, s[8:11], s19 offen lds
    s_add_u32 m0, s44, 13520
    s_add_u32 s19, s39, 13312
    buffer_load_dwordx4 v105, s[8:11], s19 offen lds
    s_add_u32 m0, s44, 14560
    s_add_u32 s19, s39, 14336
    buffer_load_dwordx4 v105, s[8:11], s19 offen lds
    s_add_u32 m0, s44, 15600
    s_add_u32 s19, s39, 15360
    buffer_load_dwordx4 v105, s[8:11], s19 offen lds
    s_add_u32 m0, s44, 16640
    s_add_u32 s19, s39, 16384
    buffer_load_dwordx4 v105, s[8:11], s19 offen lds
    s_add_u32 m0, s44, 17680
    s_add_u32 s19, s39, 17408
    buffer_load_dwordx4 v105, s[8:11], s19 offen lds
    s_add_u32 m0, s44, 18720
    s_add_u32 s19, s39, 18432
    buffer_load_dwordx4 v105, s[8:11], s19 offen lds
    s_add_u32 m0, s44, 19760
    s_add_u32 s19, s39, 19456
    buffer_load_dwordx4 v105, s[8:11], s19 offen lds
    s_add_u32 m0, s44, 20800
    s_add_u32 s19, s39, 20480
    buffer_load_dwordx4 v105, s[8:11], s19 offen lds
    s_add_u32 m0, s44, 21840
    s_add_u32 s19, s39, 21504
    buffer_load_dwordx4 v105, s[8:11], s19 offen lds
    s_add_u32 m0, s44, 22880
    s_add_u32 s19, s39, 22528
    buffer_load_dwordx4 v105, s[8:11], s19 offen lds
    s_add_u32 m0, s44, 23920
    s_add_u32 s19, s39, 23552
    buffer_load_dwordx4 v105, s[8:11], s19 offen lds
    s_add_u32 m0, s44, 24960
    s_add_u32 s19, s39, 24576
    buffer_load_dwordx4 v105, s[8:11], s19 offen lds
    s_add_u32 m0, s44, 26000
    s_add_u32 s19, s39, 25600
    buffer_load_dwordx4 v105, s[8:11], s19 offen lds
    s_add_u32 m0, s44, 27040
    s_add_u32 s19, s39, 26624
    buffer_load_dwordx4 v105, s[8:11], s19 offen lds
    s_add_u32 m0, s44, 28080
    s_add_u32 s19, s39, 27648
    buffer_load_dwordx4 v105, s[8:11], s19 offen lds
    s_add_u32 m0, s44, 29120
    s_add_u32 s19, s39, 28672
    buffer_load_dwordx4 v105, s[8:11], s19 offen lds
    s_add_u32 m0, s44, 30160
    s_add_u32 s19, s39, 29696
    buffer_load_dwordx4 v105, s[8:11], s19 offen lds
    s_add_u32 m0, s44, 31200
    s_add_u32 s19, s39, 30720
    buffer_load_dwordx4 v105, s[8:11], s19 offen lds
    s_add_u32 m0, s44, 32240
    s_add_u32 s19, s39, 31744
    buffer_load_dwordx4 v105, s[8:11], s19 offen lds
    s_waitcnt vmcnt(0)
    ds_read_b128 v[8:11], v1 offset:0
    ds_read_b128 v[12:15], v1 offset:32
    ds_read_b128 v[16:19], v1 offset:64
    s_waitcnt lgkmcnt(2)
    v_mfma_f32_32x32x16_bf16 v[40:55], a[0:3], v[8:11], 0
    ds_read_b128 v[20:23], v1 offset:96
    v_mfma_f32_32x32x16_bf16 v[56:71], v[8:11], a[128:131], 0
    s_waitcnt lgkmcnt(2)
    v_mfma_f32_32x32x16_bf16 v[40:55], a[4:7], v[12:15], v[40:55]
    ds_read_b128 v[8:11], v1 offset:128
    v_mfma_f32_32x32x16_bf16 v[56:71], v[12:15], a[132:135], v[56:71]
    s_waitcnt lgkmcnt(2)
    v_mfma_f32_32x32x16_bf16 v[40:55], a[8:11], v[16:19], v[40:55]
    ds_read_b128 v[12:15], v1 offset:160
    v_mfma_f32_32x32x16_bf16 v[56:71], v[16:19], a[136:139], v[56:71]
    s_waitcnt lgkmcnt(2)
    v_mfma_f32_32x32x16_bf16 v[40:55], a[12:15], v[20:23], v[40:55]
    ds_read_b128 v[16:19], v1 offset:192
    v_mfma_f32_32x32x16_bf16 v[56:71], v[20:23], a[140:143], v[56:71]
    s_waitcnt lgkmcnt(2)
    v_mfma_f32_32x32x16_bf16 v[40:55], a[16:19], v[8:11], v[40:55]
    ds_read_b128 v[20:23], v1 offset:224
    v_mfma_f32_32x32x16_bf16 v[56:71], v[8:11], a[144:147], v[56:71]
    s_waitcnt lgkmcnt(2)
    v_mfma_f32_32x32x16_bf16 v[40:55], a[20:23], v[12:15], v[40:55]
    ds_read_b128 v[8:11], v1 offset:256
    v_mfma_f32_32x32x16_bf16 v[56:71], v[12:15], a[148:151], v[56:71]
    s_waitcnt lgkmcnt(2)
    v_mfma_f32_32x32x16_bf16 v[40:55], a[24:27], v[16:19], v[40:55]
    ds_read_b128 v[12:15], v1 offset:288
    v_mfma_f32_32x32x16_bf16 v[56:71], v[16:19], a[152:155], v[56:71]
    s_waitcnt lgkmcnt(2)
    v_mfma_f32_32x32x16_bf16 v[40:55], a[28:31], v[20:23], v[40:55]
    ds_read_b128 v[16:19], v1 offset:320
    v_mfma_f32_32x32x16_bf16 v[56:71], v[20:23], a[156:159], v[56:71]
    s_waitcnt lgkmcnt(2)
    v_mfma_f32_32x32x16_bf16 v[40:55], a[32:35], v[8:11], v[40:55]
    ds_read_b128 v[20:23], v1 offset:352
    v_mfma_f32_32x32x16_bf16 v[56:71], v[8:11], a[160:163], v[56:71]
    s_waitcnt lgkmcnt(2)
    v_mfma_f32_32x32x16_bf16 v[40:55], a[36:39], v[12:15], v[40:55]
    ds_read_b128 v[8:11], v1 offset:384
    v_mfma_f32_32x32x16_bf16 v[56:71], v[12:15], a[164:167], v[56:71]
    s_waitcnt lgkmcnt(2)
    v_mfma_f32_32x32x16_bf16 v[40:55], a[40:43], v[16:19], v[40:55]
    ds_read_b128 v[12:15], v1 offset:416
    v_mfma_f32_32x32x16_bf16 v[56:71], v[16:19], a[168:171], v[56:71]
    s_waitcnt lgkmcnt(2)
    v_mfma_f32_32x32x16_bf16 v[40:55], a[44:47], v[20:23], v[40:55]
    ds_read_b128 v[16:19], v1 offset:448
    v_mfma_f32_32x32x16_bf16 v[56:71], v[20:23], a[172:175], v[56:71]
    s_waitcnt lgkmcnt(2)
    v_mfma_f32_32x32x16_bf16 v[40:55], a[48:51], v[8:11], v[40:55]
    ds_read_b128 v[20:23], v1 offset:480
    v_mfma_f32_32x32x16_bf16 v[56:71], v[8:11], a[176:179], v[56:71]
    s_waitcnt lgkmcnt(2)
    v_mfma_f32_32x32x16_bf16 v[40:55], a[52:55], v[12:15], v[40:55]
    ds_read_b128 v[8:11], v1 offset:512
    v_mfma_f32_32x32x16_bf16 v[56:71], v[12:15], a[180:183], v[56:71]
    s_waitcnt lgkmcnt(2)
    v_mfma_f32_32x32x16_bf16 v[40:55], a[56:59], v[16:19], v[40:55]
    ds_read_b128 v[12:15], v1 offset:544
    v_mfma_f32_32x32x16_bf16 v[56:71], v[16:19], a[184:187], v[56:71]
    s_waitcnt lgkmcnt(2)
    v_mfma_f32_32x32x16_bf16 v[40:55], a[60:63], v[20:23], v[40:55]
    ds_read_b128 v[16:19], v1 offset:576
    v_mfma_f32_32x32x16_bf16 v[56:71], v[20:23], a[188:191], v[56:71]
    s_waitcnt lgkmcnt(2)
    v_mfma_f32_32x32x16_bf16 v[40:55], a[64:67], v[8:11], v[40:55]
    ds_read_b128 v[20:23], v1 offset:608
    v_mfma_f32_32x32x16_bf16 v[56:71], v[8:11], a[192:195], v[56:71]
    s_waitcnt lgkmcnt(2)
    v_mfma_f32_32x32x16_bf16 v[40:55], a[68:71], v[12:15], v[40:55]
    ds_read_b128 v[8:11], v1 offset:640
    v_mfma_f32_32x32x16_bf16 v[56:71], v[12:15], a[196:199], v[56:71]
    s_waitcnt lgkmcnt(2)
    v_mfma_f32_32x32x16_bf16 v[40:55], a[72:75], v[16:19], v[40:55]
    ds_read_b128 v[12:15], v1 offset:672
    v_mfma_f32_32x32x16_bf16 v[56:71], v[16:19], a[200:203], v[56:71]
    s_waitcnt lgkmcnt(2)
    v_mfma_f32_32x32x16_bf16 v[40:55], a[76:79], v[20:23], v[40:55]
    ds_read_b128 v[16:19], v1 offset:704
    v_mfma_f32_32x32x16_bf16 v[56:71], v[20:23], a[204:207], v[56:71]
    s_waitcnt lgkmcnt(2)
    v_mfma_f32_32x32x16_bf16 v[40:55], a[80:83], v[8:11], v[40:55]
    ds_read_b128 v[20:23], v1 offset:736
    v_mfma_f32_32x32x16_bf16 v[56:71], v[8:11], a[208:211], v[56:71]
    s_waitcnt lgkmcnt(2)
    v_mfma_f32_32x32x16_bf16 v[40:55], a[84:87], v[12:15], v[40:55]
    ds_read_b128 v[8:11], v1 offset:768
    v_mfma_f32_32x32x16_bf16 v[56:71], v[12:15], a[212:215], v[56:71]
    s_waitcnt lgkmcnt(2)
    v_mfma_f32_32x32x16_bf16 v[40:55], a[88:91], v[16:19], v[40:55]
    ds_read_b128 v[12:15], v1 offset:800
    v_mfma_f32_32x32x16_bf16 v[56:71], v[16:19], a[216:219], v[56:71]
    s_waitcnt lgkmcnt(2)
    v_mfma_f32_32x32x16_bf16 v[40:55], a[92:95], v[20:23], v[40:55]
    ds_read_b128 v[16:19], v1 offset:832
    v_mfma_f32_32x32x16_bf16 v[56:71], v[20:23], a[220:223], v[56:71]
    s_waitcnt lgkmcnt(2)
    v_mfma_f32_32x32x16_bf16 v[40:55], a[96:99], v[8:11], v[40:55]
    ds_read_b128 v[20:23], v1 offset:864
    v_mfma_f32_32x32x16_bf16 v[56:71], v[8:11], a[224:227], v[56:71]
    s_waitcnt lgkmcnt(2)
    v_mfma_f32_32x32x16_bf16 v[40:55], a[100:103], v[12:15], v[40:55]
    ds_read_b128 v[8:11], v1 offset:896
    v_mfma_f32_32x32x16_bf16 v[56:71], v[12:15], a[228:231], v[56:71]
    s_waitcnt lgkmcnt(2)
    v_mfma_f32_32x32x16_bf16 v[40:55], a[104:107], v[16:19], v[40:55]
    ds_read_b128 v[12:15], v1 offset:928
    v_mfma_f32_32x32x16_bf16 v[56:71], v[16:19], a[232:235], v[56:71]
    s_waitcnt lgkmcnt(2)
    v_mfma_f32_32x32x16_bf16 v[40:55], a[108:111], v[20:23], v[40:55]
    ds_read_b128 v[16:19], v1 offset:960
    v_mfma_f32_32x32x16_bf16 v[56:71], v[20:23], a[236:239], v[56:71]
    s_waitcnt lgkmcnt(2)
    v_mfma_f32_32x32x16_bf16 v[40:55], a[112:115], v[8:11], v[40:55]
    ds_read_b128 v[20:23], v1 offset:992
    v_mfma_f32_32x32x16_bf16 v[56:71], v[8:11], a[240:243], v[56:71]
    s_waitcnt lgkmcnt(2)
    v_mfma_f32_32x32x16_bf16 v[40:55], a[116:119], v[12:15], v[40:55]
    v_mfma_f32_32x32x16_bf16 v[56:71], v[12:15], a[244:247], v[56:71]
    s_waitcnt lgkmcnt(1)
    v_mfma_f32_32x32x16_bf16 v[40:55], a[120:123], v[16:19], v[40:55]
    v_mfma_f32_32x32x16_bf16 v[56:71], v[16:19], a[248:251], v[56:71]
    s_waitcnt lgkmcnt(0)
    v_mfma_f32_32x32x16_bf16 v[40:55], a[124:127], v[20:23], v[40:55]
    v_mfma_f32_32x32x16_bf16 v[56:71], v[20:23], a[252:255], v[56:71]
    s_lshl_b32 s40, s16, 6
    s_add_u32 s40, s40, s38
    s_lshl_b32 s40, s40, 11
    s_add_u32 s40, s40, 62914560
    s_lshl_b32 s19, s45, 10
    v_add_u32 v2, s19, v105
    s_nop 4
    v_mul_f32 v40, s42, v40
    v_mul_f32 v41, s42, v41
    v_mul_f32 v42, s42, v42
    v_mul_f32 v43, s42, v43
    v_mul_f32 v44, s42, v44
    v_mul_f32 v45, s42, v45
    v_mul_f32 v46, s42, v46
    v_mul_f32 v47, s42, v47
    v_cvt_pk_bf16_f32 v72, v40, v41
    v_cvt_pk_bf16_f32 v73, v42, v43
    v_cvt_pk_bf16_f32 v74, v44, v45
    v_cvt_pk_bf16_f32 v75, v46, v47
    v_cvt_pk_bf16_f32 v76, v48, v49
    v_cvt_pk_bf16_f32 v77, v50, v51
    v_cvt_pk_bf16_f32 v78, v52, v53
    v_cvt_pk_bf16_f32 v79, v54, v55
    ds_write_b128 v2, v[72:75] offset:0
    buffer_store_dwordx4 v[76:79], v105, s[4:7], s40 offen sc1
    v_cvt_pk_bf16_f32 v80, v56, v57
    v_cvt_pk_bf16_f32 v81, v58, v59
    v_cvt_pk_bf16_f32 v82, v60, v61
    v_cvt_pk_bf16_f32 v83, v62, v63
    s_mov_b64 exec, s[50:51]
    v_cvt_pk_bf16_f32 v80, v64, v65
    v_cvt_pk_bf16_f32 v81, v66, v67
    v_cvt_pk_bf16_f32 v82, v68, v69
    v_cvt_pk_bf16_f32 v83, v70, v71
    s_mov_b64 exec, -1
    buffer_store_dwordx4 v[80:83], v105, s[4:7], s40 offen offset:1024 sc1
    s_add_u32 s45, s45, 4
    s_branch L_a1_128
L_a1d_129:
    s_waitcnt vmcnt(0) lgkmcnt(0)
    s_barrier
    s_lshl_b32 s40, s16, 5
    s_lshl_b32 s19, s57, 2
    s_add_u32 s41, s40, 60833792
    s_add_u32 s40, s41, s19
    v_and_b32 v2, 7, v104
    v_lshlrev_b32 v2, 2, v2
L_init_130:
    global_load_dword v107, v2, s[86:87] offset:0 sc1
    s_sub_u32 s48, s48, 1
    s_cbranch_scc1 W_bail
    s_waitcnt vmcnt(0)
    v_cmp_ne_u32 vcc, -1, v107
    s_cbranch_vccz L_init_130_ok
    s_sleep 16
    s_branch L_init_130
L_init_130_ok:
    s_cmp_lg_u32 s17, 0
    s_cbranch_scc1 L_flag_131
    v_mov_b32 v107, 1
    s_mov_b64 exec, 1
    buffer_store_dword v107, v106, s[4:7], s40 offen sc1
    s_mov_b64 exec, -1
L_flag_131:
    v_min_u32 v2, 2, v104
    v_lshlrev_b32 v2, 2, v2
L_fa_132:
    buffer_load_dword v107, v2, s[4:7], s41 offen sc1
    s_sub_u32 s48, s48, 1
    s_cbranch_scc1 W_bail
    s_waitcnt vmcnt(0)
    v_cmp_ne_u32 vcc, 1, v107
    s_cbranch_vccz L_fa_132_ok
    s_sleep 2
    s_branch L_fa_132
L_fa_132_ok:
    v_and_b32 v3, 27, v104
    v_mov_b32 v2, 0x3f803f80
    v_cmp_eq_u32 vcc, 16, v3
    s_nop 1
    v_cndmask_b32 v2, v106, v2, vcc
    s_not_b64 s[52:53], s[50:51]
    s_mov_b32 s55, 0x30800000
    s_mov_b32 s56, 0x1e000000
    s_mov_b32 s38, 0
    v_mov_b32 v16, v2
    v_mov_b32 v17, v2
    v_mov_b32 v18, v2
    v_mov_b32 v19, v2
    v_mov_b32 v20, v2
    v_mov_b32 v21, v2
    v_mov_b32 v22, v2
    v_mov_b32 v23, v2
L_a2b_133:
    s_mul_i32 s19, s38, 11264
    v_add_u32 v97, s19, v105
    s_mov_b32 s54, 0
    ds_write_b32 v106, v106 offset:33792
    ds_read_b128 v[128:131], v97 offset:0
    ds_read_b128 v[132:135], v97 offset:1024
    ds_read_b128 v[136:139], v97 offset:2048
    ds_read_b128 v[140:143], v97 offset:3072
    ds_read_b128 v[144:147], v97 offset:4096
    ds_read_b128 v[148:151], v97 offset:5120
    ds_read_b128 v[152:155], v97 offset:6144
    ds_read_b128 v[156:159], v97 offset:7168
    ds_read_b128 v[160:163], v97 offset:8192
    ds_read_b128 v[164:167], v97 offset:9216
    ds_read_b128 v[168:171], v97 offset:10240
    v_mfma_f32_16x16x1_4b_f32 a[0:15], v106, v106, 0
    v_mfma_f32_16x16x1_4b_f32 a[16:31], v106, v106, 0
    v_mfma_f32_16x16x1_4b_f32 a[32:47], v106, v106, 0
    v_mfma_f32_16x16x1_4b_f32 a[48:63], v106, v106, 0
    v_mfma_f32_16x16x1_4b_f32 a[64:79], v106, v106, 0
    v_mfma_f32_16x16x1_4b_f32 a[80:95], v106, v106, 0
    v_mfma_f32_16x16x1_4b_f32 a[96:111], v106, v106, 0
    v_mfma_f32_16x16x1_4b_f32 a[112:127], v106, v106, 0
    v_mfma_f32_16x16x1_4b_f32 a[128:143], v106, v106, 0
    v_mfma_f32_16x16x1_4b_f32 a[144:159], v106, v106, 0
    v_mfma_f32_16x16x1_4b_f32 a[160:175], v106, v106, 0
    s_waitcnt lgkmcnt(0)
    s_lshl_b32 s40, s16, 17
    s_lshl_b32 s19, s17, 15
    s_add_u32 s40, s40, s19
    s_add_u32 s40, s40, 62914560
    s_mov_b32 s42, 0
    buffer_load_dwordx4 v[12:15], v105, s[4:7], s40 offen sc1
    s_mov_b64 exec, s[52:53]
    buffer_load_dwordx4 v[16:19], v105, s[4:7], s40 offen offset:1024 sc1
    buffer_load_dwordx4 v[20:23], v105, s[4:7], s40 offen offset:1280 sc1
    s_mov_b64 exec, -1
    s_add_u32 s40, s40, 2048
L_a2p_136:
    s_waitcnt vmcnt(0)
    v_mov_b32 v0, v12
    v_mov_b32 v1, v13
    v_mov_b32 v2, v14
    v_mov_b32 v3, v15
    v_mov_b32 v4, v16
    v_mov_b32 v5, v17
    v_mov_b32 v6, v18
    v_mov_b32 v7, v19
    v_mov_b32 v8, v20
    v_mov_b32 v9, v21
    v_mov_b32 v10, v22
    v_mov_b32 v11, v23
    buffer_load_dwordx4 v[12:15], v105, s[4:7], s40 offen sc1
    s_mov_b64 exec, s[52:53]
    buffer_load_dwordx4 v[16:19], v105, s[4:7], s40 offen offset:1024 sc1
    buffer_load_dwordx4 v[20:23], v105, s[4:7], s40 offen offset:1280 sc1
    s_mov_b64 exec, -1
    s_add_u32 s40, s40, 2048
    v_mfma_f32_32x32x16_bf16 v[24:39], v[0:3], v[128:131], 0
    v_mfma_f32_32x32x16_bf16 v[40:55], v[0:3], v[132:135], 0
    s_nop 10
    v_exp_f32 v56, v24
    v_exp_f32 v57, v25
    v_exp_f32 v58, v26
    v_exp_f32 v59, v27
    v_exp_f32 v60, v28
    v_exp_f32 v61, v29
    v_exp_f32 v62, v30
    v_exp_f32 v63, v31
    v_cvt_pk_bf16_f32 v72, v56, v57
    v_cvt_pk_bf16_f32 v73, v58, v59
    v_cvt_pk_bf16_f32 v74, v60, v61
    v_cvt_pk_bf16_f32 v75, v62, v63
    v_exp_f32 v64, v32
    v_exp_f32 v65, v33
    v_exp_f32 v66, v34
    v_exp_f32 v67, v35
    v_mfma_f32_32x32x16_bf16 a[0:15], v[4:7], v[72:75], a[0:15]
    v_exp_f32 v68, v36
    v_exp_f32 v69, v37
    v_exp_f32 v70, v38
    v_exp_f32 v71, v39
    v_cvt_pk_bf16_f32 v76, v64, v65
    v_cvt_pk_bf16_f32 v77, v66, v67
    v_cvt_pk_bf16_f32 v78, v68, v69
    v_cvt_pk_bf16_f32 v79, v70, v71
    v_mfma_f32_32x32x16_bf16 v[24:39], v[0:3], v[136:139], 0
    v_exp_f32 v56, v40
    v_exp_f32 v57, v41
    v_exp_f32 v58, v42
    v_exp_f32 v59, v43
    v_exp_f32 v60, v44
    v_exp_f32 v61, v45
    v_exp_f32 v62, v46
    v_exp_f32 v63, v47
    v_mfma_f32_32x32x16_bf16 a[0:15], v[8:11], v[76:79], a[0:15]
    v_cvt_pk_bf16_f32 v72, v56, v57
    v_cvt_pk_bf16_f32 v73, v58, v59
    v_cvt_pk_bf16_f32 v74, v60, v61
    v_cvt_pk_bf16_f32 v75, v62, v63
    v_exp_f32 v64, v48
    v_exp_f32 v65, v49
    v_exp_f32 v66, v50
    v_exp_f32 v67, v51
    v_mfma_f32_32x32x16_bf16 a[16:31], v[4:7], v[72:75], a[16:31]
    v_exp_f32 v68, v52
    v_exp_f32 v69, v53
    v_exp_f32 v70, v54
    v_exp_f32 v71, v55
    v_cvt_pk_bf16_f32 v76, v64, v65
    v_cvt_pk_bf16_f32 v77, v66, v67
    v_cvt_pk_bf16_f32 v78, v68, v69
    v_cvt_pk_bf16_f32 v79, v70, v71
    v_mfma_f32_32x32x16_bf16 v[40:55], v[0:3], v[140:143], 0
    v_exp_f32 v56, v24
    v_exp_f32 v57, v25
    v_exp_f32 v58, v26
    v_exp_f32 v59, v27
    v_exp_f32 v60, v28
    v_exp_f32 v61, v29
    v_exp_f32 v62, v30
    v_exp_f32 v63, v31
    v_mfma_f32_32x32x16_bf16 a[16:31], v[8:11], v[76:79], a[16:31]
    v_cvt_pk_bf16_f32 v72, v56, v57
    v_cvt_pk_bf16_f32 v73, v58, v59
    v_cvt_pk_bf16_f32 v74, v60, v61
    v_cvt_pk_bf16_f32 v75, v62, v63
    v_exp_f32 v64, v32
    v_exp_f32 v65, v33
    v_exp_f32 v66, v34
    v_exp_f32 v67, v35
    v_mfma_f32_32x32x16_bf16 a[32:47], v[4:7], v[72:75], a[32:47]
    v_exp_f32 v68, v36
    v_exp_f32 v69, v37
    v_exp_f32 v70, v38
    v_exp_f32 v71, v39
    v_cvt_pk_bf16_f32 v76, v64, v65
    v_cvt_pk_bf16_f32 v77, v66, v67
    v_cvt_pk_bf16_f32 v78, v68, v69
    v_cvt_pk_bf16_f32 v79, v70, v71
    v_mfma_f32_32x32x16_bf16 v[24:39], v[0:3], v[144:147], 0
    v_exp_f32 v56, v40
    v_exp_f32 v57, v41
    v_exp_f32 v58, v42
    v_exp_f32 v59, v43
    v_exp_f32 v60, v44
    v_exp_f32 v61, v45
    v_exp_f32 v62, v46
    v_exp_f32 v63, v47
    v_mfma_f32_32x32x16_bf16 a[32:47], v[8:11], v[76:79], a[32:47]
    v_cvt_pk_bf16_f32 v72, v56, v57
    v_cvt_pk_bf16_f32 v73, v58, v59
    v_cvt_pk_bf16_f32 v74, v60, v61
    v_cvt_pk_bf16_f32 v75, v62, v63
    v_exp_f32 v64, v48
    v_exp_f32 v65, v49
    v_exp_f32 v66, v50
    v_exp_f32 v67, v51
    v_mfma_f32_32x32x16_bf16 a[48:63], v[4:7], v[72:75], a[48:63]
    v_exp_f32 v68, v52
    v_exp_f32 v69, v53
    v_exp_f32 v70, v54
    v_exp_f32 v71, v55
    v_cvt_pk_bf16_f32 v76, v64, v65
    v_cvt_pk_bf16_f32 v77, v66, v67
    v_cvt_pk_bf16_f32 v78, v68, v69
    v_cvt_pk_bf16_f32 v79, v70, v71
    v_mfma_f32_32x32x16_bf16 v[40:55], v[0:3], v[148:151], 0
    v_exp_f32 v56, v24
    v_exp_f32 v57, v25
    v_exp_f32 v58, v26
    v_exp_f32 v59, v27
    v_exp_f32 v60, v28
    v_exp_f32 v61, v29
    v_exp_f32 v62, v30
    v_exp_f32 v63, v31
    v_mfma_f32_32x32x16_bf16 a[48:63], v[8:11], v[76:79], a[48:63]
    v_cvt_pk_bf16_f32 v72, v56, v57
    v_cvt_pk_bf16_f32 v73, v58, v59
    v_cvt_pk_bf16_f32 v74, v60, v61
    v_cvt_pk_bf16_f32 v75, v62, v63
    v_exp_f32 v64, v32
    v_exp_f32 v65, v33
    v_exp_f32 v66, v34
    v_exp_f32 v67, v35
    v_mfma_f32_32x32x16_bf16 a[64:79], v[4:7], v[72:75], a[64:79]
    v_exp_f32 v68, v36
    v_exp_f32 v69, v37
    v_exp_f32 v70, v38
    v_exp_f32 v71, v39
    v_cvt_pk_bf16_f32 v76, v64, v65
    v_cvt_pk_bf16_f32 v77, v66, v67
    v_cvt_pk_bf16_f32 v78, v68, v69
    v_cvt_pk_bf16_f32 v79, v70, v71
    v_mfma_f32_32x32x16_bf16 v[24:39], v[0:3], v[152:155], 0
    v_exp_f32 v56, v40
    v_exp_f32 v57, v41
    v_exp_f32 v58, v42
    v_exp_f32 v59, v43
    v_exp_f32 v60, v44
    v_exp_f32 v61, v45
    v_exp_f32 v62, v46
    v_exp_f32 v63, v47
    v_mfma_f32_32x32x16_bf16 a[64:79], v[8:11], v[76:79], a[64:79]
    v_cvt_pk_bf16_f32 v72, v56, v57
    v_cvt_pk_bf16_f32 v73, v58, v59
    v_cvt_pk_bf16_f32 v74, v60, v61
    v_cvt_pk_bf16_f32 v75, v62, v63
    v_exp_f32 v64, v48
    v_exp_f32 v65, v49
    v_exp_f32 v66, v50
    v_exp_f32 v67, v51
    v_mfma_f32_32x32x16_bf16 a[80:95], v[4:7], v[72:75], a[80:95]
    v_exp_f32 v68, v52
    v_exp_f32 v69, v53
    v_exp_f32 v70, v54
    v_exp_f32 v71, v55
    v_cvt_pk_bf16_f32 v76, v64, v65
    v_cvt_pk_bf16_f32 v77, v66, v67
    v_cvt_pk_bf16_f32 v78, v68, v69
    v_cvt_pk_bf16_f32 v79, v70, v71
    v_mfma_f32_32x32x16_bf16 v[40:55], v[0:3], v[156:159], 0
    v_exp_f32 v56, v24
    v_exp_f32 v57, v25
    v_exp_f32 v58, v26
    v_exp_f32 v59, v27
    v_exp_f32 v60, v28
    v_exp_f32 v61, v29
    v_exp_f32 v62, v30
    v_exp_f32 v63, v31
    v_mfma_f32_32x32x16_bf16 a[80:95], v[8:11], v[76:79], a[80:95]
    v_cvt_pk_bf16_f32 v72, v56, v57
    v_cvt_pk_bf16_f32 v73, v58, v59
    v_cvt_pk_bf16_f32 v74, v60, v61
    v_cvt_pk_bf16_f32 v75, v62, v63
    v_exp_f32 v64, v32
    v_exp_f32 v65, v33
    v_exp_f32 v66, v34
    v_exp_f32 v67, v35
    v_mfma_f32_32x32x16_bf16 a[96:111], v[4:7], v[72:75], a[96:111]
    v_exp_f32 v68, v36
    v_exp_f32 v69, v37
    v_exp_f32 v70, v38
    v_exp_f32 v71, v39
    v_cvt_pk_bf16_f32 v76, v64, v65
    v_cvt_pk_bf16_f32 v77, v66, v67
    v_cvt_pk_bf16_f32 v78, v68, v69
    v_cvt_pk_bf16_f32 v79, v70, v71
    v_mfma_f32_32x32x16_bf16 v[24:39], v[0:3], v[160:163], 0
    v_exp_f32 v56, v40
    v_exp_f32 v57, v41
    v_exp_f32 v58, v42
    v_exp_f32 v59, v43
    v_exp_f32 v60, v44
    v_exp_f32 v61, v45
    v_exp_f32 v62, v46
    v_exp_f32 v63, v47
    v_mfma_f32_32x32x16_bf16 a[96:111], v[8:11], v[76:79], a[96:111]
    v_cvt_pk_bf16_f32 v72, v56, v57
    v_cvt_pk_bf16_f32 v73, v58, v59
    v_cvt_pk_bf16_f32 v74, v60, v61
    v_cvt_pk_bf16_f32 v75, v62, v63
    v_exp_f32 v64, v48
    v_exp_f32 v65, v49
    v_exp_f32 v66, v50
    v_exp_f32 v67, v51
    v_mfma_f32_32x32x16_bf16 a[112:127], v[4:7], v[72:75], a[112:127]
    v_exp_f32 v68, v52
    v_exp_f32 v69, v53
    v_exp_f32 v70, v54
    v_exp_f32 v71, v55
    v_cvt_pk_bf16_f32 v76, v64, v65
    v_cvt_pk_bf16_f32 v77, v66, v67
    v_cvt_pk_bf16_f32 v78, v68, v69
    v_cvt_pk_bf16_f32 v79, v70, v71
    v_mfma_f32_32x32x16_bf16 v[40:55], v[0:3], v[164:167], 0
    v_exp_f32 v56, v24
    v_exp_f32 v57, v25
    v_exp_f32 v58, v26
    v_exp_f32 v59, v27
    v_exp_f32 v60, v28
    v_exp_f32 v61, v29
    v_exp_f32 v62, v30
    v_exp_f32 v63, v31
    v_mfma_f32_32x32x16_bf16 a[112:127], v[8:11], v[76:79], a[112:127]
    v_cvt_pk_bf16_f32 v72, v56, v57
    v_cvt_pk_bf16_f32 v73, v58, v59
    v_cvt_pk_bf16_f32 v74, v60, v61
    v_cvt_pk_bf16_f32 v75, v62, v63
    v_exp_f32 v64, v32
    v_exp_f32 v65, v33
    v_exp_f32 v66, v34
    v_exp_f32 v67, v35
    v_mfma_f32_32x32x16_bf16 a[128:143], v[4:7], v[72:75], a[128:143]
    v_exp_f32 v68, v36
    v_exp_f32 v69, v37
    v_exp_f32 v70, v38
    v_exp_f32 v71, v39
    v_cvt_pk_bf16_f32 v76, v64, v65
    v_cvt_pk_bf16_f32 v77, v66, v67
    v_cvt_pk_bf16_f32 v78, v68, v69
    v_cvt_pk_bf16_f32 v79, v70, v71
    v_mfma_f32_32x32x16_bf16 v[24:39], v[0:3], v[168:171], 0
    v_exp_f32 v56, v40
    v_exp_f32 v57, v41
    v_exp_f32 v58, v42
    v_exp_f32 v59, v43
    v_exp_f32 v60, v44
    v_exp_f32 v61, v45
    v_exp_f32 v62, v46
    v_exp_f32 v63, v47
    v_mfma_f32_32x32x16_bf16 a[128:143], v[8:11], v[76:79], a[128:143]
    v_cvt_pk_bf16_f32 v72, v56, v57
    v_cvt_pk_bf16_f32 v73, v58, v59
    v_cvt_pk_bf16_f32 v74, v60, v61
    v_cvt_pk_bf16_f32 v75, v62, v63
    v_exp_f32 v64, v48
    v_exp_f32 v65, v49
    v_exp_f32 v66, v50
    v_exp_f32 v67, v51
    v_mfma_f32_32x32x16_bf16 a[144:159], v[4:7], v[72:75], a[144:159]
    v_exp_f32 v68, v52
    v_exp_f32 v69, v53
    v_exp_f32 v70, v54
    v_exp_f32 v71, v55
    v_cvt_pk_bf16_f32 v76, v64, v65
    v_cvt_pk_bf16_f32 v77, v66, v67
    v_cvt_pk_bf16_f32 v78, v68, v69
    v_cvt_pk_bf16_f32 v79, v70, v71
    v_exp_f32 v56, v24
    v_exp_f32 v57, v25
    v_exp_f32 v58, v26
    v_exp_f32 v59, v27
    v_exp_f32 v60, v28
    v_exp_f32 v61, v29
    v_exp_f32 v62, v30
    v_exp_f32 v63, v31
    v_mfma_f32_32x32x16_bf16 a[144:159], v[8:11], v[76:79], a[144:159]
    v_cvt_pk_bf16_f32 v72, v56, v57
    v_cvt_pk_bf16_f32 v73, v58, v59
    v_cvt_pk_bf16_f32 v74, v60, v61
    v_cvt_pk_bf16_f32 v75, v62, v63
    v_exp_f32 v64, v32
    v_exp_f32 v65, v33
    v_exp_f32 v66, v34
    v_exp_f32 v67, v35
    v_mfma_f32_32x32x16_bf16 a[160:175], v[4:7], v[72:75], a[160:175]
    v_exp_f32 v68, v36
    v_exp_f32 v69, v37
    v_exp_f32 v70, v38
    v_exp_f32 v71, v39
    v_cvt_pk_bf16_f32 v76, v64, v65
    v_cvt_pk_bf16_f32 v77, v66, v67
    v_cvt_pk_bf16_f32 v78, v68, v69
    v_cvt_pk_bf16_f32 v79, v70, v71
    s_nop 1
    v_mfma_f32_32x32x16_bf16 a[160:175], v[8:11], v[76:79], a[160:175]
    s_add_u32 s42, s42, 1
    s_cmp_lt_u32 s42, 16
    s_cbranch_scc1 L_a2p_136
    s_waitcnt vmcnt(0)
    s_branch L_a2f_135
L_a2r_134:
    s_mov_b32 s54, 1
    v_mov_b32 v176, 0xff800000
    v_mov_b32 v177, 0xff800000
    v_mov_b32 v178, 0xff800000
    v_mov_b32 v179, 0xff800000
    v_mov_b32 v180, 0xff800000
    v_mov_b32 v181, 0xff800000
    v_mov_b32 v182, 0xff800000
    v_mov_b32 v183, 0xff800000
    v_mov_b32 v184, 0xff800000
    v_mov_b32 v185, 0xff800000
    v_mov_b32 v186, 0xff800000
    s_lshl_b32 s40, s16, 17
    s_lshl_b32 s19, s17, 15
    s_add_u32 s40, s40, s19
    s_add_u32 s40, s40, 62914560
    s_mov_b32 s42, 0
    buffer_load_dwordx4 v[12:15], v105, s[4:7], s40 offen sc1
    s_mov_b64 exec, s[52:53]
    buffer_load_dwordx4 v[16:19], v105, s[4:7], s40 offen offset:1024 sc1
    buffer_load_dwordx4 v[20:23], v105, s[4:7], s40 offen offset:1280 sc1
    s_mov_b64 exec, -1
    s_add_u32 s40, s40, 2048
L_a2m_137:
    s_waitcnt vmcnt(0)
    v_mov_b32 v0, v12
    v_mov_b32 v1, v13
    v_mov_b32 v2, v14
    v_mov_b32 v3, v15
    v_mov_b32 v4, v16
    v_mov_b32 v5, v17
    v_mov_b32 v6, v18
    v_mov_b32 v7, v19
    v_mov_b32 v8, v20
    v_mov_b32 v9, v21
    v_mov_b32 v10, v22
    v_mov_b32 v11, v23
    buffer_load_dwordx4 v[12:15], v105, s[4:7], s40 offen sc1
    s_mov_b64 exec, s[52:53]
    buffer_load_dwordx4 v[16:19], v105, s[4:7], s40 offen offset:1024 sc1
    buffer_load_dwordx4 v[20:23], v105, s[4:7], s40 offen offset:1280 sc1
    s_mov_b64 exec, -1
    s_add_u32 s40, s40, 2048
    v_mfma_f32_32x32x16_bf16 v[24:39], v[0:3], v[128:131], 0
    v_mfma_f32_32x32x16_bf16 v[40:55], v[0:3], v[132:135], 0
    v_mfma_f32_32x32x16_bf16 v[56:71], v[0:3], v[136:139], 0
    s_nop 9
    v_max3_f32 v176, v176, v24, v25
    v_max3_f32 v176, v176, v26, v27
    v_max3_f32 v176, v176, v28, v29
    v_max3_f32 v176, v176, v30, v31
    v_max3_f32 v176, v176, v32, v33
    v_max3_f32 v176, v176, v34, v35
    v_max3_f32 v176, v176, v36, v37
    v_max3_f32 v176, v176, v38, v39
    v_mfma_f32_32x32x16_bf16 v[24:39], v[0:3], v[140:143], 0
    v_max3_f32 v177, v177, v40, v41
    v_max3_f32 v177, v177, v42, v43
    v_max3_f32 v177, v177, v44, v45
    v_max3_f32 v177, v177, v46, v47
    v_max3_f32 v177, v177, v48, v49
    v_max3_f32 v177, v177, v50, v51
    v_max3_f32 v177, v177, v52, v53
    v_max3_f32 v177, v177, v54, v55
    v_mfma_f32_32x32x16_bf16 v[40:55], v[0:3], v[144:147], 0
    v_max3_f32 v178, v178, v56, v57
    v_max3_f32 v178, v178, v58, v59
    v_max3_f32 v178, v178, v60, v61
    v_max3_f32 v178, v178, v62, v63
    v_max3_f32 v178, v178, v64, v65
    v_max3_f32 v178, v178, v66, v67
    v_max3_f32 v178, v178, v68, v69
    v_max3_f32 v178, v178, v70, v71
    v_mfma_f32_32x32x16_bf16 v[56:71], v[0:3], v[148:151], 0
    v_max3_f32 v179, v179, v24, v25
    v_max3_f32 v179, v179, v26, v27
    v_max3_f32 v179, v179, v28, v29
    v_max3_f32 v179, v179, v30, v31
    v_max3_f32 v179, v179, v32, v33
    v_max3_f32 v179, v179, v34, v35
    v_max3_f32 v179, v179, v36, v37
    v_max3_f32 v179, v179, v38, v39
    v_mfma_f32_32x32x16_bf16 v[24:39], v[0:3], v[152:155], 0
    v_max3_f32 v180, v180, v40, v41
    v_max3_f32 v180, v180, v42, v43
    v_max3_f32 v180, v180, v44, v45
    v_max3_f32 v180, v180, v46, v47
    v_max3_f32 v180, v180, v48, v49
    v_max3_f32 v180, v180, v50, v51
    v_max3_f32 v180, v180, v52, v53
    v_max3_f32 v180, v180, v54, v55
    v_mfma_f32_32x32x16_bf16 v[40:55], v[0:3], v[156:159], 0
    v_max3_f32 v181, v181, v56, v57
    v_max3_f32 v181, v181, v58, v59
    v_max3_f32 v181, v181, v60, v61
    v_max3_f32 v181, v181, v62, v63
    v_max3_f32 v181, v181, v64, v65
    v_max3_f32 v181, v181, v66, v67
    v_max3_f32 v181, v181, v68, v69
    v_max3_f32 v181, v181, v70, v71
    v_mfma_f32_32x32x16_bf16 v[56:71], v[0:3], v[160:163], 0
    v_max3_f32 v182, v182, v24, v25
    v_max3_f32 v182, v182, v26, v27
    v_max3_f32 v182, v182, v28, v29
    v_max3_f32 v182, v182, v30, v31
    v_max3_f32 v182, v182, v32, v33
    v_max3_f32 v182, v182, v34, v35
    v_max3_f32 v182, v182, v36, v37
    v_max3_f32 v182, v182, v38, v39
    v_mfma_f32_32x32x16_bf16 v[24:39], v[0:3], v[164:167], 0
    v_max3_f32 v183, v183, v40, v41
    v_max3_f32 v183, v183, v42, v43
    v_max3_f32 v183, v183, v44, v45
    v_max3_f32 v183, v183, v46, v47
    v_max3_f32 v183, v183, v48, v49
    v_max3_f32 v183, v183, v50, v51
    v_max3_f32 v183, v183, v52, v53
    v_max3_f32 v183, v183, v54, v55
    v_mfma_f32_32x32x16_bf16 v[40:55], v[0:3], v[168:171], 0
    v_max3_f32 v184, v184, v56, v57
    v_max3_f32 v184, v184, v58, v59
    v_max3_f32 v184, v184, v60, v61
    v_max3_f32 v184, v184, v62, v63
    v_max3_f32 v184, v184, v64, v65
    v_max3_f32 v184, v184, v66, v67
    v_max3_f32 v184, v184, v68, v69
    v_max3_f32 v184, v184, v70, v71
    v_max3_f32 v185, v185, v24, v25
    v_max3_f32 v185, v185, v26, v27
    v_max3_f32 v185, v185, v28, v29
    v_max3_f32 v185, v185, v30, v31
    v_max3_f32 v185, v185, v32, v33
    v_max3_f32 v185, v185, v34, v35
    v_max3_f32 v185, v185, v36, v37
    v_max3_f32 v185, v185, v38, v39
    v_max3_f32 v186, v186, v40, v41
    v_max3_f32 v186, v186, v42, v43
    v_max3_f32 v186, v186, v44, v45
    v_max3_f32 v186, v186, v46, v47
    v_max3_f32 v186, v186, v48, v49
    v_max3_f32 v186, v186, v50, v51
    v_max3_f32 v186, v186, v52, v53
    v_max3_f32 v186, v186, v54, v55
    s_add_u32 s42, s42, 1
    s_cmp_lt_u32 s42, 16
    s_cbranch_scc1 L_a2m_137
    s_waitcnt vmcnt(0)
    s_mul_i32 s19, s17, 2816
    v_lshlrev_b32 v98, 2, v104
    v_add_u32 v99, s19, v98
    v_mov_b32 v56, v176
    s_nop 1
    v_permlane32_swap_b32 v56, v176
    v_max_f32 v176, v176, v56
    ds_write_b32 v99, v176 offset:22528
    v_mov_b32 v56, v177
    s_nop 1
    v_permlane32_swap_b32 v56, v177
    v_max_f32 v177, v177, v56
    ds_write_b32 v99, v177 offset:22784
    v_mov_b32 v56, v178
    s_nop 1
    v_permlane32_swap_b32 v56, v178
    v_max_f32 v178, v178, v56
    ds_write_b32 v99, v178 offset:23040
    v_mov_b32 v56, v179
    s_nop 1
    v_permlane32_swap_b32 v56, v179
    v_max_f32 v179, v179, v56
    ds_write_b32 v99, v179 offset:23296
    v_mov_b32 v56, v180
    s_nop 1
    v_permlane32_swap_b32 v56, v180
    v_max_f32 v180, v180, v56
    ds_write_b32 v99, v180 offset:23552
    v_mov_b32 v56, v181
    s_nop 1
    v_permlane32_swap_b32 v56, v181
    v_max_f32 v181, v181, v56
    ds_write_b32 v99, v181 offset:23808
    v_mov_b32 v56, v182
    s_nop 1
    v_permlane32_swap_b32 v56, v182
    v_max_f32 v182, v182, v56
    ds_write_b32 v99, v182 offset:24064
    v_mov_b32 v56, v183
    s_nop 1
    v_permlane32_swap_b32 v56, v183
    v_max_f32 v183, v183, v56
    ds_write_b32 v99, v183 offset:24320
    v_mov_b32 v56, v184
    s_nop 1
    v_permlane32_swap_b32 v56, v184
    v_max_f32 v184, v184, v56
    ds_write_b32 v99, v184 offset:24576
    v_mov_b32 v56, v185
    s_nop 1
    v_permlane32_swap_b32 v56, v185
    v_max_f32 v185, v185, v56
    ds_write_b32 v99, v185 offset:24832
    v_mov_b32 v56, v186
    s_nop 1
    v_permlane32_swap_b32 v56, v186
    v_max_f32 v186, v186, v56
    ds_write_b32 v99, v186 offset:25088
    v_mfma_f32_16x16x1_4b_f32 a[0:15], v106, v106, 0
    v_mfma_f32_16x16x1_4b_f32 a[16:31], v106, v106, 0
    v_mfma_f32_16x16x1_4b_f32 a[32:47], v106, v106, 0
    v_mfma_f32_16x16x1_4b_f32 a[48:63], v106, v106, 0
    v_mfma_f32_16x16x1_4b_f32 a[64:79], v106, v106, 0
    v_mfma_f32_16x16x1_4b_f32 a[80:95], v106, v106, 0
    v_mfma_f32_16x16x1_4b_f32 a[96:111], v106, v106, 0
    v_mfma_f32_16x16x1_4b_f32 a[112:127], v106, v106, 0
    v_mfma_f32_16x16x1_4b_f32 a[128:143], v106, v106, 0
    v_mfma_f32_16x16x1_4b_f32 a[144:159], v106, v106, 0
    v_mfma_f32_16x16x1_4b_f32 a[160:175], v106, v106, 0
    s_waitcnt lgkmcnt(0)
    s_barrier
    ds_read_b32 v56, v98 offset:22528
    ds_read_b32 v57, v98 offset:25344
    ds_read_b32 v58, v98 offset:28160
    ds_read_b32 v59, v98 offset:30976
    s_waitcnt lgkmcnt(0)
    v_max3_f32 v176, v56, v57, v58
    v_max_f32 v176, v176, v59
    ds_read_b32 v56, v98 offset:22784
    ds_read_b32 v57, v98 offset:25600
    ds_read_b32 v58, v98 offset:28416
    ds_read_b32 v59, v98 offset:31232
    s_waitcnt lgkmcnt(0)
    v_max3_f32 v177, v56, v57, v58
    v_max_f32 v177, v177, v59
    ds_read_b32 v56, v98 offset:23040
    ds_read_b32 v57, v98 offset:25856
    ds_read_b32 v58, v98 offset:28672
    ds_read_b32 v59, v98 offset:31488
    s_waitcnt lgkmcnt(0)
    v_max3_f32 v178, v56, v57, v58
    v_max_f32 v178, v178, v59
    ds_read_b32 v56, v98 offset:23296
    ds_read_b32 v57, v98 offset:26112
    ds_read_b32 v58, v98 offset:28928
    ds_read_b32 v59, v98 offset:31744
    s_waitcnt lgkmcnt(0)
    v_max3_f32 v179, v56, v57, v58
    v_max_f32 v179, v179, v59
    ds_read_b32 v56, v98 offset:23552
    ds_read_b32 v57, v98 offset:26368
    ds_read_b32 v58, v98 offset:29184
    ds_read_b32 v59, v98 offset:32000
    s_waitcnt lgkmcnt(0)
    v_max3_f32 v180, v56, v57, v58
    v_max_f32 v180, v180, v59
    ds_read_b32 v56, v98 offset:23808
    ds_read_b32 v57, v98 offset:26624
    ds_read_b32 v58, v98 offset:29440
    ds_read_b32 v59, v98 offset:32256
    s_waitcnt lgkmcnt(0)
    v_max3_f32 v181, v56, v57, v58
    v_max_f32 v181, v181, v59
    ds_read_b32 v56, v98 offset:24064
    ds_read_b32 v57, v98 offset:26880
    ds_read_b32 v58, v98 offset:29696
    ds_read_b32 v59, v98 offset:32512
    s_waitcnt lgkmcnt(0)
    v_max3_f32 v182, v56, v57, v58
    v_max_f32 v182, v182, v59
    ds_read_b32 v56, v98 offset:24320
    ds_read_b32 v57, v98 offset:27136
    ds_read_b32 v58, v98 offset:29952
    ds_read_b32 v59, v98 offset:32768
    s_waitcnt lgkmcnt(0)
    v_max3_f32 v183, v56, v57, v58
    v_max_f32 v183, v183, v59
    ds_read_b32 v56, v98 offset:24576
    ds_read_b32 v57, v98 offset:27392
    ds_read_b32 v58, v98 offset:30208
    ds_read_b32 v59, v98 offset:33024
    s_waitcnt lgkmcnt(0)
    v_max3_f32 v184, v56, v57, v58
    v_max_f32 v184, v184, v59
    ds_read_b32 v56, v98 offset:24832
    ds_read_b32 v57, v98 offset:27648
    ds_read_b32 v58, v98 offset:30464
    ds_read_b32 v59, v98 offset:33280
    s_waitcnt lgkmcnt(0)
    v_max3_f32 v185, v56, v57, v58
    v_max_f32 v185, v185, v59
    ds_read_b32 v56, v98 offset:25088
    ds_read_b32 v57, v98 offset:27904
    ds_read_b32 v58, v98 offset:30720
    ds_read_b32 v59, v98 offset:33536
    s_waitcnt lgkmcnt(0)
    v_max3_f32 v186, v56, v57, v58
    v_max_f32 v186, v186, v59
    s_lshl_b32 s40, s16, 17
    s_lshl_b32 s19, s17, 15
    s_add_u32 s40, s40, s19
    s_add_u32 s40, s40, 62914560
    s_mov_b32 s42, 0
    buffer_load_dwordx4 v[12:15], v105, s[4:7], s40 offen sc1
    s_mov_b64 exec, s[52:53]
    buffer_load_dwordx4 v[16:19], v105, s[4:7], s40 offen offset:1024 sc1
    buffer_load_dwordx4 v[20:23], v105, s[4:7], s40 offen offset:1280 sc1
    s_mov_b64 exec, -1
    s_add_u32 s40, s40, 2048
L_a2q_138:
    s_waitcnt vmcnt(0)
    v_mov_b32 v0, v12
    v_mov_b32 v1, v13
    v_mov_b32 v2, v14
    v_mov_b32 v3, v15
    v_mov_b32 v4, v16
    v_mov_b32 v5, v17
    v_mov_b32 v6, v18
    v_mov_b32 v7, v19
    v_mov_b32 v8, v20
    v_mov_b32 v9, v21
    v_mov_b32 v10, v22
    v_mov_b32 v11, v23
    buffer_load_dwordx4 v[12:15], v105, s[4:7], s40 offen sc1
    s_mov_b64 exec, s[52:53]
    buffer_load_dwordx4 v[16:19], v105, s[4:7], s40 offen offset:1024 sc1
    buffer_load_dwordx4 v[20:23], v105, s[4:7], s40 offen offset:1280 sc1
    s_mov_b64 exec, -1
    s_add_u32 s40, s40, 2048
    v_mfma_f32_32x32x16_bf16 v[24:39], v[0:3], v[128:131], 0
    v_mfma_f32_32x32x16_bf16 v[40:55], v[0:3], v[132:135], 0
    s_nop 10
    v_sub_f32 v56, v24, v176
    v_exp_f32 v56, v56
    v_sub_f32 v57, v25, v176
    v_exp_f32 v57, v57
    v_sub_f32 v58, v26, v176
    v_exp_f32 v58, v58
    v_sub_f32 v59, v27, v176
    v_exp_f32 v59, v59
    v_sub_f32 v60, v28, v176
    v_exp_f32 v60, v60
    v_sub_f32 v61, v29, v176
    v_exp_f32 v61, v61
    v_sub_f32 v62, v30, v176
    v_exp_f32 v62, v62
    v_sub_f32 v63, v31, v176
    v_exp_f32 v63, v63
    v_cvt_pk_bf16_f32 v72, v56, v57
    v_cvt_pk_bf16_f32 v73, v58, v59
    v_cvt_pk_bf16_f32 v74, v60, v61
    v_cvt_pk_bf16_f32 v75, v62, v63
    v_sub_f32 v64, v32, v176
    v_exp_f32 v64, v64
    v_sub_f32 v65, v33, v176
    v_exp_f32 v65, v65
    v_sub_f32 v66, v34, v176
    v_exp_f32 v66, v66
    v_sub_f32 v67, v35, v176
    v_exp_f32 v67, v67
    v_mfma_f32_32x32x16_bf16 a[0:15], v[4:7], v[72:75], a[0:15]
    v_sub_f32 v68, v36, v176
    v_exp_f32 v68, v68
    v_sub_f32 v69, v37, v176
    v_exp_f32 v69, v69
    v_sub_f32 v70, v38, v176
    v_exp_f32 v70, v70
    v_sub_f32 v71, v39, v176
    v_exp_f32 v71, v71
    v_cvt_pk_bf16_f32 v76, v64, v65
    v_cvt_pk_bf16_f32 v77, v66, v67
    v_cvt_pk_bf16_f32 v78, v68, v69
    v_cvt_pk_bf16_f32 v79, v70, v71
    v_mfma_f32_32x32x16_bf16 v[24:39], v[0:3], v[136:139], 0
    v_sub_f32 v56, v40, v177
    v_exp_f32 v56, v56
    v_sub_f32 v57, v41, v177
    v_exp_f32 v57, v57
    v_sub_f32 v58, v42, v177
    v_exp_f32 v58, v58
    v_sub_f32 v59, v43, v177
    v_exp_f32 v59, v59
    v_sub_f32 v60, v44, v177
    v_exp_f32 v60, v60
    v_sub_f32 v61, v45, v177
    v_exp_f32 v61, v61
    v_sub_f32 v62, v46, v177
    v_exp_f32 v62, v62
    v_sub_f32 v63, v47, v177
    v_exp_f32 v63, v63
    v_mfma_f32_32x32x16_bf16 a[0:15], v[8:11], v[76:79], a[0:15]
    v_cvt_pk_bf16_f32 v72, v56, v57
    v_cvt_pk_bf16_f32 v73, v58, v59
    v_cvt_pk_bf16_f32 v74, v60, v61
    v_cvt_pk_bf16_f32 v75, v62, v63
    v_sub_f32 v64, v48, v177
    v_exp_f32 v64, v64
    v_sub_f32 v65, v49, v177
    v_exp_f32 v65, v65
    v_sub_f32 v66, v50, v177
    v_exp_f32 v66, v66
    v_sub_f32 v67, v51, v177
    v_exp_f32 v67, v67
    v_mfma_f32_32x32x16_bf16 a[16:31], v[4:7], v[72:75], a[16:31]
    v_sub_f32 v68, v52, v177
    v_exp_f32 v68, v68
    v_sub_f32 v69, v53, v177
    v_exp_f32 v69, v69
    v_sub_f32 v70, v54, v177
    v_exp_f32 v70, v70
    v_sub_f32 v71, v55, v177
    v_exp_f32 v71, v71
    v_cvt_pk_bf16_f32 v76, v64, v65
    v_cvt_pk_bf16_f32 v77, v66, v67
    v_cvt_pk_bf16_f32 v78, v68, v69
    v_cvt_pk_bf16_f32 v79, v70, v71
    v_mfma_f32_32x32x16_bf16 v[40:55], v[0:3], v[140:143], 0
    v_sub_f32 v56, v24, v178
    v_exp_f32 v56, v56
    v_sub_f32 v57, v25, v178
    v_exp_f32 v57, v57
    v_sub_f32 v58, v26, v178
    v_exp_f32 v58, v58
    v_sub_f32 v59, v27, v178
    v_exp_f32 v59, v59
    v_sub_f32 v60, v28, v178
    v_exp_f32 v60, v60
    v_sub_f32 v61, v29, v178
    v_exp_f32 v61, v61
    v_sub_f32 v62, v30, v178
    v_exp_f32 v62, v62
    v_sub_f32 v63, v31, v178
    v_exp_f32 v63, v63
    v_mfma_f32_32x32x16_bf16 a[16:31], v[8:11], v[76:79], a[16:31]
    v_cvt_pk_bf16_f32 v72, v56, v57
    v_cvt_pk_bf16_f32 v73, v58, v59
    v_cvt_pk_bf16_f32 v74, v60, v61
    v_cvt_pk_bf16_f32 v75, v62, v63
    v_sub_f32 v64, v32, v178
    v_exp_f32 v64, v64
    v_sub_f32 v65, v33, v178
    v_exp_f32 v65, v65
    v_sub_f32 v66, v34, v178
    v_exp_f32 v66, v66
    v_sub_f32 v67, v35, v178
    v_exp_f32 v67, v67
    v_mfma_f32_32x32x16_bf16 a[32:47], v[4:7], v[72:75], a[32:47]
    v_sub_f32 v68, v36, v178
    v_exp_f32 v68, v68
    v_sub_f32 v69, v37, v178
    v_exp_f32 v69, v69
    v_sub_f32 v70, v38, v178
    v_exp_f32 v70, v70
    v_sub_f32 v71, v39, v178
    v_exp_f32 v71, v71
    v_cvt_pk_bf16_f32 v76, v64, v65
    v_cvt_pk_bf16_f32 v77, v66, v67
    v_cvt_pk_bf16_f32 v78, v68, v69
    v_cvt_pk_bf16_f32 v79, v70, v71
    v_mfma_f32_32x32x16_bf16 v[24:39], v[0:3], v[144:147], 0
    v_sub_f32 v56, v40, v179
    v_exp_f32 v56, v56
    v_sub_f32 v57, v41, v179
    v_exp_f32 v57, v57
    v_sub_f32 v58, v42, v179
    v_exp_f32 v58, v58
    v_sub_f32 v59, v43, v179
    v_exp_f32 v59, v59
    v_sub_f32 v60, v44, v179
    v_exp_f32 v60, v60
    v_sub_f32 v61, v45, v179
    v_exp_f32 v61, v61
    v_sub_f32 v62, v46, v179
    v_exp_f32 v62, v62
    v_sub_f32 v63, v47, v179
    v_exp_f32 v63, v63
    v_mfma_f32_32x32x16_bf16 a[32:47], v[8:11], v[76:79], a[32:47]
    v_cvt_pk_bf16_f32 v72, v56, v57
    v_cvt_pk_bf16_f32 v73, v58, v59
    v_cvt_pk_bf16_f32 v74, v60, v61
    v_cvt_pk_bf16_f32 v75, v62, v63
    v_sub_f32 v64, v48, v179
    v_exp_f32 v64, v64
    v_sub_f32 v65, v49, v179
    v_exp_f32 v65, v65
    v_sub_f32 v66, v50, v179
    v_exp_f32 v66, v66
    v_sub_f32 v67, v51, v179
    v_exp_f32 v67, v67
    v_mfma_f32_32x32x16_bf16 a[48:63], v[4:7], v[72:75], a[48:63]
    v_sub_f32 v68, v52, v179
    v_exp_f32 v68, v68
    v_sub_f32 v69, v53, v179
    v_exp_f32 v69, v69
    v_sub_f32 v70, v54, v179
    v_exp_f32 v70, v70
    v_sub_f32 v71, v55, v179
    v_exp_f32 v71, v71
    v_cvt_pk_bf16_f32 v76, v64, v65
    v_cvt_pk_bf16_f32 v77, v66, v67
    v_cvt_pk_bf16_f32 v78, v68, v69
    v_cvt_pk_bf16_f32 v79, v70, v71
    v_mfma_f32_32x32x16_bf16 v[40:55], v[0:3], v[148:151], 0
    v_sub_f32 v56, v24, v180
    v_exp_f32 v56, v56
    v_sub_f32 v57, v25, v180
    v_exp_f32 v57, v57
    v_sub_f32 v58, v26, v180
    v_exp_f32 v58, v58
    v_sub_f32 v59, v27, v180
    v_exp_f32 v59, v59
    v_sub_f32 v60, v28, v180
    v_exp_f32 v60, v60
    v_sub_f32 v61, v29, v180
    v_exp_f32 v61, v61
    v_sub_f32 v62, v30, v180
    v_exp_f32 v62, v62
    v_sub_f32 v63, v31, v180
    v_exp_f32 v63, v63
    v_mfma_f32_32x32x16_bf16 a[48:63], v[8:11], v[76:79], a[48:63]
    v_cvt_pk_bf16_f32 v72, v56, v57
    v_cvt_pk_bf16_f32 v73, v58, v59
    v_cvt_pk_bf16_f32 v74, v60, v61
    v_cvt_pk_bf16_f32 v75, v62, v63
    v_sub_f32 v64, v32, v180
    v_exp_f32 v64, v64
    v_sub_f32 v65, v33, v180
    v_exp_f32 v65, v65
    v_sub_f32 v66, v34, v180
    v_exp_f32 v66, v66
    v_sub_f32 v67, v35, v180
    v_exp_f32 v67, v67
    v_mfma_f32_32x32x16_bf16 a[64:79], v[4:7], v[72:75], a[64:79]
    v_sub_f32 v68, v36, v180
    v_exp_f32 v68, v68
    v_sub_f32 v69, v37, v180
    v_exp_f32 v69, v69
    v_sub_f32 v70, v38, v180
    v_exp_f32 v70, v70
    v_sub_f32 v71, v39, v180
    v_exp_f32 v71, v71
    v_cvt_pk_bf16_f32 v76, v64, v65
    v_cvt_pk_bf16_f32 v77, v66, v67
    v_cvt_pk_bf16_f32 v78, v68, v69
    v_cvt_pk_bf16_f32 v79, v70, v71
    v_mfma_f32_32x32x16_bf16 v[24:39], v[0:3], v[152:155], 0
    v_sub_f32 v56, v40, v181
    v_exp_f32 v56, v56
    v_sub_f32 v57, v41, v181
    v_exp_f32 v57, v57
    v_sub_f32 v58, v42, v181
    v_exp_f32 v58, v58
    v_sub_f32 v59, v43, v181
    v_exp_f32 v59, v59
    v_sub_f32 v60, v44, v181
    v_exp_f32 v60, v60
    v_sub_f32 v61, v45, v181
    v_exp_f32 v61, v61
    v_sub_f32 v62, v46, v181
    v_exp_f32 v62, v62
    v_sub_f32 v63, v47, v181
    v_exp_f32 v63, v63
    v_mfma_f32_32x32x16_bf16 a[64:79], v[8:11], v[76:79], a[64:79]
    v_cvt_pk_bf16_f32 v72, v56, v57
    v_cvt_pk_bf16_f32 v73, v58, v59
    v_cvt_pk_bf16_f32 v74, v60, v61
    v_cvt_pk_bf16_f32 v75, v62, v63
    v_sub_f32 v64, v48, v181
    v_exp_f32 v64, v64
    v_sub_f32 v65, v49, v181
    v_exp_f32 v65, v65
    v_sub_f32 v66, v50, v181
    v_exp_f32 v66, v66
    v_sub_f32 v67, v51, v181
    v_exp_f32 v67, v67
    v_mfma_f32_32x32x16_bf16 a[80:95], v[4:7], v[72:75], a[80:95]
    v_sub_f32 v68, v52, v181
    v_exp_f32 v68, v68
    v_sub_f32 v69, v53, v181
    v_exp_f32 v69, v69
    v_sub_f32 v70, v54, v181
    v_exp_f32 v70, v70
    v_sub_f32 v71, v55, v181
    v_exp_f32 v71, v71
    v_cvt_pk_bf16_f32 v76, v64, v65
    v_cvt_pk_bf16_f32 v77, v66, v67
    v_cvt_pk_bf16_f32 v78, v68, v69
    v_cvt_pk_bf16_f32 v79, v70, v71
    v_mfma_f32_32x32x16_bf16 v[40:55], v[0:3], v[156:159], 0
    v_sub_f32 v56, v24, v182
    v_exp_f32 v56, v56
    v_sub_f32 v57, v25, v182
    v_exp_f32 v57, v57
    v_sub_f32 v58, v26, v182
    v_exp_f32 v58, v58
    v_sub_f32 v59, v27, v182
    v_exp_f32 v59, v59
    v_sub_f32 v60, v28, v182
    v_exp_f32 v60, v60
    v_sub_f32 v61, v29, v182
    v_exp_f32 v61, v61
    v_sub_f32 v62, v30, v182
    v_exp_f32 v62, v62
    v_sub_f32 v63, v31, v182
    v_exp_f32 v63, v63
    v_mfma_f32_32x32x16_bf16 a[80:95], v[8:11], v[76:79], a[80:95]
    v_cvt_pk_bf16_f32 v72, v56, v57
    v_cvt_pk_bf16_f32 v73, v58, v59
    v_cvt_pk_bf16_f32 v74, v60, v61
    v_cvt_pk_bf16_f32 v75, v62, v63
    v_sub_f32 v64, v32, v182
    v_exp_f32 v64, v64
    v_sub_f32 v65, v33, v182
    v_exp_f32 v65, v65
    v_sub_f32 v66, v34, v182
    v_exp_f32 v66, v66
    v_sub_f32 v67, v35, v182
    v_exp_f32 v67, v67
    v_mfma_f32_32x32x16_bf16 a[96:111], v[4:7], v[72:75], a[96:111]
    v_sub_f32 v68, v36, v182
    v_exp_f32 v68, v68
    v_sub_f32 v69, v37, v182
    v_exp_f32 v69, v69
    v_sub_f32 v70, v38, v182
    v_exp_f32 v70, v70
    v_sub_f32 v71, v39, v182
    v_exp_f32 v71, v71
    v_cvt_pk_bf16_f32 v76, v64, v65
    v_cvt_pk_bf16_f32 v77, v66, v67
    v_cvt_pk_bf16_f32 v78, v68, v69
    v_cvt_pk_bf16_f32 v79, v70, v71
    v_mfma_f32_32x32x16_bf16 v[24:39], v[0:3], v[160:163], 0
    v_sub_f32 v56, v40, v183
    v_exp_f32 v56, v56
    v_sub_f32 v57, v41, v183
    v_exp_f32 v57, v57
    v_sub_f32 v58, v42, v183
    v_exp_f32 v58, v58
    v_sub_f32 v59, v43, v183
    v_exp_f32 v59, v59
    v_sub_f32 v60, v44, v183
    v_exp_f32 v60, v60
    v_sub_f32 v61, v45, v183
    v_exp_f32 v61, v61
    v_sub_f32 v62, v46, v183
    v_exp_f32 v62, v62
    v_sub_f32 v63, v47, v183
    v_exp_f32 v63, v63
    v_mfma_f32_32x32x16_bf16 a[96:111], v[8:11], v[76:79], a[96:111]
    v_cvt_pk_bf16_f32 v72, v56, v57
    v_cvt_pk_bf16_f32 v73, v58, v59
    v_cvt_pk_bf16_f32 v74, v60, v61
    v_cvt_pk_bf16_f32 v75, v62, v63
    v_sub_f32 v64, v48, v183
    v_exp_f32 v64, v64
    v_sub_f32 v65, v49, v183
    v_exp_f32 v65, v65
    v_sub_f32 v66, v50, v183
    v_exp_f32 v66, v66
    v_sub_f32 v67, v51, v183
    v_exp_f32 v67, v67
    v_mfma_f32_32x32x16_bf16 a[112:127], v[4:7], v[72:75], a[112:127]
    v_sub_f32 v68, v52, v183
    v_exp_f32 v68, v68
    v_sub_f32 v69, v53, v183
    v_exp_f32 v69, v69
    v_sub_f32 v70, v54, v183
    v_exp_f32 v70, v70
    v_sub_f32 v71, v55, v183
    v_exp_f32 v71, v71
    v_cvt_pk_bf16_f32 v76, v64, v65
    v_cvt_pk_bf16_f32 v77, v66, v67
    v_cvt_pk_bf16_f32 v78, v68, v69
    v_cvt_pk_bf16_f32 v79, v70, v71
    v_mfma_f32_32x32x16_bf16 v[40:55], v[0:3], v[164:167], 0
    v_sub_f32 v56, v24, v184
    v_exp_f32 v56, v56
    v_sub_f32 v57, v25, v184
    v_exp_f32 v57, v57
    v_sub_f32 v58, v26, v184
    v_exp_f32 v58, v58
    v_sub_f32 v59, v27, v184
    v_exp_f32 v59, v59
    v_sub_f32 v60, v28, v184
    v_exp_f32 v60, v60
    v_sub_f32 v61, v29, v184
    v_exp_f32 v61, v61
    v_sub_f32 v62, v30, v184
    v_exp_f32 v62, v62
    v_sub_f32 v63, v31, v184
    v_exp_f32 v63, v63
    v_mfma_f32_32x32x16_bf16 a[112:127], v[8:11], v[76:79], a[112:127]
    v_cvt_pk_bf16_f32 v72, v56, v57
    v_cvt_pk_bf16_f32 v73, v58, v59
    v_cvt_pk_bf16_f32 v74, v60, v61
    v_cvt_pk_bf16_f32 v75, v62, v63
    v_sub_f32 v64, v32, v184
    v_exp_f32 v64, v64
    v_sub_f32 v65, v33, v184
    v_exp_f32 v65, v65
    v_sub_f32 v66, v34, v184
    v_exp_f32 v66, v66
    v_sub_f32 v67, v35, v184
    v_exp_f32 v67, v67
    v_mfma_f32_32x32x16_bf16 a[128:143], v[4:7], v[72:75], a[128:143]
    v_sub_f32 v68, v36, v184
    v_exp_f32 v68, v68
    v_sub_f32 v69, v37, v184
    v_exp_f32 v69, v69
    v_sub_f32 v70, v38, v184
    v_exp_f32 v70, v70
    v_sub_f32 v71, v39, v184
    v_exp_f32 v71, v71
    v_cvt_pk_bf16_f32 v76, v64, v65
    v_cvt_pk_bf16_f32 v77, v66, v67
    v_cvt_pk_bf16_f32 v78, v68, v69
    v_cvt_pk_bf16_f32 v79, v70, v71
    v_mfma_f32_32x32x16_bf16 v[24:39], v[0:3], v[168:171], 0
    v_sub_f32 v56, v40, v185
    v_exp_f32 v56, v56
    v_sub_f32 v57, v41, v185
    v_exp_f32 v57, v57
    v_sub_f32 v58, v42, v185
    v_exp_f32 v58, v58
    v_sub_f32 v59, v43, v185
    v_exp_f32 v59, v59
    v_sub_f32 v60, v44, v185
    v_exp_f32 v60, v60
    v_sub_f32 v61, v45, v185
    v_exp_f32 v61, v61
    v_sub_f32 v62, v46, v185
    v_exp_f32 v62, v62
    v_sub_f32 v63, v47, v185
    v_exp_f32 v63, v63
    v_mfma_f32_32x32x16_bf16 a[128:143], v[8:11], v[76:79], a[128:143]
    v_cvt_pk_bf16_f32 v72, v56, v57
    v_cvt_pk_bf16_f32 v73, v58, v59
    v_cvt_pk_bf16_f32 v74, v60, v61
    v_cvt_pk_bf16_f32 v75, v62, v63
    v_sub_f32 v64, v48, v185
    v_exp_f32 v64, v64
    v_sub_f32 v65, v49, v185
    v_exp_f32 v65, v65
    v_sub_f32 v66, v50, v185
    v_exp_f32 v66, v66
    v_sub_f32 v67, v51, v185
    v_exp_f32 v67, v67
    v_mfma_f32_32x32x16_bf16 a[144:159], v[4:7], v[72:75], a[144:159]
    v_sub_f32 v68, v52, v185
    v_exp_f32 v68, v68
    v_sub_f32 v69, v53, v185
    v_exp_f32 v69, v69
    v_sub_f32 v70, v54, v185
    v_exp_f32 v70, v70
    v_sub_f32 v71, v55, v185
    v_exp_f32 v71, v71
    v_cvt_pk_bf16_f32 v76, v64, v65
    v_cvt_pk_bf16_f32 v77, v66, v67
    v_cvt_pk_bf16_f32 v78, v68, v69
    v_cvt_pk_bf16_f32 v79, v70, v71
    v_sub_f32 v56, v24, v186
    v_exp_f32 v56, v56
    v_sub_f32 v57, v25, v186
    v_exp_f32 v57, v57
    v_sub_f32 v58, v26, v186
    v_exp_f32 v58, v58
    v_sub_f32 v59, v27, v186
    v_exp_f32 v59, v59
    v_sub_f32 v60, v28, v186
    v_exp_f32 v60, v60
    v_sub_f32 v61, v29, v186
    v_exp_f32 v61, v61
    v_sub_f32 v62, v30, v186
    v_exp_f32 v62, v62
    v_sub_f32 v63, v31, v186
    v_exp_f32 v63, v63
    v_mfma_f32_32x32x16_bf16 a[144:159], v[8:11], v[76:79], a[144:159]
    v_cvt_pk_bf16_f32 v72, v56, v57
    v_cvt_pk_bf16_f32 v73, v58, v59
    v_cvt_pk_bf16_f32 v74, v60, v61
    v_cvt_pk_bf16_f32 v75, v62, v63
    v_sub_f32 v64, v32, v186
    v_exp_f32 v64, v64
    v_sub_f32 v65, v33, v186
    v_exp_f32 v65, v65
    v_sub_f32 v66, v34, v186
    v_exp_f32 v66, v66
    v_sub_f32 v67, v35, v186
    v_exp_f32 v67, v67
    v_mfma_f32_32x32x16_bf16 a[160:175], v[4:7], v[72:75], a[160:175]
    v_sub_f32 v68, v36, v186
    v_exp_f32 v68, v68
    v_sub_f32 v69, v37, v186
    v_exp_f32 v69, v69
    v_sub_f32 v70, v38, v186
    v_exp_f32 v70, v70
    v_sub_f32 v71, v39, v186
    v_exp_f32 v71, v71
    v_cvt_pk_bf16_f32 v76, v64, v65
    v_cvt_pk_bf16_f32 v77, v66, v67
    v_cvt_pk_bf16_f32 v78, v68, v69
    v_cvt_pk_bf16_f32 v79, v70, v71
    s_nop 1
    v_mfma_f32_32x32x16_bf16 a[160:175], v[8:11], v[76:79], a[160:175]
    s_add_u32 s42, s42, 1
    s_cmp_lt_u32 s42, 16
    s_cbranch_scc1 L_a2q_138
    s_waitcnt vmcnt(0)
L_a2f_135:
    s_mul_i32 s19, s17, 25344
    s_add_u32 s19, s19, 34048
    v_lshlrev_b32 v98, 2, v104
    v_add_u32 v99, s19, v98
    ds_write_b32 v99, a0 offset:0
    ds_write_b32 v99, a1 offset:256
    ds_write_b32 v99, a2 offset:512
    ds_write_b32 v99, a3 offset:768
    ds_write_b32 v99, a4 offset:1024
    ds_write_b32 v99, a5 offset:1280
    ds_write_b32 v99, a6 offset:1536
    ds_write_b32 v99, a7 offset:1792
    ds_write_b32 v99, a8 offset:2048
    ds_write_b32 v99, a16 offset:2304
    ds_write_b32 v99, a17 offset:2560
    ds_write_b32 v99, a18 offset:2816
    ds_write_b32 v99, a19 offset:3072
    ds_write_b32 v99, a20 offset:3328
    ds_write_b32 v99, a21 offset:3584
    ds_write_b32 v99, a22 offset:3840
    ds_write_b32 v99, a23 offset:4096
    ds_write_b32 v99, a24 offset:4352
    ds_write_b32 v99, a32 offset:4608
    ds_write_b32 v99, a33 offset:4864
    ds_write_b32 v99, a34 offset:5120
    ds_write_b32 v99, a35 offset:5376
    ds_write_b32 v99, a36 offset:5632
    ds_write_b32 v99, a37 offset:5888
    ds_write_b32 v99, a38 offset:6144
    ds_write_b32 v99, a39 offset:6400
    ds_write_b32 v99, a40 offset:6656
    ds_write_b32 v99, a48 offset:6912
    ds_write_b32 v99, a49 offset:7168
    ds_write_b32 v99, a50 offset:7424
    ds_write_b32 v99, a51 offset:7680
    ds_write_b32 v99, a52 offset:7936
    ds_write_b32 v99, a53 offset:8192
    ds_write_b32 v99, a54 offset:8448
    ds_write_b32 v99, a55 offset:8704
    ds_write_b32 v99, a56 offset:8960
    ds_write_b32 v99, a64 offset:9216
    ds_write_b32 v99, a65 offset:9472
    ds_write_b32 v99, a66 offset:9728
    ds_write_b32 v99, a67 offset:9984
    ds_write_b32 v99, a68 offset:10240
    ds_write_b32 v99, a69 offset:10496
    ds_write_b32 v99, a70 offset:10752
    ds_write_b32 v99, a71 offset:11008
    ds_write_b32 v99, a72 offset:11264
    ds_write_b32 v99, a80 offset:11520
    ds_write_b32 v99, a81 offset:11776
    ds_write_b32 v99, a82 offset:12032
    ds_write_b32 v99, a83 offset:12288
    ds_write_b32 v99, a84 offset:12544
    ds_write_b32 v99, a85 offset:12800
    ds_write_b32 v99, a86 offset:13056
    ds_write_b32 v99, a87 offset:13312
    ds_write_b32 v99, a88 offset:13568
    ds_write_b32 v99, a96 offset:13824
    ds_write_b32 v99, a97 offset:14080
    ds_write_b32 v99, a98 offset:14336
    ds_write_b32 v99, a99 offset:14592
    ds_write_b32 v99, a100 offset:14848
    ds_write_b32 v99, a101 offset:15104
    ds_write_b32 v99, a102 offset:15360
    ds_write_b32 v99, a103 offset:15616
    ds_write_b32 v99, a104 offset:15872
    ds_write_b32 v99, a112 offset:16128
    ds_write_b32 v99, a113 offset:16384
    ds_write_b32 v99, a114 offset:16640
    ds_write_b32 v99, a115 offset:16896
    ds_write_b32 v99, a116 offset:17152
    ds_write_b32 v99, a117 offset:17408
    ds_write_b32 v99, a118 offset:17664
    ds_write_b32 v99, a119 offset:17920
    ds_write_b32 v99, a120 offset:18176
    ds_write_b32 v99, a128 offset:18432
    ds_write_b32 v99, a129 offset:18688
    ds_write_b32 v99, a130 offset:18944
    ds_write_b32 v99, a131 offset:19200
    ds_write_b32 v99, a132 offset:19456
    ds_write_b32 v99, a133 offset:19712
    ds_write_b32 v99, a134 offset:19968
    ds_write_b32 v99, a135 offset:20224
    ds_write_b32 v99, a136 offset:20480
    ds_write_b32 v99, a144 offset:20736
    ds_write_b32 v99, a145 offset:20992
    ds_write_b32 v99, a146 offset:21248
    ds_write_b32 v99, a147 offset:21504
    ds_write_b32 v99, a148 offset:21760
    ds_write_b32 v99, a149 offset:22016
    ds_write_b32 v99, a150 offset:22272
    ds_write_b32 v99, a151 offset:22528
    ds_write_b32 v99, a152 offset:22784
    ds_write_b32 v99, a160 offset:23040
    ds_write_b32 v99, a161 offset:23296
    ds_write_b32 v99, a162 offset:23552
    ds_write_b32 v99, a163 offset:23808
    ds_write_b32 v99, a164 offset:24064
    ds_write_b32 v99, a165 offset:24320
    ds_write_b32 v99, a166 offset:24576
    ds_write_b32 v99, a167 offset:24832
    ds_write_b32 v99, a168 offset:25088
    s_waitcnt lgkmcnt(0)
    s_barrier
    s_mov_b32 s45, s17
L_a2c_139:
    s_mul_i32 s40, s38, 11
    s_add_u32 s40, s40, s45
    s_mul_i32 s40, s40, 3
    s_add_u32 s40, s40, s57
    s_cmp_ge_u32 s40, 64
    s_cbranch_scc1 L_a2d_140
    s_mul_i32 s19, s45, 2304
    s_add_u32 s19, s19, 34048
    v_add_u32 v97, s19, v98
    v_add_u32 v99, 50688, v97
    s_lshl_b32 s40, s40, 5
    s_add_u32 s40, s40, s16
    s_lshl_b32 s40, s40, 10
    s_add_u32 s40, s40, 67108864
    ds_read_b32 v24, v97 offset:0
    ds_read_b32 v25, v97 offset:256
    ds_read_b32 v26, v97 offset:512
    ds_read_b32 v27, v97 offset:768
    ds_read_b32 v28, v97 offset:1024
    ds_read_b32 v29, v97 offset:1280
    ds_read_b32 v30, v97 offset:1536
    ds_read_b32 v31, v97 offset:1792
    ds_read_b32 v32, v97 offset:2048
    ds_read_b32 v33, v97 offset:25344
    ds_read_b32 v34, v97 offset:25600
    ds_read_b32 v35, v97 offset:25856
    ds_read_b32 v36, v97 offset:26112
    ds_read_b32 v37, v97 offset:26368
    ds_read_b32 v38, v97 offset:26624
    ds_read_b32 v39, v97 offset:26880
    ds_read_b32 v40, v97 offset:27136
    ds_read_b32 v41, v97 offset:27392
    s_waitcnt lgkmcnt(0)
    v_add_f32 v24, v24, v33
    v_add_f32 v25, v25, v34
    v_add_f32 v26, v26, v35
    v_add_f32 v27, v27, v36
    v_add_f32 v28, v28, v37
    v_add_f32 v29, v29, v38
    v_add_f32 v30, v30, v39
    v_add_f32 v31, v31, v40
    v_add_f32 v32, v32, v41
    ds_read_b32 v42, v99 offset:0
    ds_read_b32 v43, v99 offset:256
    ds_read_b32 v44, v99 offset:512
    ds_read_b32 v45, v99 offset:768
    ds_read_b32 v46, v99 offset:1024
    ds_read_b32 v47, v99 offset:1280
    ds_read_b32 v48, v99 offset:1536
    ds_read_b32 v49, v99 offset:1792
    ds_read_b32 v50, v99 offset:2048
    s_waitcnt lgkmcnt(0)
    v_add_f32 v24, v24, v42
    v_add_f32 v25, v25, v43
    v_add_f32 v26, v26, v44
    v_add_f32 v27, v27, v45
    v_add_f32 v28, v28, v46
    v_add_f32 v29, v29, v47
    v_add_f32 v30, v30, v48
    v_add_f32 v31, v31, v49
    v_add_f32 v32, v32, v50
    ds_read_b32 v51, v99 offset:25344
    ds_read_b32 v52, v99 offset:25600
    ds_read_b32 v53, v99 offset:25856
    ds_read_b32 v54, v99 offset:26112
    ds_read_b32 v55, v99 offset:26368
    ds_read_b32 v56, v99 offset:26624
    ds_read_b32 v57, v99 offset:26880
    ds_read_b32 v58, v99 offset:27136
    ds_read_b32 v59, v99 offset:27392
    s_waitcnt lgkmcnt(0)
    v_add_f32 v24, v24, v51
    v_add_f32 v25, v25, v52
    v_add_f32 v26, v26, v53
    v_add_f32 v27, v27, v54
    v_add_f32 v28, v28, v55
    v_add_f32 v29, v29, v56
    v_add_f32 v30, v30, v57
    v_add_f32 v31, v31, v58
    v_add_f32 v32, v32, v59
    v_subrev_u32 v68, s55, v32
    v_cmp_lt_u32 vcc, s56, v68
    s_cbranch_vccz L_a2k_141
    v_mov_b32 v68, 1
    ds_write_b32 v106, v68 offset:33792
L_a2k_141:
    v_rcp_f32 v32, v32
    s_nop 0
    v_mul_f32 v24, v32, v24
    v_mul_f32 v25, v32, v25
    v_mul_f32 v26, v32, v26
    v_mul_f32 v27, v32, v27
    v_mul_f32 v28, v32, v28
    v_mul_f32 v29, v32, v29
    v_mul_f32 v30, v32, v30
    v_mul_f32 v31, v32, v31
    v_cvt_pk_bf16_f32 v64, v24, v25
    v_cvt_pk_bf16_f32 v65, v26, v27
    v_cvt_pk_bf16_f32 v66, v28, v29
    v_cvt_pk_bf16_f32 v67, v30, v31
    buffer_store_dwordx4 v[64:67], v105, s[4:7], s40 offen sc1
    s_add_u32 s45, s45, 4
    s_cmp_lt_u32 s45, 11
    s_cbranch_scc1 L_a2c_139
L_a2d_140:
    s_waitcnt vmcnt(0) lgkmcnt(0)
    s_barrier
    ds_read_b32 v68, v106 offset:33792
    s_waitcnt lgkmcnt(0)
    v_readfirstlane_b32 s19, v68
    s_barrier
    s_cmp_gt_u32 s19, s54
    s_cbranch_scc1 L_a2r_134
    s_add_u32 s38, s38, 1
    s_cmp_lt_u32 s38, 2
    s_cbranch_scc1 L_a2b_133
    s_lshl_b32 s43, s18, 7
    s_add_u32 s43, s43, 60837888
    s_lshl_b32 s19, s16, 2
    s_add_u32 s40, s43, s19
    s_cmp_lg_u32 s17, 0
    s_cbranch_scc1 L_flag_142
    v_mov_b32 v107, 1
    s_mov_b64 exec, 1
    buffer_store_dword v107, v106, s[4:7], s40 offen sc1
    s_mov_b64 exec, -1
L_flag_142:
    s_mov_b32 s8, s68
    s_and_b32 s9, s69, 0xffff
    s_mov_b32 s10, 0x80000
    s_mov_b32 s11, 0x20000
    s_mov_b32 s12, s84
    s_and_b32 s13, s85, 0xffff
    s_mov_b32 s14, 0x400000
    s_mov_b32 s15, 0x20000
    v_lshrrev_b32 v1, 2, v104
    v_lshlrev_b32 v1, 10, v1
    v_and_b32 v2, 3, v104
    v_lshl_add_u32 v1, v2, 4, v1
    s_lshr_b32 s42, s16, 1
    s_lshl_b32 s42, s42, 6
    s_lshl_b32 s19, s17, 17
    s_add_u32 s39, s42, s19
    s_lshl_b32 s44, s17, 13
    s_add_u32 m0, s44, 0
    s_add_u32 s19, s39, 0
    buffer_load_dwordx4 v1, s[8:11], s19 offen lds
    s_add_u32 m0, s44, 1024
    s_add_u32 s19, s39, 16384
    buffer_load_dwordx4 v1, s[8:11], s19 offen lds
    s_add_u32 m0, s44, 2048
    s_add_u32 s19, s39, 32768
    buffer_load_dwordx4 v1, s[8:11], s19 offen lds
    s_add_u32 m0, s44, 3072
    s_add_u32 s19, s39, 49152
    buffer_load_dwordx4 v1, s[8:11], s19 offen lds
    s_add_u32 m0, s44, 4096
    s_add_u32 s19, s39, 65536
    buffer_load_dwordx4 v1, s[8:11], s19 offen lds
    s_add_u32 m0, s44, 5120
    s_add_u32 s19, s39, 81920
    buffer_load_dwordx4 v1, s[8:11], s19 offen lds
    s_add_u32 m0, s44, 6144
    s_add_u32 s19, s39, 98304
    buffer_load_dwordx4 v1, s[8:11], s19 offen lds
    s_add_u32 m0, s44, 7168
    s_add_u32 s19, s39, 114688
    buffer_load_dwordx4 v1, s[8:11], s19 offen lds
    v_lshrrev_b32 v3, 5, v104
    v_bfe_u32 v4, v104, 2, 2
    v_lshl_add_u32 v4, v3, 2, v4
    v_lshlrev_b32 v4, 6, v4
    v_and_b32 v5, 1, v104
    v_lshl_add_u32 v4, v5, 5, v4
    v_bfe_u32 v5, v104, 4, 1
    v_lshl_add_u32 v4, v5, 4, v4
    v_bfe_u32 v5, v104, 1, 1
    v_lshl_add_u32 v4, v5, 3, v4
    v_and_b32 v5, 31, v104
    v_lshlrev_b32 v5, 11, v5
    v_lshl_add_u32 v5, v3, 5, v5
    s_waitcnt vmcnt(0)
    s_barrier
    ds_read_b64_tr_b16 a[0:1], v4 offset:0
    ds_read_b64_tr_b16 a[2:3], v4 offset:512
    ds_read_b64_tr_b16 a[4:5], v4 offset:1024
    ds_read_b64_tr_b16 a[6:7], v4 offset:1536
    ds_read_b64_tr_b16 a[8:9], v4 offset:2048
    ds_read_b64_tr_b16 a[10:11], v4 offset:2560
    ds_read_b64_tr_b16 a[12:13], v4 offset:3072
    ds_read_b64_tr_b16 a[14:15], v4 offset:3584
    ds_read_b64_tr_b16 a[16:17], v4 offset:4096
    ds_read_b64_tr_b16 a[18:19], v4 offset:4608
    ds_read_b64_tr_b16 a[20:21], v4 offset:5120
    ds_read_b64_tr_b16 a[22:23], v4 offset:5632
    ds_read_b64_tr_b16 a[24:25], v4 offset:6144
    ds_read_b64_tr_b16 a[26:27], v4 offset:6656
    ds_read_b64_tr_b16 a[28:29], v4 offset:7168
    ds_read_b64_tr_b16 a[30:31], v4 offset:7680
    ds_read_b64_tr_b16 a[32:33], v4 offset:8192
    ds_read_b64_tr_b16 a[34:35], v4 offset:8704
    ds_read_b64_tr_b16 a[36:37], v4 offset:9216
    ds_read_b64_tr_b16 a[38:39], v4 offset:9728
    ds_read_b64_tr_b16 a[40:41], v4 offset:10240
    ds_read_b64_tr_b16 a[42:43], v4 offset:10752
    ds_read_b64_tr_b16 a[44:45], v4 offset:11264
    ds_read_b64_tr_b16 a[46:47], v4 offset:11776
    ds_read_b64_tr_b16 a[48:49], v4 offset:12288
    ds_read_b64_tr_b16 a[50:51], v4 offset:12800
    ds_read_b64_tr_b16 a[52:53], v4 offset:13312
    ds_read_b64_tr_b16 a[54:55], v4 offset:13824
    ds_read_b64_tr_b16 a[56:57], v4 offset:14336
    ds_read_b64_tr_b16 a[58:59], v4 offset:14848
    ds_read_b64_tr_b16 a[60:61], v4 offset:15360
    ds_read_b64_tr_b16 a[62:63], v4 offset:15872
    ds_read_b64_tr_b16 a[64:65], v4 offset:16384
    ds_read_b64_tr_b16 a[66:67], v4 offset:16896
    ds_read_b64_tr_b16 a[68:69], v4 offset:17408
    ds_read_b64_tr_b16 a[70:71], v4 offset:17920
    ds_read_b64_tr_b16 a[72:73], v4 offset:18432
    ds_read_b64_tr_b16 a[74:75], v4 offset:18944
    ds_read_b64_tr_b16 a[76:77], v4 offset:19456
    ds_read_b64_tr_b16 a[78:79], v4 offset:19968
    ds_read_b64_tr_b16 a[80:81], v4 offset:20480
    ds_read_b64_tr_b16 a[82:83], v4 offset:20992
    ds_read_b64_tr_b16 a[84:85], v4 offset:21504
    ds_read_b64_tr_b16 a[86:87], v4 offset:22016
    ds_read_b64_tr_b16 a[88:89], v4 offset:22528
    ds_read_b64_tr_b16 a[90:91], v4 offset:23040
    ds_read_b64_tr_b16 a[92:93], v4 offset:23552
    ds_read_b64_tr_b16 a[94:95], v4 offset:24064
    ds_read_b64_tr_b16 a[96:97], v4 offset:24576
    ds_read_b64_tr_b16 a[98:99], v4 offset:25088
    ds_read_b64_tr_b16 a[100:101], v4 offset:25600
    ds_read_b64_tr_b16 a[102:103], v4 offset:26112
    ds_read_b64_tr_b16 a[104:105], v4 offset:26624
    ds_read_b64_tr_b16 a[106:107], v4 offset:27136
    ds_read_b64_tr_b16 a[108:109], v4 offset:27648
    ds_read_b64_tr_b16 a[110:111], v4 offset:28160
    ds_read_b64_tr_b16 a[112:113], v4 offset:28672
    ds_read_b64_tr_b16 a[114:115], v4 offset:29184
    ds_read_b64_tr_b16 a[116:117], v4 offset:29696
    ds_read_b64_tr_b16 a[118:119], v4 offset:30208
    ds_read_b64_tr_b16 a[120:121], v4 offset:30720
    ds_read_b64_tr_b16 a[122:123], v4 offset:31232
    ds_read_b64_tr_b16 a[124:125], v4 offset:31744
    ds_read_b64_tr_b16 a[126:127], v4 offset:32256
    v_and_b32 v2, 31, v104
    v_lshlrev_b32 v2, 2, v2
L_fo_143:
    buffer_load_dword v107, v2, s[4:7], s43 offen sc1
    s_sub_u32 s48, s48, 1
    s_cbranch_scc1 W_bail
    s_waitcnt vmcnt(0)
    v_cmp_ne_u32 vcc, 1, v107
    s_cbranch_vccz L_fo_143_ok
    s_sleep 2
    s_branch L_fo_143
L_fo_143_ok:
    s_and_b32 s45, s16, 1
    s_lshl_b32 s19, s17, 1
    s_add_u32 s45, s45, s19
    s_waitcnt lgkmcnt(0)
L_a3_144:
    s_mul_i32 s38, s45, 3
    s_add_u32 s38, s38, s57
    s_cmp_ge_u32 s38, 64
    s_cbranch_scc1 L_a3d_145
    s_lshl_b32 s39, s38, 15
    s_add_u32 s39, s39, 67108864
    buffer_load_dwordx4 v[8:11], v105, s[4:7], s39 offen offset:0 sc1
    buffer_load_dwordx4 v[12:15], v105, s[4:7], s39 offen offset:1024 sc1
    buffer_load_dwordx4 v[16:19], v105, s[4:7], s39 offen offset:2048 sc1
    buffer_load_dwordx4 v[20:23], v105, s[4:7], s39 offen offset:3072 sc1
    s_add_u32 s39, s39, 4096
    buffer_load_dwordx4 v[24:27], v105, s[4:7], s39 offen offset:0 sc1
    buffer_load_dwordx4 v[28:31], v105, s[4:7], s39 offen offset:1024 sc1
    buffer_load_dwordx4 v[32:35], v105, s[4:7], s39 offen offset:2048 sc1
    s_waitcnt vmcnt(6)
    v_mfma_f32_32x32x16_bf16 v[40:55], a[0:3], v[8:11], 0
    buffer_load_dwordx4 v[36:39], v105, s[4:7], s39 offen offset:3072 sc1
    s_add_u32 s39, s39, 4096
    s_waitcnt vmcnt(6)
    v_mfma_f32_32x32x16_bf16 v[40:55], a[4:7], v[12:15], v[40:55]
    buffer_load_dwordx4 v[8:11], v105, s[4:7], s39 offen offset:0 sc1
    s_waitcnt vmcnt(6)
    v_mfma_f32_32x32x16_bf16 v[40:55], a[8:11], v[16:19], v[40:55]
    buffer_load_dwordx4 v[12:15], v105, s[4:7], s39 offen offset:1024 sc1
    s_waitcnt vmcnt(6)
    v_mfma_f32_32x32x16_bf16 v[40:55], a[12:15], v[20:23], v[40:55]
    buffer_load_dwordx4 v[16:19], v105, s[4:7], s39 offen offset:2048 sc1
    s_waitcnt vmcnt(6)
    v_mfma_f32_32x32x16_bf16 v[40:55], a[16:19], v[24:27], v[40:55]
    buffer_load_dwordx4 v[20:23], v105, s[4:7], s39 offen offset:3072 sc1
    s_add_u32 s39, s39, 4096
    s_waitcnt vmcnt(6)
    v_mfma_f32_32x32x16_bf16 v[40:55], a[20:23], v[28:31], v[40:55]
    buffer_load_dwordx4 v[24:27], v105, s[4:7], s39 offen offset:0 sc1
    s_waitcnt vmcnt(6)
    v_mfma_f32_32x32x16_bf16 v[40:55], a[24:27], v[32:35], v[40:55]
    buffer_load_dwordx4 v[28:31], v105, s[4:7], s39 offen offset:1024 sc1
    s_waitcnt vmcnt(6)
    v_mfma_f32_32x32x16_bf16 v[40:55], a[28:31], v[36:39], v[40:55]
    buffer_load_dwordx4 v[32:35], v105, s[4:7], s39 offen offset:2048 sc1
    s_waitcnt vmcnt(6)
    v_mfma_f32_32x32x16_bf16 v[40:55], a[32:35], v[8:11], v[40:55]
    buffer_load_dwordx4 v[36:39], v105, s[4:7], s39 offen offset:3072 sc1
    s_add_u32 s39, s39, 4096
    s_waitcnt vmcnt(6)
    v_mfma_f32_32x32x16_bf16 v[40:55], a[36:39], v[12:15], v[40:55]
    buffer_load_dwordx4 v[8:11], v105, s[4:7], s39 offen offset:0 sc1
    s_waitcnt vmcnt(6)
    v_mfma_f32_32x32x16_bf16 v[40:55], a[40:43], v[16:19], v[40:55]
    buffer_load_dwordx4 v[12:15], v105, s[4:7], s39 offen offset:1024 sc1
    s_waitcnt vmcnt(6)
    v_mfma_f32_32x32x16_bf16 v[40:55], a[44:47], v[20:23], v[40:55]
    buffer_load_dwordx4 v[16:19], v105, s[4:7], s39 offen offset:2048 sc1
    s_waitcnt vmcnt(6)
    v_mfma_f32_32x32x16_bf16 v[40:55], a[48:51], v[24:27], v[40:55]
    buffer_load_dwordx4 v[20:23], v105, s[4:7], s39 offen offset:3072 sc1
    s_add_u32 s39, s39, 4096
    s_waitcnt vmcnt(6)
    v_mfma_f32_32x32x16_bf16 v[40:55], a[52:55], v[28:31], v[40:55]
    buffer_load_dwordx4 v[24:27], v105, s[4:7], s39 offen offset:0 sc1
    s_waitcnt vmcnt(6)
    v_mfma_f32_32x32x16_bf16 v[40:55], a[56:59], v[32:35], v[40:55]
    buffer_load_dwordx4 v[28:31], v105, s[4:7], s39 offen offset:1024 sc1
    s_waitcnt vmcnt(6)
    v_mfma_f32_32x32x16_bf16 v[40:55], a[60:63], v[36:39], v[40:55]
    buffer_load_dwordx4 v[32:35], v105, s[4:7], s39 offen offset:2048 sc1
    s_waitcnt vmcnt(6)
    v_mfma_f32_32x32x16_bf16 v[40:55], a[64:67], v[8:11], v[40:55]
    buffer_load_dwordx4 v[36:39], v105, s[4:7], s39 offen offset:3072 sc1
    s_add_u32 s39, s39, 4096
    s_waitcnt vmcnt(6)
    v_mfma_f32_32x32x16_bf16 v[40:55], a[68:71], v[12:15], v[40:55]
    buffer_load_dwordx4 v[8:11], v105, s[4:7], s39 offen offset:0 sc1
    s_waitcnt vmcnt(6)
    v_mfma_f32_32x32x16_bf16 v[40:55], a[72:75], v[16:19], v[40:55]
    buffer_load_dwordx4 v[12:15], v105, s[4:7], s39 offen offset:1024 sc1
    s_waitcnt vmcnt(6)
    v_mfma_f32_32x32x16_bf16 v[40:55], a[76:79], v[20:23], v[40:55]
    buffer_load_dwordx4 v[16:19], v105, s[4:7], s39 offen offset:2048 sc1
    s_waitcnt vmcnt(6)
    v_mfma_f32_32x32x16_bf16 v[40:55], a[80:83], v[24:27], v[40:55]
    buffer_load_dwordx4 v[20:23], v105, s[4:7], s39 offen offset:3072 sc1
    s_add_u32 s39, s39, 4096
    s_waitcnt vmcnt(6)
    v_mfma_f32_32x32x16_bf16 v[40:55], a[84:87], v[28:31], v[40:55]
    buffer_load_dwordx4 v[24:27], v105, s[4:7], s39 offen offset:0 sc1
    s_waitcnt vmcnt(6)
    v_mfma_f32_32x32x16_bf16 v[40:55], a[88:91], v[32:35], v[40:55]
    buffer_load_dwordx4 v[28:31], v105, s[4:7], s39 offen offset:1024 sc1
    s_waitcnt vmcnt(6)
    v_mfma_f32_32x32x16_bf16 v[40:55], a[92:95], v[36:39], v[40:55]
    buffer_load_dwordx4 v[32:35], v105, s[4:7], s39 offen offset:2048 sc1
    s_waitcnt vmcnt(6)
    v_mfma_f32_32x32x16_bf16 v[40:55], a[96:99], v[8:11], v[40:55]
    buffer_load_dwordx4 v[36:39], v105, s[4:7], s39 offen offset:3072 sc1
    s_add_u32 s39, s39, 4096
    s_waitcnt vmcnt(6)
    v_mfma_f32_32x32x16_bf16 v[40:55], a[100:103], v[12:15], v[40:55]
    s_waitcnt vmcnt(5)
    v_mfma_f32_32x32x16_bf16 v[40:55], a[104:107], v[16:19], v[40:55]
    s_waitcnt vmcnt(4)
    v_mfma_f32_32x32x16_bf16 v[40:55], a[108:111], v[20:23], v[40:55]
    s_waitcnt vmcnt(3)
    v_mfma_f32_32x32x16_bf16 v[40:55], a[112:115], v[24:27], v[40:55]
    s_waitcnt vmcnt(2)
    v_mfma_f32_32x32x16_bf16 v[40:55], a[116:119], v[28:31], v[40:55]
    s_waitcnt vmcnt(1)
    v_mfma_f32_32x32x16_bf16 v[40:55], a[120:123], v[32:35], v[40:55]
    s_waitcnt vmcnt(0)
    v_mfma_f32_32x32x16_bf16 v[40:55], a[124:127], v[36:39], v[40:55]
    s_lshl_b32 s40, s38, 16
    s_add_u32 s40, s40, s42
    s_nop 9
    v_cvt_pk_bf16_f32 v56, v40, v41
    v_cvt_pk_bf16_f32 v57, v42, v43
    v_cvt_pk_bf16_f32 v58, v44, v45
    v_cvt_pk_bf16_f32 v59, v46, v47
    v_cvt_pk_bf16_f32 v60, v48, v49
    v_cvt_pk_bf16_f32 v61, v50, v51
    v_cvt_pk_bf16_f32 v62, v52, v53
    v_cvt_pk_bf16_f32 v63, v54, v55
    buffer_store_dwordx4 v[56:59], v5, s[12:15], s40 offen
    buffer_store_dwordx4 v[60:63], v5, s[12:15], s40 offen offset:16
    s_add_u32 s45, s45, 8
    s_branch L_a3_144
L_a3d_145:
    s_barrier
    s_endpgm
.section .rodata,"a"
.p2align 6
.amdhsa_kernel concat_heads__mha_block__memory_aug_recurrent_mem_tr__prompt_kernel
  .amdhsa_next_free_vgpr 512
  .amdhsa_next_free_sgpr 102
  .amdhsa_accum_offset 256
  .amdhsa_group_segment_fixed_size 0
  .amdhsa_kernarg_size 104
  .amdhsa_user_sgpr_count 2
  .amdhsa_user_sgpr_kernarg_segment_ptr 1
  .amdhsa_system_sgpr_workgroup_id_x 1
  .amdhsa_float_denorm_mode_32 3
  .amdhsa_float_denorm_mode_16_64 3
.end_amdhsa_kernel
```
